```python
import torch

def _softmax(x, axis=-1):
    return torch.softmax(x, dim=axis)
def _gelu(x):
    return torch.nn.functional.gelu(x, approximate="tanh")
def _silu(x):
    return torch.nn.functional.silu(x)
def _sigmoid(x):
    return torch.sigmoid(x)
def _layernorm(x, axis=-1, eps=1e-5):
    m = x.mean(dim=axis, keepdim=True)
    v = x.var(dim=axis, keepdim=True, unbiased=False)
    return (x - m) / torch.sqrt(v + eps)
def _scatter_add(tgt, idx, src, axis=0):
    return tgt.clone().index_add_(axis, idx, src)
def _segment_sum(src, seg, n):
    out = torch.zeros((n,) + src.shape[1:], dtype=src.dtype)
    return out.index_add_(0, seg, src)
def _pad(x, pw):
    flat = tuple(v for pair in reversed(pw) for v in pair)
    return torch.nn.functional.pad(x, flat)

kernel_name = 'sequential_preLN__spectral_gfnet__mixer_s_mlp__prompt'

def setup_inputs():

    _w = (lambda a: (lambda t: t.to(torch.bfloat16) if t.is_floating_point() else t)(torch.as_tensor(a)))
    def _A_setup():
        B, S, D = 1, 2048, 1024
        Df = D // 2 + 1
        return {
            "x": _w((lambda *s: torch.randn(*s, dtype=torch.bfloat16) * 0.05)(B, S, D)),
            "w_r": _w((lambda *s: torch.randn(*s, dtype=torch.bfloat16) * 0.4)(S, Df) * 0.02),
            "w_i": _w((lambda *s: torch.randn(*s, dtype=torch.bfloat16) * 0.4)(S, Df) * 0.02),
        }
    _A_in = _A_setup()

    def _B_setup():
        B, S, D, F = 1, 2048, 1024, 3584
        return {
            "x":  _w((lambda *s: torch.randn(*s, dtype=torch.bfloat16) * 0.05)(B, S, D)),
            "w1": _w((lambda *s: torch.randn(*s, dtype=torch.bfloat16) * 0.8)(D, D) * (D ** -0.5)),
            "w2": _w((lambda *s: torch.randn(*s, dtype=torch.bfloat16) * 0.8)(D, D) * (D ** -0.5)),
            "w3": _w((lambda *s: torch.randn(*s, dtype=torch.bfloat16) * 0.8)(D, F) * (D ** -0.5)),
            "w4": _w((lambda *s: torch.randn(*s, dtype=torch.bfloat16) * 0.8)(F, D) * (F ** -0.5)),
        }
    _B_in = _B_setup()

    return {
        "A_x": _A_in["x"],
        "A_w_r": _A_in["w_r"],
        "A_w_i": _A_in["w_i"],
        "B_x": _B_in["x"],
        "B_w1": _B_in["w1"],
        "B_w2": _B_in["w2"],
        "B_w3": _B_in["w3"],
        "B_w4": _B_in["w4"],
    }

def reference(A_x, A_w_r, A_w_i, B_x, B_w1, B_w2, B_w3, B_w4):
    def _A_ref(x, w_r, w_i):
        B, S, D = x.shape
        X = (lambda x, axes=(-2,-1): torch.fft.rfft2(x.float(), dim=axes))(x, axes=(-2, -1))
        W = w_r + 1j * w_i
        X = X * W
        y = (lambda x, s, axes=(-2,-1): torch.fft.irfft2(x, s=s, dim=axes).to(torch.bfloat16))(X, (S, D), axes=(-2, -1))
        return y

    def _B_ref(x, w1, w2, w3, w4):
        B, S, D = x.shape
        h = _gelu(_layernorm(x, axis=-1) @ w1)
        c = D // 4
        g0 = _pad(h[:, :, 0*c:1*c], ((0, 0), (1, 0), (0, 0)))[:, :S, :]
        g1 = _pad(h[:, :, 1*c:2*c], ((0, 0), (0, 1), (0, 0)))[:, 1:, :]
        g2 = _pad(h[:, :, 2*c:3*c], ((0, 0), (2, 0), (0, 0)))[:, :S, :]
        g3 = _pad(h[:, :, 3*c:   ], ((0, 0), (0, 2), (0, 0)))[:, 2:, :]
        hs = torch.concatenate([g0, g1, g2, g3], axis=-1) @ w2
        x1 = x + hs
        h2 = _gelu(_layernorm(x1, axis=-1) @ w3) @ w4
        return x1 + h2

    x = A_x
    h = x + _A_ref(_layernorm(x, axis=-1), A_w_r, A_w_i)
    h2 = h + _B_ref(_layernorm(h, axis=-1), B_w1, B_w2, B_w3, B_w4)
    return h2
```

```asm
; @launch kernel=fft_rows_fwd_kernel grid=(512,1,1) block=(256,1,1) lds=47104
; @launch kernel=fft_cols_kernel grid=(256,1,1) block=(512,1,1) lds=92160
; @launch kernel=mixer_kernel grid=(256,1,1) block=(512,1,1) lds=163840
.amdgcn_target "amdgcn-amd-amdhsa--gfx950"
.text
.globl fft_rows_fwd_kernel
.p2align 8
.type fft_rows_fwd_kernel,@function
fft_rows_fwd_kernel:
  s_getpc_b64 s[36:37]
.Lpf_fft_rows_fwd_kernel:
  s_mov_b32 s38, .Lfft_rows_fwd_kernel_end-.Lpf_fft_rows_fwd_kernel
  s_mov_b32 s39, 0x20000
  v_and_b32 v4, 63, v0
  v_lshlrev_b32 v4, 7, v4
  buffer_load_dword v6, v4, s[36:39], 0 offen
  s_cmp_ge_u32 s2, 512
  s_cbranch_scc1 .Lfft_rows_fwd_kernel_done
  s_load_dwordx2 s[6:7], s[0:1], 80
  v_lshrrev_b32 v5, 6, v0
  v_and_b32 v1, 63, v0
  v_readfirstlane_b32 s28, v5
  v_and_b32 v2, 15, v0
  v_lshrrev_b32 v3, 4, v1
  v_lshlrev_b32 v7, 4, v1
  s_cmp_ge_u32 s2, 256
  s_cbranch_scc1 .Lfft_rows_fwd_kernel_wt
  s_load_dwordx2 s[4:5], s[0:1], 0
  s_getpc_b64 s[16:17]
.Lpc_fft_rows_fwd_kernel:
  s_add_u32 s16, s16, fft_tables-.Lpc_fft_rows_fwd_kernel
  s_addc_u32 s17, s17, 0
  s_mov_b32 s18, 0x14800
  s_mov_b32 s19, 0x20000
  s_lshr_b32 s29, s2, 5
  s_lshl_b32 s29, s29, 8
  s_and_b32 s30, s2, 31
  s_add_u32 s29, s29, s30
  s_lshl_b32 s30, s28, 6
  s_add_u32 s29, s29, s30
  s_lshl_b32 s29, s29, 11
  s_add_u32 s30, s29, 65536
  s_lshl_b32 s31, s28, 12
  s_add_u32 s31, s31, 30720
  s_waitcnt lgkmcnt(0)
  s_mov_b32 s12, s4
  s_mov_b32 s13, s5
  s_mov_b32 s14, 0x400000
  s_mov_b32 s15, 0x20000
  s_add_u32 m0, s31, 0
  s_nop 0
  buffer_load_dwordx4 v7, s[12:15], s29 offen offset:0 nt lds
  buffer_load_dwordx4 v7, s[12:15], s29 offen offset:1024 nt lds
  s_add_u32 m0, s31, 2048
  s_nop 0
  buffer_load_dwordx4 v7, s[12:15], s30 offen offset:0 nt lds
  buffer_load_dwordx4 v7, s[12:15], s30 offen offset:1024 nt lds
  s_lshl_b32 s32, s28, 12
  s_add_u32 m0, s32, 16384
  s_cmp_eq_u32 s28, 3
  buffer_load_dwordx4 v7, s[16:19], s32 offen offset:0 lds
  buffer_load_dwordx4 v7, s[16:19], s32 offen offset:1024 lds
  s_cbranch_scc1 .Lfft_rows_fwd_kernel_t3
  buffer_load_dwordx4 v7, s[16:19], s32 offen offset:2048 lds
  buffer_load_dwordx4 v7, s[16:19], s32 offen offset:3072 lds
.Lfft_rows_fwd_kernel_t3:
  s_mov_b32 s20, s6
  s_mov_b32 s21, s7
  s_mov_b32 s22, 0x400000
  s_mov_b32 s23, 0x20000
  v_lshlrev_b32 v156, 9, v3
  v_lshl_add_u32 v156, v2, 2, v156
  v_add_u32 v156, s31, v156
  v_add_u32 v157, 2048, v156
  v_lshl_add_u32 v4, v3, 6, v2
  s_lshr_b32 s32, s28, 1
  s_and_b32 s33, s28, 1
  s_lshl_b32 s33, s33, 3
  v_lshrrev_b32 v5, 1, v4
  v_and_b32 v5, 3, v5
  v_xor_b32 v5, s32, v5
  v_lshlrev_b32 v5, 4, v5
  v_lshl_add_u32 v158, v4, 6, v5
  v_add_u32 v158, s33, v158
  v_sub_u32 v161, 208, v4
  v_lshrrev_b32 v5, 1, v161
  v_and_b32 v5, 3, v5
  v_xor_b32 v5, s32, v5
  v_xor_b32 v5, 2, v5
  v_lshlrev_b32 v5, 4, v5
  v_lshl_add_u32 v159, v161, 6, v5
  v_add_u32 v159, s33, v159
  v_sub_u32 v161, 256, v4
  v_and_b32 v161, 255, v161
  v_lshrrev_b32 v5, 1, v161
  v_and_b32 v5, 3, v5
  v_xor_b32 v5, s32, v5
  v_xor_b32 v5, 2, v5
  v_lshlrev_b32 v5, 4, v5
  v_lshl_add_u32 v160, v161, 6, v5
  v_add_u32 v160, s33, v160
  v_lshrrev_b32 v4, 2, v1
  v_lshrrev_b32 v5, 1, v4
  v_xor_b32 v5, v5, v1
  v_and_b32 v5, 3, v5
  v_lshlrev_b32 v5, 4, v5
  v_lshl_add_u32 v161, v4, 6, v5
  s_lshl_b32 s32, s28, 12
  v_add_u32 v161, s32, v161
  s_lshl_b32 s33, s2, 14
  s_add_u32 s32, s32, s33
  v_cmp_eq_u32 vcc, 0, v2
  s_mov_b32 s31, 0x3f803f80
  s_waitcnt vmcnt(0)
  s_getpc_b64 s[36:37]
.Ltc_fft_rows_fwd_kernel:
  s_mov_b32 s38, fft_tables+83968-.Ltc_fft_rows_fwd_kernel
  s_mov_b32 s39, 0x20000
  s_lshr_b32 s29, s2, 3
  s_lshl_b32 s29, s29, 2
  s_add_u32 s29, s29, s28
  s_lshl_b32 s29, s29, 11
  v_and_b32 v4, 15, v1
  v_lshlrev_b32 v4, 7, v4
  buffer_load_dword v6, v4, s[36:39], s29 offen
  s_barrier
  s_nop 0
  ds_read2_b32 v[8:9], v156 offset0:0 offset1:32
  ds_read2_b32 v[10:11], v156 offset0:64 offset1:96
  ds_read2_b32 v[12:13], v156 offset0:16 offset1:48
  ds_read2_b32 v[14:15], v156 offset0:80 offset1:112
  ds_read2_b32 v[16:17], v157 offset0:0 offset1:32
  ds_read2_b32 v[18:19], v157 offset0:64 offset1:96
  ds_read2_b32 v[20:21], v157 offset0:16 offset1:48
  ds_read2_b32 v[22:23], v157 offset0:80 offset1:112
  ds_read_b128 v[24:27], v7 offset:16384
  ds_read_b128 v[28:31], v7 offset:17408
  ds_read_b128 v[32:35], v7 offset:26624
  ds_read_b128 v[36:39], v7 offset:27648
  ds_read_b128 v[40:43], v7 offset:28672
  ds_read_b128 v[44:47], v7 offset:29696
  s_waitcnt lgkmcnt(4)
  s_nop 0
  v_mfma_f32_16x16x32_bf16 v[80:83], v[8:11], v[24:27], 0
  ds_read_b128 v[48:51], v7 offset:18432
  v_mfma_f32_16x16x32_bf16 v[84:87], v[8:11], v[28:31], 0
  ds_read_b128 v[52:55], v7 offset:19456
  v_mfma_f32_16x16x32_bf16 v[88:91], v[12:15], v[24:27], 0
  ds_read_b128 v[56:59], v7 offset:20480
  v_mfma_f32_16x16x32_bf16 v[92:95], v[12:15], v[28:31], 0
  ds_read_b128 v[60:63], v7 offset:21504
  v_mfma_f32_16x16x32_bf16 v[96:99], v[16:19], v[24:27], 0
  ds_read_b128 v[64:67], v7 offset:22528
  v_mfma_f32_16x16x32_bf16 v[100:103], v[16:19], v[28:31], 0
  ds_read_b128 v[68:71], v7 offset:23552
  v_mfma_f32_16x16x32_bf16 v[104:107], v[20:23], v[24:27], 0
  ds_read_b128 v[72:75], v7 offset:24576
  v_mfma_f32_16x16x32_bf16 v[108:111], v[20:23], v[28:31], 0
  ds_read_b128 v[76:79], v7 offset:25600
  v_dot2_f32_bf16 v144, v8, s31, 0
  v_dot2_f32_bf16 v146, v8, v8, 0
  v_dot2_f32_bf16 v145, v16, s31, 0
  v_dot2_f32_bf16 v147, v16, v16, 0
  v_dot2c_f32_bf16 v144, s31, v9
  v_dot2c_f32_bf16 v146, v9, v9
  v_dot2c_f32_bf16 v145, s31, v17
  v_dot2c_f32_bf16 v147, v17, v17
  v_dot2c_f32_bf16 v144, s31, v10
  v_dot2c_f32_bf16 v146, v10, v10
  v_dot2c_f32_bf16 v145, s31, v18
  v_dot2c_f32_bf16 v147, v18, v18
  v_dot2c_f32_bf16 v144, s31, v11
  v_dot2c_f32_bf16 v146, v11, v11
  v_dot2c_f32_bf16 v145, s31, v19
  v_dot2c_f32_bf16 v147, v19, v19
  v_dot2c_f32_bf16 v144, s31, v12
  v_dot2c_f32_bf16 v146, v12, v12
  v_dot2c_f32_bf16 v145, s31, v20
  v_dot2c_f32_bf16 v147, v20, v20
  v_dot2c_f32_bf16 v144, s31, v13
  v_dot2c_f32_bf16 v146, v13, v13
  v_dot2c_f32_bf16 v145, s31, v21
  v_dot2c_f32_bf16 v147, v21, v21
  v_dot2c_f32_bf16 v144, s31, v14
  v_dot2c_f32_bf16 v146, v14, v14
  v_dot2c_f32_bf16 v145, s31, v22
  v_dot2c_f32_bf16 v147, v22, v22
  v_dot2c_f32_bf16 v144, s31, v15
  v_dot2c_f32_bf16 v146, v15, v15
  v_dot2c_f32_bf16 v145, s31, v23
  v_dot2c_f32_bf16 v147, v23, v23
  s_nop 1
  v_permlane32_swap_b32 v144, v145
  v_permlane32_swap_b32 v146, v147
  v_add_f32 v144, v144, v145
  v_add_f32 v146, v146, v147
  s_nop 1
  v_permlane16_swap_b32 v144, v146
  v_add_f32 v148, v144, v146
  s_nop 1
  v_add_f32_dpp v148, v148, v148 row_ror:8 row_mask:0xf bank_mask:0xf
  s_nop 1
  v_add_f32_dpp v148, v148, v148 row_ror:4 row_mask:0xf bank_mask:0xf
  s_nop 1
  v_add_f32_dpp v148, v148, v148 row_ror:2 row_mask:0xf bank_mask:0xf
  s_nop 1
  v_add_f32_dpp v148, v148, v148 row_ror:1 row_mask:0xf bank_mask:0xf
  v_mov_b32 v149, v148
  s_nop 1
  v_permlane16_swap_b32 v148, v149
  s_nop 0
  v_mul_f32 v148, 0x3a800000, v148
  v_mul_f32 v149, 0x3a800000, v149
  v_fma_f32 v4, -v148, v148, v149
  v_max_f32_e64 v4, 0, v4
  v_cvt_pk_bf16_f32 v150, v148, v148
  v_and_b32 v150, 0xffff0000, v150
  v_cvt_pk_bf16_f32 v4, v4, v4
  v_and_b32 v4, 0xffff0000, v4
  v_add_f32 v4, 0x3727c5ac, v4
  v_cvt_pk_bf16_f32 v4, v4, v4
  v_and_b32 v4, 0xffff0000, v4
  v_sqrt_f32 v4, v4
  s_nop 0
  v_cvt_pk_bf16_f32 v151, v4, v4
  v_and_b32 v151, 0xffff0000, v151
  v_rcp_f32 v154, v151
  v_mul_f32 v150, 0xc1800000, v150
  v_cndmask_b32 v152, 0, v150, vcc
  v_mov_b32 v153, v152
  s_nop 1
  v_permlane32_swap_b32 v152, v153
  v_mov_b32 v155, v154
  s_nop 1
  v_permlane32_swap_b32 v154, v155
  s_waitcnt lgkmcnt(0)
  s_nop 0
  v_pk_fma_f32 v[128:129], v[80:81], v[32:33], v[152:153] op_sel:[0,0,0] op_sel_hi:[1,1,0]
  v_pk_fma_f32 v[130:131], v[80:81], v[40:41], v[152:153] op_sel:[0,0,0] op_sel_hi:[1,1,0]
  v_pk_fma_f32 v[132:133], v[82:83], v[34:35], v[152:153] op_sel:[0,0,0] op_sel_hi:[1,1,0]
  v_pk_fma_f32 v[134:135], v[82:83], v[42:43], v[152:153] op_sel:[0,0,0] op_sel_hi:[1,1,0]
  v_pk_fma_f32 v[128:129], v[84:85], v[40:41], v[128:129] neg_lo:[1,0,0] neg_hi:[1,0,0]
  v_pk_fma_f32 v[130:131], v[84:85], v[32:33], v[130:131]
  v_pk_fma_f32 v[132:133], v[86:87], v[42:43], v[132:133] neg_lo:[1,0,0] neg_hi:[1,0,0]
  v_pk_fma_f32 v[134:135], v[86:87], v[34:35], v[134:135]
  v_cvt_pk_bf16_f32 v112, v128, v130
  v_cvt_pk_bf16_f32 v113, v129, v131
  v_cvt_pk_bf16_f32 v114, v132, v134
  v_cvt_pk_bf16_f32 v115, v133, v135
  v_pk_fma_f32 v[136:137], v[88:89], v[36:37], v[152:153] op_sel:[0,0,0] op_sel_hi:[1,1,0]
  v_pk_fma_f32 v[138:139], v[88:89], v[44:45], v[152:153] op_sel:[0,0,0] op_sel_hi:[1,1,0]
  v_pk_fma_f32 v[140:141], v[90:91], v[38:39], v[152:153] op_sel:[0,0,0] op_sel_hi:[1,1,0]
  v_pk_fma_f32 v[142:143], v[90:91], v[46:47], v[152:153] op_sel:[0,0,0] op_sel_hi:[1,1,0]
  v_pk_fma_f32 v[136:137], v[92:93], v[44:45], v[136:137] neg_lo:[1,0,0] neg_hi:[1,0,0]
  v_pk_fma_f32 v[138:139], v[92:93], v[36:37], v[138:139]
  v_pk_fma_f32 v[140:141], v[94:95], v[46:47], v[140:141] neg_lo:[1,0,0] neg_hi:[1,0,0]
  v_pk_fma_f32 v[142:143], v[94:95], v[38:39], v[142:143]
  v_cvt_pk_bf16_f32 v116, v136, v138
  v_cvt_pk_bf16_f32 v117, v137, v139
  v_cvt_pk_bf16_f32 v118, v140, v142
  v_cvt_pk_bf16_f32 v119, v141, v143
  v_pk_fma_f32 v[128:129], v[96:97], v[32:33], v[152:153] op_sel:[0,0,1] op_sel_hi:[1,1,1]
  v_pk_fma_f32 v[130:131], v[96:97], v[40:41], v[152:153] op_sel:[0,0,1] op_sel_hi:[1,1,1]
  v_pk_fma_f32 v[132:133], v[98:99], v[34:35], v[152:153] op_sel:[0,0,1] op_sel_hi:[1,1,1]
  v_pk_fma_f32 v[134:135], v[98:99], v[42:43], v[152:153] op_sel:[0,0,1] op_sel_hi:[1,1,1]
  v_pk_fma_f32 v[128:129], v[100:101], v[40:41], v[128:129] neg_lo:[1,0,0] neg_hi:[1,0,0]
  v_pk_fma_f32 v[130:131], v[100:101], v[32:33], v[130:131]
  v_pk_fma_f32 v[132:133], v[102:103], v[42:43], v[132:133] neg_lo:[1,0,0] neg_hi:[1,0,0]
  v_pk_fma_f32 v[134:135], v[102:103], v[34:35], v[134:135]
  v_cvt_pk_bf16_f32 v120, v128, v130
  v_cvt_pk_bf16_f32 v121, v129, v131
  v_cvt_pk_bf16_f32 v122, v132, v134
  v_cvt_pk_bf16_f32 v123, v133, v135
  v_pk_fma_f32 v[136:137], v[104:105], v[36:37], v[152:153] op_sel:[0,0,1] op_sel_hi:[1,1,1]
  v_pk_fma_f32 v[138:139], v[104:105], v[44:45], v[152:153] op_sel:[0,0,1] op_sel_hi:[1,1,1]
  v_pk_fma_f32 v[140:141], v[106:107], v[38:39], v[152:153] op_sel:[0,0,1] op_sel_hi:[1,1,1]
  v_pk_fma_f32 v[142:143], v[106:107], v[46:47], v[152:153] op_sel:[0,0,1] op_sel_hi:[1,1,1]
  v_pk_fma_f32 v[136:137], v[108:109], v[44:45], v[136:137] neg_lo:[1,0,0] neg_hi:[1,0,0]
  v_pk_fma_f32 v[138:139], v[108:109], v[36:37], v[138:139]
  v_pk_fma_f32 v[140:141], v[110:111], v[46:47], v[140:141] neg_lo:[1,0,0] neg_hi:[1,0,0]
  v_pk_fma_f32 v[142:143], v[110:111], v[38:39], v[142:143]
  v_cvt_pk_bf16_f32 v124, v136, v138
  v_cvt_pk_bf16_f32 v125, v137, v139
  v_cvt_pk_bf16_f32 v126, v140, v142
  v_cvt_pk_bf16_f32 v127, v141, v143
  v_mfma_f32_16x16x32_bf16 v[8:11], v[48:51], v[112:115], 0
  v_mfma_f32_16x16x32_bf16 v[12:15], v[56:59], v[112:115], 0
  v_mfma_f32_16x16x32_bf16 v[16:19], v[64:67], v[112:115], 0
  v_mfma_f32_16x16x32_bf16 v[20:23], v[72:75], v[112:115], 0
  v_mfma_f32_16x16x32_bf16 v[32:35], v[48:51], v[120:123], 0
  v_mfma_f32_16x16x32_bf16 v[36:39], v[56:59], v[120:123], 0
  v_mfma_f32_16x16x32_bf16 v[40:43], v[64:67], v[120:123], 0
  v_mfma_f32_16x16x32_bf16 v[44:47], v[72:75], v[120:123], 0
  v_mfma_f32_16x16x32_bf16 v[8:11], v[52:55], v[116:119], v[8:11]
  v_mfma_f32_16x16x32_bf16 v[12:15], v[60:63], v[116:119], v[12:15]
  v_mfma_f32_16x16x32_bf16 v[16:19], v[68:71], v[116:119], v[16:19]
  v_mfma_f32_16x16x32_bf16 v[20:23], v[76:79], v[116:119], v[20:23]
  v_mfma_f32_16x16x32_bf16 v[32:35], v[52:55], v[124:127], v[32:35]
  v_mfma_f32_16x16x32_bf16 v[36:39], v[60:63], v[124:127], v[36:39]
  v_mfma_f32_16x16x32_bf16 v[40:43], v[68:71], v[124:127], v[40:43]
  v_mfma_f32_16x16x32_bf16 v[44:47], v[76:79], v[124:127], v[44:47]
  s_nop 0
  s_nop 0
  v_pk_mul_f32 v[8:9], v[8:9], v[154:155] op_sel:[0,0] op_sel_hi:[1,0]
  v_pk_mul_f32 v[10:11], v[10:11], v[154:155] op_sel:[0,0] op_sel_hi:[1,0]
  v_pk_mul_f32 v[12:13], v[12:13], v[154:155] op_sel:[0,0] op_sel_hi:[1,0]
  v_pk_mul_f32 v[14:15], v[14:15], v[154:155] op_sel:[0,0] op_sel_hi:[1,0]
  v_pk_mul_f32 v[16:17], v[16:17], v[154:155] op_sel:[0,0] op_sel_hi:[1,0]
  v_pk_mul_f32 v[18:19], v[18:19], v[154:155] op_sel:[0,0] op_sel_hi:[1,0]
  v_pk_mul_f32 v[20:21], v[20:21], v[154:155] op_sel:[0,0] op_sel_hi:[1,0]
  v_pk_mul_f32 v[22:23], v[22:23], v[154:155] op_sel:[0,0] op_sel_hi:[1,0]
  v_pk_mul_f32 v[32:33], v[32:33], v[154:155] op_sel:[0,1] op_sel_hi:[1,1]
  v_pk_mul_f32 v[34:35], v[34:35], v[154:155] op_sel:[0,1] op_sel_hi:[1,1]
  v_pk_mul_f32 v[36:37], v[36:37], v[154:155] op_sel:[0,1] op_sel_hi:[1,1]
  v_pk_mul_f32 v[38:39], v[38:39], v[154:155] op_sel:[0,1] op_sel_hi:[1,1]
  v_pk_mul_f32 v[40:41], v[40:41], v[154:155] op_sel:[0,1] op_sel_hi:[1,1]
  v_pk_mul_f32 v[42:43], v[42:43], v[154:155] op_sel:[0,1] op_sel_hi:[1,1]
  v_pk_mul_f32 v[44:45], v[44:45], v[154:155] op_sel:[0,1] op_sel_hi:[1,1]
  v_pk_mul_f32 v[46:47], v[46:47], v[154:155] op_sel:[0,1] op_sel_hi:[1,1]
  v_cvt_pk_bf16_f32 v128, v8, v12
  v_cvt_pk_bf16_f32 v129, v32, v36
  ds_write_b64 v158, v[128:129] offset:0
  v_cvt_pk_bf16_f32 v130, v9, v13
  v_cvt_pk_bf16_f32 v131, v33, v37
  ds_write_b64 v158, v[130:131] offset:1024
  v_cvt_pk_bf16_f32 v132, v10, v14
  v_cvt_pk_bf16_f32 v133, v34, v38
  ds_write_b64 v158, v[132:133] offset:2048
  v_cvt_pk_bf16_f32 v134, v11, v15
  v_cvt_pk_bf16_f32 v135, v35, v39
  ds_write_b64 v158, v[134:135] offset:3072
  v_cvt_pk_bf16_f32 v136, v16, -v20
  v_cvt_pk_bf16_f32 v137, v40, -v44
  ds_write_b64 v160, v[136:137] offset:0
  v_cvt_pk_bf16_f32 v138, v17, -v21
  v_cvt_pk_bf16_f32 v139, v41, -v45
  ds_write_b64 v159, v[138:139] offset:2048
  v_cvt_pk_bf16_f32 v140, v18, -v22
  v_cvt_pk_bf16_f32 v141, v42, -v46
  ds_write_b64 v159, v[140:141] offset:1024
  v_cvt_pk_bf16_f32 v142, v19, -v23
  v_cvt_pk_bf16_f32 v143, v43, -v47
  ds_write_b64 v159, v[142:143] offset:0
  s_waitcnt lgkmcnt(0)
  s_barrier
  ds_read_b128 v[80:83], v161 offset:0
  ds_read_b128 v[84:87], v161 offset:1024
  ds_read_b128 v[88:91], v161 offset:2048
  ds_read_b128 v[92:95], v161 offset:3072
  s_waitcnt lgkmcnt(3)
  buffer_store_dwordx4 v[80:83], v7, s[20:23], s32 offen offset:0 sc1
  s_waitcnt lgkmcnt(2)
  buffer_store_dwordx4 v[84:87], v7, s[20:23], s32 offen offset:1024 sc1
  s_waitcnt lgkmcnt(1)
  buffer_store_dwordx4 v[88:91], v7, s[20:23], s32 offen offset:2048 sc1
  s_waitcnt lgkmcnt(0)
  buffer_store_dwordx4 v[92:95], v7, s[20:23], s32 offen offset:3072 sc1
  s_endpgm
.Lfft_rows_fwd_kernel_wt:
  s_nop 0
  s_load_dwordx2 s[8:9], s[0:1], 8
  s_load_dwordx2 s[10:11], s[0:1], 16
  s_sub_u32 s29, s2, 256
  s_and_b32 s41, s29, 3
  s_lshr_b32 s40, s29, 2
  s_lshr_b32 s31, s40, 4
  s_lshl_b32 s31, s31, 4
  s_and_b32 s32, s40, 1
  s_lshl_b32 s32, s32, 3
  s_add_u32 s31, s31, s32
  s_lshr_b32 s32, s40, 1
  s_and_b32 s32, s32, 7
  s_lshl_b32 s32, s32, 8
  s_add_u32 s31, s31, s32
  s_and_b32 s32, s28, 1
  s_lshl_b32 s32, s32, 7
  s_add_u32 s31, s31, s32
  s_lshl_b32 s43, s41, 7
  s_cmp_ge_u32 s41, 2
  s_cselect_b32 s42, -1, 1
  s_cselect_b32 s32, 1, 0
  s_add_u32 s43, s43, s32
  s_lshl_b32 s32, s43, 1
  s_movk_i32 s33, 1026
  s_lshr_b32 s29, s28, 1
  v_add_u32 v33, s31, v3
  s_add_u32 s30, s29, 0
  s_lshl_b32 s30, s30, 2
  v_xor_b32 v4, s30, v2
  v_lshl_add_u32 v4, v4, 4, s32
  v_add_u32 v8, 0, v33
  v_mul_i32_i24 v8, s42, v8
  v_and_b32 v8, 2047, v8
  v_mad_u32_u24 v8, v8, s33, v4
  s_add_u32 s30, s29, 0
  s_lshl_b32 s30, s30, 2
  v_xor_b32 v4, s30, v2
  v_lshl_add_u32 v4, v4, 4, s32
  v_add_u32 v9, 4, v33
  v_mul_i32_i24 v9, s42, v9
  v_and_b32 v9, 2047, v9
  v_mad_u32_u24 v9, v9, s33, v4
  s_add_u32 s30, s29, 2
  s_lshl_b32 s30, s30, 2
  v_xor_b32 v4, s30, v2
  v_lshl_add_u32 v4, v4, 4, s32
  v_add_u32 v10, 64, v33
  v_mul_i32_i24 v10, s42, v10
  v_and_b32 v10, 2047, v10
  v_mad_u32_u24 v10, v10, s33, v4
  s_add_u32 s30, s29, 2
  s_lshl_b32 s30, s30, 2
  v_xor_b32 v4, s30, v2
  v_lshl_add_u32 v4, v4, 4, s32
  v_add_u32 v11, 68, v33
  v_mul_i32_i24 v11, s42, v11
  v_and_b32 v11, 2047, v11
  v_mad_u32_u24 v11, v11, s33, v4
  s_lshl_b32 s30, s28, 12
  s_waitcnt lgkmcnt(0)
  s_cmp_ge_u32 s28, 2
  s_cselect_b32 s8, s10, s8
  s_cselect_b32 s9, s11, s9
  s_mov_b32 s12, s8
  s_mov_b32 s13, s9
  s_nop 0
  s_mov_b32 s14, 0x201000
  s_mov_b32 s15, 0x20000
  s_add_u32 s20, s6, 0x800000
  s_addc_u32 s21, s7, 0
  s_mov_b32 s22, 0x406000
  s_mov_b32 s23, 0x20000
  s_add_u32 m0, s30, 0
  s_nop 0
  buffer_load_dwordx4 v8, s[12:15], 0 offen nt lds
  s_add_u32 m0, s30, 1024
  s_nop 0
  buffer_load_dwordx4 v9, s[12:15], 0 offen nt lds
  s_add_u32 m0, s30, 2048
  s_nop 0
  buffer_load_dwordx4 v10, s[12:15], 0 offen nt lds
  s_add_u32 m0, s30, 3072
  s_nop 0
  buffer_load_dwordx4 v11, s[12:15], 0 offen nt lds
  s_and_b32 s29, s28, 1
  s_lshl_b32 s29, s29, 7
  s_sub_u32 s29, s31, s29
  v_and_b32 v4, 7, v1
  v_bfe_u32 v5, v1, 3, 2
  v_lshl_add_u32 v35, v5, 6, v4
  v_add_u32 v35, s29, v35
  v_mul_i32_i24 v35, s42, v35
  v_and_b32 v35, 2047, v35
  v_mul_u32_u24 v35, s33, v35
  s_mov_b32 s29, 1024
  s_cmp_eq_u32 s41, 1
  s_cselect_b32 s29, 512, s29
  s_cmp_eq_u32 s41, 2
  s_cselect_b32 s29, 0, s29
  s_cmp_eq_u32 s41, 3
  s_cselect_b32 s29, 0x40000000, s29
  s_bitcmp1_b32 s28, 0
  s_cselect_b32 s29, 0x40000000, s29
  s_mov_b32 exec_hi, 0
  buffer_load_ushort v34, v35, s[12:15], s29 offen nt
  s_mov_b32 exec_hi, -1
  v_lshlrev_b32 v35, 2, v1
  s_lshl_b32 s29, s28, 8
  v_add_u32 v35, s29, v35
  v_lshrrev_b32 v4, 2, v2
  v_lshlrev_b32 v5, 2, v4
  v_bfe_u32 v32, v2, 1, 1
  v_lshl_add_u32 v32, v3, 1, v32
  v_xor_b32 v5, v5, v32
  v_lshlrev_b32 v5, 4, v5
  v_and_b32 v32, 1, v2
  v_lshl_add_u32 v5, v32, 3, v5
  v_and_b32 v32, 1, v4
  v_lshl_add_u32 v5, v32, 13, v5
  v_lshrrev_b32 v32, 1, v4
  v_lshl_add_u32 v5, v32, 11, v5
  s_lshl_b32 s29, s28, 9
  v_add_u32 v28, s29, v5
  v_xor_b32 v29, 128, v28
  s_lshl_b32 s29, s28, 1
  v_and_b32 v4, 7, v1
  v_xor_b32 v4, s29, v4
  v_lshlrev_b32 v4, 4, v4
  v_lshl_add_u32 v30, v1, 7, v4
  v_xor_b32 v31, 16, v30
  v_lshrrev_b32 v4, 3, v1
  v_and_b32 v5, 7, v1
  v_lshlrev_b32 v33, 4, v5
  v_lshl_add_u32 v33, v4, 13, v33
  v_xor_b32 v5, v5, v4
  v_lshlrev_b32 v5, 4, v5
  v_lshl_add_u32 v32, v4, 7, v5
  v_add_u32 v32, s30, v32
  s_lshl_b32 s29, s28, 5
  s_add_u32 s29, s29, s43
  s_lshl_b32 s29, s29, 13
  s_lshl_b32 s31, s40, 7
  s_add_u32 s29, s29, s31
  s_waitcnt vmcnt(0)
  ds_write_b32 v35, v34 offset:32768
  s_waitcnt lgkmcnt(0)
  s_barrier
  s_nop 0
  ds_read_b64_tr_b16 v[12:13], v28 offset:0
  ds_read_b64_tr_b16 v[14:15], v28 offset:4096
  ds_read_b64_tr_b16 v[16:17], v29 offset:0
  ds_read_b64_tr_b16 v[18:19], v29 offset:4096
  ds_read_b64_tr_b16 v[20:21], v28 offset:256
  ds_read_b64_tr_b16 v[22:23], v28 offset:4352
  ds_read_b64_tr_b16 v[24:25], v29 offset:256
  ds_read_b64_tr_b16 v[26:27], v29 offset:4352
  s_waitcnt lgkmcnt(6)
  ds_write_b128 v30, v[12:15] offset:16384
  s_waitcnt lgkmcnt(5)
  ds_write_b128 v30, v[16:19] offset:24576
  s_waitcnt lgkmcnt(4)
  ds_write_b128 v31, v[20:23] offset:16384
  s_waitcnt lgkmcnt(3)
  ds_write_b128 v31, v[24:27] offset:24576
  s_waitcnt lgkmcnt(0)
  s_barrier
  ds_read_b128 v[12:15], v32 offset:16384
  ds_read_b128 v[16:19], v32 offset:17408
  ds_read_b128 v[20:23], v32 offset:18432
  ds_read_b128 v[24:27], v32 offset:19456
  s_waitcnt lgkmcnt(3)
  buffer_store_dwordx4 v[12:15], v33, s[20:23], s29 offen sc1
  s_add_u32 s29, s29, 65536
  s_waitcnt lgkmcnt(2)
  buffer_store_dwordx4 v[16:19], v33, s[20:23], s29 offen sc1
  s_add_u32 s29, s29, 65536
  s_waitcnt lgkmcnt(1)
  buffer_store_dwordx4 v[20:23], v33, s[20:23], s29 offen sc1
  s_add_u32 s29, s29, 65536
  s_waitcnt lgkmcnt(0)
  buffer_store_dwordx4 v[24:27], v33, s[20:23], s29 offen sc1
  s_cmp_eq_u32 s41, 3
  s_cbranch_scc1 .Lfft_rows_fwd_kernel_zero
  s_cmp_lg_u32 s28, 0
  s_cbranch_scc1 .Lfft_rows_fwd_kernel_wend
  v_lshlrev_b32_e64 v35, 2, v1
  ds_read_b32 v4, v35 offset:32768
  ds_read_b32 v5, v35 offset:33280
  s_mov_b32 s29, 4210688
  s_cmp_eq_u32 s41, 1
  s_cselect_b32 s29, 2097152, s29
  s_cmp_eq_u32 s41, 2
  s_cselect_b32 s29, 4202496, s29
  s_add_u32 s29, s29, s31
  v_and_b32 v35, 7, v1
  v_lshlrev_b32 v35, 4, v35
  v_bfe_u32 v34, v1, 3, 2
  v_lshl_add_u32 v35, v34, 2, v35
  s_waitcnt lgkmcnt(0)
  v_lshl_or_b32 v4, v5, 16, v4
  s_mov_b32 exec_hi, 0
  buffer_store_dword v4, v35, s[20:23], s29 offen sc1
  s_mov_b32 exec_hi, -1
  s_branch .Lfft_rows_fwd_kernel_wend
.Lfft_rows_fwd_kernel_zero:
  s_add_u32 s24, s6, 0x2bb0000
  s_addc_u32 s25, s7, 0
  s_mov_b32 s26, 0x4c000
  s_mov_b32 s27, 0x20000
  s_lshl_b32 s29, s40, 13
  v_lshlrev_b32 v4, 4, v0
  v_mov_b32 v36, 0
  v_mov_b32 v37, 0
  v_mov_b32 v38, 0
  v_mov_b32 v39, 0
  buffer_store_dwordx4 v[36:39], v4, s[24:27], s29 offen sc1
  s_add_u32 s29, s29, 4096
  buffer_store_dwordx4 v[36:39], v4, s[24:27], s29 offen sc1
  s_add_u32 s29, s29, 4096
.Lfft_rows_fwd_kernel_wend:
.Lfft_rows_fwd_kernel_done:
  s_endpgm
.Lfft_rows_fwd_kernel_end:
.size fft_rows_fwd_kernel, .Lfft_rows_fwd_kernel_end - fft_rows_fwd_kernel
.globl fft_cols_kernel
.p2align 8
.type fft_cols_kernel,@function
fft_cols_kernel:
  s_getpc_b64 s[32:33]
.Lpf_fft_cols_kernel:
  s_mov_b32 s34, .Lfft_cols_kernel_end-.Lpf_fft_cols_kernel
  s_mov_b32 s35, 0x20000
  v_and_b32 v4, 63, v0
  v_lshlrev_b32 v4, 7, v4
  buffer_load_dword v6, v4, s[32:35], 0 offen
  s_cmp_ge_u32 s2, 256
  s_cbranch_scc1 .Lfft_cols_kernel_done
  s_load_dwordx2 s[4:5], s[0:1], 80
  v_lshrrev_b32 v5, 6, v0
  v_and_b32 v1, 63, v0
  v_readfirstlane_b32 s24, v5
  v_and_b32 v2, 15, v0
  v_lshrrev_b32 v3, 4, v1
  v_lshlrev_b32 v7, 4, v1
  s_cmp_ge_u32 s24, 4
  s_cbranch_scc1 .Lfft_cols_kernel_help
  s_setprio 1
  s_getpc_b64 s[12:13]
.Lpc_fft_cols_kernel:
  s_add_u32 s12, s12, fft_tables-.Lpc_fft_cols_kernel
  s_addc_u32 s13, s13, 0
  s_mov_b32 s14, 0x14800
  s_mov_b32 s15, 0x20000
  s_and_b32 s25, s2, 7
  s_lshl_b32 s25, s25, 5
  s_lshr_b32 s26, s2, 3
  s_add_u32 s25, s25, s26
  v_lshrrev_b32 v4, 4, v1
  v_and_b32 v4, 2, v4
  v_xor_b32 v4, v4, v1
  v_and_b32 v4, 3, v4
  v_lshlrev_b32 v4, 4, v4
  v_lshrrev_b32 v5, 2, v1
  v_lshl_add_u32 v8, v5, 14, v4
  s_lshl_b32 s26, s24, 20
  s_lshl_b32 s27, s25, 6
  s_add_u32 s26, s26, s27
  s_lshl_b32 s27, s24, 12
  s_lshl_b32 s28, s25, 13
  s_lshl_b32 s29, s24, 11
  s_add_u32 s28, s28, s29
  s_sub_u32 s30, 512, s25
  s_lshl_b32 s30, s30, 13
  s_add_u32 s30, s30, s29
  s_waitcnt lgkmcnt(0)
  s_mov_b32 s8, s4
  s_mov_b32 s9, s5
  s_nop 0
  s_mov_b32 s10, 0x400000
  s_mov_b32 s11, 0x20000
  s_add_u32 s16, s4, 0x800000
  s_addc_u32 s17, s5, 0
  s_mov_b32 s18, 0x406000
  s_mov_b32 s19, 0x20000
  s_cmp_lg_u32 s25, 0
  s_cbranch_scc1 .Lfft_cols_kernel_nox
  s_nop 0
  s_add_u32 s29, s28, 4202496
  buffer_load_dwordx4 v[228:231], v7, s[16:19], s29 offen offset:0
  buffer_load_dwordx4 v[232:235], v7, s[16:19], s29 offen offset:1024
  s_add_u32 s29, s28, 4210688
  buffer_load_dwordx4 v[236:239], v7, s[16:19], s29 offen offset:0
  buffer_load_dwordx4 v[240:243], v7, s[16:19], s29 offen offset:1024
  s_add_u32 s29, s28, 2097152
  buffer_load_dwordx4 v[244:247], v7, s[16:19], s29 offen offset:0
  buffer_load_dwordx4 v[248:251], v7, s[16:19], s29 offen offset:1024
.Lfft_cols_kernel_nox:
  s_mov_b32 m0, s27
  s_nop 0
  s_add_u32 s27, s27, 1024
  buffer_load_dwordx4 v8, s[8:11], s26 offen lds
  s_add_u32 s26, s26, 262144
  s_mov_b32 m0, s27
  s_nop 0
  s_add_u32 s27, s27, 1024
  buffer_load_dwordx4 v8, s[8:11], s26 offen lds
  s_add_u32 s26, s26, 262144
  s_mov_b32 m0, s27
  s_nop 0
  s_add_u32 s27, s27, 1024
  buffer_load_dwordx4 v8, s[8:11], s26 offen lds
  s_add_u32 s26, s26, 262144
  s_mov_b32 m0, s27
  s_add_u32 s27, s27, 1024
  buffer_load_dwordx4 v8, s[8:11], s26 offen lds
  s_lshl_b32 s27, s24, 11
  s_add_u32 m0, s27, 49152
  s_add_u32 s27, s27, 2048
  buffer_load_dwordx4 v7, s[12:15], s27 offen offset:0 lds
  buffer_load_dwordx4 v7, s[12:15], s27 offen offset:1024 lds
  buffer_load_dwordx4 v[196:199], v7, s[16:19], s28 offen offset:0
  buffer_load_dwordx4 v[204:207], v7, s[16:19], s30 offen offset:0
  buffer_load_dwordx4 v[200:203], v7, s[16:19], s28 offen offset:1024
  buffer_load_dwordx4 v[208:211], v7, s[16:19], s30 offen offset:1024
  s_barrier
  s_add_u32 s20, s4, 0x800000
  s_addc_u32 s21, s5, 0
  s_mov_b32 s22, 0x406000
  s_mov_b32 s23, 0x20000
  v_lshrrev_b32 v4, 1, v3
  v_lshl_add_u32 v4, v4, 5, v2
  v_lshlrev_b32 v4, 6, v4
  v_lshrrev_b32 v5, 2, v2
  v_and_b32 v5, 2, v5
  v_and_b32 v10, 1, v3
  v_xor_b32 v5, v5, v10
  v_lshl_add_u32 v9, v5, 4, v4
  v_xor_b32 v10, 32, v9
  v_lshrrev_b32 v4, 1, v3
  v_lshlrev_b32 v4, 2, v4
  v_and_b32 v5, 1, v3
  v_or_b32 v4, v4, v5
  v_xor_b32 v4, v4, v2
  v_and_b32 v4, 7, v4
  v_lshlrev_b32 v4, 4, v4
  v_lshl_add_u32 v11, v2, 8, v4
  s_lshl_b32 s29, s24, 12
  s_add_u32 s27, s29, 32768
  v_add_u32 v11, s27, v11
  v_xor_b32 v12, 32, v11
  v_xor_b32 v4, v2, v3
  v_lshlrev_b32 v4, 4, v4
  v_lshl_add_u32 v13, v3, 8, v4
  v_add_u32 v13, s27, v13
  v_xor_b32 v14, 64, v13
  s_sub_u32 s36, 512, s25
  s_cmp_lt_u32 s24, 2
  s_cselect_b32 s36, s25, s36
  s_lshl_b32 s36, s36, 13
  s_and_b32 s29, s29, 4096
  s_add_u32 s36, s36, s29
  v_cvt_f32_u32 v4, s25
  v_mul_f32 v4, 0xba800000, v4
  v_sin_f32 v16, v4
  v_cos_f32 v17, v4
  s_lshl_b32 s26, s24, 4
  v_add_u32 v4, s26, v2
  v_cvt_f32_u32 v4, v4
  v_lshlrev_b32 v5, 2, v3
  v_cvt_f32_u32 v126, v5
  v_mul_f32 v116, 0x3c800000, v4
  v_mul_f32 v117, v116, v126
  s_mov_b32 s40, 0x0
  s_mov_b32 s41, 0x3f800000
  s_mov_b32 s42, 0x40000000
  s_nop 0
  s_mov_b32 s43, 0x40400000
  v_fma_f32 v118, v116, s40, v117
  v_fma_f32 v119, v116, s41, v117
  v_fma_f32 v120, v116, s42, v117
  v_fma_f32 v121, v116, s43, v117
  v_fract_f32 v118, v118
  v_fract_f32 v119, v119
  v_fract_f32 v120, v120
  v_fract_f32 v121, v121
  v_sin_f32 v122, v118
  v_sin_f32 v123, v119
  v_sin_f32 v124, v120
  v_sin_f32 v125, v121
  v_cos_f32 v118, v118
  v_cos_f32 v119, v119
  v_cos_f32 v120, v120
  v_cos_f32 v121, v121
  v_cvt_pk_bf16_f32 v84, v118, v122
  v_cvt_pk_bf16_f32 v88, -v122, v118
  v_cvt_pk_bf16_f32 v85, v119, v123
  v_cvt_pk_bf16_f32 v89, -v123, v119
  v_cvt_pk_bf16_f32 v86, v120, v124
  v_cvt_pk_bf16_f32 v90, -v124, v120
  v_cvt_pk_bf16_f32 v87, v121, v125
  v_cvt_pk_bf16_f32 v91, -v125, v121
  s_mov_b32 s40, 0x41800000
  s_mov_b32 s41, 0x41880000
  s_mov_b32 s42, 0x41900000
  s_mov_b32 s43, 0x41980000
  v_fma_f32 v118, v116, s40, v117
  v_fma_f32 v119, v116, s41, v117
  v_fma_f32 v120, v116, s42, v117
  v_fma_f32 v121, v116, s43, v117
  v_fract_f32 v118, v118
  v_fract_f32 v119, v119
  v_fract_f32 v120, v120
  v_fract_f32 v121, v121
  v_sin_f32 v122, v118
  v_sin_f32 v123, v119
  v_sin_f32 v124, v120
  v_sin_f32 v125, v121
  v_cos_f32 v118, v118
  v_cos_f32 v119, v119
  v_cos_f32 v120, v120
  v_cos_f32 v121, v121
  v_cvt_pk_bf16_f32 v92, v118, v122
  v_cvt_pk_bf16_f32 v96, -v122, v118
  v_cvt_pk_bf16_f32 v93, v119, v123
  v_cvt_pk_bf16_f32 v97, -v123, v119
  v_cvt_pk_bf16_f32 v94, v120, v124
  v_cvt_pk_bf16_f32 v98, -v124, v120
  v_cvt_pk_bf16_f32 v95, v121, v125
  v_cvt_pk_bf16_f32 v99, -v125, v121
  s_mov_b32 s40, 0x42000000
  s_mov_b32 s41, 0x42040000
  s_mov_b32 s42, 0x42080000
  s_mov_b32 s43, 0x420c0000
  v_fma_f32 v118, v116, s40, v117
  v_fma_f32 v119, v116, s41, v117
  v_fma_f32 v120, v116, s42, v117
  v_fma_f32 v121, v116, s43, v117
  v_fract_f32 v118, v118
  v_fract_f32 v119, v119
  v_fract_f32 v120, v120
  v_fract_f32 v121, v121
  v_sin_f32 v122, v118
  v_sin_f32 v123, v119
  v_sin_f32 v124, v120
  v_sin_f32 v125, v121
  v_cos_f32 v118, v118
  v_cos_f32 v119, v119
  v_cos_f32 v120, v120
  v_cos_f32 v121, v121
  v_cvt_pk_bf16_f32 v100, v118, v122
  v_cvt_pk_bf16_f32 v104, -v122, v118
  v_cvt_pk_bf16_f32 v101, v119, v123
  v_cvt_pk_bf16_f32 v105, -v123, v119
  v_cvt_pk_bf16_f32 v102, v120, v124
  v_cvt_pk_bf16_f32 v106, -v124, v120
  v_cvt_pk_bf16_f32 v103, v121, v125
  v_cvt_pk_bf16_f32 v107, -v125, v121
  s_mov_b32 s40, 0x42400000
  s_mov_b32 s41, 0x42440000
  s_mov_b32 s42, 0x42480000
  s_mov_b32 s43, 0x424c0000
  v_fma_f32 v118, v116, s40, v117
  v_fma_f32 v119, v116, s41, v117
  v_fma_f32 v120, v116, s42, v117
  v_fma_f32 v121, v116, s43, v117
  v_fract_f32 v118, v118
  v_fract_f32 v119, v119
  v_fract_f32 v120, v120
  v_fract_f32 v121, v121
  v_sin_f32 v122, v118
  v_sin_f32 v123, v119
  v_sin_f32 v124, v120
  v_sin_f32 v125, v121
  v_cos_f32 v118, v118
  v_cos_f32 v119, v119
  v_cos_f32 v120, v120
  v_cos_f32 v121, v121
  v_cvt_pk_bf16_f32 v108, v118, v122
  v_cvt_pk_bf16_f32 v112, -v122, v118
  v_cvt_pk_bf16_f32 v109, v119, v123
  v_cvt_pk_bf16_f32 v113, -v123, v119
  v_cvt_pk_bf16_f32 v110, v120, v124
  v_cvt_pk_bf16_f32 v114, -v124, v120
  v_cvt_pk_bf16_f32 v111, v121, v125
  v_cvt_pk_bf16_f32 v115, -v125, v121
  v_mul_f32 v116, 0xba000000, v4
  v_mul_f32 v117, v116, v126
  s_mov_b32 s40, 0x0
  s_mov_b32 s41, 0x3f800000
  s_mov_b32 s42, 0x40000000
  s_mov_b32 s43, 0x40400000
  v_fma_f32 v118, v116, s40, v117
  v_fma_f32 v119, v116, s41, v117
  v_fma_f32 v120, v116, s42, v117
  v_fma_f32 v121, v116, s43, v117
  v_cos_f32 v148, v118
  v_cos_f32 v149, v119
  v_cos_f32 v150, v120
  v_cos_f32 v151, v121
  v_sin_f32 v156, v118
  v_sin_f32 v157, v119
  v_sin_f32 v158, v120
  v_sin_f32 v159, v121
  s_mov_b32 s40, 0x41800000
  s_mov_b32 s41, 0x41880000
  s_mov_b32 s42, 0x41900000
  s_mov_b32 s43, 0x41980000
  v_fma_f32 v118, v116, s40, v117
  v_fma_f32 v119, v116, s41, v117
  v_fma_f32 v120, v116, s42, v117
  v_fma_f32 v121, v116, s43, v117
  v_cos_f32 v152, v118
  v_cos_f32 v153, v119
  v_cos_f32 v154, v120
  v_cos_f32 v155, v121
  v_sin_f32 v160, v118
  v_sin_f32 v161, v119
  v_sin_f32 v162, v120
  v_sin_f32 v163, v121
  v_cvt_f32_u32 v4, s26
  v_add_f32 v126, v126, v4
  v_cvt_f32_u32 v4, v2
  v_mul_f32 v116, 0xba000000, v4
  v_mul_f32 v117, v116, v126
  s_mov_b32 s40, 0x0
  s_mov_b32 s41, 0x3f800000
  s_mov_b32 s42, 0x40000000
  s_nop 0
  s_mov_b32 s43, 0x40400000
  v_fma_f32 v118, v116, s40, v117
  v_fma_f32 v119, v116, s41, v117
  v_fma_f32 v120, v116, s42, v117
  v_fma_f32 v121, v116, s43, v117
  v_cos_f32 v212, v118
  v_cos_f32 v213, v119
  v_cos_f32 v214, v120
  v_cos_f32 v215, v121
  v_sin_f32 v220, v118
  v_sin_f32 v221, v119
  v_sin_f32 v222, v120
  v_sin_f32 v223, v121
  v_add_f32 v4, 0x41800000, v4
  v_mul_f32 v116, 0xba000000, v4
  v_mul_f32 v117, v116, v126
  s_mov_b32 s40, 0x0
  s_mov_b32 s41, 0x3f800000
  s_mov_b32 s42, 0x40000000
  s_mov_b32 s43, 0x40400000
  v_fma_f32 v118, v116, s40, v117
  v_fma_f32 v119, v116, s41, v117
  v_fma_f32 v120, v116, s42, v117
  v_fma_f32 v121, v116, s43, v117
  v_cos_f32 v216, v118
  v_cos_f32 v217, v119
  v_cos_f32 v218, v120
  v_cos_f32 v219, v121
  v_sin_f32 v224, v118
  v_sin_f32 v225, v119
  v_sin_f32 v226, v120
  v_sin_f32 v227, v121
  s_waitcnt vmcnt(4)
  s_waitcnt lgkmcnt(0)
  v_mov_b32 v4, 91136
  v_mov_b32 v5, 1
  s_mov_b64 exec, 1
  ds_add_u32 v4, v5
  s_mov_b64 exec, -1
  s_mov_b32 s27, 0x10000
  s_nop 0
.Lsb_fft_cols_kerneld:
  ds_read_b32 v5, v4
  s_sub_u32 s27, s27, 1
  s_waitcnt lgkmcnt(0)
  v_readfirstlane_b32 s26, v5
  s_nop 0
  s_cmp_ge_u32 s26, 4
  s_cselect_b32 s27, 0, s27
  s_cmp_lg_u32 s27, 0
  s_cbranch_scc1 .Lsb_fft_cols_kerneld
  ds_read_b128 v[20:23], v9 offset:0
  ds_read_b128 v[24:27], v9 offset:4096
  ds_read_b128 v[28:31], v9 offset:8192
  ds_read_b128 v[32:35], v9 offset:12288
  ds_read_b128 v[36:39], v9 offset:1024
  ds_read_b128 v[40:43], v9 offset:5120
  ds_read_b128 v[44:47], v9 offset:9216
  ds_read_b128 v[48:51], v9 offset:13312
  s_waitcnt lgkmcnt(4)
  s_nop 0
  v_mfma_f32_16x16x32_bf16 v[116:119], v[20:23], v[84:87], 0
  ds_read_b128 v[52:55], v10 offset:0
  v_mfma_f32_16x16x32_bf16 v[120:123], v[20:23], v[88:91], 0
  ds_read_b128 v[56:59], v10 offset:4096
  v_mfma_f32_16x16x32_bf16 v[116:119], v[24:27], v[92:95], v[116:119]
  ds_read_b128 v[60:63], v10 offset:8192
  v_mfma_f32_16x16x32_bf16 v[120:123], v[24:27], v[96:99], v[120:123]
  ds_read_b128 v[64:67], v10 offset:12288
  v_mfma_f32_16x16x32_bf16 v[116:119], v[28:31], v[100:103], v[116:119]
  ds_read_b128 v[68:71], v10 offset:1024
  v_mfma_f32_16x16x32_bf16 v[120:123], v[28:31], v[104:107], v[120:123]
  ds_read_b128 v[72:75], v10 offset:5120
  v_mfma_f32_16x16x32_bf16 v[116:119], v[32:35], v[108:111], v[116:119]
  ds_read_b128 v[76:79], v10 offset:9216
  v_mfma_f32_16x16x32_bf16 v[120:123], v[32:35], v[112:115], v[120:123]
  ds_read_b128 v[80:83], v10 offset:13312
  s_waitcnt lgkmcnt(8)
  s_nop 0
  v_mfma_f32_16x16x32_bf16 v[124:127], v[36:39], v[84:87], 0
  v_mfma_f32_16x16x32_bf16 v[128:131], v[36:39], v[88:91], 0
  v_mfma_f32_16x16x32_bf16 v[124:127], v[40:43], v[92:95], v[124:127]
  v_mfma_f32_16x16x32_bf16 v[128:131], v[40:43], v[96:99], v[128:131]
  v_mfma_f32_16x16x32_bf16 v[124:127], v[44:47], v[100:103], v[124:127]
  v_mfma_f32_16x16x32_bf16 v[128:131], v[44:47], v[104:107], v[128:131]
  v_mfma_f32_16x16x32_bf16 v[124:127], v[48:51], v[108:111], v[124:127]
  v_mfma_f32_16x16x32_bf16 v[128:131], v[48:51], v[112:115], v[128:131]
  s_waitcnt lgkmcnt(4)
  s_nop 0
  v_mfma_f32_16x16x32_bf16 v[132:135], v[52:55], v[84:87], 0
  v_mfma_f32_16x16x32_bf16 v[136:139], v[52:55], v[88:91], 0
  v_mfma_f32_16x16x32_bf16 v[132:135], v[56:59], v[92:95], v[132:135]
  v_mfma_f32_16x16x32_bf16 v[136:139], v[56:59], v[96:99], v[136:139]
  v_mfma_f32_16x16x32_bf16 v[132:135], v[60:63], v[100:103], v[132:135]
  v_mfma_f32_16x16x32_bf16 v[136:139], v[60:63], v[104:107], v[136:139]
  v_mfma_f32_16x16x32_bf16 v[132:135], v[64:67], v[108:111], v[132:135]
  v_mfma_f32_16x16x32_bf16 v[136:139], v[64:67], v[112:115], v[136:139]
  s_waitcnt lgkmcnt(0)
  s_nop 0
  v_mfma_f32_16x16x32_bf16 v[140:143], v[68:71], v[84:87], 0
  v_mfma_f32_16x16x32_bf16 v[144:147], v[68:71], v[88:91], 0
  v_mfma_f32_16x16x32_bf16 v[140:143], v[72:75], v[92:95], v[140:143]
  v_mfma_f32_16x16x32_bf16 v[144:147], v[72:75], v[96:99], v[144:147]
  v_mfma_f32_16x16x32_bf16 v[140:143], v[76:79], v[100:103], v[140:143]
  v_mfma_f32_16x16x32_bf16 v[144:147], v[76:79], v[104:107], v[144:147]
  v_mfma_f32_16x16x32_bf16 v[140:143], v[80:83], v[108:111], v[140:143]
  v_mfma_f32_16x16x32_bf16 v[144:147], v[80:83], v[112:115], v[144:147]
  ds_read_b128 v[164:167], v7 offset:49152
  ds_read_b128 v[168:171], v7 offset:50176
  ds_read_b128 v[172:175], v7 offset:51200
  ds_read_b128 v[176:179], v7 offset:52224
  ds_read_b128 v[180:183], v7 offset:53248
  ds_read_b128 v[184:187], v7 offset:54272
  ds_read_b128 v[188:191], v7 offset:55296
  ds_read_b128 v[192:195], v7 offset:56320
  v_pk_mul_f32 v[20:21], v[116:117], v[148:149]
  v_pk_mul_f32 v[22:23], v[116:117], v[156:157]
  v_pk_mul_f32 v[24:25], v[118:119], v[150:151]
  v_pk_mul_f32 v[26:27], v[118:119], v[158:159]
  v_pk_fma_f32 v[20:21], v[120:121], v[156:157], v[20:21] neg_lo:[1,0,0] neg_hi:[1,0,0]
  v_pk_fma_f32 v[22:23], v[120:121], v[148:149], v[22:23]
  v_pk_fma_f32 v[24:25], v[122:123], v[158:159], v[24:25] neg_lo:[1,0,0] neg_hi:[1,0,0]
  v_pk_fma_f32 v[26:27], v[122:123], v[150:151], v[26:27]
  v_cvt_pk_bf16_f32 v36, v20, v22
  v_cvt_pk_bf16_f32 v37, v21, v23
  v_cvt_pk_bf16_f32 v38, v24, v26
  v_cvt_pk_bf16_f32 v39, v25, v27
  v_pk_mul_f32 v[28:29], v[124:125], v[152:153]
  v_pk_mul_f32 v[30:31], v[124:125], v[160:161]
  v_pk_mul_f32 v[32:33], v[126:127], v[154:155]
  v_pk_mul_f32 v[34:35], v[126:127], v[162:163]
  v_pk_fma_f32 v[28:29], v[128:129], v[160:161], v[28:29] neg_lo:[1,0,0] neg_hi:[1,0,0]
  v_pk_fma_f32 v[30:31], v[128:129], v[152:153], v[30:31]
  v_pk_fma_f32 v[32:33], v[130:131], v[162:163], v[32:33] neg_lo:[1,0,0] neg_hi:[1,0,0]
  v_pk_fma_f32 v[34:35], v[130:131], v[154:155], v[34:35]
  v_cvt_pk_bf16_f32 v40, v28, v30
  v_cvt_pk_bf16_f32 v41, v29, v31
  v_cvt_pk_bf16_f32 v42, v32, v34
  v_cvt_pk_bf16_f32 v43, v33, v35
  v_pk_mul_f32 v[20:21], v[132:133], v[148:149]
  v_pk_mul_f32 v[22:23], v[132:133], v[156:157]
  v_pk_mul_f32 v[24:25], v[134:135], v[150:151]
  v_pk_mul_f32 v[26:27], v[134:135], v[158:159]
  v_pk_fma_f32 v[20:21], v[136:137], v[156:157], v[20:21] neg_lo:[1,0,0] neg_hi:[1,0,0]
  v_pk_fma_f32 v[22:23], v[136:137], v[148:149], v[22:23]
  v_pk_fma_f32 v[24:25], v[138:139], v[158:159], v[24:25] neg_lo:[1,0,0] neg_hi:[1,0,0]
  v_pk_fma_f32 v[26:27], v[138:139], v[150:151], v[26:27]
  v_cvt_pk_bf16_f32 v44, v20, v22
  v_cvt_pk_bf16_f32 v45, v21, v23
  v_cvt_pk_bf16_f32 v46, v24, v26
  v_cvt_pk_bf16_f32 v47, v25, v27
  v_pk_mul_f32 v[28:29], v[140:141], v[152:153]
  v_pk_mul_f32 v[30:31], v[140:141], v[160:161]
  v_pk_mul_f32 v[32:33], v[142:143], v[154:155]
  v_pk_mul_f32 v[34:35], v[142:143], v[162:163]
  v_pk_fma_f32 v[28:29], v[144:145], v[160:161], v[28:29] neg_lo:[1,0,0] neg_hi:[1,0,0]
  v_pk_fma_f32 v[30:31], v[144:145], v[152:153], v[30:31]
  v_pk_fma_f32 v[32:33], v[146:147], v[162:163], v[32:33] neg_lo:[1,0,0] neg_hi:[1,0,0]
  v_pk_fma_f32 v[34:35], v[146:147], v[154:155], v[34:35]
  v_cvt_pk_bf16_f32 v48, v28, v30
  v_cvt_pk_bf16_f32 v49, v29, v31
  v_cvt_pk_bf16_f32 v50, v32, v34
  v_cvt_pk_bf16_f32 v51, v33, v35
  s_waitcnt lgkmcnt(0)
  s_nop 0
  v_mfma_f32_16x16x32_bf16 v[52:55], v[164:167], v[36:39], 0
  v_mfma_f32_16x16x32_bf16 v[56:59], v[172:175], v[36:39], 0
  v_mfma_f32_16x16x32_bf16 v[60:63], v[180:183], v[36:39], 0
  v_mfma_f32_16x16x32_bf16 v[64:67], v[188:191], v[36:39], 0
  v_mfma_f32_16x16x32_bf16 v[68:71], v[164:167], v[44:47], 0
  v_mfma_f32_16x16x32_bf16 v[72:75], v[172:175], v[44:47], 0
  v_mfma_f32_16x16x32_bf16 v[76:79], v[180:183], v[44:47], 0
  v_mfma_f32_16x16x32_bf16 v[80:83], v[188:191], v[44:47], 0
  v_mfma_f32_16x16x32_bf16 v[52:55], v[168:171], v[40:43], v[52:55]
  v_mfma_f32_16x16x32_bf16 v[56:59], v[176:179], v[40:43], v[56:59]
  v_mfma_f32_16x16x32_bf16 v[60:63], v[184:187], v[40:43], v[60:63]
  v_mfma_f32_16x16x32_bf16 v[64:67], v[192:195], v[40:43], v[64:67]
  v_mfma_f32_16x16x32_bf16 v[68:71], v[168:171], v[48:51], v[68:71]
  v_mfma_f32_16x16x32_bf16 v[72:75], v[176:179], v[48:51], v[72:75]
  v_mfma_f32_16x16x32_bf16 v[76:79], v[184:187], v[48:51], v[76:79]
  v_mfma_f32_16x16x32_bf16 v[80:83], v[192:195], v[48:51], v[80:83]
  s_waitcnt vmcnt(0)
  s_cmp_eq_u32 s25, 0
  s_cbranch_scc1 .Lfft_cols_kernel_special
  v_lshlrev_b32 v116, 16, v196
  v_lshlrev_b32 v136, 16, v198
  v_lshlrev_b32 v117, 16, v197
  v_lshlrev_b32_e64 v137, 16, v199
  v_and_b32 v118, 0xffff0000, v196
  v_and_b32 v138, 0xffff0000, v198
  v_and_b32 v119, 0xffff0000, v197
  v_and_b32 v139, 0xffff0000, v199
  v_lshlrev_b32 v120, 16, v204
  v_lshlrev_b32 v140, 16, v206
  v_lshlrev_b32 v121, 16, v205
  v_lshlrev_b32 v141, 16, v207
  v_and_b32 v122, 0xffff0000, v204
  v_and_b32 v142, 0xffff0000, v206
  v_and_b32 v123, 0xffff0000, v205
  v_and_b32 v143, 0xffff0000, v207
  v_pk_add_f32 v[124:125], v[116:117], v[120:121]
  v_pk_add_f32 v[144:145], v[136:137], v[140:141]
  v_pk_add_f32 v[128:129], v[116:117], v[120:121] neg_lo:[0,1] neg_hi:[0,1]
  v_pk_add_f32 v[148:149], v[136:137], v[140:141] neg_lo:[0,1] neg_hi:[0,1]
  v_pk_add_f32 v[126:127], v[118:119], v[122:123] neg_lo:[0,1] neg_hi:[0,1]
  v_pk_add_f32 v[146:147], v[138:139], v[142:143] neg_lo:[0,1] neg_hi:[0,1]
  v_pk_add_f32 v[130:131], v[118:119], v[122:123]
  v_pk_add_f32 v[150:151], v[138:139], v[142:143]
  v_pk_fma_f32 v[116:117], v[128:129], v[16:17], v[124:125] op_sel:[0,0,0] op_sel_hi:[1,0,1]
  v_pk_fma_f32 v[136:137], v[148:149], v[16:17], v[144:145] op_sel:[0,0,0] op_sel_hi:[1,0,1]
  v_pk_fma_f32 v[118:119], v[130:131], v[16:17], v[126:127] op_sel:[0,0,0] op_sel_hi:[1,0,1]
  v_pk_fma_f32 v[138:139], v[150:151], v[16:17], v[146:147] op_sel:[0,0,0] op_sel_hi:[1,0,1]
  v_pk_fma_f32 v[120:121], v[128:129], v[16:17], v[124:125] op_sel:[0,0,0] op_sel_hi:[1,0,1] neg_lo:[1,0,0] neg_hi:[1,0,0]
  v_pk_fma_f32 v[140:141], v[148:149], v[16:17], v[144:145] op_sel:[0,0,0] op_sel_hi:[1,0,1] neg_lo:[1,0,0] neg_hi:[1,0,0]
  v_pk_fma_f32 v[122:123], v[130:131], v[16:17], v[126:127] op_sel:[0,0,0] op_sel_hi:[1,0,1] neg_lo:[1,0,0] neg_hi:[1,0,0]
  v_pk_fma_f32 v[142:143], v[150:151], v[16:17], v[146:147] op_sel:[0,0,0] op_sel_hi:[1,0,1] neg_lo:[1,0,0] neg_hi:[1,0,0]
  v_pk_mul_f32 v[128:129], v[128:129], v[16:17] op_sel:[0,1] op_sel_hi:[1,1]
  v_pk_mul_f32 v[148:149], v[148:149], v[16:17] op_sel:[0,1] op_sel_hi:[1,1]
  v_pk_mul_f32 v[130:131], v[130:131], v[16:17] op_sel:[0,1] op_sel_hi:[1,1]
  v_pk_mul_f32 v[150:151], v[150:151], v[16:17] op_sel:[0,1] op_sel_hi:[1,1]
  v_pk_mul_f32 v[124:125], v[116:117], v[52:53]
  v_pk_mul_f32 v[144:145], v[136:137], v[54:55]
  v_pk_mul_f32 v[126:127], v[116:117], v[56:57]
  v_pk_mul_f32 v[146:147], v[136:137], v[58:59]
  v_pk_mul_f32 v[132:133], v[120:121], v[68:69]
  v_pk_mul_f32 v[152:153], v[140:141], v[70:71]
  v_pk_mul_f32 v[134:135], v[120:121], v[72:73]
  v_pk_mul_f32 v[154:155], v[140:141], v[74:75]
  v_pk_fma_f32 v[124:125], v[118:119], v[56:57], v[124:125] neg_lo:[1,0,0] neg_hi:[1,0,0]
  v_pk_fma_f32 v[144:145], v[138:139], v[58:59], v[144:145] neg_lo:[1,0,0] neg_hi:[1,0,0]
  v_pk_fma_f32 v[126:127], v[118:119], v[52:53], v[126:127]
  v_pk_fma_f32 v[146:147], v[138:139], v[54:55], v[146:147]
  v_pk_fma_f32 v[132:133], v[122:123], v[72:73], v[132:133] neg_lo:[1,0,0] neg_hi:[1,0,0]
  v_pk_fma_f32 v[152:153], v[142:143], v[74:75], v[152:153] neg_lo:[1,0,0] neg_hi:[1,0,0]
  v_pk_fma_f32 v[134:135], v[122:123], v[68:69], v[134:135]
  v_pk_fma_f32 v[154:155], v[142:143], v[70:71], v[154:155]
  v_pk_fma_f32 v[124:125], v[128:129], v[72:73], v[124:125] neg_lo:[1,0,0] neg_hi:[1,0,0]
  v_pk_fma_f32 v[144:145], v[148:149], v[74:75], v[144:145] neg_lo:[1,0,0] neg_hi:[1,0,0]
  v_pk_fma_f32 v[126:127], v[128:129], v[68:69], v[126:127]
  v_pk_fma_f32 v[146:147], v[148:149], v[70:71], v[146:147]
  v_pk_fma_f32 v[132:133], v[128:129], v[56:57], v[132:133]
  v_pk_fma_f32 v[152:153], v[148:149], v[58:59], v[152:153]
  v_pk_fma_f32 v[134:135], v[128:129], v[52:53], v[134:135] neg_lo:[1,0,0] neg_hi:[1,0,0]
  v_pk_fma_f32 v[154:155], v[148:149], v[54:55], v[154:155] neg_lo:[1,0,0] neg_hi:[1,0,0]
  v_pk_fma_f32 v[124:125], v[130:131], v[68:69], v[124:125] neg_lo:[1,0,0] neg_hi:[1,0,0]
  v_pk_fma_f32 v[144:145], v[150:151], v[70:71], v[144:145] neg_lo:[1,0,0] neg_hi:[1,0,0]
  v_pk_fma_f32 v[126:127], v[130:131], v[72:73], v[126:127] neg_lo:[1,0,0] neg_hi:[1,0,0]
  v_pk_fma_f32 v[146:147], v[150:151], v[74:75], v[146:147] neg_lo:[1,0,0] neg_hi:[1,0,0]
  v_pk_fma_f32 v[132:133], v[130:131], v[52:53], v[132:133]
  v_pk_fma_f32 v[152:153], v[150:151], v[54:55], v[152:153]
  v_pk_fma_f32 v[134:135], v[130:131], v[56:57], v[134:135]
  v_pk_fma_f32 v[154:155], v[150:151], v[58:59], v[154:155]
  v_cvt_pk_bf16_f32 v36, v124, -v126
  v_cvt_pk_bf16_f32 v38, v144, -v146
  v_cvt_pk_bf16_f32 v44, v132, -v134
  v_cvt_pk_bf16_f32 v46, v152, -v154
  v_cvt_pk_bf16_f32 v37, v125, -v127
  v_cvt_pk_bf16_f32 v39, v145, -v147
  v_cvt_pk_bf16_f32 v45, v133, -v135
  v_cvt_pk_bf16_f32 v47, v153, -v155
  v_lshlrev_b32 v116, 16, v200
  v_lshlrev_b32 v136, 16, v202
  v_lshlrev_b32 v117, 16, v201
  v_lshlrev_b32 v137, 16, v203
  v_and_b32 v118, 0xffff0000, v200
  v_and_b32 v138, 0xffff0000, v202
  v_and_b32 v119, 0xffff0000, v201
  v_and_b32 v139, 0xffff0000, v203
  v_lshlrev_b32 v120, 16, v208
  v_lshlrev_b32 v140, 16, v210
  v_lshlrev_b32 v121, 16, v209
  v_lshlrev_b32 v141, 16, v211
  v_and_b32 v122, 0xffff0000, v208
  v_and_b32 v142, 0xffff0000, v210
  v_and_b32 v123, 0xffff0000, v209
  v_and_b32 v143, 0xffff0000, v211
  v_pk_add_f32 v[124:125], v[116:117], v[120:121]
  v_pk_add_f32 v[144:145], v[136:137], v[140:141]
  v_pk_add_f32 v[128:129], v[116:117], v[120:121] neg_lo:[0,1] neg_hi:[0,1]
  v_pk_add_f32 v[148:149], v[136:137], v[140:141] neg_lo:[0,1] neg_hi:[0,1]
  v_pk_add_f32 v[126:127], v[118:119], v[122:123] neg_lo:[0,1] neg_hi:[0,1]
  v_pk_add_f32 v[146:147], v[138:139], v[142:143] neg_lo:[0,1] neg_hi:[0,1]
  v_pk_add_f32 v[130:131], v[118:119], v[122:123]
  v_pk_add_f32 v[150:151], v[138:139], v[142:143]
  v_pk_fma_f32 v[116:117], v[128:129], v[16:17], v[124:125] op_sel:[0,0,0] op_sel_hi:[1,0,1]
  v_pk_fma_f32 v[136:137], v[148:149], v[16:17], v[144:145] op_sel:[0,0,0] op_sel_hi:[1,0,1]
  v_pk_fma_f32 v[118:119], v[130:131], v[16:17], v[126:127] op_sel:[0,0,0] op_sel_hi:[1,0,1]
  v_pk_fma_f32 v[138:139], v[150:151], v[16:17], v[146:147] op_sel:[0,0,0] op_sel_hi:[1,0,1]
  v_pk_fma_f32 v[120:121], v[128:129], v[16:17], v[124:125] op_sel:[0,0,0] op_sel_hi:[1,0,1] neg_lo:[1,0,0] neg_hi:[1,0,0]
  v_pk_fma_f32 v[140:141], v[148:149], v[16:17], v[144:145] op_sel:[0,0,0] op_sel_hi:[1,0,1] neg_lo:[1,0,0] neg_hi:[1,0,0]
  v_pk_fma_f32 v[122:123], v[130:131], v[16:17], v[126:127] op_sel:[0,0,0] op_sel_hi:[1,0,1] neg_lo:[1,0,0] neg_hi:[1,0,0]
  v_pk_fma_f32 v[142:143], v[150:151], v[16:17], v[146:147] op_sel:[0,0,0] op_sel_hi:[1,0,1] neg_lo:[1,0,0] neg_hi:[1,0,0]
  v_pk_mul_f32 v[128:129], v[128:129], v[16:17] op_sel:[0,1] op_sel_hi:[1,1]
  v_pk_mul_f32 v[148:149], v[148:149], v[16:17] op_sel:[0,1] op_sel_hi:[1,1]
  v_pk_mul_f32 v[130:131], v[130:131], v[16:17] op_sel:[0,1] op_sel_hi:[1,1]
  v_pk_mul_f32 v[150:151], v[150:151], v[16:17] op_sel:[0,1] op_sel_hi:[1,1]
  v_pk_mul_f32 v[124:125], v[116:117], v[60:61]
  v_pk_mul_f32 v[144:145], v[136:137], v[62:63]
  v_pk_mul_f32 v[126:127], v[116:117], v[64:65]
  v_pk_mul_f32 v[146:147], v[136:137], v[66:67]
  v_pk_mul_f32 v[132:133], v[120:121], v[76:77]
  v_pk_mul_f32 v[152:153], v[140:141], v[78:79]
  v_pk_mul_f32 v[134:135], v[120:121], v[80:81]
  v_pk_mul_f32 v[154:155], v[140:141], v[82:83]
  v_pk_fma_f32 v[124:125], v[118:119], v[64:65], v[124:125] neg_lo:[1,0,0] neg_hi:[1,0,0]
  v_pk_fma_f32 v[144:145], v[138:139], v[66:67], v[144:145] neg_lo:[1,0,0] neg_hi:[1,0,0]
  v_pk_fma_f32 v[126:127], v[118:119], v[60:61], v[126:127]
  v_pk_fma_f32 v[146:147], v[138:139], v[62:63], v[146:147]
  v_pk_fma_f32 v[132:133], v[122:123], v[80:81], v[132:133] neg_lo:[1,0,0] neg_hi:[1,0,0]
  v_pk_fma_f32 v[152:153], v[142:143], v[82:83], v[152:153] neg_lo:[1,0,0] neg_hi:[1,0,0]
  v_pk_fma_f32 v[134:135], v[122:123], v[76:77], v[134:135]
  v_pk_fma_f32 v[154:155], v[142:143], v[78:79], v[154:155]
  v_pk_fma_f32 v[124:125], v[128:129], v[80:81], v[124:125] neg_lo:[1,0,0] neg_hi:[1,0,0]
  v_pk_fma_f32 v[144:145], v[148:149], v[82:83], v[144:145] neg_lo:[1,0,0] neg_hi:[1,0,0]
  v_pk_fma_f32 v[126:127], v[128:129], v[76:77], v[126:127]
  v_pk_fma_f32 v[146:147], v[148:149], v[78:79], v[146:147]
  v_pk_fma_f32 v[132:133], v[128:129], v[64:65], v[132:133]
  v_pk_fma_f32 v[152:153], v[148:149], v[66:67], v[152:153]
  v_pk_fma_f32 v[134:135], v[128:129], v[60:61], v[134:135] neg_lo:[1,0,0] neg_hi:[1,0,0]
  v_pk_fma_f32 v[154:155], v[148:149], v[62:63], v[154:155] neg_lo:[1,0,0] neg_hi:[1,0,0]
  v_pk_fma_f32 v[124:125], v[130:131], v[76:77], v[124:125] neg_lo:[1,0,0] neg_hi:[1,0,0]
  v_pk_fma_f32 v[144:145], v[150:151], v[78:79], v[144:145] neg_lo:[1,0,0] neg_hi:[1,0,0]
  v_pk_fma_f32 v[126:127], v[130:131], v[80:81], v[126:127] neg_lo:[1,0,0] neg_hi:[1,0,0]
  v_pk_fma_f32 v[146:147], v[150:151], v[82:83], v[146:147] neg_lo:[1,0,0] neg_hi:[1,0,0]
  v_pk_fma_f32 v[132:133], v[130:131], v[60:61], v[132:133]
  v_pk_fma_f32 v[152:153], v[150:151], v[62:63], v[152:153]
  v_pk_fma_f32 v[134:135], v[130:131], v[64:65], v[134:135]
  v_pk_fma_f32 v[154:155], v[150:151], v[66:67], v[154:155]
  v_cvt_pk_bf16_f32 v40, v124, -v126
  v_cvt_pk_bf16_f32 v42, v144, -v146
  v_cvt_pk_bf16_f32 v48, v132, -v134
  v_cvt_pk_bf16_f32 v50, v152, -v154
  v_cvt_pk_bf16_f32 v41, v125, -v127
  v_cvt_pk_bf16_f32 v43, v145, -v147
  v_cvt_pk_bf16_f32 v49, v133, -v135
  v_cvt_pk_bf16_f32 v51, v153, -v155
.Lfft_cols_kernel_inv:
  v_mfma_f32_16x16x32_bf16 v[116:119], v[36:39], v[164:167], 0
  v_mfma_f32_16x16x32_bf16 v[120:123], v[36:39], v[172:175], 0
  v_mfma_f32_16x16x32_bf16 v[124:127], v[36:39], v[180:183], 0
  v_mfma_f32_16x16x32_bf16 v[128:131], v[36:39], v[188:191], 0
  v_mfma_f32_16x16x32_bf16 v[132:135], v[44:47], v[164:167], 0
  v_mfma_f32_16x16x32_bf16 v[136:139], v[44:47], v[172:175], 0
  v_mfma_f32_16x16x32_bf16 v[140:143], v[44:47], v[180:183], 0
  v_mfma_f32_16x16x32_bf16 v[144:147], v[44:47], v[188:191], 0
  v_mfma_f32_16x16x32_bf16 v[116:119], v[40:43], v[168:171], v[116:119]
  v_mfma_f32_16x16x32_bf16 v[120:123], v[40:43], v[176:179], v[120:123]
  v_mfma_f32_16x16x32_bf16 v[124:127], v[40:43], v[184:187], v[124:127]
  v_mfma_f32_16x16x32_bf16 v[128:131], v[40:43], v[192:195], v[128:131]
  v_mfma_f32_16x16x32_bf16 v[132:135], v[48:51], v[168:171], v[132:135]
  v_mfma_f32_16x16x32_bf16 v[136:139], v[48:51], v[176:179], v[136:139]
  v_mfma_f32_16x16x32_bf16 v[140:143], v[48:51], v[184:187], v[140:143]
  v_mfma_f32_16x16x32_bf16 v[144:147], v[48:51], v[192:195], v[144:147]
  s_lshl_b32 s26, s24, 10
  v_add_u32 v4, s26, v7
  v_pk_mul_f32 v[20:21], v[116:117], v[212:213]
  v_pk_mul_f32 v[22:23], v[116:117], v[220:221]
  v_pk_mul_f32 v[24:25], v[118:119], v[214:215]
  v_pk_mul_f32 v[26:27], v[118:119], v[222:223]
  v_pk_fma_f32 v[20:21], v[120:121], v[220:221], v[20:21] neg_lo:[1,0,0] neg_hi:[1,0,0]
  v_pk_fma_f32 v[22:23], v[120:121], v[212:213], v[22:23]
  v_pk_fma_f32 v[24:25], v[122:123], v[222:223], v[24:25] neg_lo:[1,0,0] neg_hi:[1,0,0]
  v_pk_fma_f32 v[26:27], v[122:123], v[214:215], v[26:27]
  v_cvt_pk_bf16_f32 v52, v20, v22
  v_cvt_pk_bf16_f32 v53, v21, v23
  v_cvt_pk_bf16_f32 v54, v24, v26
  v_cvt_pk_bf16_f32 v55, v25, v27
  ds_write_b128 v4, v[52:55] offset:16384
  v_pk_mul_f32 v[28:29], v[124:125], v[216:217]
  v_pk_mul_f32 v[30:31], v[124:125], v[224:225]
  v_pk_mul_f32 v[32:33], v[126:127], v[218:219]
  v_pk_mul_f32 v[34:35], v[126:127], v[226:227]
  v_pk_fma_f32 v[28:29], v[128:129], v[224:225], v[28:29] neg_lo:[1,0,0] neg_hi:[1,0,0]
  v_pk_fma_f32 v[30:31], v[128:129], v[216:217], v[30:31]
  v_pk_fma_f32 v[32:33], v[130:131], v[226:227], v[32:33] neg_lo:[1,0,0] neg_hi:[1,0,0]
  v_pk_fma_f32 v[34:35], v[130:131], v[218:219], v[34:35]
  v_cvt_pk_bf16_f32 v56, v28, v30
  v_cvt_pk_bf16_f32 v57, v29, v31
  v_cvt_pk_bf16_f32 v58, v32, v34
  v_cvt_pk_bf16_f32 v59, v33, v35
  ds_write_b128 v4, v[56:59] offset:20480
  v_pk_mul_f32 v[20:21], v[132:133], v[212:213]
  v_pk_mul_f32 v[22:23], v[132:133], v[220:221]
  v_pk_mul_f32 v[24:25], v[134:135], v[214:215]
  v_pk_mul_f32 v[26:27], v[134:135], v[222:223]
  v_pk_fma_f32 v[20:21], v[136:137], v[220:221], v[20:21] neg_lo:[1,0,0] neg_hi:[1,0,0]
  v_pk_fma_f32 v[22:23], v[136:137], v[212:213], v[22:23]
  v_pk_fma_f32 v[24:25], v[138:139], v[222:223], v[24:25] neg_lo:[1,0,0] neg_hi:[1,0,0]
  v_pk_fma_f32 v[26:27], v[138:139], v[214:215], v[26:27]
  v_cvt_pk_bf16_f32 v60, v20, v22
  v_cvt_pk_bf16_f32 v61, v21, v23
  v_cvt_pk_bf16_f32 v62, v24, v26
  v_cvt_pk_bf16_f32 v63, v25, v27
  ds_write_b128 v4, v[60:63] offset:24576
  v_pk_mul_f32 v[28:29], v[140:141], v[216:217]
  v_pk_mul_f32 v[30:31], v[140:141], v[224:225]
  v_pk_mul_f32 v[32:33], v[142:143], v[218:219]
  v_pk_mul_f32 v[34:35], v[142:143], v[226:227]
  v_pk_fma_f32 v[28:29], v[144:145], v[224:225], v[28:29] neg_lo:[1,0,0] neg_hi:[1,0,0]
  v_pk_fma_f32 v[30:31], v[144:145], v[216:217], v[30:31]
  v_pk_fma_f32 v[32:33], v[146:147], v[226:227], v[32:33] neg_lo:[1,0,0] neg_hi:[1,0,0]
  v_pk_fma_f32 v[34:35], v[146:147], v[218:219], v[34:35]
  v_cvt_pk_bf16_f32 v64, v28, v30
  v_cvt_pk_bf16_f32 v65, v29, v31
  v_cvt_pk_bf16_f32 v66, v32, v34
  v_cvt_pk_bf16_f32 v67, v33, v35
  ds_write_b128 v4, v[64:67] offset:28672
  s_waitcnt lgkmcnt(0)
  v_mov_b32 v4, 91140
  v_mov_b32 v5, 1
  s_mov_b64 exec, 1
  ds_add_u32 v4, v5
  s_mov_b64 exec, -1
  s_mov_b32 s27, 0x10000
.Lsb_fft_cols_kernelx:
  ds_read_b32 v5, v4
  s_sub_u32 s27, s27, 1
  s_waitcnt lgkmcnt(0)
  v_readfirstlane_b32 s26, v5
  s_nop 0
  s_cmp_ge_u32 s26, 4
  s_cselect_b32 s27, 0, s27
  s_cmp_lg_u32 s27, 0
  s_cbranch_scc1 .Lsb_fft_cols_kernelx
  ds_read_b128 v[20:23], v7 offset:16384
  ds_read_b128 v[24:27], v7 offset:17408
  ds_read_b128 v[28:31], v7 offset:18432
  ds_read_b128 v[32:35], v7 offset:19456
  ds_read_b128 v[36:39], v7 offset:20480
  ds_read_b128 v[40:43], v7 offset:21504
  ds_read_b128 v[44:47], v7 offset:22528
  ds_read_b128 v[48:51], v7 offset:23552
  s_waitcnt lgkmcnt(4)
  s_nop 0
  v_mfma_f32_16x16x32_bf16 v[116:119], v[20:23], v[84:87], 0
  ds_read_b128 v[52:55], v7 offset:24576
  v_mfma_f32_16x16x32_bf16 v[120:123], v[20:23], v[88:91], 0
  ds_read_b128 v[56:59], v7 offset:25600
  v_mfma_f32_16x16x32_bf16 v[116:119], v[24:27], v[92:95], v[116:119]
  ds_read_b128 v[60:63], v7 offset:26624
  v_mfma_f32_16x16x32_bf16 v[120:123], v[24:27], v[96:99], v[120:123]
  ds_read_b128 v[64:67], v7 offset:27648
  v_mfma_f32_16x16x32_bf16 v[116:119], v[28:31], v[100:103], v[116:119]
  ds_read_b128 v[68:71], v7 offset:28672
  v_mfma_f32_16x16x32_bf16 v[120:123], v[28:31], v[104:107], v[120:123]
  ds_read_b128 v[72:75], v7 offset:29696
  v_mfma_f32_16x16x32_bf16 v[116:119], v[32:35], v[108:111], v[116:119]
  ds_read_b128 v[76:79], v7 offset:30720
  v_mfma_f32_16x16x32_bf16 v[120:123], v[32:35], v[112:115], v[120:123]
  ds_read_b128 v[80:83], v7 offset:31744
  s_waitcnt lgkmcnt(8)
  s_nop 0
  v_mfma_f32_16x16x32_bf16 v[124:127], v[36:39], v[84:87], 0
  v_mfma_f32_16x16x32_bf16 v[128:131], v[36:39], v[88:91], 0
  v_mfma_f32_16x16x32_bf16 v[124:127], v[40:43], v[92:95], v[124:127]
  v_mfma_f32_16x16x32_bf16 v[128:131], v[40:43], v[96:99], v[128:131]
  v_mfma_f32_16x16x32_bf16 v[124:127], v[44:47], v[100:103], v[124:127]
  v_mfma_f32_16x16x32_bf16 v[128:131], v[44:47], v[104:107], v[128:131]
  v_mfma_f32_16x16x32_bf16 v[124:127], v[48:51], v[108:111], v[124:127]
  v_mfma_f32_16x16x32_bf16 v[128:131], v[48:51], v[112:115], v[128:131]
  s_waitcnt lgkmcnt(4)
  s_nop 0
  v_mfma_f32_16x16x32_bf16 v[132:135], v[52:55], v[84:87], 0
  v_mfma_f32_16x16x32_bf16 v[136:139], v[52:55], v[88:91], 0
  v_mfma_f32_16x16x32_bf16 v[132:135], v[56:59], v[92:95], v[132:135]
  v_mfma_f32_16x16x32_bf16 v[136:139], v[56:59], v[96:99], v[136:139]
  v_mfma_f32_16x16x32_bf16 v[132:135], v[60:63], v[100:103], v[132:135]
  v_mfma_f32_16x16x32_bf16 v[136:139], v[60:63], v[104:107], v[136:139]
  v_mfma_f32_16x16x32_bf16 v[132:135], v[64:67], v[108:111], v[132:135]
  v_mfma_f32_16x16x32_bf16 v[136:139], v[64:67], v[112:115], v[136:139]
  s_waitcnt lgkmcnt(0)
  s_nop 0
  v_mfma_f32_16x16x32_bf16 v[140:143], v[68:71], v[84:87], 0
  v_mfma_f32_16x16x32_bf16 v[144:147], v[68:71], v[88:91], 0
  v_mfma_f32_16x16x32_bf16 v[140:143], v[72:75], v[92:95], v[140:143]
  v_mfma_f32_16x16x32_bf16 v[144:147], v[72:75], v[96:99], v[144:147]
  v_mfma_f32_16x16x32_bf16 v[140:143], v[76:79], v[100:103], v[140:143]
  v_mfma_f32_16x16x32_bf16 v[144:147], v[76:79], v[104:107], v[144:147]
  v_mfma_f32_16x16x32_bf16 v[140:143], v[80:83], v[108:111], v[140:143]
  v_mfma_f32_16x16x32_bf16 v[144:147], v[80:83], v[112:115], v[144:147]
  v_cvt_pk_bf16_f32 v212, v116, v120
  v_cvt_pk_bf16_f32 v213, v117, v121
  v_cvt_pk_bf16_f32 v214, v118, v122
  v_cvt_pk_bf16_f32 v215, v119, v123
  ds_write_b128 v11, v[212:215] offset:0
  v_cvt_pk_bf16_f32 v216, v124, v128
  v_cvt_pk_bf16_f32 v217, v125, v129
  v_cvt_pk_bf16_f32 v218, v126, v130
  v_cvt_pk_bf16_f32 v219, v127, v131
  ds_write_b128 v11, v[216:219] offset:128
  v_cvt_pk_bf16_f32 v220, v132, -v136
  v_cvt_pk_bf16_f32 v221, v133, -v137
  v_cvt_pk_bf16_f32 v222, v134, -v138
  v_cvt_pk_bf16_f32 v223, v135, -v139
  ds_write_b128 v12, v[220:223] offset:0
  v_cvt_pk_bf16_f32 v224, v140, -v144
  v_cvt_pk_bf16_f32 v225, v141, -v145
  v_cvt_pk_bf16_f32 v226, v142, -v146
  v_cvt_pk_bf16_f32 v227, v143, -v147
  ds_write_b128 v12, v[224:227] offset:128
  s_waitcnt lgkmcnt(0)
  s_nop 0
  ds_read_b128 v[20:23], v13 offset:0
  ds_read_b128 v[24:27], v14 offset:1024
  ds_read_b128 v[28:31], v13 offset:2048
  ds_read_b128 v[32:35], v14 offset:3072
  s_waitcnt lgkmcnt(3)
  buffer_store_dwordx4 v[20:23], v7, s[20:23], s36 offen offset:0 sc1
  s_waitcnt lgkmcnt(2)
  buffer_store_dwordx4 v[24:27], v7, s[20:23], s36 offen offset:1024 sc1
  s_waitcnt lgkmcnt(1)
  buffer_store_dwordx4 v[28:31], v7, s[20:23], s36 offen offset:2048 sc1
  s_waitcnt lgkmcnt(0)
  buffer_store_dwordx4 v[32:35], v7, s[20:23], s36 offen offset:3072 sc1
  s_endpgm
.Lfft_cols_kernel_special:
  v_lshl_add_u32 v152, v3, 8, v2
  s_lshl_b32 s26, s24, 4
  v_add_u32 v152, s26, v152
  v_sub_u32 v153, 832, v152
  v_lshlrev_b32 v153, 2, v153
  v_sub_u32 v154, 0x800, v152
  v_and_b32 v154, 0x7ff, v154
  v_lshlrev_b32 v154, 2, v154
  v_lshlrev_b32 v152, 2, v152
  ds_write_b32 v152, v52 offset:32768
  ds_write_b32 v152, v53 offset:33024
  ds_write_b32 v152, v54 offset:33280
  ds_write_b32 v152, v55 offset:33536
  ds_write_b32 v152, v56 offset:40960
  ds_write_b32 v152, v57 offset:41216
  ds_write_b32 v152, v58 offset:41472
  ds_write_b32 v152, v59 offset:41728
  ds_write_b32 v152, v60 offset:36864
  ds_write_b32 v152, v61 offset:37120
  ds_write_b32 v152, v62 offset:37376
  ds_write_b32 v152, v63 offset:37632
  ds_write_b32 v152, v64 offset:45056
  ds_write_b32 v152, v65 offset:45312
  ds_write_b32 v152, v66 offset:45568
  ds_write_b32 v152, v67 offset:45824
  s_waitcnt lgkmcnt(0)
  v_mov_b32 v4, 91144
  v_mov_b32 v5, 1
  s_mov_b64 exec, 1
  ds_add_u32 v4, v5
  s_mov_b64 exec, -1
  s_mov_b32 s27, 0x10000
.Lsb_fft_cols_kernels:
  ds_read_b32 v5, v4
  s_sub_u32 s27, s27, 1
  s_waitcnt lgkmcnt(0)
  v_readfirstlane_b32 s26, v5
  s_nop 0
  s_cmp_ge_u32 s26, 4
  s_cselect_b32 s27, 0, s27
  s_cmp_lg_u32 s27, 0
  s_cbranch_scc1 .Lsb_fft_cols_kernels
  ds_read_b32 v156, v154 offset:32768
  ds_read_b32 v157, v153 offset:37376
  ds_read_b32 v158, v153 offset:37120
  ds_read_b32 v159, v153 offset:36864
  ds_read_b32 v20, v154 offset:40960
  ds_read_b32 v21, v153 offset:45568
  ds_read_b32 v22, v153 offset:45312
  ds_read_b32 v23, v153 offset:45056
  s_waitcnt lgkmcnt(0)
  s_nop 0
  ds_read_b32 v160, v153 offset:33536
  ds_read_b32 v161, v153 offset:33280
  ds_read_b32 v162, v153 offset:33024
  ds_read_b32 v163, v153 offset:32768
  ds_read_b32 v24, v153 offset:41728
  ds_read_b32 v25, v153 offset:41472
  ds_read_b32 v26, v153 offset:41216
  ds_read_b32 v27, v153 offset:40960
  s_waitcnt lgkmcnt(0)
  v_lshlrev_b32 v116, 16, v196
  v_lshlrev_b32 v117, 16, v197
  v_and_b32 v118, 0xffff0000, v196
  v_and_b32 v119, 0xffff0000, v197
  v_lshlrev_b32 v124, 16, v228
  v_lshlrev_b32 v125, 16, v229
  v_and_b32 v126, 0xffff0000, v228
  v_and_b32 v127, 0xffff0000, v229
  v_lshlrev_b32 v120, 16, v204
  v_lshlrev_b32 v121, 16, v205
  v_and_b32 v122, 0xffff0000, v204
  v_and_b32 v123, 0xffff0000, v205
  v_lshlrev_b32 v128, 16, v236
  v_lshlrev_b32_e64 v129, 16, v237
  v_and_b32 v130, 0xffff0000, v236
  v_and_b32 v131, 0xffff0000, v237
  v_pk_add_f32 v[116:117], v[116:117], v[124:125]
  v_pk_add_f32 v[118:119], v[118:119], v[126:127] neg_lo:[0,1] neg_hi:[0,1]
  v_pk_add_f32 v[120:121], v[120:121], v[128:129]
  v_pk_add_f32 v[122:123], v[130:131], v[122:123] neg_lo:[0,1] neg_hi:[0,1]
  v_pk_add_f32 v[124:125], v[116:117], v[120:121]
  v_pk_add_f32 v[126:127], v[118:119], v[122:123]
  v_pk_add_f32 v[128:129], v[116:117], v[120:121] neg_lo:[0,1] neg_hi:[0,1]
  v_pk_add_f32 v[130:131], v[118:119], v[122:123] neg_lo:[0,1] neg_hi:[0,1]
  v_pk_mul_f32 v[116:117], v[124:125], v[52:53]
  v_pk_mul_f32 v[118:119], v[124:125], v[56:57]
  v_pk_fma_f32 v[116:117], v[126:127], v[56:57], v[116:117] neg_lo:[1,0,0] neg_hi:[1,0,0]
  v_pk_fma_f32 v[118:119], v[126:127], v[52:53], v[118:119]
  v_pk_fma_f32 v[116:117], v[130:131], v[156:157], v[116:117] neg_lo:[1,0,0] neg_hi:[1,0,0]
  v_pk_fma_f32 v[118:119], v[128:129], v[156:157], v[118:119]
  v_pk_fma_f32 v[116:117], v[128:129], v[20:21], v[116:117]
  v_pk_fma_f32 v[118:119], v[130:131], v[20:21], v[118:119]
  v_lshlrev_b32 v120, 16, v244
  v_lshlrev_b32 v121, 16, v245
  v_and_b32 v122, 0xffff0000, v244
  v_and_b32 v123, 0xffff0000, v245
  v_pk_mul_f32 v[124:125], v[120:121], v[68:69]
  v_pk_mul_f32 v[126:127], v[120:121], v[72:73]
  v_pk_fma_f32 v[124:125], v[122:123], v[72:73], v[124:125] neg_lo:[1,0,0] neg_hi:[1,0,0]
  v_pk_fma_f32 v[126:127], v[122:123], v[68:69], v[126:127]
  v_mul_f32 v116, 0.5, v116
  v_mul_f32 v118, -0.5, v118
  v_add_f32 v124, v124, v124
  v_mul_f32 v126, -2.0, v126
  v_mul_f32 v117, 0.5, v117
  v_mul_f32 v119, -0.5, v119
  v_add_f32 v125, v125, v125
  v_mul_f32 v127, -2.0, v127
  v_cvt_pk_bf16_f32 v36, v116, v118
  v_cvt_pk_bf16_f32 v44, v124, v126
  v_cvt_pk_bf16_f32 v37, v117, v119
  v_cvt_pk_bf16_f32 v45, v125, v127
  v_lshlrev_b32 v116, 16, v198
  v_lshlrev_b32 v117, 16, v199
  v_and_b32 v118, 0xffff0000, v198
  v_and_b32 v119, 0xffff0000, v199
  v_lshlrev_b32 v124, 16, v230
  v_lshlrev_b32 v125, 16, v231
  v_and_b32 v126, 0xffff0000, v230
  v_and_b32 v127, 0xffff0000, v231
  v_lshlrev_b32 v120, 16, v206
  v_lshlrev_b32 v121, 16, v207
  v_and_b32 v122, 0xffff0000, v206
  v_and_b32 v123, 0xffff0000, v207
  v_lshlrev_b32 v128, 16, v238
  v_lshlrev_b32 v129, 16, v239
  v_and_b32 v130, 0xffff0000, v238
  v_and_b32 v131, 0xffff0000, v239
  v_pk_add_f32 v[116:117], v[116:117], v[124:125]
  v_pk_add_f32 v[118:119], v[118:119], v[126:127] neg_lo:[0,1] neg_hi:[0,1]
  v_pk_add_f32 v[120:121], v[120:121], v[128:129]
  v_pk_add_f32 v[122:123], v[130:131], v[122:123] neg_lo:[0,1] neg_hi:[0,1]
  v_pk_add_f32 v[124:125], v[116:117], v[120:121]
  v_pk_add_f32 v[126:127], v[118:119], v[122:123]
  v_pk_add_f32 v[128:129], v[116:117], v[120:121] neg_lo:[0,1] neg_hi:[0,1]
  v_pk_add_f32 v[130:131], v[118:119], v[122:123] neg_lo:[0,1] neg_hi:[0,1]
  v_pk_mul_f32 v[116:117], v[124:125], v[54:55]
  v_pk_mul_f32 v[118:119], v[124:125], v[58:59]
  v_pk_fma_f32 v[116:117], v[126:127], v[58:59], v[116:117] neg_lo:[1,0,0] neg_hi:[1,0,0]
  v_pk_fma_f32 v[118:119], v[126:127], v[54:55], v[118:119]
  v_pk_fma_f32 v[116:117], v[130:131], v[158:159], v[116:117] neg_lo:[1,0,0] neg_hi:[1,0,0]
  v_pk_fma_f32 v[118:119], v[128:129], v[158:159], v[118:119]
  v_pk_fma_f32 v[116:117], v[128:129], v[22:23], v[116:117]
  v_pk_fma_f32 v[118:119], v[130:131], v[22:23], v[118:119]
  v_lshlrev_b32 v120, 16, v246
  v_lshlrev_b32 v121, 16, v247
  v_and_b32 v122, 0xffff0000, v246
  v_and_b32 v123, 0xffff0000, v247
  v_pk_mul_f32 v[124:125], v[120:121], v[70:71]
  v_pk_mul_f32 v[126:127], v[120:121], v[74:75]
  v_pk_fma_f32 v[124:125], v[122:123], v[74:75], v[124:125] neg_lo:[1,0,0] neg_hi:[1,0,0]
  v_pk_fma_f32 v[126:127], v[122:123], v[70:71], v[126:127]
  v_mul_f32 v116, 0.5, v116
  v_mul_f32 v118, -0.5, v118
  v_add_f32 v124, v124, v124
  v_mul_f32 v126, -2.0, v126
  v_mul_f32 v117, 0.5, v117
  v_mul_f32 v119, -0.5, v119
  v_add_f32 v125, v125, v125
  v_mul_f32 v127, -2.0, v127
  v_cvt_pk_bf16_f32 v38, v116, v118
  v_cvt_pk_bf16_f32 v46, v124, v126
  v_cvt_pk_bf16_f32 v39, v117, v119
  v_cvt_pk_bf16_f32 v47, v125, v127
  v_lshlrev_b32 v116, 16, v200
  v_lshlrev_b32 v117, 16, v201
  v_and_b32 v118, 0xffff0000, v200
  v_and_b32 v119, 0xffff0000, v201
  v_lshlrev_b32 v124, 16, v232
  v_lshlrev_b32 v125, 16, v233
  v_and_b32 v126, 0xffff0000, v232
  v_and_b32 v127, 0xffff0000, v233
  v_lshlrev_b32 v120, 16, v208
  v_lshlrev_b32 v121, 16, v209
  v_and_b32 v122, 0xffff0000, v208
  v_and_b32 v123, 0xffff0000, v209
  v_lshlrev_b32 v128, 16, v240
  v_lshlrev_b32 v129, 16, v241
  v_and_b32 v130, 0xffff0000, v240
  v_and_b32 v131, 0xffff0000, v241
  v_pk_add_f32 v[116:117], v[116:117], v[124:125]
  v_pk_add_f32 v[118:119], v[118:119], v[126:127] neg_lo:[0,1] neg_hi:[0,1]
  v_pk_add_f32 v[120:121], v[120:121], v[128:129]
  v_pk_add_f32 v[122:123], v[130:131], v[122:123] neg_lo:[0,1] neg_hi:[0,1]
  v_pk_add_f32 v[124:125], v[116:117], v[120:121]
  v_pk_add_f32 v[126:127], v[118:119], v[122:123]
  v_pk_add_f32 v[128:129], v[116:117], v[120:121] neg_lo:[0,1] neg_hi:[0,1]
  v_pk_add_f32 v[130:131], v[118:119], v[122:123] neg_lo:[0,1] neg_hi:[0,1]
  v_pk_mul_f32 v[116:117], v[124:125], v[60:61]
  v_pk_mul_f32 v[118:119], v[124:125], v[64:65]
  v_pk_fma_f32 v[116:117], v[126:127], v[64:65], v[116:117] neg_lo:[1,0,0] neg_hi:[1,0,0]
  v_pk_fma_f32 v[118:119], v[126:127], v[60:61], v[118:119]
  v_pk_fma_f32 v[116:117], v[130:131], v[160:161], v[116:117] neg_lo:[1,0,0] neg_hi:[1,0,0]
  v_pk_fma_f32 v[118:119], v[128:129], v[160:161], v[118:119]
  v_pk_fma_f32 v[116:117], v[128:129], v[24:25], v[116:117]
  v_pk_fma_f32 v[118:119], v[130:131], v[24:25], v[118:119]
  v_lshlrev_b32 v120, 16, v248
  v_lshlrev_b32 v121, 16, v249
  v_and_b32 v122, 0xffff0000, v248
  v_and_b32 v123, 0xffff0000, v249
  v_pk_mul_f32 v[124:125], v[120:121], v[76:77]
  v_pk_mul_f32 v[126:127], v[120:121], v[80:81]
  v_pk_fma_f32 v[124:125], v[122:123], v[80:81], v[124:125] neg_lo:[1,0,0] neg_hi:[1,0,0]
  v_pk_fma_f32 v[126:127], v[122:123], v[76:77], v[126:127]
  v_mul_f32 v116, 0.5, v116
  v_mul_f32 v118, -0.5, v118
  v_add_f32 v124, v124, v124
  v_mul_f32 v126, -2.0, v126
  v_mul_f32 v117, 0.5, v117
  v_mul_f32 v119, -0.5, v119
  v_add_f32 v125, v125, v125
  v_mul_f32 v127, -2.0, v127
  v_cvt_pk_bf16_f32 v40, v116, v118
  v_cvt_pk_bf16_f32 v48, v124, v126
  v_cvt_pk_bf16_f32 v41, v117, v119
  v_cvt_pk_bf16_f32 v49, v125, v127
  v_lshlrev_b32 v116, 16, v202
  v_lshlrev_b32 v117, 16, v203
  v_and_b32 v118, 0xffff0000, v202
  v_and_b32 v119, 0xffff0000, v203
  v_lshlrev_b32 v124, 16, v234
  v_lshlrev_b32 v125, 16, v235
  v_and_b32 v126, 0xffff0000, v234
  v_and_b32 v127, 0xffff0000, v235
  v_lshlrev_b32 v120, 16, v210
  v_lshlrev_b32 v121, 16, v211
  v_and_b32 v122, 0xffff0000, v210
  v_and_b32 v123, 0xffff0000, v211
  v_lshlrev_b32 v128, 16, v242
  v_lshlrev_b32 v129, 16, v243
  v_and_b32 v130, 0xffff0000, v242
  v_and_b32 v131, 0xffff0000, v243
  v_pk_add_f32 v[116:117], v[116:117], v[124:125]
  v_pk_add_f32 v[118:119], v[118:119], v[126:127] neg_lo:[0,1] neg_hi:[0,1]
  v_pk_add_f32 v[120:121], v[120:121], v[128:129]
  v_pk_add_f32 v[122:123], v[130:131], v[122:123] neg_lo:[0,1] neg_hi:[0,1]
  v_pk_add_f32 v[124:125], v[116:117], v[120:121]
  v_pk_add_f32 v[126:127], v[118:119], v[122:123]
  v_pk_add_f32 v[128:129], v[116:117], v[120:121] neg_lo:[0,1] neg_hi:[0,1]
  v_pk_add_f32 v[130:131], v[118:119], v[122:123] neg_lo:[0,1] neg_hi:[0,1]
  v_pk_mul_f32 v[116:117], v[124:125], v[62:63]
  v_pk_mul_f32 v[118:119], v[124:125], v[66:67]
  v_pk_fma_f32 v[116:117], v[126:127], v[66:67], v[116:117] neg_lo:[1,0,0] neg_hi:[1,0,0]
  v_pk_fma_f32 v[118:119], v[126:127], v[62:63], v[118:119]
  v_pk_fma_f32 v[116:117], v[130:131], v[162:163], v[116:117] neg_lo:[1,0,0] neg_hi:[1,0,0]
  v_pk_fma_f32 v[118:119], v[128:129], v[162:163], v[118:119]
  v_pk_fma_f32 v[116:117], v[128:129], v[26:27], v[116:117]
  v_pk_fma_f32 v[118:119], v[130:131], v[26:27], v[118:119]
  v_lshlrev_b32 v120, 16, v250
  v_lshlrev_b32 v121, 16, v251
  v_and_b32 v122, 0xffff0000, v250
  v_and_b32 v123, 0xffff0000, v251
  v_pk_mul_f32 v[124:125], v[120:121], v[78:79]
  v_pk_mul_f32 v[126:127], v[120:121], v[82:83]
  v_pk_fma_f32 v[124:125], v[122:123], v[82:83], v[124:125] neg_lo:[1,0,0] neg_hi:[1,0,0]
  v_pk_fma_f32 v[126:127], v[122:123], v[78:79], v[126:127]
  v_mul_f32 v116, 0.5, v116
  v_mul_f32 v118, -0.5, v118
  v_add_f32 v124, v124, v124
  v_mul_f32 v126, -2.0, v126
  v_mul_f32 v117, 0.5, v117
  v_mul_f32 v119, -0.5, v119
  v_add_f32 v125, v125, v125
  v_mul_f32 v127, -2.0, v127
  v_cvt_pk_bf16_f32 v42, v116, v118
  v_cvt_pk_bf16_f32 v50, v124, v126
  v_cvt_pk_bf16_f32 v43, v117, v119
  v_cvt_pk_bf16_f32 v51, v125, v127
  s_branch .Lfft_cols_kernel_inv
.Lfft_cols_kernel_help:
  v_mov_b32 v4, 91136
  v_mov_b32 v5, 0
  ds_write_b32 v4, v5 offset:0
  ds_write_b32 v4, v5 offset:4
  ds_write_b32 v4, v5 offset:8
  ds_write_b32 v4, v5 offset:12
  s_sub_u32 s24, s24, 4
  s_waitcnt lgkmcnt(0)
  s_cmp_ge_u32 s2, 64
  s_cbranch_scc1 .Lprep_k2_1
  s_load_dwordx2 s[8:9], s[0:1], 32
  s_add_u32 s38, s2, 0
  s_lshr_b32 s36, s38, 2
  s_and_b32 s23, s38, 3
  s_lshl_b32 s23, s23, 2
  s_add_u32 s23, s23, s24
  s_mov_b32 s20, 2048
  s_mov_b32 s21, 64
  s_mov_b32 s22, 0
  s_mov_b32 s14, 2097152
  s_mul_i32 s37, s36, 18432
  s_lshl_b32 s39, s23, 8
  s_add_u32 s37, s37, s39
  s_branch .Lprep_k2_go
.Lprep_k2_1:
  s_cmp_ge_u32 s2, 256
  s_cbranch_scc1 .Lprep_k2_2
  s_load_dwordx2 s[8:9], s[0:1], 48
  s_sub_u32 s38, s2, 64
  s_mul_hi_u32 s36, s38, 306783379
  s_mul_i32 s39, s36, 14
  s_sub_u32 s23, s38, s39
  s_lshl_b32 s23, s23, 2
  s_add_u32 s23, s23, s24
  s_mov_b32 s20, 7168
  s_mov_b32 s21, 224
  s_mov_b32 s22, 4194304
  s_mov_b32 s14, 7340032
  s_mul_i32 s37, s36, 18432
  s_lshl_b32 s39, s23, 8
  s_add_u32 s37, s37, s39
  s_add_u32 s37, s37, 4096
  s_branch .Lprep_k2_go
.Lprep_k2_2:
  s_load_dwordx2 s[8:9], s[0:1], 32
  s_mov_b32 s36, 0
  s_mov_b32 s23, 0
  s_mov_b32 s20, 0
  s_mov_b32 s21, 0
  s_mov_b32 s22, 0x40000000
  s_mov_b32 s14, 0
  s_mov_b32 s37, 0x40000000
.Lprep_k2_go:
  v_lshrrev_b32 v9, 3, v1
  v_mul_u32_u24 v8, s20, v9
  v_lshlrev_b32 v9, 1, v3
  v_xor_b32 v9, v9, v1
  v_and_b32 v9, 7, v9
  v_lshl_add_u32 v8, v9, 4, v8
  s_mul_i32 s38, s36, s20
  s_lshl_b32 s38, s38, 6
  s_lshl_b32 s39, s23, 7
  s_add_u32 s38, s38, s39
  s_lshl_b32 s20, s20, 3
  s_lshl_b32 s40, s24, 13
  s_add_u32 s40, s40, 57344
  v_lshrrev_b32 v9, 2, v2
  v_lshl_add_u32 v9, v3, 2, v9
  v_bfe_u32 v10, v9, 1, 2
  v_lshlrev_b32 v10, 1, v10
  v_lshlrev_b32 v9, 7, v9
  v_and_b32 v11, 1, v1
  v_lshl_add_u32 v9, v11, 3, v9
  v_bfe_u32 v11, v1, 1, 1
  v_xor_b32 v10, v10, v11
  v_lshl_add_u32 v9, v10, 4, v9
  v_add_u32 v12, s40, v9
  v_xor_b32 v13, 32, v12
  v_xor_b32_e64 v14, 64, v12
  v_xor_b32 v15, 96, v12
  v_mov_b32 v48, 0x3f803f80
  v_mov_b32 v49, 0x3f803f80
  v_mov_b32 v50, 0x3f803f80
  v_mov_b32 v51, 0x3f803f80
  s_waitcnt lgkmcnt(0)
  s_mov_b32 s12, s8
  s_mov_b32 s13, s9
  s_mov_b32 s15, 0x20000
  s_add_u32 s16, s4, 0x3800000
  s_addc_u32 s17, s5, 0
  s_mov_b32 s18, 0x1200000
  s_mov_b32 s19, 0x20000
  s_barrier
  s_add_u32 m0, s40, 0
  s_nop 0
  buffer_load_dwordx4 v8, s[12:15], s38 offen nt lds
  s_add_u32 s38, s38, s20
  s_add_u32 m0, s40, 1024
  s_nop 0
  buffer_load_dwordx4 v8, s[12:15], s38 offen nt lds
  s_add_u32 s38, s38, s20
  s_add_u32 m0, s40, 2048
  s_nop 0
  buffer_load_dwordx4 v8, s[12:15], s38 offen nt lds
  s_add_u32 s38, s38, s20
  s_add_u32 m0, s40, 3072
  s_nop 0
  buffer_load_dwordx4 v8, s[12:15], s38 offen nt lds
  s_add_u32 s38, s38, s20
  s_add_u32 m0, s40, 4096
  s_nop 0
  buffer_load_dwordx4 v8, s[12:15], s38 offen nt lds
  s_add_u32 s38, s38, s20
  s_add_u32 m0, s40, 5120
  s_nop 0
  buffer_load_dwordx4 v8, s[12:15], s38 offen nt lds
  s_add_u32 s38, s38, s20
  s_add_u32 m0, s40, 6144
  s_nop 0
  buffer_load_dwordx4 v8, s[12:15], s38 offen nt lds
  s_add_u32 s38, s38, s20
  s_add_u32 m0, s40, 7168
  s_nop 0
  buffer_load_dwordx4 v8, s[12:15], s38 offen nt lds
  s_waitcnt vmcnt(0)
  s_lshl_b32 s38, s36, 1
  s_mul_i32 s38, s38, s21
  s_lshl_b32 s39, s23, 2
  s_add_u32 s38, s38, s39
  s_lshl_b32 s38, s38, 10
  s_add_u32 s38, s38, s22
  s_lshl_b32 s39, s21, 10
  s_add_u32 s39, s39, s38
  ds_read_b64_tr_b16 v[16:17], v12 offset:0
  ds_read_b64_tr_b16 v[18:19], v12 offset:2048
  ds_read_b64_tr_b16 v[20:21], v13 offset:0
  ds_read_b64_tr_b16 v[22:23], v13 offset:2048
  ds_read_b64_tr_b16 v[24:25], v14 offset:0
  ds_read_b64_tr_b16 v[26:27], v14 offset:2048
  ds_read_b64_tr_b16 v[28:29], v15 offset:0
  ds_read_b64_tr_b16 v[30:31], v15 offset:2048
  s_waitcnt lgkmcnt(0)
  s_nop 0
  v_mfma_f32_16x16x32_bf16 v[52:55], v[16:19], v[48:51], 0
  v_mfma_f32_16x16x32_bf16 v[56:59], v[20:23], v[48:51], 0
  v_mfma_f32_16x16x32_bf16 v[60:63], v[24:27], v[48:51], 0
  v_mfma_f32_16x16x32_bf16 v[64:67], v[28:31], v[48:51], 0
  ds_read_b64_tr_b16 v[32:33], v12 offset:4096
  ds_read_b64_tr_b16 v[34:35], v12 offset:6144
  ds_read_b64_tr_b16 v[36:37], v13 offset:4096
  ds_read_b64_tr_b16 v[38:39], v13 offset:6144
  ds_read_b64_tr_b16 v[40:41], v14 offset:4096
  ds_read_b64_tr_b16 v[42:43], v14 offset:6144
  ds_read_b64_tr_b16 v[44:45], v15 offset:4096
  ds_read_b64_tr_b16 v[46:47], v15 offset:6144
  s_waitcnt lgkmcnt(0)
  s_nop 0
  v_mfma_f32_16x16x32_bf16 v[52:55], v[32:35], v[48:51], v[52:55]
  v_mfma_f32_16x16x32_bf16 v[56:59], v[36:39], v[48:51], v[56:59]
  v_mfma_f32_16x16x32_bf16 v[60:63], v[40:43], v[48:51], v[60:63]
  v_mfma_f32_16x16x32_bf16 v[64:67], v[44:47], v[48:51], v[64:67]
  s_add_u32 s12, s4, 0x2b60000
  s_addc_u32 s13, s5, 0
  s_mov_b32 s14, 0x48000
  s_mov_b32 s15, 0x20000
  v_lshlrev_b32 v9, 4, v3
  v_lshl_add_u32 v9, v2, 6, v9
  v_cmp_eq_u32 vcc, 1, v2
  s_nop 1
  v_cndmask_b32 v52, v52, v56, vcc
  v_cndmask_b32 v53, v53, v57, vcc
  v_cndmask_b32 v54, v54, v58, vcc
  v_cndmask_b32 v55, v55, v59, vcc
  v_cmp_eq_u32 vcc, 2, v2
  s_nop 1
  v_cndmask_b32 v52, v52, v60, vcc
  v_cndmask_b32 v53, v53, v61, vcc
  v_cndmask_b32 v54, v54, v62, vcc
  v_cndmask_b32 v55, v55, v63, vcc
  v_cmp_eq_u32 vcc, 3, v2
  s_nop 1
  v_cndmask_b32 v52, v52, v64, vcc
  v_cndmask_b32 v53, v53, v65, vcc
  v_cndmask_b32 v54, v54, v66, vcc
  v_cndmask_b32 v55, v55, v67, vcc
  s_mov_b32 exec_lo, 0x000f000f
  s_mov_b32 exec_hi, 0x000f000f
  buffer_store_dwordx4 v[52:55], v9, s[12:15], s37 offen sc1
  s_mov_b64 exec, -1
  s_nop 0
  buffer_store_dwordx4 v[16:19], v7, s[16:19], s38 offen offset:0 sc1
  buffer_store_dwordx4 v[20:23], v7, s[16:19], s38 offen offset:1024 sc1
  buffer_store_dwordx4 v[24:27], v7, s[16:19], s38 offen offset:2048 sc1
  buffer_store_dwordx4 v[28:31], v7, s[16:19], s38 offen offset:3072 sc1
  buffer_store_dwordx4 v[32:35], v7, s[16:19], s39 offen offset:0 sc1
  buffer_store_dwordx4 v[36:39], v7, s[16:19], s39 offen offset:1024 sc1
  buffer_store_dwordx4 v[40:43], v7, s[16:19], s39 offen offset:2048 sc1
  buffer_store_dwordx4 v[44:47], v7, s[16:19], s39 offen offset:3072 sc1
.Lfft_cols_kernel_done:
  s_endpgm
.Lfft_cols_kernel_end:
.size fft_cols_kernel, .Lfft_cols_kernel_end - fft_cols_kernel
.globl mixer_kernel
.p2align 8
.type mixer_kernel,@function
mixer_kernel:
  s_getpc_b64 s[16:17]
.Lpf_mixer_kernel:
  s_mov_b32 s18, .Lmixer_kernel_end-.Lpf_mixer_kernel
  s_mov_b32 s19, 0x20000
  v_and_b32 v4, 63, v0
  v_lshlrev_b32 v4, 7, v4
  buffer_load_dword v6, v4, s[16:19], 0 offen
  s_cmp_ge_u32 s2, 256
  s_cbranch_scc1 .Lmixer_kernel_done
  s_load_dwordx2 s[4:5], s[0:1], 80
  s_load_dwordx2 s[6:7], s[0:1], 0
  s_load_dwordx2 s[8:9], s[0:1], 64
  v_lshrrev_b32 v5, 6, v0
  v_and_b32 v1, 63, v0
  v_readfirstlane_b32 s10, v5
  v_and_b32 v2, 15, v0
  v_lshrrev_b32 v3, 4, v1
  v_lshlrev_b32 v7, 4, v1
  v_mov_b32 v8, 1
  s_cmp_ge_u32 s10, 4
  s_cbranch_scc1 .Lmixer_kernel_prod
  s_getpc_b64 s[20:21]
.Lpc_mixer_kernel:
  s_add_u32 s20, s20, fft_tables-.Lpc_mixer_kernel
  s_addc_u32 s21, s21, 0
  s_mov_b32 s22, 0x14800
  s_mov_b32 s23, 0x20000
  s_and_b32 s49, s2, 7
  s_lshl_b32 s49, s49, 5
  s_lshr_b32 s43, s2, 3
  s_add_u32 s49, s49, s43
  v_xor_b32 v4, v3, v1
  v_and_b32 v4, 3, v4
  v_lshlrev_b32 v4, 4, v4
  v_lshrrev_b32 v5, 2, v1
  s_lshl_b32 s43, s10, 6
  s_sub_u32 s44, 497, s43
  s_cmp_lt_u32 s49, 128
  s_cselect_b32 s43, s43, s44
  s_cselect_b32 s44, 0, 15
  s_mov_b32 s39, -131072
  s_cselect_b32 s39, 131072, s39
  v_xor_b32 v5, s44, v5
  v_lshl_add_u32 v9, v5, 13, v4
  s_lshl_b32 s43, s43, 13
  s_and_b32 s44, s49, 127
  s_lshl_b32 s44, s44, 6
  s_add_u32 s43, s43, s44
  s_lshl_b32 s44, s10, 12
  s_add_u32 s44, s44, 98304
  v_lshlrev_b32 v10, 4, v3
  v_lshl_add_u32 v10, v2, 7, v10
  s_lshl_b32 s45, s49, 2
  s_add_u32 s45, s45, s10
  s_lshl_b32 s45, s45, 12
  s_waitcnt lgkmcnt(0)
  s_add_u32 s16, s4, 0x800000
  s_addc_u32 s17, s5, 0
  s_mov_b32 s18, 0x406000
  s_mov_b32 s19, 0x20000
  s_mov_b32 s24, s6
  s_mov_b32 s25, s7
  s_mov_b32 s26, 0x400000
  s_mov_b32 s27, 0x20000
  s_mov_b32 m0, s44
  s_add_u32 s44, s44, 1024
  buffer_load_dwordx4 v9, s[16:19], s43 offen lds
  s_add_u32 s43, s43, s39
  s_mov_b32 m0, s44
  s_add_u32 s44, s44, 1024
  buffer_load_dwordx4 v9, s[16:19], s43 offen lds
  s_add_u32 s43, s43, s39
  s_mov_b32 m0, s44
  s_add_u32 s44, s44, 1024
  buffer_load_dwordx4 v9, s[16:19], s43 offen lds
  s_add_u32 s43, s43, s39
  s_mov_b32 m0, s44
  s_add_u32 s44, s44, 1024
  buffer_load_dwordx4 v9, s[16:19], s43 offen lds
  s_lshl_b32 s46, s10, 12
  s_cmp_eq_u32 s10, 3
  s_cselect_b32 s47, 14336, s46
  s_add_u32 m0, s46, 114688
  s_cmp_eq_u32 s10, 2
  buffer_load_dwordx4 v7, s[20:23], s47 offen offset:0 lds
  buffer_load_dwordx4 v7, s[20:23], s47 offen offset:1024 lds
  s_cbranch_scc1 .Lmixer_kernel_t2
  buffer_load_dwordx4 v7, s[20:23], s47 offen offset:2048 lds
  buffer_load_dwordx4 v7, s[20:23], s47 offen offset:3072 lds
.Lmixer_kernel_t2:
  buffer_load_dwordx4 v[96:99], v10, s[24:27], s45 offen offset:0 nt
  buffer_load_dwordx4 v[100:103], v10, s[24:27], s45 offen offset:64 nt
  buffer_load_dwordx4 v[104:107], v10, s[24:27], s45 offen offset:2048 nt
  buffer_load_dwordx4 v[108:111], v10, s[24:27], s45 offen offset:2112 nt
  s_add_u32 s28, s4, 0x1100000
  s_addc_u32 s29, s5, 0
  s_nop 0
  s_mov_b32 s30, 0x400000
  s_mov_b32 s31, 0x20000
  s_add_u32 s52, s4, 0x2b00000
  s_addc_u32 s53, s5, 0
  s_nop 0
  s_mov_b32 s54, 0x8000
  s_mov_b32 s55, 0x20000
  s_add_u32 s12, s4, 0x2bb0000
  s_addc_u32 s13, s5, 0
  s_nop 0
  s_mov_b32 s14, 0x4c000
  s_mov_b32 s15, 0x20000
  v_add_u32 v15, 98304, v7
  v_lshl_add_u32 v4, v3, 6, v2
  s_lshr_b32 s46, s10, 1
  s_and_b32 s47, s10, 1
  s_lshl_b32 s47, s47, 3
  s_add_u32 s47, s47, 98304
  v_bfe_u32 v5, v4, 2, 2
  v_xor_b32 v5, s46, v5
  v_lshlrev_b32 v5, 4, v5
  v_lshl_add_u32 v11, v4, 6, v5
  v_add_u32 v11, s47, v11
  v_sub_u32 v9, 208, v4
  v_bfe_u32 v5, v9, 2, 2
  v_xor_b32 v5, s46, v5
  v_xor_b32 v5, 2, v5
  v_lshlrev_b32 v5, 4, v5
  v_lshl_add_u32 v12, v9, 6, v5
  v_add_u32 v12, s47, v12
  v_sub_u32 v9, 256, v4
  v_and_b32 v9, 255, v9
  v_bfe_u32 v5, v9, 2, 2
  v_xor_b32 v5, s46, v5
  v_xor_b32 v5, 2, v5
  v_lshlrev_b32 v5, 4, v5
  v_lshl_add_u32 v13, v9, 6, v5
  v_add_u32 v13, s47, v13
  s_lshl_b32 s46, s10, 1
  v_and_b32 v4, 7, v2
  v_xor_b32 v4, s46, v4
  v_lshlrev_b32 v4, 4, v4
  v_lshl_add_u32 v4, v2, 10, v4
  v_lshrrev_b32 v5, 1, v3
  v_lshl_add_u32 v4, v5, 3, v4
  v_and_b32 v5, 1, v3
  v_lshl_add_u32 v16, v5, 8, v4
  v_add_u32 v16, 98304, v16
  v_xor_b32 v17, 16, v16
  v_lshrrev_b32 v4, 3, v1
  v_and_b32 v5, 7, v1
  s_lshl_b32 s46, s10, 2
  s_and_b32 s46, s46, 4
  v_lshlrev_b32 v14, 4, v5
  v_xor_b32 v5, s46, v5
  v_lshlrev_b32 v5, 4, v5
  v_lshl_add_u32 v20, v4, 7, v5
  s_lshl_b32 s46, s10, 12
  s_add_u32 s46, s46, 98304
  v_add_u32 v20, s46, v20
  v_lshl_add_u32 v14, v4, 8, v14
  s_lshr_b32 s43, s49, 1
  s_lshl_b32 s43, s43, 15
  s_and_b32 s44, s49, 1
  s_lshl_b32 s44, s44, 7
  s_add_u32 s43, s43, s44
  s_lshl_b32 s44, s10, 13
  s_add_u32 s43, s43, s44
  s_mov_b32 s48, 0x3f803f80
  s_waitcnt vmcnt(4)
  s_barrier
  s_nop 0
  ds_read_b64 v[24:25], v11 offset:0
  ds_read_b64 v[26:27], v11 offset:2048
  ds_read_b64 v[28:29], v11 offset:1024
  ds_read_b64 v[30:31], v11 offset:3072
  ds_read_b64 v[32:33], v13 offset:0
  ds_read_b64 v[34:35], v12 offset:1024
  ds_read_b64 v[36:37], v12 offset:2048
  ds_read_b64 v[38:39], v12 offset:0
  ds_read_b128 v[40:43], v15 offset:18432
  ds_read_b128 v[48:51], v15 offset:20480
  ds_read_b128 v[56:59], v15 offset:22528
  ds_read_b128 v[64:67], v15 offset:24576
  s_waitcnt lgkmcnt(8)
  v_swap_b32 v25, v28
  v_swap_b32 v27, v30
  s_waitcnt lgkmcnt(4)
  v_swap_b32 v33, v36
  v_swap_b32 v35, v38
  ds_read_b128 v[44:47], v15 offset:19456
  ds_read_b128 v[52:55], v15 offset:21504
  ds_read_b128 v[60:63], v15 offset:23552
  ds_read_b128 v[68:71], v15 offset:25600
  ds_read_b128 v[72:75], v15 offset:28672
  ds_read_b128 v[76:79], v15 offset:29696
  ds_read_b128 v[80:83], v15 offset:30720
  ds_read_b128 v[84:87], v15 offset:31744
  ds_read_b128 v[88:91], v15 offset:16384
  ds_read_b128 v[92:95], v15 offset:17408
  s_waitcnt lgkmcnt(10)
  s_nop 0
  v_mfma_f32_16x16x32_bf16 v[112:115], v[24:27], v[40:43], 0
  v_mfma_f32_16x16x32_bf16 v[116:119], v[24:27], v[48:51], 0
  v_mfma_f32_16x16x32_bf16 v[120:123], v[24:27], v[56:59], 0
  v_mfma_f32_16x16x32_bf16 v[124:127], v[24:27], v[64:67], 0
  v_mfma_f32_16x16x32_bf16 v[128:131], v[28:31], v[40:43], 0
  v_mfma_f32_16x16x32_bf16 v[132:135], v[28:31], v[48:51], 0
  v_mfma_f32_16x16x32_bf16 v[136:139], v[28:31], v[56:59], 0
  v_mfma_f32_16x16x32_bf16 v[140:143], v[28:31], v[64:67], 0
  s_waitcnt lgkmcnt(6)
  s_nop 0
  v_mfma_f32_16x16x32_bf16 v[112:115], v[32:35], v[44:47], v[112:115]
  v_mfma_f32_16x16x32_bf16 v[116:119], v[32:35], v[52:55], v[116:119]
  v_mfma_f32_16x16x32_bf16 v[120:123], v[32:35], v[60:63], v[120:123]
  v_mfma_f32_16x16x32_bf16 v[124:127], v[32:35], v[68:71], v[124:127]
  v_mfma_f32_16x16x32_bf16 v[128:131], v[36:39], v[44:47], v[128:131]
  v_mfma_f32_16x16x32_bf16 v[132:135], v[36:39], v[52:55], v[132:135]
  v_mfma_f32_16x16x32_bf16 v[136:139], v[36:39], v[60:63], v[136:139]
  v_mfma_f32_16x16x32_bf16 v[140:143], v[36:39], v[68:71], v[140:143]
  s_waitcnt lgkmcnt(0)
  s_nop 0
  v_pk_mul_f32 v[144:145], v[112:113], v[72:73]
  v_pk_mul_f32 v[146:147], v[112:113], v[80:81]
  v_pk_mul_f32 v[148:149], v[114:115], v[74:75]
  v_pk_mul_f32 v[150:151], v[114:115], v[82:83]
  v_pk_fma_f32 v[144:145], v[116:117], v[80:81], v[144:145] neg_lo:[1,0,0] neg_hi:[1,0,0]
  v_pk_fma_f32 v[146:147], v[116:117], v[72:73], v[146:147]
  v_pk_fma_f32 v[148:149], v[118:119], v[82:83], v[148:149] neg_lo:[1,0,0] neg_hi:[1,0,0]
  v_pk_fma_f32 v[150:151], v[118:119], v[74:75], v[150:151]
  v_cvt_pk_bf16_f32 v24, v144, v146
  v_cvt_pk_bf16_f32 v25, v145, v147
  v_cvt_pk_bf16_f32 v26, v148, v150
  v_cvt_pk_bf16_f32 v27, v149, v151
  v_pk_mul_f32 v[152:153], v[120:121], v[76:77]
  v_pk_mul_f32 v[154:155], v[120:121], v[84:85]
  v_pk_mul_f32 v[156:157], v[122:123], v[78:79]
  v_pk_mul_f32 v[158:159], v[122:123], v[86:87]
  v_pk_fma_f32 v[152:153], v[124:125], v[84:85], v[152:153] neg_lo:[1,0,0] neg_hi:[1,0,0]
  v_pk_fma_f32 v[154:155], v[124:125], v[76:77], v[154:155]
  v_pk_fma_f32 v[156:157], v[126:127], v[86:87], v[156:157] neg_lo:[1,0,0] neg_hi:[1,0,0]
  v_pk_fma_f32 v[158:159], v[126:127], v[78:79], v[158:159]
  v_cvt_pk_bf16_f32 v28, v152, v154
  v_cvt_pk_bf16_f32 v29, v153, v155
  v_cvt_pk_bf16_f32 v30, v156, v158
  v_cvt_pk_bf16_f32 v31, v157, v159
  v_pk_mul_f32 v[144:145], v[128:129], v[72:73]
  v_pk_mul_f32 v[146:147], v[128:129], v[80:81]
  v_pk_mul_f32 v[148:149], v[130:131], v[74:75]
  v_pk_mul_f32 v[150:151], v[130:131], v[82:83]
  v_pk_fma_f32 v[144:145], v[132:133], v[80:81], v[144:145] neg_lo:[1,0,0] neg_hi:[1,0,0]
  v_pk_fma_f32 v[146:147], v[132:133], v[72:73], v[146:147]
  v_pk_fma_f32 v[148:149], v[134:135], v[82:83], v[148:149] neg_lo:[1,0,0] neg_hi:[1,0,0]
  v_pk_fma_f32 v[150:151], v[134:135], v[74:75], v[150:151]
  v_cvt_pk_bf16_f32 v32, v144, v146
  v_cvt_pk_bf16_f32 v33, v145, v147
  v_cvt_pk_bf16_f32 v34, v148, v150
  v_cvt_pk_bf16_f32 v35, v149, v151
  v_pk_mul_f32 v[152:153], v[136:137], v[76:77]
  v_pk_mul_f32 v[154:155], v[136:137], v[84:85]
  v_pk_mul_f32 v[156:157], v[138:139], v[78:79]
  v_pk_mul_f32 v[158:159], v[138:139], v[86:87]
  v_pk_fma_f32 v[152:153], v[140:141], v[84:85], v[152:153] neg_lo:[1,0,0] neg_hi:[1,0,0]
  v_pk_fma_f32 v[154:155], v[140:141], v[76:77], v[154:155]
  v_pk_fma_f32 v[156:157], v[142:143], v[86:87], v[156:157] neg_lo:[1,0,0] neg_hi:[1,0,0]
  v_pk_fma_f32 v[158:159], v[142:143], v[78:79], v[158:159]
  v_cvt_pk_bf16_f32 v36, v152, v154
  v_cvt_pk_bf16_f32 v37, v153, v155
  v_cvt_pk_bf16_f32 v38, v156, v158
  v_cvt_pk_bf16_f32 v39, v157, v159
  v_mfma_f32_16x16x32_bf16 v[112:115], v[24:27], v[88:91], 0
  v_mfma_f32_16x16x32_bf16 v[116:119], v[24:27], v[92:95], 0
  v_mfma_f32_16x16x32_bf16 v[120:123], v[28:31], v[88:91], 0
  v_mfma_f32_16x16x32_bf16 v[124:127], v[28:31], v[92:95], 0
  v_mfma_f32_16x16x32_bf16 v[128:131], v[32:35], v[88:91], 0
  v_mfma_f32_16x16x32_bf16 v[132:135], v[32:35], v[92:95], 0
  v_mfma_f32_16x16x32_bf16 v[136:139], v[36:39], v[88:91], 0
  v_mfma_f32_16x16x32_bf16 v[140:143], v[36:39], v[92:95], 0
  s_waitcnt vmcnt(0)
  v_lshlrev_b32 v160, 16, v96
  v_and_b32 v164, 0xffff0000, v96
  v_lshlrev_b32 v161, 16, v97
  v_and_b32 v165, 0xffff0000, v97
  v_lshlrev_b32 v162, 16, v98
  v_and_b32 v166, 0xffff0000, v98
  v_lshlrev_b32 v163, 16, v99
  v_and_b32 v167, 0xffff0000, v99
  v_lshlrev_b32 v168, 16, v100
  v_and_b32 v172, 0xffff0000, v100
  v_lshlrev_b32 v169, 16, v101
  v_and_b32 v173, 0xffff0000, v101
  v_lshlrev_b32 v170, 16, v102
  v_and_b32 v174, 0xffff0000, v102
  v_lshlrev_b32 v171, 16, v103
  v_and_b32 v175, 0xffff0000, v103
  v_lshlrev_b32 v176, 16, v104
  v_and_b32 v180, 0xffff0000, v104
  v_lshlrev_b32 v177, 16, v105
  v_and_b32 v181, 0xffff0000, v105
  v_lshlrev_b32 v178, 16, v106
  v_and_b32 v182, 0xffff0000, v106
  v_lshlrev_b32 v179, 16, v107
  v_and_b32 v183, 0xffff0000, v107
  v_lshlrev_b32 v184, 16, v108
  v_and_b32 v188, 0xffff0000, v108
  v_lshlrev_b32 v185, 16, v109
  v_and_b32 v189, 0xffff0000, v109
  v_lshlrev_b32 v186, 16, v110
  v_and_b32 v190, 0xffff0000, v110
  v_lshlrev_b32_e64 v187, 16, v111
  v_and_b32 v191, 0xffff0000, v111
  v_pk_add_f32 v[160:161], v[160:161], v[112:113]
  v_pk_add_f32 v[164:165], v[164:165], v[116:117] neg_lo:[0,1] neg_hi:[0,1]
  v_pk_add_f32 v[162:163], v[162:163], v[114:115]
  v_pk_add_f32 v[166:167], v[166:167], v[118:119] neg_lo:[0,1] neg_hi:[0,1]
  v_pk_add_f32 v[168:169], v[168:169], v[120:121]
  v_pk_add_f32 v[172:173], v[172:173], v[124:125] neg_lo:[0,1] neg_hi:[0,1]
  v_pk_add_f32 v[170:171], v[170:171], v[122:123]
  v_pk_add_f32 v[174:175], v[174:175], v[126:127] neg_lo:[0,1] neg_hi:[0,1]
  v_pk_add_f32 v[176:177], v[176:177], v[128:129]
  v_pk_add_f32 v[180:181], v[180:181], v[132:133] neg_lo:[0,1] neg_hi:[0,1]
  v_pk_add_f32 v[178:179], v[178:179], v[130:131]
  v_pk_add_f32 v[182:183], v[182:183], v[134:135] neg_lo:[0,1] neg_hi:[0,1]
  v_pk_add_f32 v[184:185], v[184:185], v[136:137]
  v_pk_add_f32 v[188:189], v[188:189], v[140:141] neg_lo:[0,1] neg_hi:[0,1]
  v_pk_add_f32 v[186:187], v[186:187], v[138:139]
  v_pk_add_f32 v[190:191], v[190:191], v[142:143] neg_lo:[0,1] neg_hi:[0,1]
  v_cvt_pk_bf16_f32 v192, v160, v164
  v_cvt_pk_bf16_f32 v193, v161, v165
  v_cvt_pk_bf16_f32 v194, v162, v166
  v_cvt_pk_bf16_f32 v195, v163, v167
  v_cvt_pk_bf16_f32 v196, v168, v172
  v_cvt_pk_bf16_f32 v197, v169, v173
  v_cvt_pk_bf16_f32 v198, v170, v174
  v_cvt_pk_bf16_f32 v199, v171, v175
  v_cvt_pk_bf16_f32 v200, v176, v180
  v_cvt_pk_bf16_f32 v201, v177, v181
  v_cvt_pk_bf16_f32 v202, v178, v182
  v_cvt_pk_bf16_f32 v203, v179, v183
  v_cvt_pk_bf16_f32 v204, v184, v188
  v_cvt_pk_bf16_f32 v205, v185, v189
  v_cvt_pk_bf16_f32 v206, v186, v190
  v_cvt_pk_bf16_f32 v207, v187, v191
  ds_write_b64 v16, v[192:193] offset:32768
  ds_write_b64 v16, v[194:195] offset:32896
  ds_write_b64 v16, v[196:197] offset:33280
  ds_write_b64 v16, v[198:199] offset:33408
  ds_write_b64 v17, v[200:201] offset:32768
  ds_write_b64 v17, v[202:203] offset:32896
  ds_write_b64 v17, v[204:205] offset:33280
  ds_write_b64 v17, v[206:207] offset:33408
  v_dot2_f32_bf16 v224, v192, s48, 0
  v_dot2_f32_bf16 v226, v192, v192, 0
  v_dot2_f32_bf16 v225, v200, s48, 0
  v_dot2_f32_bf16 v227, v200, v200, 0
  v_dot2c_f32_bf16 v224, s48, v193
  v_dot2c_f32_bf16 v226, v193, v193
  v_dot2c_f32_bf16 v225, s48, v201
  v_dot2c_f32_bf16 v227, v201, v201
  v_dot2c_f32_bf16 v224, s48, v194
  v_dot2c_f32_bf16 v226, v194, v194
  v_dot2c_f32_bf16 v225, s48, v202
  v_dot2c_f32_bf16 v227, v202, v202
  v_dot2c_f32_bf16 v224, s48, v195
  v_dot2c_f32_bf16 v226, v195, v195
  v_dot2c_f32_bf16 v225, s48, v203
  v_dot2c_f32_bf16 v227, v203, v203
  v_dot2c_f32_bf16 v224, s48, v196
  v_dot2c_f32_bf16 v226, v196, v196
  v_dot2c_f32_bf16 v225, s48, v204
  v_dot2c_f32_bf16 v227, v204, v204
  v_dot2c_f32_bf16 v224, s48, v197
  v_dot2c_f32_bf16 v226, v197, v197
  v_dot2c_f32_bf16 v225, s48, v205
  v_dot2c_f32_bf16 v227, v205, v205
  v_dot2c_f32_bf16 v224, s48, v198
  v_dot2c_f32_bf16 v226, v198, v198
  v_dot2c_f32_bf16 v225, s48, v206
  v_dot2c_f32_bf16 v227, v206, v206
  v_dot2c_f32_bf16 v224, s48, v199
  v_dot2c_f32_bf16 v226, v199, v199
  v_dot2c_f32_bf16 v225, s48, v207
  v_dot2c_f32_bf16 v227, v207, v207
  s_nop 1
  v_permlane32_swap_b32 v224, v225
  v_permlane32_swap_b32 v226, v227
  v_add_f32 v224, v224, v225
  v_add_f32 v226, v226, v227
  s_nop 1
  v_permlane16_swap_b32 v224, v226
  v_add_f32 v228, v224, v226
  s_nop 1
  v_add_f32_dpp v228, v228, v228 row_ror:8 row_mask:0xf bank_mask:0xf
  s_nop 1
  v_add_f32_dpp v228, v228, v228 row_ror:4 row_mask:0xf bank_mask:0xf
  s_nop 1
  v_add_f32_dpp v228, v228, v228 row_ror:2 row_mask:0xf bank_mask:0xf
  s_nop 1
  v_add_f32_dpp v228, v228, v228 row_ror:1 row_mask:0xf bank_mask:0xf
  v_mov_b32 v229, v228
  s_nop 1
  v_permlane16_swap_b32 v228, v229
  s_waitcnt lgkmcnt(0)
  v_mov_b32 v4, 151556
  v_mov_b32 v5, 1
  s_mov_b64 exec, 1
  ds_add_u32 v4, v5
  s_mov_b64 exec, -1
  s_mov_b32 s47, 0x10000
  s_nop 0
.Lsb_mixer_kernelx:
  ds_read_b32 v5, v4
  s_sub_u32 s47, s47, 1
  s_waitcnt lgkmcnt(0)
  v_readfirstlane_b32 s46, v5
  s_nop 0
  s_cmp_ge_u32 s46, 4
  s_cselect_b32 s47, 0, s47
  s_cmp_lg_u32 s47, 0
  s_cbranch_scc1 .Lsb_mixer_kernelx
  v_xor_b32 v17, 16, v20
  v_xor_b32 v18, 32, v20
  v_xor_b32_e64 v19, 48, v20
  ds_read_b128 v[96:99], v20 offset:32768
  ds_read_b128 v[100:103], v17 offset:33792
  ds_read_b128 v[104:107], v18 offset:34816
  ds_read_b128 v[108:111], v19 offset:35840
  v_lshlrev_b32 v160, 16, v192
  v_and_b32 v164, 0xffff0000, v192
  v_lshlrev_b32 v161, 16, v193
  v_and_b32 v165, 0xffff0000, v193
  v_lshlrev_b32 v162, 16, v194
  v_and_b32 v166, 0xffff0000, v194
  v_lshlrev_b32 v163, 16, v195
  v_and_b32 v167, 0xffff0000, v195
  v_lshlrev_b32 v168, 16, v196
  v_and_b32 v172, 0xffff0000, v196
  v_lshlrev_b32 v169, 16, v197
  v_and_b32 v173, 0xffff0000, v197
  v_lshlrev_b32 v170, 16, v198
  v_and_b32 v174, 0xffff0000, v198
  v_lshlrev_b32 v171, 16, v199
  v_and_b32 v175, 0xffff0000, v199
  v_lshlrev_b32 v176, 16, v200
  v_and_b32 v180, 0xffff0000, v200
  v_lshlrev_b32 v177, 16, v201
  v_and_b32 v181, 0xffff0000, v201
  v_lshlrev_b32 v178, 16, v202
  v_and_b32 v182, 0xffff0000, v202
  v_lshlrev_b32 v179, 16, v203
  v_and_b32 v183, 0xffff0000, v203
  v_lshlrev_b32 v184, 16, v204
  v_and_b32 v188, 0xffff0000, v204
  v_lshlrev_b32 v185, 16, v205
  v_and_b32 v189, 0xffff0000, v205
  v_lshlrev_b32 v186, 16, v206
  v_and_b32 v190, 0xffff0000, v206
  v_lshlrev_b32 v187, 16, v207
  v_and_b32 v191, 0xffff0000, v207
  s_add_u32 s44, s43, 4096
  s_waitcnt lgkmcnt(3)
  buffer_store_dwordx4 v[96:99], v14, s[28:31], s43 offen offset:0 sc1
  s_waitcnt lgkmcnt(2)
  buffer_store_dwordx4 v[100:103], v14, s[28:31], s43 offen offset:2048 sc1
  s_waitcnt lgkmcnt(1)
  buffer_store_dwordx4 v[104:107], v14, s[28:31], s44 offen offset:0 sc1
  s_waitcnt lgkmcnt(0)
  buffer_store_dwordx4 v[108:111], v14, s[28:31], s44 offen offset:2048 sc1
  v_mul_f32 v228, 0x3a800000, v228
  v_mul_f32 v229, 0x3a800000, v229
  v_fma_f32 v4, -v228, v228, v229
  v_max_f32_e64 v4, 0, v4
  v_cvt_pk_bf16_f32 v232, v228, v228
  v_and_b32 v232, 0xffff0000, v232
  v_cvt_pk_bf16_f32 v4, v4, v4
  v_and_b32 v4, 0xffff0000, v4
  v_add_f32 v4, 0x3727c5ac, v4
  v_cvt_pk_bf16_f32 v4, v4, v4
  v_and_b32 v4, 0xffff0000, v4
  v_sqrt_f32 v4, v4
  s_nop 0
  v_cvt_pk_bf16_f32 v230, v4, v4
  v_and_b32 v230, 0xffff0000, v230
  v_rcp_f32 v234, v230
  v_mov_b32 v238, v232
  v_mov_b32 v239, v234
  v_mov_b32 v233, v232
  s_nop 1
  v_permlane32_swap_b32 v232, v233
  v_mov_b32 v235, v234
  s_nop 1
  v_permlane32_swap_b32 v234, v235
  s_nop 0
  v_pk_add_f32 v[160:161], v[160:161], v[232:233] op_sel:[0,0] op_sel_hi:[1,0] neg_lo:[0,1] neg_hi:[0,1]
  v_pk_add_f32 v[162:163], v[162:163], v[232:233] op_sel:[0,0] op_sel_hi:[1,0] neg_lo:[0,1] neg_hi:[0,1]
  v_pk_add_f32 v[164:165], v[164:165], v[232:233] op_sel:[0,0] op_sel_hi:[1,0] neg_lo:[0,1] neg_hi:[0,1]
  v_pk_add_f32 v[166:167], v[166:167], v[232:233] op_sel:[0,0] op_sel_hi:[1,0] neg_lo:[0,1] neg_hi:[0,1]
  v_pk_add_f32 v[168:169], v[168:169], v[232:233] op_sel:[0,0] op_sel_hi:[1,0] neg_lo:[0,1] neg_hi:[0,1]
  v_pk_add_f32 v[170:171], v[170:171], v[232:233] op_sel:[0,0] op_sel_hi:[1,0] neg_lo:[0,1] neg_hi:[0,1]
  v_pk_add_f32 v[172:173], v[172:173], v[232:233] op_sel:[0,0] op_sel_hi:[1,0] neg_lo:[0,1] neg_hi:[0,1]
  v_pk_add_f32 v[174:175], v[174:175], v[232:233] op_sel:[0,0] op_sel_hi:[1,0] neg_lo:[0,1] neg_hi:[0,1]
  v_pk_add_f32 v[176:177], v[176:177], v[232:233] op_sel:[0,1] op_sel_hi:[1,1] neg_lo:[0,1] neg_hi:[0,1]
  v_pk_add_f32 v[178:179], v[178:179], v[232:233] op_sel:[0,1] op_sel_hi:[1,1] neg_lo:[0,1] neg_hi:[0,1]
  v_pk_add_f32 v[180:181], v[180:181], v[232:233] op_sel:[0,1] op_sel_hi:[1,1] neg_lo:[0,1] neg_hi:[0,1]
  v_pk_add_f32 v[182:183], v[182:183], v[232:233] op_sel:[0,1] op_sel_hi:[1,1] neg_lo:[0,1] neg_hi:[0,1]
  v_pk_add_f32 v[184:185], v[184:185], v[232:233] op_sel:[0,1] op_sel_hi:[1,1] neg_lo:[0,1] neg_hi:[0,1]
  v_pk_add_f32 v[186:187], v[186:187], v[232:233] op_sel:[0,1] op_sel_hi:[1,1] neg_lo:[0,1] neg_hi:[0,1]
  v_pk_add_f32 v[188:189], v[188:189], v[232:233] op_sel:[0,1] op_sel_hi:[1,1] neg_lo:[0,1] neg_hi:[0,1]
  v_pk_add_f32 v[190:191], v[190:191], v[232:233] op_sel:[0,1] op_sel_hi:[1,1] neg_lo:[0,1] neg_hi:[0,1]
  v_cvt_pk_bf16_f32 v208, v160, v164
  v_cvt_pk_bf16_f32 v209, v161, v165
  v_cvt_pk_bf16_f32 v210, v162, v166
  v_cvt_pk_bf16_f32 v211, v163, v167
  v_cvt_pk_bf16_f32 v212, v168, v172
  v_cvt_pk_bf16_f32 v213, v169, v173
  v_cvt_pk_bf16_f32 v214, v170, v174
  v_cvt_pk_bf16_f32 v215, v171, v175
  v_cvt_pk_bf16_f32 v216, v176, v180
  v_cvt_pk_bf16_f32 v217, v177, v181
  v_cvt_pk_bf16_f32 v218, v178, v182
  v_cvt_pk_bf16_f32 v219, v179, v183
  v_cvt_pk_bf16_f32 v220, v184, v188
  v_cvt_pk_bf16_f32 v221, v185, v189
  v_cvt_pk_bf16_f32 v222, v186, v190
  v_cvt_pk_bf16_f32 v223, v187, v191
  v_lshlrev_b32 v160, 16, v208
  v_and_b32 v164, 0xffff0000, v208
  v_lshlrev_b32 v161, 16, v209
  v_and_b32 v165, 0xffff0000, v209
  v_lshlrev_b32 v162, 16, v210
  v_and_b32 v166, 0xffff0000, v210
  v_lshlrev_b32 v163, 16, v211
  v_and_b32 v167, 0xffff0000, v211
  v_lshlrev_b32 v168, 16, v212
  v_and_b32 v172, 0xffff0000, v212
  v_lshlrev_b32 v169, 16, v213
  v_and_b32 v173, 0xffff0000, v213
  v_lshlrev_b32 v170, 16, v214
  v_and_b32 v174, 0xffff0000, v214
  v_lshlrev_b32 v171, 16, v215
  v_and_b32 v175, 0xffff0000, v215
  v_lshlrev_b32 v176, 16, v216
  v_and_b32 v180, 0xffff0000, v216
  v_lshlrev_b32 v177, 16, v217
  v_and_b32 v181, 0xffff0000, v217
  v_lshlrev_b32 v178, 16, v218
  v_and_b32 v182, 0xffff0000, v218
  v_lshlrev_b32 v179, 16, v219
  v_and_b32 v183, 0xffff0000, v219
  v_lshlrev_b32 v184, 16, v220
  v_and_b32 v188, 0xffff0000, v220
  v_lshlrev_b32 v185, 16, v221
  v_and_b32 v189, 0xffff0000, v221
  v_lshlrev_b32 v186, 16, v222
  v_and_b32 v190, 0xffff0000, v222
  v_lshlrev_b32 v187, 16, v223
  v_and_b32 v191, 0xffff0000, v223
  v_pk_mul_f32 v[160:161], v[160:161], v[234:235] op_sel:[0,0] op_sel_hi:[1,0]
  v_pk_mul_f32 v[162:163], v[162:163], v[234:235] op_sel:[0,0] op_sel_hi:[1,0]
  v_pk_mul_f32 v[164:165], v[164:165], v[234:235] op_sel:[0,0] op_sel_hi:[1,0]
  v_pk_mul_f32 v[166:167], v[166:167], v[234:235] op_sel:[0,0] op_sel_hi:[1,0]
  v_pk_mul_f32 v[168:169], v[168:169], v[234:235] op_sel:[0,0] op_sel_hi:[1,0]
  v_pk_mul_f32 v[170:171], v[170:171], v[234:235] op_sel:[0,0] op_sel_hi:[1,0]
  v_pk_mul_f32 v[172:173], v[172:173], v[234:235] op_sel:[0,0] op_sel_hi:[1,0]
  v_pk_mul_f32 v[174:175], v[174:175], v[234:235] op_sel:[0,0] op_sel_hi:[1,0]
  v_pk_mul_f32 v[176:177], v[176:177], v[234:235] op_sel:[0,1] op_sel_hi:[1,1]
  v_pk_mul_f32 v[178:179], v[178:179], v[234:235] op_sel:[0,1] op_sel_hi:[1,1]
  v_pk_mul_f32 v[180:181], v[180:181], v[234:235] op_sel:[0,1] op_sel_hi:[1,1]
  v_pk_mul_f32 v[182:183], v[182:183], v[234:235] op_sel:[0,1] op_sel_hi:[1,1]
  v_pk_mul_f32 v[184:185], v[184:185], v[234:235] op_sel:[0,1] op_sel_hi:[1,1]
  v_pk_mul_f32 v[186:187], v[186:187], v[234:235] op_sel:[0,1] op_sel_hi:[1,1]
  v_pk_mul_f32 v[188:189], v[188:189], v[234:235] op_sel:[0,1] op_sel_hi:[1,1]
  v_pk_mul_f32 v[190:191], v[190:191], v[234:235] op_sel:[0,1] op_sel_hi:[1,1]
  v_cvt_pk_bf16_f32 v208, v160, v164
  v_cvt_pk_bf16_f32 v209, v161, v165
  v_cvt_pk_bf16_f32 v210, v162, v166
  v_cvt_pk_bf16_f32 v211, v163, v167
  v_cvt_pk_bf16_f32 v212, v168, v172
  v_cvt_pk_bf16_f32 v213, v169, v173
  v_cvt_pk_bf16_f32 v214, v170, v174
  v_cvt_pk_bf16_f32 v215, v171, v175
  v_cvt_pk_bf16_f32 v216, v176, v180
  v_cvt_pk_bf16_f32 v217, v177, v181
  v_cvt_pk_bf16_f32 v218, v178, v182
  v_cvt_pk_bf16_f32 v219, v179, v183
  v_cvt_pk_bf16_f32 v220, v184, v188
  v_cvt_pk_bf16_f32 v221, v185, v189
  v_cvt_pk_bf16_f32 v222, v186, v190
  v_cvt_pk_bf16_f32 v223, v187, v191
  v_dot2_f32_bf16 v224, v208, s48, 0
  v_dot2_f32_bf16 v226, v208, v208, 0
  v_dot2_f32_bf16 v225, v216, s48, 0
  v_dot2_f32_bf16 v227, v216, v216, 0
  v_dot2c_f32_bf16 v224, s48, v209
  v_dot2c_f32_bf16 v226, v209, v209
  v_dot2c_f32_bf16 v225, s48, v217
  v_dot2c_f32_bf16 v227, v217, v217
  v_dot2c_f32_bf16 v224, s48, v210
  v_dot2c_f32_bf16 v226, v210, v210
  v_dot2c_f32_bf16 v225, s48, v218
  v_dot2c_f32_bf16 v227, v218, v218
  v_dot2c_f32_bf16 v224, s48, v211
  v_dot2c_f32_bf16 v226, v211, v211
  v_dot2c_f32_bf16 v225, s48, v219
  v_dot2c_f32_bf16 v227, v219, v219
  v_dot2c_f32_bf16 v224, s48, v212
  v_dot2c_f32_bf16 v226, v212, v212
  v_dot2c_f32_bf16 v225, s48, v220
  v_dot2c_f32_bf16 v227, v220, v220
  v_dot2c_f32_bf16 v224, s48, v213
  v_dot2c_f32_bf16 v226, v213, v213
  v_dot2c_f32_bf16 v225, s48, v221
  v_dot2c_f32_bf16 v227, v221, v221
  v_dot2c_f32_bf16 v224, s48, v214
  v_dot2c_f32_bf16 v226, v214, v214
  v_dot2c_f32_bf16 v225, s48, v222
  v_dot2c_f32_bf16 v227, v222, v222
  v_dot2c_f32_bf16 v224, s48, v215
  v_dot2c_f32_bf16 v226, v215, v215
  v_dot2c_f32_bf16 v225, s48, v223
  v_dot2c_f32_bf16 v227, v223, v223
  s_nop 1
  v_permlane32_swap_b32 v224, v225
  v_permlane32_swap_b32 v226, v227
  v_add_f32 v224, v224, v225
  v_add_f32 v226, v226, v227
  s_nop 1
  v_permlane16_swap_b32 v224, v226
  v_add_f32 v228, v224, v226
  s_nop 1
  v_add_f32_dpp v228, v228, v228 row_ror:8 row_mask:0xf bank_mask:0xf
  s_nop 1
  v_add_f32_dpp v228, v228, v228 row_ror:4 row_mask:0xf bank_mask:0xf
  s_nop 1
  v_add_f32_dpp v228, v228, v228 row_ror:2 row_mask:0xf bank_mask:0xf
  s_nop 1
  v_add_f32_dpp v228, v228, v228 row_ror:1 row_mask:0xf bank_mask:0xf
  v_mov_b32 v229, v228
  s_nop 1
  v_permlane16_swap_b32 v228, v229
  s_nop 0
  v_mul_f32 v228, 0x3a800000, v228
  v_mul_f32 v229, 0x3a800000, v229
  v_fma_f32 v4, -v228, v228, v229
  v_max_f32_e64 v4, 0, v4
  v_cvt_pk_bf16_f32 v236, v228, v228
  v_and_b32 v236, 0xffff0000, v236
  v_cvt_pk_bf16_f32 v4, v4, v4
  v_and_b32 v4, 0xffff0000, v4
  v_add_f32 v4, 0x3727c5ac, v4
  v_cvt_pk_bf16_f32 v4, v4, v4
  v_and_b32 v4, 0xffff0000, v4
  v_sqrt_f32 v4, v4
  s_nop 0
  v_cvt_pk_bf16_f32 v237, v4, v4
  v_and_b32 v237, 0xffff0000, v237
  v_fma_f32 v236, v236, v230, v238
  v_mul_f32 v237, v237, v230
  v_lshrrev_b32 v4, 1, v1
  s_lshr_b32 s45, s45, 7
  s_mov_b32 exec_lo, 1
  s_mov_b32 exec_hi, 1
  buffer_store_dwordx4 v[236:239], v4, s[52:55], s45 offen sc1
  s_mov_b64 exec, -1
  s_and_b32 s45, s49, 15
  s_lshr_b32 s49, s49, 4
  s_waitcnt vmcnt(0)
  v_mov_b32 v4, 151564
  s_mov_b64 exec, 1
  ds_add_rtn_u32 v5, v4, v8
  s_waitcnt lgkmcnt(0)
  s_mov_b64 exec, -1
  v_readfirstlane_b32 s47, v5
  s_nop 0
  s_cmp_lg_u32 s47, 3
  s_cbranch_scc1 .Lmixer_kernel_k3sig
  s_lshl_b32 s43, s49, 12
  s_lshl_b32 s47, s45, 2
  s_add_u32 s43, s43, s47
  v_lshlrev_b32 v4, 8, v1
  s_add_u32 s43, s43, 16384
  s_mov_b32 exec_lo, 0xffff
  s_mov_b32 exec_hi, 0
  buffer_store_dword v8, v4, s[12:15], s43 offen sc1
  s_mov_b64 exec, -1
.Lmixer_kernel_k3sig:
  s_and_b32 s43, s2, 7
  s_lshr_b32 s44, s2, 3
  s_lshr_b32 s36, s43, 2
  s_lshl_b32 s36, s36, 3
  s_lshr_b32 s45, s44, 2
  s_add_u32 s36, s36, s45
  s_and_b32 s37, s43, 2
  s_lshl_b32 s37, s37, 1
  s_and_b32 s45, s44, 3
  s_add_u32 s37, s37, s45
  s_lshl_b32 s37, s37, 1
  s_and_b32 s45, s2, 1
  s_add_u32 s37, s37, s45
  s_lshr_b32 s45, s10, 1
  s_and_b32 s48, s10, 1
  s_and_b32 s46, s2, 1
  s_lshl_b32 s43, s45, 1
  s_add_u32 s43, s43, s46
  s_lshl_b32 s38, s36, 2
  s_add_u32 s38, s38, s43
  s_lshl_b32 s38, s38, 1
  s_lshl_b32 s45, s45, 12
  s_add_u32 s45, s45, 16384
  v_add_u32 v9, s45, v7
  s_lshl_b32 s43, s48, 12
  v_add_u32 v12, s43, v7
  s_mov_b32 s49, s37
  s_and_b32 s37, s37, 14
  s_add_u32 s37, s37, s48
  v_add_u32 v10, 49152, v9
  v_add_u32 v13, 49152, v12
  v_add_u32 v11, 98304, v9
  v_add_u32 v14, 98304, v12
  v_mov_b32 v16, 0
  v_mov_b32 v17, 0
  v_mov_b32 v18, 0
  v_mov_b32 v19, 0
  v_mov_b32 v20, 0
  v_mov_b32 v21, 0
  v_mov_b32 v22, 0
  v_mov_b32 v23, 0
  v_mov_b32 v24, 0
  v_mov_b32 v25, 0
  v_mov_b32 v26, 0
  v_mov_b32 v27, 0
  v_mov_b32 v28, 0
  v_mov_b32 v29, 0
  v_mov_b32 v30, 0
  v_mov_b32 v31, 0
  v_mov_b32 v32, 0
  v_mov_b32 v33, 0
  v_mov_b32 v34, 0
  v_mov_b32 v35, 0
  v_mov_b32 v36, 0
  v_mov_b32 v37, 0
  v_mov_b32 v38, 0
  v_mov_b32 v39, 0
  v_mov_b32 v40, 0
  v_mov_b32 v41, 0
  v_mov_b32 v42, 0
  v_mov_b32 v43, 0
  v_mov_b32 v44, 0
  v_mov_b32 v45, 0
  v_mov_b32 v46, 0
  v_mov_b32 v47, 0
  s_add_u32 s24, s4, 0x2b00000
  s_addc_u32 s25, s5, 0
  s_nop 0
  s_mov_b32 s26, 0x8000
  s_mov_b32 s27, 0x20000
  s_add_u32 s32, s4, 0x1500000
  s_addc_u32 s33, s5, 0
  s_mov_b32 s34, 0x400000
  s_mov_b32 s35, 0x20000
  s_barrier
  s_barrier
  s_nop 0
  ds_read_b128 v[48:51], v9 offset:0
  ds_read_b128 v[52:55], v9 offset:2048
  ds_read_b128 v[56:59], v12 offset:0
  ds_read_b128 v[60:63], v12 offset:1024
  ds_read_b128 v[64:67], v12 offset:2048
  ds_read_b128 v[68:71], v12 offset:3072
  ds_read_b128 v[72:75], v9 offset:1024
  ds_read_b128 v[76:79], v9 offset:3072
  ds_read_b128 v[80:83], v12 offset:8192
  ds_read_b128 v[84:87], v12 offset:9216
  ds_read_b128 v[88:91], v12 offset:10240
  ds_read_b128 v[92:95], v12 offset:11264
  s_mov_b32 s11, 2
  s_nop 0
.Lmixer_kernel_c1:
  s_waitcnt lgkmcnt(0)
  s_barrier
  v_mfma_f32_16x16x32_bf16 v[16:19], v[56:59], v[48:51], v[16:19]
  ds_read_b128 v[96:99], v9 offset:24576
  v_mfma_f32_16x16x32_bf16 v[32:35], v[56:59], v[52:55], v[32:35]
  ds_read_b128 v[100:103], v9 offset:26624
  v_mfma_f32_16x16x32_bf16 v[20:23], v[60:63], v[48:51], v[20:23]
  ds_read_b128 v[104:107], v12 offset:24576
  v_mfma_f32_16x16x32_bf16 v[36:39], v[60:63], v[52:55], v[36:39]
  ds_read_b128 v[108:111], v12 offset:25600
  v_mfma_f32_16x16x32_bf16 v[24:27], v[64:67], v[48:51], v[24:27]
  ds_read_b128 v[112:115], v12 offset:26624
  v_mfma_f32_16x16x32_bf16 v[40:43], v[64:67], v[52:55], v[40:43]
  ds_read_b128 v[116:119], v12 offset:27648
  v_mfma_f32_16x16x32_bf16 v[28:31], v[68:71], v[48:51], v[28:31]
  ds_read_b128 v[120:123], v9 offset:25600
  v_mfma_f32_16x16x32_bf16 v[44:47], v[68:71], v[52:55], v[44:47]
  ds_read_b128 v[124:127], v9 offset:27648
  v_mfma_f32_16x16x32_bf16 v[16:19], v[80:83], v[72:75], v[16:19]
  ds_read_b128 v[128:131], v12 offset:32768
  v_mfma_f32_16x16x32_bf16 v[32:35], v[80:83], v[76:79], v[32:35]
  ds_read_b128 v[132:135], v12 offset:33792
  v_mfma_f32_16x16x32_bf16 v[20:23], v[84:87], v[72:75], v[20:23]
  ds_read_b128 v[136:139], v12 offset:34816
  v_mfma_f32_16x16x32_bf16 v[36:39], v[84:87], v[76:79], v[36:39]
  ds_read_b128 v[140:143], v12 offset:35840
  v_mfma_f32_16x16x32_bf16 v[24:27], v[88:91], v[72:75], v[24:27]
  v_mfma_f32_16x16x32_bf16 v[40:43], v[88:91], v[76:79], v[40:43]
  v_mfma_f32_16x16x32_bf16 v[28:31], v[92:95], v[72:75], v[28:31]
  v_mfma_f32_16x16x32_bf16 v[44:47], v[92:95], v[76:79], v[44:47]
  s_waitcnt lgkmcnt(0)
  s_barrier
  v_mfma_f32_16x16x32_bf16 v[16:19], v[104:107], v[96:99], v[16:19]
  ds_read_b128 v[48:51], v10 offset:0
  v_mfma_f32_16x16x32_bf16 v[32:35], v[104:107], v[100:103], v[32:35]
  ds_read_b128 v[52:55], v10 offset:2048
  v_mfma_f32_16x16x32_bf16 v[20:23], v[108:111], v[96:99], v[20:23]
  ds_read_b128 v[56:59], v13 offset:0
  v_mfma_f32_16x16x32_bf16 v[36:39], v[108:111], v[100:103], v[36:39]
  ds_read_b128 v[60:63], v13 offset:1024
  v_mfma_f32_16x16x32_bf16 v[24:27], v[112:115], v[96:99], v[24:27]
  ds_read_b128 v[64:67], v13 offset:2048
  v_mfma_f32_16x16x32_bf16 v[40:43], v[112:115], v[100:103], v[40:43]
  ds_read_b128 v[68:71], v13 offset:3072
  v_mfma_f32_16x16x32_bf16 v[28:31], v[116:119], v[96:99], v[28:31]
  ds_read_b128 v[72:75], v10 offset:1024
  v_mfma_f32_16x16x32_bf16 v[44:47], v[116:119], v[100:103], v[44:47]
  ds_read_b128 v[76:79], v10 offset:3072
  v_mfma_f32_16x16x32_bf16 v[16:19], v[128:131], v[120:123], v[16:19]
  ds_read_b128 v[80:83], v13 offset:8192
  v_mfma_f32_16x16x32_bf16 v[32:35], v[128:131], v[124:127], v[32:35]
  ds_read_b128 v[84:87], v13 offset:9216
  v_mfma_f32_16x16x32_bf16 v[20:23], v[132:135], v[120:123], v[20:23]
  ds_read_b128 v[88:91], v13 offset:10240
  v_mfma_f32_16x16x32_bf16 v[36:39], v[132:135], v[124:127], v[36:39]
  ds_read_b128 v[92:95], v13 offset:11264
  v_mfma_f32_16x16x32_bf16 v[24:27], v[136:139], v[120:123], v[24:27]
  v_mfma_f32_16x16x32_bf16 v[40:43], v[136:139], v[124:127], v[40:43]
  v_mfma_f32_16x16x32_bf16 v[28:31], v[140:143], v[120:123], v[28:31]
  v_mfma_f32_16x16x32_bf16 v[44:47], v[140:143], v[124:127], v[44:47]
  s_waitcnt lgkmcnt(0)
  s_barrier
  v_mfma_f32_16x16x32_bf16 v[16:19], v[56:59], v[48:51], v[16:19]
  ds_read_b128 v[96:99], v10 offset:24576
  v_mfma_f32_16x16x32_bf16 v[32:35], v[56:59], v[52:55], v[32:35]
  ds_read_b128 v[100:103], v10 offset:26624
  v_mfma_f32_16x16x32_bf16 v[20:23], v[60:63], v[48:51], v[20:23]
  ds_read_b128 v[104:107], v13 offset:24576
  v_mfma_f32_16x16x32_bf16 v[36:39], v[60:63], v[52:55], v[36:39]
  ds_read_b128 v[108:111], v13 offset:25600
  v_mfma_f32_16x16x32_bf16 v[24:27], v[64:67], v[48:51], v[24:27]
  ds_read_b128 v[112:115], v13 offset:26624
  v_mfma_f32_16x16x32_bf16 v[40:43], v[64:67], v[52:55], v[40:43]
  ds_read_b128 v[116:119], v13 offset:27648
  v_mfma_f32_16x16x32_bf16 v[28:31], v[68:71], v[48:51], v[28:31]
  ds_read_b128 v[120:123], v10 offset:25600
  v_mfma_f32_16x16x32_bf16 v[44:47], v[68:71], v[52:55], v[44:47]
  ds_read_b128 v[124:127], v10 offset:27648
  v_mfma_f32_16x16x32_bf16 v[16:19], v[80:83], v[72:75], v[16:19]
  ds_read_b128 v[128:131], v13 offset:32768
  v_mfma_f32_16x16x32_bf16 v[32:35], v[80:83], v[76:79], v[32:35]
  ds_read_b128 v[132:135], v13 offset:33792
  v_mfma_f32_16x16x32_bf16 v[20:23], v[84:87], v[72:75], v[20:23]
  ds_read_b128 v[136:139], v13 offset:34816
  v_mfma_f32_16x16x32_bf16 v[36:39], v[84:87], v[76:79], v[36:39]
  ds_read_b128 v[140:143], v13 offset:35840
  v_mfma_f32_16x16x32_bf16 v[24:27], v[88:91], v[72:75], v[24:27]
  v_mfma_f32_16x16x32_bf16 v[40:43], v[88:91], v[76:79], v[40:43]
  v_mfma_f32_16x16x32_bf16 v[28:31], v[92:95], v[72:75], v[28:31]
  v_mfma_f32_16x16x32_bf16 v[44:47], v[92:95], v[76:79], v[44:47]
  s_waitcnt lgkmcnt(0)
  s_barrier
  v_mfma_f32_16x16x32_bf16 v[16:19], v[104:107], v[96:99], v[16:19]
  ds_read_b128 v[48:51], v11 offset:0
  v_mfma_f32_16x16x32_bf16 v[32:35], v[104:107], v[100:103], v[32:35]
  ds_read_b128 v[52:55], v11 offset:2048
  v_mfma_f32_16x16x32_bf16 v[20:23], v[108:111], v[96:99], v[20:23]
  ds_read_b128 v[56:59], v14 offset:0
  v_mfma_f32_16x16x32_bf16 v[36:39], v[108:111], v[100:103], v[36:39]
  ds_read_b128 v[60:63], v14 offset:1024
  v_mfma_f32_16x16x32_bf16 v[24:27], v[112:115], v[96:99], v[24:27]
  ds_read_b128 v[64:67], v14 offset:2048
  v_mfma_f32_16x16x32_bf16 v[40:43], v[112:115], v[100:103], v[40:43]
  ds_read_b128 v[68:71], v14 offset:3072
  v_mfma_f32_16x16x32_bf16 v[28:31], v[116:119], v[96:99], v[28:31]
  ds_read_b128 v[72:75], v11 offset:1024
  v_mfma_f32_16x16x32_bf16 v[44:47], v[116:119], v[100:103], v[44:47]
  ds_read_b128 v[76:79], v11 offset:3072
  v_mfma_f32_16x16x32_bf16 v[16:19], v[128:131], v[120:123], v[16:19]
  ds_read_b128 v[80:83], v14 offset:8192
  v_mfma_f32_16x16x32_bf16 v[32:35], v[128:131], v[124:127], v[32:35]
  ds_read_b128 v[84:87], v14 offset:9216
  v_mfma_f32_16x16x32_bf16 v[20:23], v[132:135], v[120:123], v[20:23]
  ds_read_b128 v[88:91], v14 offset:10240
  v_mfma_f32_16x16x32_bf16 v[36:39], v[132:135], v[124:127], v[36:39]
  ds_read_b128 v[92:95], v14 offset:11264
  v_mfma_f32_16x16x32_bf16 v[24:27], v[136:139], v[120:123], v[24:27]
  v_mfma_f32_16x16x32_bf16 v[40:43], v[136:139], v[124:127], v[40:43]
  v_mfma_f32_16x16x32_bf16 v[28:31], v[140:143], v[120:123], v[28:31]
  v_mfma_f32_16x16x32_bf16 v[44:47], v[140:143], v[124:127], v[44:47]
  s_waitcnt lgkmcnt(0)
  s_barrier
  v_mfma_f32_16x16x32_bf16 v[16:19], v[56:59], v[48:51], v[16:19]
  ds_read_b128 v[96:99], v11 offset:24576
  v_mfma_f32_16x16x32_bf16 v[32:35], v[56:59], v[52:55], v[32:35]
  ds_read_b128 v[100:103], v11 offset:26624
  v_mfma_f32_16x16x32_bf16 v[20:23], v[60:63], v[48:51], v[20:23]
  ds_read_b128 v[104:107], v14 offset:24576
  v_mfma_f32_16x16x32_bf16 v[36:39], v[60:63], v[52:55], v[36:39]
  ds_read_b128 v[108:111], v14 offset:25600
  v_mfma_f32_16x16x32_bf16 v[24:27], v[64:67], v[48:51], v[24:27]
  ds_read_b128 v[112:115], v14 offset:26624
  v_mfma_f32_16x16x32_bf16 v[40:43], v[64:67], v[52:55], v[40:43]
  ds_read_b128 v[116:119], v14 offset:27648
  v_mfma_f32_16x16x32_bf16 v[28:31], v[68:71], v[48:51], v[28:31]
  ds_read_b128 v[120:123], v11 offset:25600
  v_mfma_f32_16x16x32_bf16 v[44:47], v[68:71], v[52:55], v[44:47]
  ds_read_b128 v[124:127], v11 offset:27648
  v_mfma_f32_16x16x32_bf16 v[16:19], v[80:83], v[72:75], v[16:19]
  ds_read_b128 v[128:131], v14 offset:32768
  v_mfma_f32_16x16x32_bf16 v[32:35], v[80:83], v[76:79], v[32:35]
  ds_read_b128 v[132:135], v14 offset:33792
  v_mfma_f32_16x16x32_bf16 v[20:23], v[84:87], v[72:75], v[20:23]
  ds_read_b128 v[136:139], v14 offset:34816
  v_mfma_f32_16x16x32_bf16 v[36:39], v[84:87], v[76:79], v[36:39]
  ds_read_b128 v[140:143], v14 offset:35840
  v_mfma_f32_16x16x32_bf16 v[24:27], v[88:91], v[72:75], v[24:27]
  v_mfma_f32_16x16x32_bf16 v[40:43], v[88:91], v[76:79], v[40:43]
  v_mfma_f32_16x16x32_bf16 v[28:31], v[92:95], v[72:75], v[28:31]
  v_mfma_f32_16x16x32_bf16 v[44:47], v[92:95], v[76:79], v[44:47]
  s_waitcnt lgkmcnt(0)
  s_barrier
  v_mfma_f32_16x16x32_bf16 v[16:19], v[104:107], v[96:99], v[16:19]
  ds_read_b128 v[48:51], v9 offset:0
  v_mfma_f32_16x16x32_bf16 v[32:35], v[104:107], v[100:103], v[32:35]
  ds_read_b128 v[52:55], v9 offset:2048
  v_mfma_f32_16x16x32_bf16 v[20:23], v[108:111], v[96:99], v[20:23]
  ds_read_b128 v[56:59], v12 offset:0
  v_mfma_f32_16x16x32_bf16 v[36:39], v[108:111], v[100:103], v[36:39]
  ds_read_b128 v[60:63], v12 offset:1024
  v_mfma_f32_16x16x32_bf16 v[24:27], v[112:115], v[96:99], v[24:27]
  ds_read_b128 v[64:67], v12 offset:2048
  v_mfma_f32_16x16x32_bf16 v[40:43], v[112:115], v[100:103], v[40:43]
  ds_read_b128 v[68:71], v12 offset:3072
  v_mfma_f32_16x16x32_bf16 v[28:31], v[116:119], v[96:99], v[28:31]
  ds_read_b128 v[72:75], v9 offset:1024
  v_mfma_f32_16x16x32_bf16 v[44:47], v[116:119], v[100:103], v[44:47]
  ds_read_b128 v[76:79], v9 offset:3072
  v_mfma_f32_16x16x32_bf16 v[16:19], v[128:131], v[120:123], v[16:19]
  ds_read_b128 v[80:83], v12 offset:8192
  v_mfma_f32_16x16x32_bf16 v[32:35], v[128:131], v[124:127], v[32:35]
  ds_read_b128 v[84:87], v12 offset:9216
  v_mfma_f32_16x16x32_bf16 v[20:23], v[132:135], v[120:123], v[20:23]
  ds_read_b128 v[88:91], v12 offset:10240
  v_mfma_f32_16x16x32_bf16 v[36:39], v[132:135], v[124:127], v[36:39]
  ds_read_b128 v[92:95], v12 offset:11264
  v_mfma_f32_16x16x32_bf16 v[24:27], v[136:139], v[120:123], v[24:27]
  v_mfma_f32_16x16x32_bf16 v[40:43], v[136:139], v[124:127], v[40:43]
  v_mfma_f32_16x16x32_bf16 v[28:31], v[140:143], v[120:123], v[28:31]
  v_mfma_f32_16x16x32_bf16 v[44:47], v[140:143], v[124:127], v[44:47]
  s_sub_u32 s11, s11, 1
  s_cmp_lg_u32 s11, 0
  s_cbranch_scc1 .Lmixer_kernel_c1
  s_waitcnt lgkmcnt(0)
  s_barrier
  s_nop 0
  v_mfma_f32_16x16x32_bf16 v[16:19], v[56:59], v[48:51], v[16:19]
  ds_read_b128 v[96:99], v9 offset:24576
  v_mfma_f32_16x16x32_bf16 v[32:35], v[56:59], v[52:55], v[32:35]
  ds_read_b128 v[100:103], v9 offset:26624
  v_mfma_f32_16x16x32_bf16 v[20:23], v[60:63], v[48:51], v[20:23]
  ds_read_b128 v[104:107], v12 offset:24576
  v_mfma_f32_16x16x32_bf16 v[36:39], v[60:63], v[52:55], v[36:39]
  ds_read_b128 v[108:111], v12 offset:25600
  v_mfma_f32_16x16x32_bf16 v[24:27], v[64:67], v[48:51], v[24:27]
  ds_read_b128 v[112:115], v12 offset:26624
  v_mfma_f32_16x16x32_bf16 v[40:43], v[64:67], v[52:55], v[40:43]
  ds_read_b128 v[116:119], v12 offset:27648
  v_mfma_f32_16x16x32_bf16 v[28:31], v[68:71], v[48:51], v[28:31]
  ds_read_b128 v[120:123], v9 offset:25600
  v_mfma_f32_16x16x32_bf16 v[44:47], v[68:71], v[52:55], v[44:47]
  ds_read_b128 v[124:127], v9 offset:27648
  v_mfma_f32_16x16x32_bf16 v[16:19], v[80:83], v[72:75], v[16:19]
  ds_read_b128 v[128:131], v12 offset:32768
  v_mfma_f32_16x16x32_bf16 v[32:35], v[80:83], v[76:79], v[32:35]
  ds_read_b128 v[132:135], v12 offset:33792
  v_mfma_f32_16x16x32_bf16 v[20:23], v[84:87], v[72:75], v[20:23]
  ds_read_b128 v[136:139], v12 offset:34816
  v_lshlrev_b32 v4, 4, v2
  v_mfma_f32_16x16x32_bf16 v[36:39], v[84:87], v[76:79], v[36:39]
  ds_read_b128 v[140:143], v12 offset:35840
  s_lshl_b32 s43, s38, 8
  v_mfma_f32_16x16x32_bf16 v[24:27], v[88:91], v[72:75], v[24:27]
  buffer_load_dwordx2 v[144:145], v4, s[24:27], s43 offen offset:0 sc1
  v_mfma_f32_16x16x32_bf16 v[40:43], v[88:91], v[76:79], v[40:43]
  buffer_load_dwordx2 v[146:147], v4, s[24:27], s43 offen offset:256 sc1
  v_mfma_f32_16x16x32_bf16 v[28:31], v[92:95], v[72:75], v[28:31]
  v_mfma_f32_16x16x32_bf16 v[44:47], v[92:95], v[76:79], v[44:47]
  s_waitcnt lgkmcnt(0)
  s_barrier
  v_mfma_f32_16x16x32_bf16 v[16:19], v[104:107], v[96:99], v[16:19]
  ds_read_b128 v[48:51], v10 offset:0
  v_mfma_f32_16x16x32_bf16 v[32:35], v[104:107], v[100:103], v[32:35]
  ds_read_b128 v[52:55], v10 offset:2048
  v_mfma_f32_16x16x32_bf16 v[20:23], v[108:111], v[96:99], v[20:23]
  ds_read_b128 v[56:59], v13 offset:0
  v_mfma_f32_16x16x32_bf16 v[36:39], v[108:111], v[100:103], v[36:39]
  ds_read_b128 v[60:63], v13 offset:1024
  v_mfma_f32_16x16x32_bf16 v[24:27], v[112:115], v[96:99], v[24:27]
  ds_read_b128 v[64:67], v13 offset:2048
  v_mfma_f32_16x16x32_bf16 v[40:43], v[112:115], v[100:103], v[40:43]
  ds_read_b128 v[68:71], v13 offset:3072
  v_mfma_f32_16x16x32_bf16 v[28:31], v[116:119], v[96:99], v[28:31]
  ds_read_b128 v[72:75], v10 offset:1024
  v_mfma_f32_16x16x32_bf16 v[44:47], v[116:119], v[100:103], v[44:47]
  ds_read_b128 v[76:79], v10 offset:3072
  v_mfma_f32_16x16x32_bf16 v[16:19], v[128:131], v[120:123], v[16:19]
  ds_read_b128 v[80:83], v13 offset:8192
  v_mfma_f32_16x16x32_bf16 v[32:35], v[128:131], v[124:127], v[32:35]
  ds_read_b128 v[84:87], v13 offset:9216
  v_mfma_f32_16x16x32_bf16 v[20:23], v[132:135], v[120:123], v[20:23]
  ds_read_b128 v[88:91], v13 offset:10240
  v_mfma_f32_16x16x32_bf16 v[36:39], v[132:135], v[124:127], v[36:39]
  ds_read_b128 v[92:95], v13 offset:11264
  v_mfma_f32_16x16x32_bf16 v[24:27], v[136:139], v[120:123], v[24:27]
  v_mfma_f32_16x16x32_bf16 v[40:43], v[136:139], v[124:127], v[40:43]
  v_mfma_f32_16x16x32_bf16 v[28:31], v[140:143], v[120:123], v[28:31]
  v_mfma_f32_16x16x32_bf16 v[44:47], v[140:143], v[124:127], v[44:47]
  s_waitcnt lgkmcnt(0)
  s_barrier
  v_mfma_f32_16x16x32_bf16 v[16:19], v[56:59], v[48:51], v[16:19]
  ds_read_b128 v[96:99], v10 offset:24576
  v_mfma_f32_16x16x32_bf16 v[32:35], v[56:59], v[52:55], v[32:35]
  ds_read_b128 v[100:103], v10 offset:26624
  v_mfma_f32_16x16x32_bf16 v[20:23], v[60:63], v[48:51], v[20:23]
  ds_read_b128 v[104:107], v13 offset:24576
  v_mfma_f32_16x16x32_bf16 v[36:39], v[60:63], v[52:55], v[36:39]
  ds_read_b128 v[108:111], v13 offset:25600
  v_mfma_f32_16x16x32_bf16 v[24:27], v[64:67], v[48:51], v[24:27]
  ds_read_b128 v[112:115], v13 offset:26624
  v_mfma_f32_16x16x32_bf16 v[40:43], v[64:67], v[52:55], v[40:43]
  ds_read_b128 v[116:119], v13 offset:27648
  v_mfma_f32_16x16x32_bf16 v[28:31], v[68:71], v[48:51], v[28:31]
  ds_read_b128 v[120:123], v10 offset:25600
  v_mfma_f32_16x16x32_bf16 v[44:47], v[68:71], v[52:55], v[44:47]
  ds_read_b128 v[124:127], v10 offset:27648
  v_mfma_f32_16x16x32_bf16 v[16:19], v[80:83], v[72:75], v[16:19]
  ds_read_b128 v[128:131], v13 offset:32768
  v_mfma_f32_16x16x32_bf16 v[32:35], v[80:83], v[76:79], v[32:35]
  ds_read_b128 v[132:135], v13 offset:33792
  v_mfma_f32_16x16x32_bf16 v[20:23], v[84:87], v[72:75], v[20:23]
  ds_read_b128 v[136:139], v13 offset:34816
  v_mfma_f32_16x16x32_bf16 v[36:39], v[84:87], v[76:79], v[36:39]
  ds_read_b128 v[140:143], v13 offset:35840
  v_mfma_f32_16x16x32_bf16 v[24:27], v[88:91], v[72:75], v[24:27]
  v_mfma_f32_16x16x32_bf16 v[40:43], v[88:91], v[76:79], v[40:43]
  v_mfma_f32_16x16x32_bf16 v[28:31], v[92:95], v[72:75], v[28:31]
  v_mfma_f32_16x16x32_bf16 v[44:47], v[92:95], v[76:79], v[44:47]
  s_waitcnt lgkmcnt(0)
  s_nop 0
  v_mfma_f32_16x16x32_bf16 v[16:19], v[104:107], v[96:99], v[16:19]
  v_mfma_f32_16x16x32_bf16 v[32:35], v[104:107], v[100:103], v[32:35]
  v_mfma_f32_16x16x32_bf16 v[20:23], v[108:111], v[96:99], v[20:23]
  v_mfma_f32_16x16x32_bf16 v[36:39], v[108:111], v[100:103], v[36:39]
  v_mfma_f32_16x16x32_bf16 v[24:27], v[112:115], v[96:99], v[24:27]
  v_mfma_f32_16x16x32_bf16 v[40:43], v[112:115], v[100:103], v[40:43]
  v_mfma_f32_16x16x32_bf16 v[28:31], v[116:119], v[96:99], v[28:31]
  v_mfma_f32_16x16x32_bf16 v[44:47], v[116:119], v[100:103], v[44:47]
  v_mfma_f32_16x16x32_bf16 v[16:19], v[128:131], v[120:123], v[16:19]
  v_mfma_f32_16x16x32_bf16 v[32:35], v[128:131], v[124:127], v[32:35]
  v_mfma_f32_16x16x32_bf16 v[20:23], v[132:135], v[120:123], v[20:23]
  v_mfma_f32_16x16x32_bf16 v[36:39], v[132:135], v[124:127], v[36:39]
  v_mfma_f32_16x16x32_bf16 v[24:27], v[136:139], v[120:123], v[24:27]
  v_mfma_f32_16x16x32_bf16 v[40:43], v[136:139], v[124:127], v[40:43]
  v_mfma_f32_16x16x32_bf16 v[28:31], v[140:143], v[120:123], v[28:31]
  v_mfma_f32_16x16x32_bf16 v[44:47], v[140:143], v[124:127], v[44:47]
  s_barrier
  v_lshlrev_b32 v4, 4, v3
  v_add_u32 v4, 147456, v4
  s_lshl_b32 s44, s48, 8
  v_add_u32 v4, s44, v4
  ds_read_b128 v[152:155], v4 offset:0
  ds_read_b128 v[156:159], v4 offset:64
  ds_read_b128 v[160:163], v4 offset:128
  ds_read_b128 v[164:167], v4 offset:192
  s_waitcnt vmcnt(0) lgkmcnt(0)
  v_rcp_f32 v4, v145
  s_nop 0
  v_mul_f32 v148, 0xc0135761, v4
  v_mul_f32 v5, v4, v4
  v_mul_f32 v5, v5, v4
  v_mul_f32 v149, 0xbdd2d3e8, v5
  v_rcp_f32 v4, v147
  s_nop 0
  v_mul_f32 v150, 0xc0135761, v4
  v_mul_f32 v5, v4, v4
  v_mul_f32 v5, v5, v4
  v_mul_f32 v151, 0xbdd2d3e8, v5
  s_lshl_b32 s43, s38, 15
  s_lshl_b32 s44, s37, 11
  s_add_u32 s43, s43, s44
  s_add_u32 s44, s43, 32768
  v_pk_fma_f32 v[16:17], v[152:153], v[144:145], v[16:17] op_sel:[0,0,0] op_sel_hi:[1,0,1] neg_lo:[1,0,0] neg_hi:[1,0,0]
  v_pk_fma_f32 v[18:19], v[154:155], v[144:145], v[18:19] op_sel:[0,0,0] op_sel_hi:[1,0,1] neg_lo:[1,0,0] neg_hi:[1,0,0]
  v_pk_fma_f32 v[20:21], v[156:157], v[144:145], v[20:21] op_sel:[0,0,0] op_sel_hi:[1,0,1] neg_lo:[1,0,0] neg_hi:[1,0,0]
  v_pk_fma_f32 v[22:23], v[158:159], v[144:145], v[22:23] op_sel:[0,0,0] op_sel_hi:[1,0,1] neg_lo:[1,0,0] neg_hi:[1,0,0]
  v_pk_mul_f32 v[168:169], v[16:17], v[16:17]
  v_pk_mul_f32 v[172:173], v[18:19], v[18:19]
  v_pk_mul_f32 v[176:177], v[20:21], v[20:21]
  v_pk_mul_f32 v[180:181], v[22:23], v[22:23]
  v_pk_fma_f32 v[168:169], v[168:169], v[148:149], v[148:149] op_sel:[0,1,0] op_sel_hi:[1,1,0]
  v_pk_fma_f32 v[172:173], v[172:173], v[148:149], v[148:149] op_sel:[0,1,0] op_sel_hi:[1,1,0]
  v_pk_fma_f32 v[176:177], v[176:177], v[148:149], v[148:149] op_sel:[0,1,0] op_sel_hi:[1,1,0]
  v_pk_fma_f32 v[180:181], v[180:181], v[148:149], v[148:149] op_sel:[0,1,0] op_sel_hi:[1,1,0]
  v_pk_mul_f32 v[168:169], v[16:17], v[168:169]
  v_pk_mul_f32 v[172:173], v[18:19], v[172:173]
  v_pk_mul_f32 v[176:177], v[20:21], v[176:177]
  v_pk_mul_f32 v[180:181], v[22:23], v[180:181]
  v_exp_f32 v170, v168
  v_exp_f32 v174, v172
  v_exp_f32 v178, v176
  v_exp_f32 v182, v180
  v_exp_f32 v171, v169
  v_exp_f32 v175, v173
  v_exp_f32 v179, v177
  v_exp_f32 v183, v181
  v_pk_fma_f32 v[170:171], v[170:171], v[144:145], v[144:145] op_sel:[0,1,1] op_sel_hi:[1,1,1]
  v_pk_fma_f32 v[174:175], v[174:175], v[144:145], v[144:145] op_sel:[0,1,1] op_sel_hi:[1,1,1]
  v_pk_fma_f32 v[178:179], v[178:179], v[144:145], v[144:145] op_sel:[0,1,1] op_sel_hi:[1,1,1]
  v_pk_fma_f32 v[182:183], v[182:183], v[144:145], v[144:145] op_sel:[0,1,1] op_sel_hi:[1,1,1]
  v_rcp_f32 v168, v170
  v_rcp_f32 v172, v174
  v_rcp_f32 v176, v178
  v_rcp_f32 v180, v182
  v_rcp_f32 v169, v171
  v_rcp_f32 v173, v175
  v_rcp_f32 v177, v179
  v_rcp_f32 v181, v183
  v_pk_mul_f32 v[16:17], v[16:17], v[168:169]
  v_pk_mul_f32 v[18:19], v[18:19], v[172:173]
  v_pk_mul_f32 v[20:21], v[20:21], v[176:177]
  v_pk_mul_f32 v[22:23], v[22:23], v[180:181]
  v_cvt_pk_bf16_f32 v184, v16, v17
  v_cvt_pk_bf16_f32 v185, v18, v19
  v_cvt_pk_bf16_f32 v186, v20, v21
  v_cvt_pk_bf16_f32 v187, v22, v23
  buffer_store_dwordx4 v[184:187], v7, s[32:35], s43 offen offset:0 sc1
  v_pk_fma_f32 v[32:33], v[152:153], v[146:147], v[32:33] op_sel:[0,0,0] op_sel_hi:[1,0,1] neg_lo:[1,0,0] neg_hi:[1,0,0]
  v_pk_fma_f32 v[34:35], v[154:155], v[146:147], v[34:35] op_sel:[0,0,0] op_sel_hi:[1,0,1] neg_lo:[1,0,0] neg_hi:[1,0,0]
  v_pk_fma_f32 v[36:37], v[156:157], v[146:147], v[36:37] op_sel:[0,0,0] op_sel_hi:[1,0,1] neg_lo:[1,0,0] neg_hi:[1,0,0]
  v_pk_fma_f32 v[38:39], v[158:159], v[146:147], v[38:39] op_sel:[0,0,0] op_sel_hi:[1,0,1] neg_lo:[1,0,0] neg_hi:[1,0,0]
  v_pk_mul_f32 v[168:169], v[32:33], v[32:33]
  v_pk_mul_f32 v[172:173], v[34:35], v[34:35]
  v_pk_mul_f32 v[176:177], v[36:37], v[36:37]
  v_pk_mul_f32 v[180:181], v[38:39], v[38:39]
  v_pk_fma_f32 v[168:169], v[168:169], v[150:151], v[150:151] op_sel:[0,1,0] op_sel_hi:[1,1,0]
  v_pk_fma_f32 v[172:173], v[172:173], v[150:151], v[150:151] op_sel:[0,1,0] op_sel_hi:[1,1,0]
  v_pk_fma_f32 v[176:177], v[176:177], v[150:151], v[150:151] op_sel:[0,1,0] op_sel_hi:[1,1,0]
  v_pk_fma_f32 v[180:181], v[180:181], v[150:151], v[150:151] op_sel:[0,1,0] op_sel_hi:[1,1,0]
  v_pk_mul_f32 v[168:169], v[32:33], v[168:169]
  v_pk_mul_f32 v[172:173], v[34:35], v[172:173]
  v_pk_mul_f32 v[176:177], v[36:37], v[176:177]
  v_pk_mul_f32 v[180:181], v[38:39], v[180:181]
  v_exp_f32 v170, v168
  v_exp_f32 v174, v172
  v_exp_f32 v178, v176
  v_exp_f32 v182, v180
  v_exp_f32 v171, v169
  v_exp_f32 v175, v173
  v_exp_f32 v179, v177
  v_exp_f32 v183, v181
  v_pk_fma_f32 v[170:171], v[170:171], v[146:147], v[146:147] op_sel:[0,1,1] op_sel_hi:[1,1,1]
  v_pk_fma_f32 v[174:175], v[174:175], v[146:147], v[146:147] op_sel:[0,1,1] op_sel_hi:[1,1,1]
  v_pk_fma_f32 v[178:179], v[178:179], v[146:147], v[146:147] op_sel:[0,1,1] op_sel_hi:[1,1,1]
  v_pk_fma_f32 v[182:183], v[182:183], v[146:147], v[146:147] op_sel:[0,1,1] op_sel_hi:[1,1,1]
  v_rcp_f32 v168, v170
  v_rcp_f32 v172, v174
  v_rcp_f32 v176, v178
  v_rcp_f32 v180, v182
  v_rcp_f32 v169, v171
  v_rcp_f32 v173, v175
  v_rcp_f32 v177, v179
  v_rcp_f32 v181, v183
  v_pk_mul_f32 v[32:33], v[32:33], v[168:169]
  v_pk_mul_f32 v[34:35], v[34:35], v[172:173]
  v_pk_mul_f32 v[36:37], v[36:37], v[176:177]
  v_pk_mul_f32 v[38:39], v[38:39], v[180:181]
  v_cvt_pk_bf16_f32 v188, v32, v33
  v_cvt_pk_bf16_f32 v189, v34, v35
  v_cvt_pk_bf16_f32 v190, v36, v37
  v_cvt_pk_bf16_f32 v191, v38, v39
  buffer_store_dwordx4 v[188:191], v7, s[32:35], s44 offen offset:0 sc1
  v_pk_fma_f32 v[24:25], v[160:161], v[144:145], v[24:25] op_sel:[0,0,0] op_sel_hi:[1,0,1] neg_lo:[1,0,0] neg_hi:[1,0,0]
  v_pk_fma_f32 v[26:27], v[162:163], v[144:145], v[26:27] op_sel:[0,0,0] op_sel_hi:[1,0,1] neg_lo:[1,0,0] neg_hi:[1,0,0]
  v_pk_fma_f32 v[28:29], v[164:165], v[144:145], v[28:29] op_sel:[0,0,0] op_sel_hi:[1,0,1] neg_lo:[1,0,0] neg_hi:[1,0,0]
  v_pk_fma_f32 v[30:31], v[166:167], v[144:145], v[30:31] op_sel:[0,0,0] op_sel_hi:[1,0,1] neg_lo:[1,0,0] neg_hi:[1,0,0]
  v_pk_mul_f32 v[168:169], v[24:25], v[24:25]
  v_pk_mul_f32 v[172:173], v[26:27], v[26:27]
  v_pk_mul_f32 v[176:177], v[28:29], v[28:29]
  v_pk_mul_f32 v[180:181], v[30:31], v[30:31]
  v_pk_fma_f32 v[168:169], v[168:169], v[148:149], v[148:149] op_sel:[0,1,0] op_sel_hi:[1,1,0]
  v_pk_fma_f32 v[172:173], v[172:173], v[148:149], v[148:149] op_sel:[0,1,0] op_sel_hi:[1,1,0]
  v_pk_fma_f32 v[176:177], v[176:177], v[148:149], v[148:149] op_sel:[0,1,0] op_sel_hi:[1,1,0]
  v_pk_fma_f32 v[180:181], v[180:181], v[148:149], v[148:149] op_sel:[0,1,0] op_sel_hi:[1,1,0]
  v_pk_mul_f32 v[168:169], v[24:25], v[168:169]
  v_pk_mul_f32 v[172:173], v[26:27], v[172:173]
  v_pk_mul_f32 v[176:177], v[28:29], v[176:177]
  v_pk_mul_f32 v[180:181], v[30:31], v[180:181]
  v_exp_f32 v170, v168
  v_exp_f32 v174, v172
  v_exp_f32 v178, v176
  v_exp_f32 v182, v180
  v_exp_f32 v171, v169
  v_exp_f32 v175, v173
  v_exp_f32 v179, v177
  v_exp_f32 v183, v181
  v_pk_fma_f32 v[170:171], v[170:171], v[144:145], v[144:145] op_sel:[0,1,1] op_sel_hi:[1,1,1]
  v_pk_fma_f32 v[174:175], v[174:175], v[144:145], v[144:145] op_sel:[0,1,1] op_sel_hi:[1,1,1]
  v_pk_fma_f32 v[178:179], v[178:179], v[144:145], v[144:145] op_sel:[0,1,1] op_sel_hi:[1,1,1]
  v_pk_fma_f32 v[182:183], v[182:183], v[144:145], v[144:145] op_sel:[0,1,1] op_sel_hi:[1,1,1]
  v_rcp_f32 v168, v170
  v_rcp_f32 v172, v174
  v_rcp_f32 v176, v178
  v_rcp_f32 v180, v182
  v_rcp_f32 v169, v171
  v_rcp_f32 v173, v175
  v_rcp_f32 v177, v179
  v_rcp_f32 v181, v183
  v_pk_mul_f32 v[24:25], v[24:25], v[168:169]
  v_pk_mul_f32 v[26:27], v[26:27], v[172:173]
  v_pk_mul_f32 v[28:29], v[28:29], v[176:177]
  v_pk_mul_f32 v[30:31], v[30:31], v[180:181]
  v_cvt_pk_bf16_f32 v192, v24, v25
  v_cvt_pk_bf16_f32 v193, v26, v27
  v_cvt_pk_bf16_f32 v194, v28, v29
  v_cvt_pk_bf16_f32 v195, v30, v31
  buffer_store_dwordx4 v[192:195], v7, s[32:35], s43 offen offset:1024 sc1
  v_pk_fma_f32 v[40:41], v[160:161], v[146:147], v[40:41] op_sel:[0,0,0] op_sel_hi:[1,0,1] neg_lo:[1,0,0] neg_hi:[1,0,0]
  v_pk_fma_f32 v[42:43], v[162:163], v[146:147], v[42:43] op_sel:[0,0,0] op_sel_hi:[1,0,1] neg_lo:[1,0,0] neg_hi:[1,0,0]
  v_pk_fma_f32 v[44:45], v[164:165], v[146:147], v[44:45] op_sel:[0,0,0] op_sel_hi:[1,0,1] neg_lo:[1,0,0] neg_hi:[1,0,0]
  v_pk_fma_f32 v[46:47], v[166:167], v[146:147], v[46:47] op_sel:[0,0,0] op_sel_hi:[1,0,1] neg_lo:[1,0,0] neg_hi:[1,0,0]
  v_pk_mul_f32 v[168:169], v[40:41], v[40:41]
  v_pk_mul_f32 v[172:173], v[42:43], v[42:43]
  v_pk_mul_f32 v[176:177], v[44:45], v[44:45]
  v_pk_mul_f32 v[180:181], v[46:47], v[46:47]
  v_pk_fma_f32 v[168:169], v[168:169], v[150:151], v[150:151] op_sel:[0,1,0] op_sel_hi:[1,1,0]
  v_pk_fma_f32 v[172:173], v[172:173], v[150:151], v[150:151] op_sel:[0,1,0] op_sel_hi:[1,1,0]
  v_pk_fma_f32 v[176:177], v[176:177], v[150:151], v[150:151] op_sel:[0,1,0] op_sel_hi:[1,1,0]
  v_pk_fma_f32 v[180:181], v[180:181], v[150:151], v[150:151] op_sel:[0,1,0] op_sel_hi:[1,1,0]
  v_pk_mul_f32 v[168:169], v[40:41], v[168:169]
  v_pk_mul_f32 v[172:173], v[42:43], v[172:173]
  v_pk_mul_f32 v[176:177], v[44:45], v[176:177]
  v_pk_mul_f32 v[180:181], v[46:47], v[180:181]
  v_exp_f32 v170, v168
  v_exp_f32 v174, v172
  v_exp_f32 v178, v176
  v_exp_f32 v182, v180
  v_exp_f32 v171, v169
  v_exp_f32 v175, v173
  v_exp_f32 v179, v177
  v_exp_f32 v183, v181
  v_pk_fma_f32 v[170:171], v[170:171], v[146:147], v[146:147] op_sel:[0,1,1] op_sel_hi:[1,1,1]
  v_pk_fma_f32 v[174:175], v[174:175], v[146:147], v[146:147] op_sel:[0,1,1] op_sel_hi:[1,1,1]
  v_pk_fma_f32 v[178:179], v[178:179], v[146:147], v[146:147] op_sel:[0,1,1] op_sel_hi:[1,1,1]
  v_pk_fma_f32 v[182:183], v[182:183], v[146:147], v[146:147] op_sel:[0,1,1] op_sel_hi:[1,1,1]
  v_rcp_f32 v168, v170
  v_rcp_f32 v172, v174
  v_rcp_f32 v176, v178
  v_rcp_f32 v180, v182
  v_rcp_f32 v169, v171
  v_rcp_f32 v173, v175
  v_rcp_f32 v177, v179
  v_rcp_f32 v181, v183
  v_pk_mul_f32 v[40:41], v[40:41], v[168:169]
  v_pk_mul_f32 v[42:43], v[42:43], v[172:173]
  v_pk_mul_f32 v[44:45], v[44:45], v[176:177]
  v_pk_mul_f32 v[46:47], v[46:47], v[180:181]
  v_cvt_pk_bf16_f32 v196, v40, v41
  v_cvt_pk_bf16_f32 v197, v42, v43
  v_cvt_pk_bf16_f32 v198, v44, v45
  v_cvt_pk_bf16_f32 v199, v46, v47
  buffer_store_dwordx4 v[196:199], v7, s[32:35], s44 offen offset:1024 sc1
  s_waitcnt vmcnt(0) lgkmcnt(0)
  s_barrier
  s_cmp_lg_u32 s10, 3
  s_cbranch_scc1 .Lmixer_kernel_sig1
  s_lshl_b32 s43, s36, 12
  s_lshl_b32 s47, s49, 2
  s_add_u32 s43, s43, s47
  v_lshlrev_b32 v4, 8, v1
  s_add_u32 s43, s43, 77824
  v_lshlrev_b32 v5, 6, v3
  v_sub_u32 v4, v4, v5
  v_add_u32 v4, 128, v4
  s_add_u32 s47, s36, -1
  v_add_u32 v5, s47, v3
  v_cmp_gt_u32 vcc, 16, v5
  s_nop 0
  s_and_b32 vcc_hi, vcc_hi, 0xffff
  s_mov_b64 exec, vcc
  buffer_store_dword v8, v4, s[12:15], s43 offen sc1
  s_mov_b64 exec, -1
.Lmixer_kernel_sig1:
  s_and_b32 s43, s2, 7
  s_lshr_b32 s44, s2, 3
  s_lshr_b32 s36, s43, 2
  s_lshl_b32 s36, s36, 3
  s_lshr_b32 s45, s44, 2
  s_add_u32 s36, s36, s45
  s_and_b32 s37, s43, 2
  s_lshl_b32 s37, s37, 1
  s_and_b32 s45, s44, 3
  s_add_u32 s37, s37, s45
  s_lshl_b32 s37, s37, 1
  s_and_b32 s45, s2, 1
  s_add_u32 s37, s37, s45
  s_lshr_b32 s45, s10, 1
  s_and_b32 s48, s10, 1
  s_and_b32 s46, s2, 1
  s_lshl_b32 s43, s45, 1
  s_add_u32 s43, s43, s46
  s_lshl_b32 s38, s36, 2
  s_add_u32 s38, s38, s43
  s_lshl_b32 s38, s38, 1
  s_lshl_b32 s45, s45, 12
  s_add_u32 s45, s45, 16384
  v_add_u32 v9, s45, v7
  s_lshl_b32 s43, s48, 12
  v_add_u32 v12, s43, v7
  s_mov_b32 s49, s37
  s_and_b32 s37, s37, 14
  s_add_u32 s37, s37, s48
  v_add_u32 v10, 49152, v9
  v_add_u32 v13, 49152, v12
  v_add_u32 v11, 98304, v9
  v_add_u32 v14, 98304, v12
  v_mov_b32 v16, 0
  v_mov_b32 v17, 0
  v_mov_b32 v18, 0
  v_mov_b32 v19, 0
  v_mov_b32 v20, 0
  v_mov_b32 v21, 0
  v_mov_b32 v22, 0
  v_mov_b32 v23, 0
  v_mov_b32 v24, 0
  v_mov_b32 v25, 0
  v_mov_b32 v26, 0
  v_mov_b32 v27, 0
  v_mov_b32 v28, 0
  v_mov_b32 v29, 0
  v_mov_b32 v30, 0
  v_mov_b32 v31, 0
  v_mov_b32 v32, 0
  v_mov_b32 v33, 0
  v_mov_b32 v34, 0
  v_mov_b32 v35, 0
  v_mov_b32 v36, 0
  v_mov_b32 v37, 0
  v_mov_b32 v38, 0
  v_mov_b32 v39, 0
  v_mov_b32 v40, 0
  v_mov_b32 v41, 0
  v_mov_b32 v42, 0
  v_mov_b32 v43, 0
  v_mov_b32 v44, 0
  v_mov_b32 v45, 0
  v_mov_b32 v46, 0
  v_mov_b32 v47, 0
  s_add_u32 s28, s4, 0x2b10000
  s_addc_u32 s29, s5, 0
  s_nop 0
  s_mov_b32 s30, 0x40000
  s_mov_b32 s31, 0x20000
  s_add_u32 s32, s4, 0x1900000
  s_addc_u32 s33, s5, 0
  s_mov_b32 s34, 0x400000
  s_mov_b32 s35, 0x20000
  s_barrier
  s_barrier
  s_nop 0
  ds_read_b128 v[48:51], v11 offset:0
  ds_read_b128 v[52:55], v11 offset:2048
  ds_read_b128 v[56:59], v14 offset:0
  ds_read_b128 v[60:63], v14 offset:1024
  ds_read_b128 v[64:67], v14 offset:2048
  ds_read_b128 v[68:71], v14 offset:3072
  ds_read_b128 v[72:75], v11 offset:1024
  ds_read_b128 v[76:79], v11 offset:3072
  ds_read_b128 v[80:83], v14 offset:8192
  ds_read_b128 v[84:87], v14 offset:9216
  ds_read_b128 v[88:91], v14 offset:10240
  ds_read_b128 v[92:95], v14 offset:11264
  s_mov_b32 s11, 2
  s_nop 0
.Lmixer_kernel_c2:
  s_waitcnt lgkmcnt(0)
  s_barrier
  v_mfma_f32_16x16x32_bf16 v[16:19], v[56:59], v[48:51], v[16:19]
  ds_read_b128 v[96:99], v11 offset:24576
  v_mfma_f32_16x16x32_bf16 v[32:35], v[56:59], v[52:55], v[32:35]
  ds_read_b128 v[100:103], v11 offset:26624
  v_mfma_f32_16x16x32_bf16 v[20:23], v[60:63], v[48:51], v[20:23]
  ds_read_b128 v[104:107], v14 offset:24576
  v_mfma_f32_16x16x32_bf16 v[36:39], v[60:63], v[52:55], v[36:39]
  ds_read_b128 v[108:111], v14 offset:25600
  v_mfma_f32_16x16x32_bf16 v[24:27], v[64:67], v[48:51], v[24:27]
  ds_read_b128 v[112:115], v14 offset:26624
  v_mfma_f32_16x16x32_bf16 v[40:43], v[64:67], v[52:55], v[40:43]
  ds_read_b128 v[116:119], v14 offset:27648
  v_mfma_f32_16x16x32_bf16 v[28:31], v[68:71], v[48:51], v[28:31]
  ds_read_b128 v[120:123], v11 offset:25600
  v_mfma_f32_16x16x32_bf16 v[44:47], v[68:71], v[52:55], v[44:47]
  ds_read_b128 v[124:127], v11 offset:27648
  v_mfma_f32_16x16x32_bf16 v[16:19], v[80:83], v[72:75], v[16:19]
  ds_read_b128 v[128:131], v14 offset:32768
  v_mfma_f32_16x16x32_bf16 v[32:35], v[80:83], v[76:79], v[32:35]
  ds_read_b128 v[132:135], v14 offset:33792
  v_mfma_f32_16x16x32_bf16 v[20:23], v[84:87], v[72:75], v[20:23]
  ds_read_b128 v[136:139], v14 offset:34816
  v_mfma_f32_16x16x32_bf16 v[36:39], v[84:87], v[76:79], v[36:39]
  ds_read_b128 v[140:143], v14 offset:35840
  v_mfma_f32_16x16x32_bf16 v[24:27], v[88:91], v[72:75], v[24:27]
  v_mfma_f32_16x16x32_bf16 v[40:43], v[88:91], v[76:79], v[40:43]
  v_mfma_f32_16x16x32_bf16 v[28:31], v[92:95], v[72:75], v[28:31]
  v_mfma_f32_16x16x32_bf16 v[44:47], v[92:95], v[76:79], v[44:47]
  s_waitcnt lgkmcnt(0)
  s_barrier
  v_mfma_f32_16x16x32_bf16 v[16:19], v[104:107], v[96:99], v[16:19]
  ds_read_b128 v[48:51], v9 offset:0
  v_mfma_f32_16x16x32_bf16 v[32:35], v[104:107], v[100:103], v[32:35]
  ds_read_b128 v[52:55], v9 offset:2048
  v_mfma_f32_16x16x32_bf16 v[20:23], v[108:111], v[96:99], v[20:23]
  ds_read_b128 v[56:59], v12 offset:0
  v_mfma_f32_16x16x32_bf16 v[36:39], v[108:111], v[100:103], v[36:39]
  ds_read_b128 v[60:63], v12 offset:1024
  v_mfma_f32_16x16x32_bf16 v[24:27], v[112:115], v[96:99], v[24:27]
  ds_read_b128 v[64:67], v12 offset:2048
  v_mfma_f32_16x16x32_bf16 v[40:43], v[112:115], v[100:103], v[40:43]
  ds_read_b128 v[68:71], v12 offset:3072
  v_mfma_f32_16x16x32_bf16 v[28:31], v[116:119], v[96:99], v[28:31]
  ds_read_b128 v[72:75], v9 offset:1024
  v_mfma_f32_16x16x32_bf16 v[44:47], v[116:119], v[100:103], v[44:47]
  ds_read_b128 v[76:79], v9 offset:3072
  v_mfma_f32_16x16x32_bf16 v[16:19], v[128:131], v[120:123], v[16:19]
  ds_read_b128 v[80:83], v12 offset:8192
  v_mfma_f32_16x16x32_bf16 v[32:35], v[128:131], v[124:127], v[32:35]
  ds_read_b128 v[84:87], v12 offset:9216
  v_mfma_f32_16x16x32_bf16 v[20:23], v[132:135], v[120:123], v[20:23]
  ds_read_b128 v[88:91], v12 offset:10240
  v_mfma_f32_16x16x32_bf16 v[36:39], v[132:135], v[124:127], v[36:39]
  ds_read_b128 v[92:95], v12 offset:11264
  v_mfma_f32_16x16x32_bf16 v[24:27], v[136:139], v[120:123], v[24:27]
  v_mfma_f32_16x16x32_bf16 v[40:43], v[136:139], v[124:127], v[40:43]
  v_mfma_f32_16x16x32_bf16 v[28:31], v[140:143], v[120:123], v[28:31]
  v_mfma_f32_16x16x32_bf16 v[44:47], v[140:143], v[124:127], v[44:47]
  s_waitcnt lgkmcnt(0)
  s_barrier
  v_mfma_f32_16x16x32_bf16 v[16:19], v[56:59], v[48:51], v[16:19]
  ds_read_b128 v[96:99], v9 offset:24576
  v_mfma_f32_16x16x32_bf16 v[32:35], v[56:59], v[52:55], v[32:35]
  ds_read_b128 v[100:103], v9 offset:26624
  v_mfma_f32_16x16x32_bf16 v[20:23], v[60:63], v[48:51], v[20:23]
  ds_read_b128 v[104:107], v12 offset:24576
  v_mfma_f32_16x16x32_bf16 v[36:39], v[60:63], v[52:55], v[36:39]
  ds_read_b128 v[108:111], v12 offset:25600
  v_mfma_f32_16x16x32_bf16 v[24:27], v[64:67], v[48:51], v[24:27]
  ds_read_b128 v[112:115], v12 offset:26624
  v_mfma_f32_16x16x32_bf16 v[40:43], v[64:67], v[52:55], v[40:43]
  ds_read_b128 v[116:119], v12 offset:27648
  v_mfma_f32_16x16x32_bf16 v[28:31], v[68:71], v[48:51], v[28:31]
  ds_read_b128 v[120:123], v9 offset:25600
  v_mfma_f32_16x16x32_bf16 v[44:47], v[68:71], v[52:55], v[44:47]
  ds_read_b128 v[124:127], v9 offset:27648
  v_mfma_f32_16x16x32_bf16 v[16:19], v[80:83], v[72:75], v[16:19]
  ds_read_b128 v[128:131], v12 offset:32768
  v_mfma_f32_16x16x32_bf16 v[32:35], v[80:83], v[76:79], v[32:35]
  ds_read_b128 v[132:135], v12 offset:33792
  v_mfma_f32_16x16x32_bf16 v[20:23], v[84:87], v[72:75], v[20:23]
  ds_read_b128 v[136:139], v12 offset:34816
  v_mfma_f32_16x16x32_bf16 v[36:39], v[84:87], v[76:79], v[36:39]
  ds_read_b128 v[140:143], v12 offset:35840
  v_mfma_f32_16x16x32_bf16 v[24:27], v[88:91], v[72:75], v[24:27]
  v_mfma_f32_16x16x32_bf16 v[40:43], v[88:91], v[76:79], v[40:43]
  v_mfma_f32_16x16x32_bf16 v[28:31], v[92:95], v[72:75], v[28:31]
  v_mfma_f32_16x16x32_bf16 v[44:47], v[92:95], v[76:79], v[44:47]
  s_waitcnt lgkmcnt(0)
  s_barrier
  v_mfma_f32_16x16x32_bf16 v[16:19], v[104:107], v[96:99], v[16:19]
  ds_read_b128 v[48:51], v10 offset:0
  v_mfma_f32_16x16x32_bf16 v[32:35], v[104:107], v[100:103], v[32:35]
  ds_read_b128 v[52:55], v10 offset:2048
  v_mfma_f32_16x16x32_bf16 v[20:23], v[108:111], v[96:99], v[20:23]
  ds_read_b128 v[56:59], v13 offset:0
  v_mfma_f32_16x16x32_bf16 v[36:39], v[108:111], v[100:103], v[36:39]
  ds_read_b128 v[60:63], v13 offset:1024
  v_mfma_f32_16x16x32_bf16 v[24:27], v[112:115], v[96:99], v[24:27]
  ds_read_b128 v[64:67], v13 offset:2048
  v_mfma_f32_16x16x32_bf16 v[40:43], v[112:115], v[100:103], v[40:43]
  ds_read_b128 v[68:71], v13 offset:3072
  v_mfma_f32_16x16x32_bf16 v[28:31], v[116:119], v[96:99], v[28:31]
  ds_read_b128 v[72:75], v10 offset:1024
  v_mfma_f32_16x16x32_bf16 v[44:47], v[116:119], v[100:103], v[44:47]
  ds_read_b128 v[76:79], v10 offset:3072
  v_mfma_f32_16x16x32_bf16 v[16:19], v[128:131], v[120:123], v[16:19]
  ds_read_b128 v[80:83], v13 offset:8192
  v_mfma_f32_16x16x32_bf16 v[32:35], v[128:131], v[124:127], v[32:35]
  ds_read_b128 v[84:87], v13 offset:9216
  v_mfma_f32_16x16x32_bf16 v[20:23], v[132:135], v[120:123], v[20:23]
  ds_read_b128 v[88:91], v13 offset:10240
  v_mfma_f32_16x16x32_bf16 v[36:39], v[132:135], v[124:127], v[36:39]
  ds_read_b128 v[92:95], v13 offset:11264
  v_mfma_f32_16x16x32_bf16 v[24:27], v[136:139], v[120:123], v[24:27]
  v_mfma_f32_16x16x32_bf16 v[40:43], v[136:139], v[124:127], v[40:43]
  v_mfma_f32_16x16x32_bf16 v[28:31], v[140:143], v[120:123], v[28:31]
  v_mfma_f32_16x16x32_bf16 v[44:47], v[140:143], v[124:127], v[44:47]
  s_waitcnt lgkmcnt(0)
  s_barrier
  v_mfma_f32_16x16x32_bf16 v[16:19], v[56:59], v[48:51], v[16:19]
  ds_read_b128 v[96:99], v10 offset:24576
  v_mfma_f32_16x16x32_bf16 v[32:35], v[56:59], v[52:55], v[32:35]
  ds_read_b128 v[100:103], v10 offset:26624
  v_mfma_f32_16x16x32_bf16 v[20:23], v[60:63], v[48:51], v[20:23]
  ds_read_b128 v[104:107], v13 offset:24576
  v_mfma_f32_16x16x32_bf16 v[36:39], v[60:63], v[52:55], v[36:39]
  ds_read_b128 v[108:111], v13 offset:25600
  v_mfma_f32_16x16x32_bf16 v[24:27], v[64:67], v[48:51], v[24:27]
  ds_read_b128 v[112:115], v13 offset:26624
  v_mfma_f32_16x16x32_bf16 v[40:43], v[64:67], v[52:55], v[40:43]
  ds_read_b128 v[116:119], v13 offset:27648
  v_mfma_f32_16x16x32_bf16 v[28:31], v[68:71], v[48:51], v[28:31]
  ds_read_b128 v[120:123], v10 offset:25600
  v_mfma_f32_16x16x32_bf16 v[44:47], v[68:71], v[52:55], v[44:47]
  ds_read_b128 v[124:127], v10 offset:27648
  v_mfma_f32_16x16x32_bf16 v[16:19], v[80:83], v[72:75], v[16:19]
  ds_read_b128 v[128:131], v13 offset:32768
  v_mfma_f32_16x16x32_bf16 v[32:35], v[80:83], v[76:79], v[32:35]
  ds_read_b128 v[132:135], v13 offset:33792
  v_mfma_f32_16x16x32_bf16 v[20:23], v[84:87], v[72:75], v[20:23]
  ds_read_b128 v[136:139], v13 offset:34816
  v_mfma_f32_16x16x32_bf16 v[36:39], v[84:87], v[76:79], v[36:39]
  ds_read_b128 v[140:143], v13 offset:35840
  v_mfma_f32_16x16x32_bf16 v[24:27], v[88:91], v[72:75], v[24:27]
  v_mfma_f32_16x16x32_bf16 v[40:43], v[88:91], v[76:79], v[40:43]
  v_mfma_f32_16x16x32_bf16 v[28:31], v[92:95], v[72:75], v[28:31]
  v_mfma_f32_16x16x32_bf16 v[44:47], v[92:95], v[76:79], v[44:47]
  s_waitcnt lgkmcnt(0)
  s_barrier
  v_mfma_f32_16x16x32_bf16 v[16:19], v[104:107], v[96:99], v[16:19]
  ds_read_b128 v[48:51], v11 offset:0
  v_mfma_f32_16x16x32_bf16 v[32:35], v[104:107], v[100:103], v[32:35]
  ds_read_b128 v[52:55], v11 offset:2048
  v_mfma_f32_16x16x32_bf16 v[20:23], v[108:111], v[96:99], v[20:23]
  ds_read_b128 v[56:59], v14 offset:0
  v_mfma_f32_16x16x32_bf16 v[36:39], v[108:111], v[100:103], v[36:39]
  ds_read_b128 v[60:63], v14 offset:1024
  v_mfma_f32_16x16x32_bf16 v[24:27], v[112:115], v[96:99], v[24:27]
  ds_read_b128 v[64:67], v14 offset:2048
  v_mfma_f32_16x16x32_bf16 v[40:43], v[112:115], v[100:103], v[40:43]
  ds_read_b128 v[68:71], v14 offset:3072
  v_mfma_f32_16x16x32_bf16 v[28:31], v[116:119], v[96:99], v[28:31]
  ds_read_b128 v[72:75], v11 offset:1024
  v_mfma_f32_16x16x32_bf16 v[44:47], v[116:119], v[100:103], v[44:47]
  ds_read_b128 v[76:79], v11 offset:3072
  v_mfma_f32_16x16x32_bf16 v[16:19], v[128:131], v[120:123], v[16:19]
  ds_read_b128 v[80:83], v14 offset:8192
  v_mfma_f32_16x16x32_bf16 v[32:35], v[128:131], v[124:127], v[32:35]
  ds_read_b128 v[84:87], v14 offset:9216
  v_mfma_f32_16x16x32_bf16 v[20:23], v[132:135], v[120:123], v[20:23]
  ds_read_b128 v[88:91], v14 offset:10240
  v_mfma_f32_16x16x32_bf16 v[36:39], v[132:135], v[124:127], v[36:39]
  ds_read_b128 v[92:95], v14 offset:11264
  v_mfma_f32_16x16x32_bf16 v[24:27], v[136:139], v[120:123], v[24:27]
  v_mfma_f32_16x16x32_bf16 v[40:43], v[136:139], v[124:127], v[40:43]
  v_mfma_f32_16x16x32_bf16 v[28:31], v[140:143], v[120:123], v[28:31]
  v_mfma_f32_16x16x32_bf16 v[44:47], v[140:143], v[124:127], v[44:47]
  s_sub_u32 s11, s11, 1
  s_cmp_lg_u32 s11, 0
  s_cbranch_scc1 .Lmixer_kernel_c2
  s_waitcnt lgkmcnt(0)
  s_barrier
  s_nop 0
  v_mfma_f32_16x16x32_bf16 v[16:19], v[56:59], v[48:51], v[16:19]
  ds_read_b128 v[96:99], v11 offset:24576
  v_mfma_f32_16x16x32_bf16 v[32:35], v[56:59], v[52:55], v[32:35]
  ds_read_b128 v[100:103], v11 offset:26624
  v_mfma_f32_16x16x32_bf16 v[20:23], v[60:63], v[48:51], v[20:23]
  ds_read_b128 v[104:107], v14 offset:24576
  v_mfma_f32_16x16x32_bf16 v[36:39], v[60:63], v[52:55], v[36:39]
  ds_read_b128 v[108:111], v14 offset:25600
  v_mfma_f32_16x16x32_bf16 v[24:27], v[64:67], v[48:51], v[24:27]
  ds_read_b128 v[112:115], v14 offset:26624
  v_mfma_f32_16x16x32_bf16 v[40:43], v[64:67], v[52:55], v[40:43]
  ds_read_b128 v[116:119], v14 offset:27648
  v_mfma_f32_16x16x32_bf16 v[28:31], v[68:71], v[48:51], v[28:31]
  ds_read_b128 v[120:123], v11 offset:25600
  v_mfma_f32_16x16x32_bf16 v[44:47], v[68:71], v[52:55], v[44:47]
  ds_read_b128 v[124:127], v11 offset:27648
  v_mfma_f32_16x16x32_bf16 v[16:19], v[80:83], v[72:75], v[16:19]
  ds_read_b128 v[128:131], v14 offset:32768
  v_mfma_f32_16x16x32_bf16 v[32:35], v[80:83], v[76:79], v[32:35]
  ds_read_b128 v[132:135], v14 offset:33792
  v_mfma_f32_16x16x32_bf16 v[20:23], v[84:87], v[72:75], v[20:23]
  ds_read_b128 v[136:139], v14 offset:34816
  s_lshl_b32 s43, s38, 15
  v_mfma_f32_16x16x32_bf16 v[36:39], v[84:87], v[76:79], v[36:39]
  ds_read_b128 v[140:143], v14 offset:35840
  s_lshl_b32 s44, s37, 11
  v_mfma_f32_16x16x32_bf16 v[24:27], v[88:91], v[72:75], v[24:27]
  s_add_u32 s43, s43, s44
  s_nop 0
  v_mfma_f32_16x16x32_bf16 v[40:43], v[88:91], v[76:79], v[40:43]
  s_add_u32 s44, s43, 32768
  v_mfma_f32_16x16x32_bf16 v[28:31], v[92:95], v[72:75], v[28:31]
  v_mfma_f32_16x16x32_bf16 v[44:47], v[92:95], v[76:79], v[44:47]
  s_waitcnt lgkmcnt(0)
  s_barrier
  v_mfma_f32_16x16x32_bf16 v[16:19], v[104:107], v[96:99], v[16:19]
  ds_read_b128 v[48:51], v9 offset:0
  v_mfma_f32_16x16x32_bf16 v[32:35], v[104:107], v[100:103], v[32:35]
  ds_read_b128 v[52:55], v9 offset:2048
  v_mfma_f32_16x16x32_bf16 v[20:23], v[108:111], v[96:99], v[20:23]
  ds_read_b128 v[56:59], v12 offset:0
  v_mfma_f32_16x16x32_bf16 v[36:39], v[108:111], v[100:103], v[36:39]
  ds_read_b128 v[60:63], v12 offset:1024
  v_mfma_f32_16x16x32_bf16 v[24:27], v[112:115], v[96:99], v[24:27]
  ds_read_b128 v[64:67], v12 offset:2048
  v_mfma_f32_16x16x32_bf16 v[40:43], v[112:115], v[100:103], v[40:43]
  ds_read_b128 v[68:71], v12 offset:3072
  v_mfma_f32_16x16x32_bf16 v[28:31], v[116:119], v[96:99], v[28:31]
  ds_read_b128 v[72:75], v9 offset:1024
  v_mfma_f32_16x16x32_bf16 v[44:47], v[116:119], v[100:103], v[44:47]
  ds_read_b128 v[76:79], v9 offset:3072
  v_mfma_f32_16x16x32_bf16 v[16:19], v[128:131], v[120:123], v[16:19]
  ds_read_b128 v[80:83], v12 offset:8192
  v_mfma_f32_16x16x32_bf16 v[32:35], v[128:131], v[124:127], v[32:35]
  ds_read_b128 v[84:87], v12 offset:9216
  v_mfma_f32_16x16x32_bf16 v[20:23], v[132:135], v[120:123], v[20:23]
  ds_read_b128 v[88:91], v12 offset:10240
  v_mfma_f32_16x16x32_bf16 v[36:39], v[132:135], v[124:127], v[36:39]
  ds_read_b128 v[92:95], v12 offset:11264
  v_mfma_f32_16x16x32_bf16 v[24:27], v[136:139], v[120:123], v[24:27]
  v_mfma_f32_16x16x32_bf16 v[40:43], v[136:139], v[124:127], v[40:43]
  v_mfma_f32_16x16x32_bf16 v[28:31], v[140:143], v[120:123], v[28:31]
  v_mfma_f32_16x16x32_bf16 v[44:47], v[140:143], v[124:127], v[44:47]
  s_waitcnt lgkmcnt(0)
  s_barrier
  v_mfma_f32_16x16x32_bf16 v[16:19], v[56:59], v[48:51], v[16:19]
  ds_read_b128 v[96:99], v9 offset:24576
  v_mfma_f32_16x16x32_bf16 v[32:35], v[56:59], v[52:55], v[32:35]
  ds_read_b128 v[100:103], v9 offset:26624
  v_mfma_f32_16x16x32_bf16 v[20:23], v[60:63], v[48:51], v[20:23]
  ds_read_b128 v[104:107], v12 offset:24576
  v_mfma_f32_16x16x32_bf16 v[36:39], v[60:63], v[52:55], v[36:39]
  ds_read_b128 v[108:111], v12 offset:25600
  v_mfma_f32_16x16x32_bf16 v[24:27], v[64:67], v[48:51], v[24:27]
  ds_read_b128 v[112:115], v12 offset:26624
  v_mfma_f32_16x16x32_bf16 v[40:43], v[64:67], v[52:55], v[40:43]
  ds_read_b128 v[116:119], v12 offset:27648
  v_mfma_f32_16x16x32_bf16 v[28:31], v[68:71], v[48:51], v[28:31]
  ds_read_b128 v[120:123], v9 offset:25600
  v_mfma_f32_16x16x32_bf16 v[44:47], v[68:71], v[52:55], v[44:47]
  ds_read_b128 v[124:127], v9 offset:27648
  v_mfma_f32_16x16x32_bf16 v[16:19], v[80:83], v[72:75], v[16:19]
  ds_read_b128 v[128:131], v12 offset:32768
  v_mfma_f32_16x16x32_bf16 v[32:35], v[80:83], v[76:79], v[32:35]
  ds_read_b128 v[132:135], v12 offset:33792
  v_mfma_f32_16x16x32_bf16 v[20:23], v[84:87], v[72:75], v[20:23]
  ds_read_b128 v[136:139], v12 offset:34816
  v_mfma_f32_16x16x32_bf16 v[36:39], v[84:87], v[76:79], v[36:39]
  ds_read_b128 v[140:143], v12 offset:35840
  v_mfma_f32_16x16x32_bf16 v[24:27], v[88:91], v[72:75], v[24:27]
  v_mfma_f32_16x16x32_bf16 v[40:43], v[88:91], v[76:79], v[40:43]
  v_mfma_f32_16x16x32_bf16 v[28:31], v[92:95], v[72:75], v[28:31]
  v_mfma_f32_16x16x32_bf16 v[44:47], v[92:95], v[76:79], v[44:47]
  s_waitcnt lgkmcnt(0)
  s_nop 0
  v_mfma_f32_16x16x32_bf16 v[16:19], v[104:107], v[96:99], v[16:19]
  v_mfma_f32_16x16x32_bf16 v[32:35], v[104:107], v[100:103], v[32:35]
  v_mfma_f32_16x16x32_bf16 v[20:23], v[108:111], v[96:99], v[20:23]
  v_mfma_f32_16x16x32_bf16 v[36:39], v[108:111], v[100:103], v[36:39]
  v_mfma_f32_16x16x32_bf16 v[24:27], v[112:115], v[96:99], v[24:27]
  v_mfma_f32_16x16x32_bf16 v[40:43], v[112:115], v[100:103], v[40:43]
  v_mfma_f32_16x16x32_bf16 v[28:31], v[116:119], v[96:99], v[28:31]
  v_mfma_f32_16x16x32_bf16 v[44:47], v[116:119], v[100:103], v[44:47]
  v_mfma_f32_16x16x32_bf16 v[16:19], v[128:131], v[120:123], v[16:19]
  v_mfma_f32_16x16x32_bf16 v[32:35], v[128:131], v[124:127], v[32:35]
  v_mfma_f32_16x16x32_bf16 v[20:23], v[132:135], v[120:123], v[20:23]
  v_mfma_f32_16x16x32_bf16 v[36:39], v[132:135], v[124:127], v[36:39]
  v_mfma_f32_16x16x32_bf16 v[24:27], v[136:139], v[120:123], v[24:27]
  v_mfma_f32_16x16x32_bf16 v[40:43], v[136:139], v[124:127], v[40:43]
  v_mfma_f32_16x16x32_bf16 v[28:31], v[140:143], v[120:123], v[28:31]
  v_mfma_f32_16x16x32_bf16 v[44:47], v[140:143], v[124:127], v[44:47]
  s_mul_i32 s45, s10, 24576
  s_add_u32 s45, s45, 63488
  v_add_u32 v4, s45, v7
  s_barrier
  ds_read_b128 v[224:227], v4 offset:0
  ds_read_b128 v[228:231], v4 offset:1024
  ds_read_b128 v[232:235], v4 offset:2048
  ds_read_b128 v[236:239], v4 offset:3072
  ds_read_b128 v[240:243], v4 offset:4096
  ds_read_b128 v[244:247], v4 offset:5120
  ds_read_b128 v[248:251], v4 offset:6144
  ds_read_b128 v[252:255], v4 offset:7168
  s_waitcnt lgkmcnt(4)
  s_mov_b32 s45, 0x3f803f80
  v_mov_b32 v176, 0
  v_mov_b32 v177, 0
  v_mov_b32 v178, 0
  v_mov_b32_e64 v179, 0
  v_cvt_pk_bf16_f32 v16, v16, v17
  v_cvt_pk_bf16_f32 v18, v18, v19
  v_cvt_pk_bf16_f32 v20, v20, v21
  v_cvt_pk_bf16_f32 v22, v22, v23
  v_lshlrev_b32 v144, 16, v224
  v_lshlrev_b32 v146, 16, v225
  v_lshlrev_b32 v148, 16, v226
  v_lshlrev_b32 v150, 16, v227
  v_and_b32 v145, 0xffff0000, v224
  v_and_b32 v147, 0xffff0000, v225
  v_and_b32 v149, 0xffff0000, v226
  v_and_b32 v151, 0xffff0000, v227
  v_and_b32 v17, 0xffff0000, v16
  v_and_b32 v19, 0xffff0000, v18
  v_and_b32 v21, 0xffff0000, v20
  v_and_b32 v23, 0xffff0000, v22
  v_lshlrev_b32 v16, 16, v16
  v_lshlrev_b32 v18, 16, v18
  v_lshlrev_b32 v20, 16, v20
  v_lshlrev_b32 v22, 16, v22
  v_pk_add_f32 v[16:17], v[16:17], v[144:145]
  v_pk_add_f32 v[18:19], v[18:19], v[146:147]
  v_pk_add_f32 v[20:21], v[20:21], v[148:149]
  v_pk_add_f32 v[22:23], v[22:23], v[150:151]
  v_cvt_pk_bf16_f32 v224, v16, v17
  v_cvt_pk_bf16_f32 v225, v18, v19
  v_cvt_pk_bf16_f32 v226, v20, v21
  v_cvt_pk_bf16_f32 v227, v22, v23
  buffer_store_dwordx4 v[224:227], v7, s[32:35], s43 offen offset:0 sc1
  v_cvt_pk_bf16_f32 v24, v24, v25
  v_cvt_pk_bf16_f32 v26, v26, v27
  v_cvt_pk_bf16_f32 v28, v28, v29
  v_cvt_pk_bf16_f32 v30, v30, v31
  v_lshlrev_b32 v144, 16, v228
  v_lshlrev_b32 v146, 16, v229
  v_lshlrev_b32 v148, 16, v230
  v_lshlrev_b32 v150, 16, v231
  v_and_b32 v145, 0xffff0000, v228
  v_and_b32 v147, 0xffff0000, v229
  v_and_b32 v149, 0xffff0000, v230
  v_and_b32 v151, 0xffff0000, v231
  v_and_b32 v25, 0xffff0000, v24
  v_and_b32 v27, 0xffff0000, v26
  v_and_b32 v29, 0xffff0000, v28
  v_and_b32 v31, 0xffff0000, v30
  v_lshlrev_b32 v24, 16, v24
  v_lshlrev_b32 v26, 16, v26
  v_lshlrev_b32 v28, 16, v28
  v_lshlrev_b32 v30, 16, v30
  v_pk_add_f32 v[24:25], v[24:25], v[144:145]
  v_pk_add_f32 v[26:27], v[26:27], v[146:147]
  v_pk_add_f32 v[28:29], v[28:29], v[148:149]
  v_pk_add_f32 v[30:31], v[30:31], v[150:151]
  v_cvt_pk_bf16_f32 v228, v24, v25
  v_cvt_pk_bf16_f32 v229, v26, v27
  v_cvt_pk_bf16_f32 v230, v28, v29
  v_cvt_pk_bf16_f32 v231, v30, v31
  buffer_store_dwordx4 v[228:231], v7, s[32:35], s43 offen offset:1024 sc1
  v_cvt_pk_bf16_f32 v32, v32, v33
  v_cvt_pk_bf16_f32 v34, v34, v35
  v_cvt_pk_bf16_f32 v36, v36, v37
  v_cvt_pk_bf16_f32 v38, v38, v39
  v_lshlrev_b32 v144, 16, v232
  v_lshlrev_b32 v146, 16, v233
  v_lshlrev_b32 v148, 16, v234
  v_lshlrev_b32 v150, 16, v235
  v_and_b32 v145, 0xffff0000, v232
  v_and_b32 v147, 0xffff0000, v233
  v_and_b32 v149, 0xffff0000, v234
  v_and_b32 v151, 0xffff0000, v235
  v_and_b32 v33, 0xffff0000, v32
  v_and_b32 v35, 0xffff0000, v34
  v_and_b32 v37, 0xffff0000, v36
  v_and_b32 v39, 0xffff0000, v38
  v_lshlrev_b32 v32, 16, v32
  v_lshlrev_b32 v34, 16, v34
  v_lshlrev_b32 v36, 16, v36
  v_lshlrev_b32 v38, 16, v38
  v_pk_add_f32 v[32:33], v[32:33], v[144:145]
  v_pk_add_f32 v[34:35], v[34:35], v[146:147]
  v_pk_add_f32 v[36:37], v[36:37], v[148:149]
  v_pk_add_f32 v[38:39], v[38:39], v[150:151]
  v_cvt_pk_bf16_f32 v232, v32, v33
  v_cvt_pk_bf16_f32 v233, v34, v35
  v_cvt_pk_bf16_f32 v234, v36, v37
  v_cvt_pk_bf16_f32 v235, v38, v39
  buffer_store_dwordx4 v[232:235], v7, s[32:35], s44 offen offset:0 sc1
  v_cvt_pk_bf16_f32 v40, v40, v41
  v_cvt_pk_bf16_f32 v42, v42, v43
  v_cvt_pk_bf16_f32 v44, v44, v45
  v_cvt_pk_bf16_f32 v46, v46, v47
  v_lshlrev_b32 v144, 16, v236
  v_lshlrev_b32 v146, 16, v237
  v_lshlrev_b32 v148, 16, v238
  v_lshlrev_b32 v150, 16, v239
  v_and_b32 v145, 0xffff0000, v236
  v_and_b32 v147, 0xffff0000, v237
  v_and_b32 v149, 0xffff0000, v238
  v_and_b32 v151, 0xffff0000, v239
  v_and_b32 v41, 0xffff0000, v40
  v_and_b32 v43, 0xffff0000, v42
  v_and_b32 v45, 0xffff0000, v44
  v_and_b32 v47, 0xffff0000, v46
  v_lshlrev_b32 v40, 16, v40
  v_lshlrev_b32 v42, 16, v42
  v_lshlrev_b32 v44, 16, v44
  v_lshlrev_b32 v46, 16, v46
  v_pk_add_f32 v[40:41], v[40:41], v[144:145]
  v_pk_add_f32 v[42:43], v[42:43], v[146:147]
  v_pk_add_f32 v[44:45], v[44:45], v[148:149]
  v_pk_add_f32 v[46:47], v[46:47], v[150:151]
  v_cvt_pk_bf16_f32 v236, v40, v41
  v_cvt_pk_bf16_f32 v237, v42, v43
  v_cvt_pk_bf16_f32 v238, v44, v45
  v_cvt_pk_bf16_f32 v239, v46, v47
  buffer_store_dwordx4 v[236:239], v7, s[32:35], s44 offen offset:1024 sc1
  v_dot2c_f32_bf16 v176, s45, v224
  v_dot2c_f32_bf16 v178, v224, v224
  v_dot2c_f32_bf16 v177, s45, v232
  v_dot2c_f32_bf16 v179, v232, v232
  v_dot2c_f32_bf16 v176, s45, v225
  v_dot2c_f32_bf16 v178, v225, v225
  v_dot2c_f32_bf16 v177, s45, v233
  v_dot2c_f32_bf16 v179, v233, v233
  v_dot2c_f32_bf16 v176, s45, v226
  v_dot2c_f32_bf16 v178, v226, v226
  v_dot2c_f32_bf16 v177, s45, v234
  v_dot2c_f32_bf16 v179, v234, v234
  v_dot2c_f32_bf16 v176, s45, v227
  v_dot2c_f32_bf16 v178, v227, v227
  v_dot2c_f32_bf16 v177, s45, v235
  v_dot2c_f32_bf16 v179, v235, v235
  v_dot2c_f32_bf16 v176, s45, v228
  v_dot2c_f32_bf16 v178, v228, v228
  v_dot2c_f32_bf16 v177, s45, v236
  v_dot2c_f32_bf16 v179, v236, v236
  v_dot2c_f32_bf16 v176, s45, v229
  v_dot2c_f32_bf16 v178, v229, v229
  v_dot2c_f32_bf16 v177, s45, v237
  v_dot2c_f32_bf16 v179, v237, v237
  v_dot2c_f32_bf16 v176, s45, v230
  v_dot2c_f32_bf16 v178, v230, v230
  v_dot2c_f32_bf16 v177, s45, v238
  v_dot2c_f32_bf16 v179, v238, v238
  v_dot2c_f32_bf16 v176, s45, v231
  v_dot2c_f32_bf16 v178, v231, v231
  v_dot2c_f32_bf16 v177, s45, v239
  v_dot2c_f32_bf16 v179, v239, v239
  s_nop 1
  v_permlane32_swap_b32 v176, v177
  v_permlane32_swap_b32 v178, v179
  v_add_f32 v176, v176, v177
  v_add_f32 v178, v178, v179
  s_nop 1
  v_permlane16_swap_b32 v176, v178
  v_add_f32 v176, v176, v178
  v_lshrrev_b32 v4, 1, v3
  v_lshl_add_u32 v4, v4, 4, v2
  v_lshlrev_b32 v4, 3, v4
  v_and_b32 v5, 1, v3
  v_lshl_add_u32 v4, v5, 2, v4
  s_lshl_b32 s43, s36, 4
  s_add_u32 s43, s43, s37
  s_lshl_b32 s43, s43, 2
  s_lshl_b32 s43, s43, 8
  s_and_b32 s44, s38, 7
  s_lshl_b32 s44, s44, 7
  s_add_u32 s43, s43, s44
  buffer_store_dword v176, v4, s[28:31], s43 offen sc1
  s_waitcnt vmcnt(0) lgkmcnt(0)
  s_barrier
  s_cmp_lg_u32 s10, 3
  s_cbranch_scc1 .Lmixer_kernel_sig2
  s_lshl_b32 s43, s36, 12
  s_lshl_b32 s47, s49, 2
  s_add_u32 s43, s43, s47
  v_lshlrev_b32 v4, 8, v1
  s_add_u32 s43, s43, 147456
  s_mov_b32 exec_lo, 0xffff
  s_mov_b32 exec_hi, 0
  buffer_store_dword v8, v4, s[12:15], s43 offen sc1
  s_mov_b64 exec, -1
.Lmixer_kernel_sig2:
  s_and_b32 s43, s2, 7
  s_lshr_b32 s44, s2, 3
  s_lshr_b32 s36, s43, 2
  s_lshl_b32 s36, s36, 3
  s_lshr_b32 s45, s44, 2
  s_add_u32 s36, s36, s45
  s_and_b32 s37, s43, 3
  s_lshl_b32 s37, s37, 2
  s_and_b32 s45, s44, 3
  s_add_u32 s37, s37, s45
  s_lshr_b32 s45, s10, 1
  s_and_b32 s48, s10, 1
  s_lshl_b32 s38, s36, 3
  s_lshl_b32 s46, s45, 2
  s_add_u32 s38, s38, s46
  s_lshl_b32 s45, s45, 12
  s_add_u32 s45, s45, 14336
  v_add_u32 v9, s45, v7
  s_lshl_b32 s43, s48, 13
  v_add_u32 v12, s43, v7
  s_lshl_b32 s43, s48, 10
  s_add_u32 s43, s43, 6144
  v_add_u32_e64 v15, s43, v7
  v_add_u32 v10, 49152, v9
  v_add_u32 v13, 49152, v12
  v_add_u32 v16, 49152, v15
  v_add_u32 v11, 98304, v9
  v_add_u32 v14, 98304, v12
  v_add_u32 v17, 98304, v15
  v_mov_b32 v20, 0
  v_mov_b32 v21, 0
  v_mov_b32 v22, 0
  v_mov_b32 v23, 0
  v_mov_b32 v24, 0
  v_mov_b32 v25, 0
  v_mov_b32 v26, 0
  v_mov_b32 v27, 0
  v_mov_b32 v28, 0
  v_mov_b32 v29, 0
  v_mov_b32 v30, 0
  v_mov_b32 v31, 0
  v_mov_b32 v32, 0
  v_mov_b32 v33, 0
  v_mov_b32 v34, 0
  v_mov_b32 v35, 0
  v_mov_b32 v36, 0
  v_mov_b32 v37, 0
  v_mov_b32 v38, 0
  v_mov_b32 v39, 0
  v_mov_b32 v40, 0
  v_mov_b32 v41, 0
  v_mov_b32 v42, 0
  v_mov_b32 v43, 0
  v_mov_b32 v44, 0
  v_mov_b32 v45, 0
  v_mov_b32 v46, 0
  v_mov_b32 v47, 0
  v_mov_b32 v48, 0
  v_mov_b32 v49, 0
  v_mov_b32 v50, 0
  v_mov_b32 v51, 0
  v_mov_b32 v52, 0
  v_mov_b32 v53, 0
  v_mov_b32 v54, 0
  v_mov_b32 v55, 0
  v_mov_b32 v56, 0
  v_mov_b32 v57, 0
  v_mov_b32 v58, 0
  v_mov_b32 v59, 0
  v_mov_b32 v60, 0
  v_mov_b32 v61, 0
  v_mov_b32 v62, 0
  v_mov_b32 v63, 0
  v_mov_b32 v64, 0
  v_mov_b32 v65, 0
  v_mov_b32 v66, 0
  v_mov_b32 v67, 0
  v_mov_b32 v68, 0
  v_mov_b32 v69, 0
  v_mov_b32 v70, 0
  v_mov_b32 v71, 0
  v_mov_b32 v72, 0
  v_mov_b32 v73, 0
  v_mov_b32 v74, 0
  v_mov_b32 v75, 0
  v_mov_b32 v76, 0
  v_mov_b32 v77, 0
  v_mov_b32 v78, 0
  v_mov_b32 v79, 0
  v_mov_b32 v80, 0
  v_mov_b32 v81, 0
  v_mov_b32 v82, 0
  v_mov_b32 v83, 0
  v_mov_b32 v84, 0
  v_mov_b32 v85, 0
  v_mov_b32 v86, 0
  v_mov_b32 v87, 0
  v_mov_b32 v88, 0
  v_mov_b32 v89, 0
  v_mov_b32 v90, 0
  v_mov_b32 v91, 0
  v_mov_b32 v92, 0
  v_mov_b32 v93, 0
  v_mov_b32 v94, 0
  v_mov_b32 v95, 0
  v_mov_b32 v96, 0
  v_mov_b32 v97, 0
  v_mov_b32 v98, 0
  v_mov_b32 v99, 0
  v_mov_b32 v100, 0
  v_mov_b32 v101, 0
  v_mov_b32 v102, 0
  v_mov_b32 v103, 0
  v_mov_b32 v104, 0
  v_mov_b32 v105, 0
  v_mov_b32 v106, 0
  v_mov_b32 v107, 0
  v_mov_b32 v108, 0
  v_mov_b32 v109, 0
  v_mov_b32 v110, 0
  v_mov_b32 v111, 0
  v_mov_b32 v112, 0
  v_mov_b32 v113, 0
  v_mov_b32 v114, 0
  v_mov_b32 v115, 0
  v_mov_b32 v116, 0
  v_mov_b32 v117, 0
  v_mov_b32 v118, 0
  v_mov_b32 v119, 0
  v_mov_b32 v120, 0
  v_mov_b32 v121, 0
  v_mov_b32 v122, 0
  v_mov_b32 v123, 0
  v_mov_b32 v124, 0
  v_mov_b32 v125, 0
  v_mov_b32 v126, 0
  v_mov_b32 v127, 0
  v_mov_b32 v128, 0
  v_mov_b32 v129, 0
  v_mov_b32 v130, 0
  v_mov_b32 v131, 0
  s_add_u32 s32, s4, 0x1d00000
  s_addc_u32 s33, s5, 0
  s_mov_b32 s34, 0xe00000
  s_mov_b32 s35, 0x20000
  s_barrier
  s_barrier
  s_nop 0
  ds_read_b128 v[132:135], v10 offset:0
  ds_read_b128 v[136:139], v10 offset:1024
  ds_read_b128 v[140:143], v10 offset:2048
  ds_read_b128 v[144:147], v10 offset:3072
  ds_read_b128 v[148:151], v13 offset:0
  ds_read_b128 v[152:155], v13 offset:1024
  ds_read_b128 v[156:159], v13 offset:2048
  ds_read_b128 v[160:163], v13 offset:3072
  ds_read_b128 v[164:167], v13 offset:4096
  ds_read_b128 v[168:171], v13 offset:5120
  ds_read_b128 v[172:175], v16 offset:0
  s_mov_b32 s11, 4
  s_nop 0
.Lmixer_kernel_c3:
  s_waitcnt lgkmcnt(0)
  s_barrier
  v_mfma_f32_16x16x32_bf16 v[20:23], v[148:151], v[132:135], v[20:23]
  ds_read_b128 v[176:179], v10 offset:24576
  v_mfma_f32_16x16x32_bf16 v[48:51], v[148:151], v[136:139], v[48:51]
  v_mfma_f32_16x16x32_bf16 v[76:79], v[148:151], v[140:143], v[76:79]
  ds_read_b128 v[180:183], v10 offset:25600
  v_mfma_f32_16x16x32_bf16 v[104:107], v[148:151], v[144:147], v[104:107]
  v_mfma_f32_16x16x32_bf16 v[24:27], v[152:155], v[132:135], v[24:27]
  ds_read_b128 v[184:187], v10 offset:26624
  v_mfma_f32_16x16x32_bf16 v[52:55], v[152:155], v[136:139], v[52:55]
  v_mfma_f32_16x16x32_bf16 v[80:83], v[152:155], v[140:143], v[80:83]
  ds_read_b128 v[188:191], v10 offset:27648
  v_mfma_f32_16x16x32_bf16 v[108:111], v[152:155], v[144:147], v[108:111]
  v_mfma_f32_16x16x32_bf16 v[28:31], v[156:159], v[132:135], v[28:31]
  ds_read_b128 v[192:195], v13 offset:24576
  v_mfma_f32_16x16x32_bf16 v[56:59], v[156:159], v[136:139], v[56:59]
  v_mfma_f32_16x16x32_bf16 v[84:87], v[156:159], v[140:143], v[84:87]
  ds_read_b128 v[196:199], v13 offset:25600
  v_mfma_f32_16x16x32_bf16 v[112:115], v[156:159], v[144:147], v[112:115]
  v_mfma_f32_16x16x32_bf16 v[32:35], v[160:163], v[132:135], v[32:35]
  ds_read_b128 v[200:203], v13 offset:26624
  v_mfma_f32_16x16x32_bf16 v[60:63], v[160:163], v[136:139], v[60:63]
  v_mfma_f32_16x16x32_bf16 v[88:91], v[160:163], v[140:143], v[88:91]
  ds_read_b128 v[204:207], v13 offset:27648
  v_mfma_f32_16x16x32_bf16 v[116:119], v[160:163], v[144:147], v[116:119]
  v_mfma_f32_16x16x32_bf16 v[36:39], v[164:167], v[132:135], v[36:39]
  ds_read_b128 v[208:211], v13 offset:28672
  v_mfma_f32_16x16x32_bf16 v[64:67], v[164:167], v[136:139], v[64:67]
  v_mfma_f32_16x16x32_bf16 v[92:95], v[164:167], v[140:143], v[92:95]
  ds_read_b128 v[212:215], v13 offset:29696
  v_mfma_f32_16x16x32_bf16 v[120:123], v[164:167], v[144:147], v[120:123]
  v_mfma_f32_16x16x32_bf16 v[40:43], v[168:171], v[132:135], v[40:43]
  ds_read_b128 v[216:219], v16 offset:24576
  v_mfma_f32_16x16x32_bf16 v[68:71], v[168:171], v[136:139], v[68:71]
  v_mfma_f32_16x16x32_bf16 v[96:99], v[168:171], v[140:143], v[96:99]
  v_mfma_f32_16x16x32_bf16 v[124:127], v[168:171], v[144:147], v[124:127]
  v_mfma_f32_16x16x32_bf16 v[44:47], v[172:175], v[132:135], v[44:47]
  v_mfma_f32_16x16x32_bf16 v[72:75], v[172:175], v[136:139], v[72:75]
  v_mfma_f32_16x16x32_bf16 v[100:103], v[172:175], v[140:143], v[100:103]
  v_mfma_f32_16x16x32_bf16 v[128:131], v[172:175], v[144:147], v[128:131]
  s_waitcnt lgkmcnt(0)
  s_barrier
  v_mfma_f32_16x16x32_bf16 v[20:23], v[192:195], v[176:179], v[20:23]
  ds_read_b128 v[132:135], v11 offset:0
  v_mfma_f32_16x16x32_bf16 v[48:51], v[192:195], v[180:183], v[48:51]
  v_mfma_f32_16x16x32_bf16 v[76:79], v[192:195], v[184:187], v[76:79]
  ds_read_b128 v[136:139], v11 offset:1024
  v_mfma_f32_16x16x32_bf16 v[104:107], v[192:195], v[188:191], v[104:107]
  v_mfma_f32_16x16x32_bf16 v[24:27], v[196:199], v[176:179], v[24:27]
  ds_read_b128 v[140:143], v11 offset:2048
  v_mfma_f32_16x16x32_bf16 v[52:55], v[196:199], v[180:183], v[52:55]
  v_mfma_f32_16x16x32_bf16 v[80:83], v[196:199], v[184:187], v[80:83]
  ds_read_b128 v[144:147], v11 offset:3072
  v_mfma_f32_16x16x32_bf16 v[108:111], v[196:199], v[188:191], v[108:111]
  v_mfma_f32_16x16x32_bf16 v[28:31], v[200:203], v[176:179], v[28:31]
  ds_read_b128 v[148:151], v14 offset:0
  v_mfma_f32_16x16x32_bf16 v[56:59], v[200:203], v[180:183], v[56:59]
  v_mfma_f32_16x16x32_bf16 v[84:87], v[200:203], v[184:187], v[84:87]
  ds_read_b128 v[152:155], v14 offset:1024
  v_mfma_f32_16x16x32_bf16 v[112:115], v[200:203], v[188:191], v[112:115]
  v_mfma_f32_16x16x32_bf16 v[32:35], v[204:207], v[176:179], v[32:35]
  ds_read_b128 v[156:159], v14 offset:2048
  v_mfma_f32_16x16x32_bf16 v[60:63], v[204:207], v[180:183], v[60:63]
  v_mfma_f32_16x16x32_bf16 v[88:91], v[204:207], v[184:187], v[88:91]
  ds_read_b128 v[160:163], v14 offset:3072
  v_mfma_f32_16x16x32_bf16 v[116:119], v[204:207], v[188:191], v[116:119]
  v_mfma_f32_16x16x32_bf16 v[36:39], v[208:211], v[176:179], v[36:39]
  ds_read_b128 v[164:167], v14 offset:4096
  v_mfma_f32_16x16x32_bf16 v[64:67], v[208:211], v[180:183], v[64:67]
  v_mfma_f32_16x16x32_bf16 v[92:95], v[208:211], v[184:187], v[92:95]
  ds_read_b128 v[168:171], v14 offset:5120
  v_mfma_f32_16x16x32_bf16 v[120:123], v[208:211], v[188:191], v[120:123]
  v_mfma_f32_16x16x32_bf16 v[40:43], v[212:215], v[176:179], v[40:43]
  ds_read_b128 v[172:175], v17 offset:0
  v_mfma_f32_16x16x32_bf16 v[68:71], v[212:215], v[180:183], v[68:71]
  v_mfma_f32_16x16x32_bf16 v[96:99], v[212:215], v[184:187], v[96:99]
  v_mfma_f32_16x16x32_bf16 v[124:127], v[212:215], v[188:191], v[124:127]
  v_mfma_f32_16x16x32_bf16 v[44:47], v[216:219], v[176:179], v[44:47]
  v_mfma_f32_16x16x32_bf16 v[72:75], v[216:219], v[180:183], v[72:75]
  v_mfma_f32_16x16x32_bf16 v[100:103], v[216:219], v[184:187], v[100:103]
  v_mfma_f32_16x16x32_bf16 v[128:131], v[216:219], v[188:191], v[128:131]
  s_waitcnt lgkmcnt(0)
  s_barrier
  v_mfma_f32_16x16x32_bf16 v[20:23], v[148:151], v[132:135], v[20:23]
  ds_read_b128 v[176:179], v11 offset:24576
  v_mfma_f32_16x16x32_bf16 v[48:51], v[148:151], v[136:139], v[48:51]
  v_mfma_f32_16x16x32_bf16 v[76:79], v[148:151], v[140:143], v[76:79]
  ds_read_b128 v[180:183], v11 offset:25600
  v_mfma_f32_16x16x32_bf16 v[104:107], v[148:151], v[144:147], v[104:107]
  v_mfma_f32_16x16x32_bf16 v[24:27], v[152:155], v[132:135], v[24:27]
  ds_read_b128 v[184:187], v11 offset:26624
  v_mfma_f32_16x16x32_bf16 v[52:55], v[152:155], v[136:139], v[52:55]
  v_mfma_f32_16x16x32_bf16 v[80:83], v[152:155], v[140:143], v[80:83]
  ds_read_b128 v[188:191], v11 offset:27648
  v_mfma_f32_16x16x32_bf16 v[108:111], v[152:155], v[144:147], v[108:111]
  v_mfma_f32_16x16x32_bf16 v[28:31], v[156:159], v[132:135], v[28:31]
  ds_read_b128 v[192:195], v14 offset:24576
  v_mfma_f32_16x16x32_bf16 v[56:59], v[156:159], v[136:139], v[56:59]
  v_mfma_f32_16x16x32_bf16 v[84:87], v[156:159], v[140:143], v[84:87]
  ds_read_b128 v[196:199], v14 offset:25600
  v_mfma_f32_16x16x32_bf16 v[112:115], v[156:159], v[144:147], v[112:115]
  v_mfma_f32_16x16x32_bf16 v[32:35], v[160:163], v[132:135], v[32:35]
  ds_read_b128 v[200:203], v14 offset:26624
  v_mfma_f32_16x16x32_bf16 v[60:63], v[160:163], v[136:139], v[60:63]
  v_mfma_f32_16x16x32_bf16 v[88:91], v[160:163], v[140:143], v[88:91]
  ds_read_b128 v[204:207], v14 offset:27648
  v_mfma_f32_16x16x32_bf16 v[116:119], v[160:163], v[144:147], v[116:119]
  v_mfma_f32_16x16x32_bf16 v[36:39], v[164:167], v[132:135], v[36:39]
  ds_read_b128 v[208:211], v14 offset:28672
  v_mfma_f32_16x16x32_bf16 v[64:67], v[164:167], v[136:139], v[64:67]
  v_mfma_f32_16x16x32_bf16 v[92:95], v[164:167], v[140:143], v[92:95]
  ds_read_b128 v[212:215], v14 offset:29696
  v_mfma_f32_16x16x32_bf16 v[120:123], v[164:167], v[144:147], v[120:123]
  v_mfma_f32_16x16x32_bf16 v[40:43], v[168:171], v[132:135], v[40:43]
  ds_read_b128 v[216:219], v17 offset:24576
  v_mfma_f32_16x16x32_bf16 v[68:71], v[168:171], v[136:139], v[68:71]
  v_mfma_f32_16x16x32_bf16 v[96:99], v[168:171], v[140:143], v[96:99]
  v_mfma_f32_16x16x32_bf16 v[124:127], v[168:171], v[144:147], v[124:127]
  v_mfma_f32_16x16x32_bf16 v[44:47], v[172:175], v[132:135], v[44:47]
  v_mfma_f32_16x16x32_bf16 v[72:75], v[172:175], v[136:139], v[72:75]
  v_mfma_f32_16x16x32_bf16 v[100:103], v[172:175], v[140:143], v[100:103]
  v_mfma_f32_16x16x32_bf16 v[128:131], v[172:175], v[144:147], v[128:131]
  s_waitcnt lgkmcnt(0)
  s_barrier
  v_mfma_f32_16x16x32_bf16 v[20:23], v[192:195], v[176:179], v[20:23]
  ds_read_b128 v[132:135], v9 offset:0
  v_mfma_f32_16x16x32_bf16 v[48:51], v[192:195], v[180:183], v[48:51]
  v_mfma_f32_16x16x32_bf16 v[76:79], v[192:195], v[184:187], v[76:79]
  ds_read_b128 v[136:139], v9 offset:1024
  v_mfma_f32_16x16x32_bf16 v[104:107], v[192:195], v[188:191], v[104:107]
  v_mfma_f32_16x16x32_bf16 v[24:27], v[196:199], v[176:179], v[24:27]
  ds_read_b128 v[140:143], v9 offset:2048
  v_mfma_f32_16x16x32_bf16 v[52:55], v[196:199], v[180:183], v[52:55]
  v_mfma_f32_16x16x32_bf16 v[80:83], v[196:199], v[184:187], v[80:83]
  ds_read_b128 v[144:147], v9 offset:3072
  v_mfma_f32_16x16x32_bf16 v[108:111], v[196:199], v[188:191], v[108:111]
  v_mfma_f32_16x16x32_bf16 v[28:31], v[200:203], v[176:179], v[28:31]
  ds_read_b128 v[148:151], v12 offset:0
  v_mfma_f32_16x16x32_bf16 v[56:59], v[200:203], v[180:183], v[56:59]
  v_mfma_f32_16x16x32_bf16 v[84:87], v[200:203], v[184:187], v[84:87]
  ds_read_b128 v[152:155], v12 offset:1024
  v_mfma_f32_16x16x32_bf16 v[112:115], v[200:203], v[188:191], v[112:115]
  v_mfma_f32_16x16x32_bf16 v[32:35], v[204:207], v[176:179], v[32:35]
  ds_read_b128 v[156:159], v12 offset:2048
  v_mfma_f32_16x16x32_bf16 v[60:63], v[204:207], v[180:183], v[60:63]
  v_mfma_f32_16x16x32_bf16 v[88:91], v[204:207], v[184:187], v[88:91]
  ds_read_b128 v[160:163], v12 offset:3072
  v_mfma_f32_16x16x32_bf16 v[116:119], v[204:207], v[188:191], v[116:119]
  v_mfma_f32_16x16x32_bf16 v[36:39], v[208:211], v[176:179], v[36:39]
  ds_read_b128 v[164:167], v12 offset:4096
  v_mfma_f32_16x16x32_bf16 v[64:67], v[208:211], v[180:183], v[64:67]
  v_mfma_f32_16x16x32_bf16 v[92:95], v[208:211], v[184:187], v[92:95]
  ds_read_b128 v[168:171], v12 offset:5120
  v_mfma_f32_16x16x32_bf16 v[120:123], v[208:211], v[188:191], v[120:123]
  v_mfma_f32_16x16x32_bf16 v[40:43], v[212:215], v[176:179], v[40:43]
  ds_read_b128 v[172:175], v15 offset:0
  v_mfma_f32_16x16x32_bf16 v[68:71], v[212:215], v[180:183], v[68:71]
  v_mfma_f32_16x16x32_bf16 v[96:99], v[212:215], v[184:187], v[96:99]
  v_mfma_f32_16x16x32_bf16 v[124:127], v[212:215], v[188:191], v[124:127]
  v_mfma_f32_16x16x32_bf16 v[44:47], v[216:219], v[176:179], v[44:47]
  v_mfma_f32_16x16x32_bf16 v[72:75], v[216:219], v[180:183], v[72:75]
  v_mfma_f32_16x16x32_bf16 v[100:103], v[216:219], v[184:187], v[100:103]
  v_mfma_f32_16x16x32_bf16 v[128:131], v[216:219], v[188:191], v[128:131]
  s_waitcnt lgkmcnt(0)
  s_barrier
  v_mfma_f32_16x16x32_bf16 v[20:23], v[148:151], v[132:135], v[20:23]
  ds_read_b128 v[176:179], v9 offset:24576
  v_mfma_f32_16x16x32_bf16 v[48:51], v[148:151], v[136:139], v[48:51]
  v_mfma_f32_16x16x32_bf16 v[76:79], v[148:151], v[140:143], v[76:79]
  ds_read_b128 v[180:183], v9 offset:25600
  v_mfma_f32_16x16x32_bf16 v[104:107], v[148:151], v[144:147], v[104:107]
  v_mfma_f32_16x16x32_bf16 v[24:27], v[152:155], v[132:135], v[24:27]
  ds_read_b128 v[184:187], v9 offset:26624
  v_mfma_f32_16x16x32_bf16 v[52:55], v[152:155], v[136:139], v[52:55]
  v_mfma_f32_16x16x32_bf16 v[80:83], v[152:155], v[140:143], v[80:83]
  ds_read_b128 v[188:191], v9 offset:27648
  v_mfma_f32_16x16x32_bf16 v[108:111], v[152:155], v[144:147], v[108:111]
  v_mfma_f32_16x16x32_bf16 v[28:31], v[156:159], v[132:135], v[28:31]
  ds_read_b128 v[192:195], v12 offset:24576
  v_mfma_f32_16x16x32_bf16 v[56:59], v[156:159], v[136:139], v[56:59]
  v_mfma_f32_16x16x32_bf16 v[84:87], v[156:159], v[140:143], v[84:87]
  ds_read_b128 v[196:199], v12 offset:25600
  v_mfma_f32_16x16x32_bf16 v[112:115], v[156:159], v[144:147], v[112:115]
  v_mfma_f32_16x16x32_bf16 v[32:35], v[160:163], v[132:135], v[32:35]
  ds_read_b128 v[200:203], v12 offset:26624
  v_mfma_f32_16x16x32_bf16 v[60:63], v[160:163], v[136:139], v[60:63]
  v_mfma_f32_16x16x32_bf16 v[88:91], v[160:163], v[140:143], v[88:91]
  ds_read_b128 v[204:207], v12 offset:27648
  v_mfma_f32_16x16x32_bf16 v[116:119], v[160:163], v[144:147], v[116:119]
  v_mfma_f32_16x16x32_bf16 v[36:39], v[164:167], v[132:135], v[36:39]
  ds_read_b128 v[208:211], v12 offset:28672
  v_mfma_f32_16x16x32_bf16 v[64:67], v[164:167], v[136:139], v[64:67]
  v_mfma_f32_16x16x32_bf16 v[92:95], v[164:167], v[140:143], v[92:95]
  ds_read_b128 v[212:215], v12 offset:29696
  v_mfma_f32_16x16x32_bf16 v[120:123], v[164:167], v[144:147], v[120:123]
  v_mfma_f32_16x16x32_bf16 v[40:43], v[168:171], v[132:135], v[40:43]
  ds_read_b128 v[216:219], v15 offset:24576
  v_mfma_f32_16x16x32_bf16 v[68:71], v[168:171], v[136:139], v[68:71]
  v_mfma_f32_16x16x32_bf16 v[96:99], v[168:171], v[140:143], v[96:99]
  v_mfma_f32_16x16x32_bf16 v[124:127], v[168:171], v[144:147], v[124:127]
  v_mfma_f32_16x16x32_bf16 v[44:47], v[172:175], v[132:135], v[44:47]
  v_mfma_f32_16x16x32_bf16 v[72:75], v[172:175], v[136:139], v[72:75]
  v_mfma_f32_16x16x32_bf16 v[100:103], v[172:175], v[140:143], v[100:103]
  v_mfma_f32_16x16x32_bf16 v[128:131], v[172:175], v[144:147], v[128:131]
  s_waitcnt lgkmcnt(0)
  s_barrier
  v_mfma_f32_16x16x32_bf16 v[20:23], v[192:195], v[176:179], v[20:23]
  ds_read_b128 v[132:135], v10 offset:0
  v_mfma_f32_16x16x32_bf16 v[48:51], v[192:195], v[180:183], v[48:51]
  v_mfma_f32_16x16x32_bf16 v[76:79], v[192:195], v[184:187], v[76:79]
  ds_read_b128 v[136:139], v10 offset:1024
  v_mfma_f32_16x16x32_bf16 v[104:107], v[192:195], v[188:191], v[104:107]
  v_mfma_f32_16x16x32_bf16 v[24:27], v[196:199], v[176:179], v[24:27]
  ds_read_b128 v[140:143], v10 offset:2048
  v_mfma_f32_16x16x32_bf16 v[52:55], v[196:199], v[180:183], v[52:55]
  v_mfma_f32_16x16x32_bf16 v[80:83], v[196:199], v[184:187], v[80:83]
  ds_read_b128 v[144:147], v10 offset:3072
  v_mfma_f32_16x16x32_bf16 v[108:111], v[196:199], v[188:191], v[108:111]
  v_mfma_f32_16x16x32_bf16 v[28:31], v[200:203], v[176:179], v[28:31]
  ds_read_b128 v[148:151], v13 offset:0
  v_mfma_f32_16x16x32_bf16 v[56:59], v[200:203], v[180:183], v[56:59]
  v_mfma_f32_16x16x32_bf16 v[84:87], v[200:203], v[184:187], v[84:87]
  ds_read_b128 v[152:155], v13 offset:1024
  v_mfma_f32_16x16x32_bf16 v[112:115], v[200:203], v[188:191], v[112:115]
  v_mfma_f32_16x16x32_bf16 v[32:35], v[204:207], v[176:179], v[32:35]
  ds_read_b128 v[156:159], v13 offset:2048
  v_mfma_f32_16x16x32_bf16 v[60:63], v[204:207], v[180:183], v[60:63]
  v_mfma_f32_16x16x32_bf16 v[88:91], v[204:207], v[184:187], v[88:91]
  ds_read_b128 v[160:163], v13 offset:3072
  v_mfma_f32_16x16x32_bf16 v[116:119], v[204:207], v[188:191], v[116:119]
  v_mfma_f32_16x16x32_bf16 v[36:39], v[208:211], v[176:179], v[36:39]
  ds_read_b128 v[164:167], v13 offset:4096
  v_mfma_f32_16x16x32_bf16 v[64:67], v[208:211], v[180:183], v[64:67]
  v_mfma_f32_16x16x32_bf16 v[92:95], v[208:211], v[184:187], v[92:95]
  ds_read_b128 v[168:171], v13 offset:5120
  v_mfma_f32_16x16x32_bf16 v[120:123], v[208:211], v[188:191], v[120:123]
  v_mfma_f32_16x16x32_bf16 v[40:43], v[212:215], v[176:179], v[40:43]
  ds_read_b128 v[172:175], v16 offset:0
  v_mfma_f32_16x16x32_bf16 v[68:71], v[212:215], v[180:183], v[68:71]
  v_mfma_f32_16x16x32_bf16 v[96:99], v[212:215], v[184:187], v[96:99]
  v_mfma_f32_16x16x32_bf16 v[124:127], v[212:215], v[188:191], v[124:127]
  v_mfma_f32_16x16x32_bf16 v[44:47], v[216:219], v[176:179], v[44:47]
  v_mfma_f32_16x16x32_bf16 v[72:75], v[216:219], v[180:183], v[72:75]
  v_mfma_f32_16x16x32_bf16 v[100:103], v[216:219], v[184:187], v[100:103]
  v_mfma_f32_16x16x32_bf16 v[128:131], v[216:219], v[188:191], v[128:131]
  s_sub_u32 s11, s11, 1
  s_cmp_lg_u32 s11, 0
  s_cbranch_scc1 .Lmixer_kernel_c3
  s_waitcnt lgkmcnt(0)
  s_barrier
  s_nop 0
  v_mfma_f32_16x16x32_bf16 v[20:23], v[148:151], v[132:135], v[20:23]
  ds_read_b128 v[176:179], v10 offset:24576
  v_mfma_f32_16x16x32_bf16 v[48:51], v[148:151], v[136:139], v[48:51]
  v_mfma_f32_16x16x32_bf16 v[76:79], v[148:151], v[140:143], v[76:79]
  ds_read_b128 v[180:183], v10 offset:25600
  v_mfma_f32_16x16x32_bf16 v[104:107], v[148:151], v[144:147], v[104:107]
  v_mfma_f32_16x16x32_bf16 v[24:27], v[152:155], v[132:135], v[24:27]
  ds_read_b128 v[184:187], v10 offset:26624
  v_mfma_f32_16x16x32_bf16 v[52:55], v[152:155], v[136:139], v[52:55]
  v_mfma_f32_16x16x32_bf16 v[80:83], v[152:155], v[140:143], v[80:83]
  ds_read_b128 v[188:191], v10 offset:27648
  v_mfma_f32_16x16x32_bf16 v[108:111], v[152:155], v[144:147], v[108:111]
  v_mfma_f32_16x16x32_bf16 v[28:31], v[156:159], v[132:135], v[28:31]
  ds_read_b128 v[192:195], v13 offset:24576
  v_mfma_f32_16x16x32_bf16 v[56:59], v[156:159], v[136:139], v[56:59]
  v_mfma_f32_16x16x32_bf16 v[84:87], v[156:159], v[140:143], v[84:87]
  ds_read_b128 v[196:199], v13 offset:25600
  v_mfma_f32_16x16x32_bf16 v[112:115], v[156:159], v[144:147], v[112:115]
  v_mfma_f32_16x16x32_bf16 v[32:35], v[160:163], v[132:135], v[32:35]
  ds_read_b128 v[200:203], v13 offset:26624
  v_mfma_f32_16x16x32_bf16 v[60:63], v[160:163], v[136:139], v[60:63]
  v_mfma_f32_16x16x32_bf16 v[88:91], v[160:163], v[140:143], v[88:91]
  ds_read_b128 v[204:207], v13 offset:27648
  v_mfma_f32_16x16x32_bf16 v[116:119], v[160:163], v[144:147], v[116:119]
  v_mfma_f32_16x16x32_bf16 v[36:39], v[164:167], v[132:135], v[36:39]
  ds_read_b128 v[208:211], v13 offset:28672
  v_mfma_f32_16x16x32_bf16 v[64:67], v[164:167], v[136:139], v[64:67]
  v_mfma_f32_16x16x32_bf16 v[92:95], v[164:167], v[140:143], v[92:95]
  ds_read_b128 v[212:215], v13 offset:29696
  v_mfma_f32_16x16x32_bf16 v[120:123], v[164:167], v[144:147], v[120:123]
  v_mfma_f32_16x16x32_bf16 v[40:43], v[168:171], v[132:135], v[40:43]
  ds_read_b128 v[216:219], v16 offset:24576
  v_mfma_f32_16x16x32_bf16 v[68:71], v[168:171], v[136:139], v[68:71]
  v_mfma_f32_16x16x32_bf16 v[96:99], v[168:171], v[140:143], v[96:99]
  v_mfma_f32_16x16x32_bf16 v[124:127], v[168:171], v[144:147], v[124:127]
  v_mfma_f32_16x16x32_bf16 v[44:47], v[172:175], v[132:135], v[44:47]
  v_mfma_f32_16x16x32_bf16 v[72:75], v[172:175], v[136:139], v[72:75]
  v_mfma_f32_16x16x32_bf16 v[100:103], v[172:175], v[140:143], v[100:103]
  v_mfma_f32_16x16x32_bf16 v[128:131], v[172:175], v[144:147], v[128:131]
  s_waitcnt lgkmcnt(0)
  s_barrier
  v_mfma_f32_16x16x32_bf16 v[20:23], v[192:195], v[176:179], v[20:23]
  ds_read_b128 v[132:135], v11 offset:0
  v_mfma_f32_16x16x32_bf16 v[48:51], v[192:195], v[180:183], v[48:51]
  v_mfma_f32_16x16x32_bf16 v[76:79], v[192:195], v[184:187], v[76:79]
  ds_read_b128 v[136:139], v11 offset:1024
  v_mfma_f32_16x16x32_bf16 v[104:107], v[192:195], v[188:191], v[104:107]
  v_mfma_f32_16x16x32_bf16 v[24:27], v[196:199], v[176:179], v[24:27]
  ds_read_b128 v[140:143], v11 offset:2048
  v_mfma_f32_16x16x32_bf16 v[52:55], v[196:199], v[180:183], v[52:55]
  v_mfma_f32_16x16x32_bf16 v[80:83], v[196:199], v[184:187], v[80:83]
  ds_read_b128 v[144:147], v11 offset:3072
  v_mfma_f32_16x16x32_bf16 v[108:111], v[196:199], v[188:191], v[108:111]
  v_mfma_f32_16x16x32_bf16 v[28:31], v[200:203], v[176:179], v[28:31]
  ds_read_b128 v[148:151], v14 offset:0
  v_mfma_f32_16x16x32_bf16 v[56:59], v[200:203], v[180:183], v[56:59]
  v_mfma_f32_16x16x32_bf16 v[84:87], v[200:203], v[184:187], v[84:87]
  ds_read_b128 v[152:155], v14 offset:1024
  v_mfma_f32_16x16x32_bf16 v[112:115], v[200:203], v[188:191], v[112:115]
  v_mfma_f32_16x16x32_bf16 v[32:35], v[204:207], v[176:179], v[32:35]
  ds_read_b128 v[156:159], v14 offset:2048
  v_mfma_f32_16x16x32_bf16 v[60:63], v[204:207], v[180:183], v[60:63]
  v_mfma_f32_16x16x32_bf16 v[88:91], v[204:207], v[184:187], v[88:91]
  ds_read_b128 v[160:163], v14 offset:3072
  v_mfma_f32_16x16x32_bf16 v[116:119], v[204:207], v[188:191], v[116:119]
  v_mfma_f32_16x16x32_bf16 v[36:39], v[208:211], v[176:179], v[36:39]
  ds_read_b128 v[164:167], v14 offset:4096
  v_mfma_f32_16x16x32_bf16 v[64:67], v[208:211], v[180:183], v[64:67]
  v_mfma_f32_16x16x32_bf16 v[92:95], v[208:211], v[184:187], v[92:95]
  ds_read_b128 v[168:171], v14 offset:5120
  v_mfma_f32_16x16x32_bf16 v[120:123], v[208:211], v[188:191], v[120:123]
  v_mfma_f32_16x16x32_bf16 v[40:43], v[212:215], v[176:179], v[40:43]
  ds_read_b128 v[172:175], v17 offset:0
  v_mfma_f32_16x16x32_bf16 v[68:71], v[212:215], v[180:183], v[68:71]
  v_mfma_f32_16x16x32_bf16 v[96:99], v[212:215], v[184:187], v[96:99]
  v_mfma_f32_16x16x32_bf16 v[124:127], v[212:215], v[188:191], v[124:127]
  v_mfma_f32_16x16x32_bf16 v[44:47], v[216:219], v[176:179], v[44:47]
  v_mfma_f32_16x16x32_bf16 v[72:75], v[216:219], v[180:183], v[72:75]
  v_mfma_f32_16x16x32_bf16 v[100:103], v[216:219], v[184:187], v[100:103]
  v_mfma_f32_16x16x32_bf16 v[128:131], v[216:219], v[188:191], v[128:131]
  s_waitcnt lgkmcnt(0)
  s_barrier
  v_mfma_f32_16x16x32_bf16 v[20:23], v[148:151], v[132:135], v[20:23]
  ds_read_b128 v[176:179], v11 offset:24576
  v_mfma_f32_16x16x32_bf16 v[48:51], v[148:151], v[136:139], v[48:51]
  v_mfma_f32_16x16x32_bf16 v[76:79], v[148:151], v[140:143], v[76:79]
  ds_read_b128 v[180:183], v11 offset:25600
  v_mfma_f32_16x16x32_bf16 v[104:107], v[148:151], v[144:147], v[104:107]
  v_mfma_f32_16x16x32_bf16 v[24:27], v[152:155], v[132:135], v[24:27]
  ds_read_b128 v[184:187], v11 offset:26624
  v_mfma_f32_16x16x32_bf16 v[52:55], v[152:155], v[136:139], v[52:55]
  v_mfma_f32_16x16x32_bf16 v[80:83], v[152:155], v[140:143], v[80:83]
  ds_read_b128 v[188:191], v11 offset:27648
  v_mfma_f32_16x16x32_bf16 v[108:111], v[152:155], v[144:147], v[108:111]
  v_mfma_f32_16x16x32_bf16 v[28:31], v[156:159], v[132:135], v[28:31]
  ds_read_b128 v[192:195], v14 offset:24576
  v_mfma_f32_16x16x32_bf16 v[56:59], v[156:159], v[136:139], v[56:59]
  v_mfma_f32_16x16x32_bf16 v[84:87], v[156:159], v[140:143], v[84:87]
  ds_read_b128 v[196:199], v14 offset:25600
  v_mfma_f32_16x16x32_bf16 v[112:115], v[156:159], v[144:147], v[112:115]
  v_mfma_f32_16x16x32_bf16 v[32:35], v[160:163], v[132:135], v[32:35]
  ds_read_b128 v[200:203], v14 offset:26624
  v_mfma_f32_16x16x32_bf16 v[60:63], v[160:163], v[136:139], v[60:63]
  v_mfma_f32_16x16x32_bf16 v[88:91], v[160:163], v[140:143], v[88:91]
  ds_read_b128 v[204:207], v14 offset:27648
  v_mfma_f32_16x16x32_bf16 v[116:119], v[160:163], v[144:147], v[116:119]
  v_mfma_f32_16x16x32_bf16 v[36:39], v[164:167], v[132:135], v[36:39]
  ds_read_b128 v[208:211], v14 offset:28672
  v_mfma_f32_16x16x32_bf16 v[64:67], v[164:167], v[136:139], v[64:67]
  v_mfma_f32_16x16x32_bf16 v[92:95], v[164:167], v[140:143], v[92:95]
  ds_read_b128 v[212:215], v14 offset:29696
  v_mfma_f32_16x16x32_bf16 v[120:123], v[164:167], v[144:147], v[120:123]
  v_mfma_f32_16x16x32_bf16 v[40:43], v[168:171], v[132:135], v[40:43]
  ds_read_b128 v[216:219], v17 offset:24576
  v_mfma_f32_16x16x32_bf16 v[68:71], v[168:171], v[136:139], v[68:71]
  v_mfma_f32_16x16x32_bf16 v[96:99], v[168:171], v[140:143], v[96:99]
  v_mfma_f32_16x16x32_bf16 v[124:127], v[168:171], v[144:147], v[124:127]
  v_mfma_f32_16x16x32_bf16 v[44:47], v[172:175], v[132:135], v[44:47]
  v_mfma_f32_16x16x32_bf16 v[72:75], v[172:175], v[136:139], v[72:75]
  v_mfma_f32_16x16x32_bf16 v[100:103], v[172:175], v[140:143], v[100:103]
  v_mfma_f32_16x16x32_bf16 v[128:131], v[172:175], v[144:147], v[128:131]
  s_waitcnt lgkmcnt(0)
  s_barrier
  v_mfma_f32_16x16x32_bf16 v[20:23], v[192:195], v[176:179], v[20:23]
  ds_read_b128 v[132:135], v9 offset:0
  v_mfma_f32_16x16x32_bf16 v[48:51], v[192:195], v[180:183], v[48:51]
  v_mfma_f32_16x16x32_bf16 v[76:79], v[192:195], v[184:187], v[76:79]
  ds_read_b128 v[136:139], v9 offset:1024
  v_mfma_f32_16x16x32_bf16 v[104:107], v[192:195], v[188:191], v[104:107]
  v_mfma_f32_16x16x32_bf16 v[24:27], v[196:199], v[176:179], v[24:27]
  ds_read_b128 v[140:143], v9 offset:2048
  v_mfma_f32_16x16x32_bf16 v[52:55], v[196:199], v[180:183], v[52:55]
  v_mfma_f32_16x16x32_bf16 v[80:83], v[196:199], v[184:187], v[80:83]
  ds_read_b128 v[144:147], v9 offset:3072
  v_mfma_f32_16x16x32_bf16 v[108:111], v[196:199], v[188:191], v[108:111]
  v_mfma_f32_16x16x32_bf16 v[28:31], v[200:203], v[176:179], v[28:31]
  ds_read_b128 v[148:151], v12 offset:0
  v_mfma_f32_16x16x32_bf16 v[56:59], v[200:203], v[180:183], v[56:59]
  v_mfma_f32_16x16x32_bf16 v[84:87], v[200:203], v[184:187], v[84:87]
  ds_read_b128 v[152:155], v12 offset:1024
  v_mfma_f32_16x16x32_bf16 v[112:115], v[200:203], v[188:191], v[112:115]
  v_mfma_f32_16x16x32_bf16 v[32:35], v[204:207], v[176:179], v[32:35]
  ds_read_b128 v[156:159], v12 offset:2048
  v_mfma_f32_16x16x32_bf16 v[60:63], v[204:207], v[180:183], v[60:63]
  v_mfma_f32_16x16x32_bf16 v[88:91], v[204:207], v[184:187], v[88:91]
  ds_read_b128 v[160:163], v12 offset:3072
  v_mfma_f32_16x16x32_bf16 v[116:119], v[204:207], v[188:191], v[116:119]
  v_mfma_f32_16x16x32_bf16 v[36:39], v[208:211], v[176:179], v[36:39]
  ds_read_b128 v[164:167], v12 offset:4096
  v_mfma_f32_16x16x32_bf16 v[64:67], v[208:211], v[180:183], v[64:67]
  v_mfma_f32_16x16x32_bf16 v[92:95], v[208:211], v[184:187], v[92:95]
  ds_read_b128 v[168:171], v12 offset:5120
  v_mfma_f32_16x16x32_bf16 v[120:123], v[208:211], v[188:191], v[120:123]
  v_mfma_f32_16x16x32_bf16 v[40:43], v[212:215], v[176:179], v[40:43]
  ds_read_b128 v[172:175], v15 offset:0
  v_mfma_f32_16x16x32_bf16 v[68:71], v[212:215], v[180:183], v[68:71]
  v_mfma_f32_16x16x32_bf16 v[96:99], v[212:215], v[184:187], v[96:99]
  v_mfma_f32_16x16x32_bf16 v[124:127], v[212:215], v[188:191], v[124:127]
  v_mfma_f32_16x16x32_bf16 v[44:47], v[216:219], v[176:179], v[44:47]
  v_mfma_f32_16x16x32_bf16 v[72:75], v[216:219], v[180:183], v[72:75]
  v_mfma_f32_16x16x32_bf16 v[100:103], v[216:219], v[184:187], v[100:103]
  v_mfma_f32_16x16x32_bf16 v[128:131], v[216:219], v[188:191], v[128:131]
  s_waitcnt lgkmcnt(0)
  s_barrier
  v_mfma_f32_16x16x32_bf16 v[20:23], v[148:151], v[132:135], v[20:23]
  ds_read_b128 v[176:179], v9 offset:24576
  v_mfma_f32_16x16x32_bf16 v[48:51], v[148:151], v[136:139], v[48:51]
  v_mfma_f32_16x16x32_bf16 v[76:79], v[148:151], v[140:143], v[76:79]
  ds_read_b128 v[180:183], v9 offset:25600
  v_mfma_f32_16x16x32_bf16 v[104:107], v[148:151], v[144:147], v[104:107]
  v_mfma_f32_16x16x32_bf16 v[24:27], v[152:155], v[132:135], v[24:27]
  ds_read_b128 v[184:187], v9 offset:26624
  v_mfma_f32_16x16x32_bf16 v[52:55], v[152:155], v[136:139], v[52:55]
  v_mfma_f32_16x16x32_bf16 v[80:83], v[152:155], v[140:143], v[80:83]
  ds_read_b128 v[188:191], v9 offset:27648
  v_mfma_f32_16x16x32_bf16 v[108:111], v[152:155], v[144:147], v[108:111]
  v_mfma_f32_16x16x32_bf16 v[28:31], v[156:159], v[132:135], v[28:31]
  ds_read_b128 v[192:195], v12 offset:24576
  v_mfma_f32_16x16x32_bf16 v[56:59], v[156:159], v[136:139], v[56:59]
  v_mfma_f32_16x16x32_bf16 v[84:87], v[156:159], v[140:143], v[84:87]
  ds_read_b128 v[196:199], v12 offset:25600
  v_mfma_f32_16x16x32_bf16 v[112:115], v[156:159], v[144:147], v[112:115]
  v_mfma_f32_16x16x32_bf16 v[32:35], v[160:163], v[132:135], v[32:35]
  ds_read_b128 v[200:203], v12 offset:26624
  v_mfma_f32_16x16x32_bf16 v[60:63], v[160:163], v[136:139], v[60:63]
  v_mfma_f32_16x16x32_bf16 v[88:91], v[160:163], v[140:143], v[88:91]
  ds_read_b128 v[204:207], v12 offset:27648
  v_mfma_f32_16x16x32_bf16 v[116:119], v[160:163], v[144:147], v[116:119]
  v_mfma_f32_16x16x32_bf16 v[36:39], v[164:167], v[132:135], v[36:39]
  ds_read_b128 v[208:211], v12 offset:28672
  v_mfma_f32_16x16x32_bf16 v[64:67], v[164:167], v[136:139], v[64:67]
  v_mfma_f32_16x16x32_bf16 v[92:95], v[164:167], v[140:143], v[92:95]
  ds_read_b128 v[212:215], v12 offset:29696
  v_mfma_f32_16x16x32_bf16 v[120:123], v[164:167], v[144:147], v[120:123]
  v_mfma_f32_16x16x32_bf16 v[40:43], v[168:171], v[132:135], v[40:43]
  ds_read_b128 v[216:219], v15 offset:24576
  v_mfma_f32_16x16x32_bf16 v[68:71], v[168:171], v[136:139], v[68:71]
  v_mfma_f32_16x16x32_bf16 v[96:99], v[168:171], v[140:143], v[96:99]
  v_mfma_f32_16x16x32_bf16 v[124:127], v[168:171], v[144:147], v[124:127]
  v_mfma_f32_16x16x32_bf16 v[44:47], v[172:175], v[132:135], v[44:47]
  v_mfma_f32_16x16x32_bf16 v[72:75], v[172:175], v[136:139], v[72:75]
  v_mfma_f32_16x16x32_bf16 v[100:103], v[172:175], v[140:143], v[100:103]
  v_mfma_f32_16x16x32_bf16 v[128:131], v[172:175], v[144:147], v[128:131]
  s_waitcnt lgkmcnt(0)
  s_barrier
  v_mfma_f32_16x16x32_bf16 v[20:23], v[192:195], v[176:179], v[20:23]
  ds_read_b128 v[132:135], v10 offset:0
  v_mfma_f32_16x16x32_bf16 v[48:51], v[192:195], v[180:183], v[48:51]
  v_mfma_f32_16x16x32_bf16 v[76:79], v[192:195], v[184:187], v[76:79]
  ds_read_b128 v[136:139], v10 offset:1024
  v_mfma_f32_16x16x32_bf16 v[104:107], v[192:195], v[188:191], v[104:107]
  v_mfma_f32_16x16x32_bf16 v[24:27], v[196:199], v[176:179], v[24:27]
  ds_read_b128 v[140:143], v10 offset:2048
  v_mfma_f32_16x16x32_bf16 v[52:55], v[196:199], v[180:183], v[52:55]
  v_mfma_f32_16x16x32_bf16 v[80:83], v[196:199], v[184:187], v[80:83]
  ds_read_b128 v[144:147], v10 offset:3072
  v_mfma_f32_16x16x32_bf16 v[108:111], v[196:199], v[188:191], v[108:111]
  v_mfma_f32_16x16x32_bf16 v[28:31], v[200:203], v[176:179], v[28:31]
  ds_read_b128 v[148:151], v13 offset:0
  v_mfma_f32_16x16x32_bf16 v[56:59], v[200:203], v[180:183], v[56:59]
  v_mfma_f32_16x16x32_bf16 v[84:87], v[200:203], v[184:187], v[84:87]
  ds_read_b128 v[152:155], v13 offset:1024
  v_mfma_f32_16x16x32_bf16 v[112:115], v[200:203], v[188:191], v[112:115]
  v_mfma_f32_16x16x32_bf16 v[32:35], v[204:207], v[176:179], v[32:35]
  ds_read_b128 v[156:159], v13 offset:2048
  v_mfma_f32_16x16x32_bf16 v[60:63], v[204:207], v[180:183], v[60:63]
  v_mfma_f32_16x16x32_bf16 v[88:91], v[204:207], v[184:187], v[88:91]
  ds_read_b128 v[160:163], v13 offset:3072
  v_mfma_f32_16x16x32_bf16 v[116:119], v[204:207], v[188:191], v[116:119]
  v_mfma_f32_16x16x32_bf16 v[36:39], v[208:211], v[176:179], v[36:39]
  ds_read_b128 v[164:167], v13 offset:4096
  v_mfma_f32_16x16x32_bf16 v[64:67], v[208:211], v[180:183], v[64:67]
  v_mfma_f32_16x16x32_bf16 v[92:95], v[208:211], v[184:187], v[92:95]
  ds_read_b128 v[168:171], v13 offset:5120
  v_mfma_f32_16x16x32_bf16 v[120:123], v[208:211], v[188:191], v[120:123]
  v_mfma_f32_16x16x32_bf16 v[40:43], v[212:215], v[176:179], v[40:43]
  ds_read_b128 v[172:175], v16 offset:0
  v_mfma_f32_16x16x32_bf16 v[68:71], v[212:215], v[180:183], v[68:71]
  v_mfma_f32_16x16x32_bf16 v[96:99], v[212:215], v[184:187], v[96:99]
  v_mfma_f32_16x16x32_bf16 v[124:127], v[212:215], v[188:191], v[124:127]
  v_mfma_f32_16x16x32_bf16 v[44:47], v[216:219], v[176:179], v[44:47]
  v_mfma_f32_16x16x32_bf16 v[72:75], v[216:219], v[180:183], v[72:75]
  v_mfma_f32_16x16x32_bf16 v[100:103], v[216:219], v[184:187], v[100:103]
  v_mfma_f32_16x16x32_bf16 v[128:131], v[216:219], v[188:191], v[128:131]
  s_waitcnt lgkmcnt(0)
  s_barrier
  v_mfma_f32_16x16x32_bf16 v[20:23], v[148:151], v[132:135], v[20:23]
  ds_read_b128 v[176:179], v10 offset:24576
  v_mfma_f32_16x16x32_bf16 v[48:51], v[148:151], v[136:139], v[48:51]
  v_mfma_f32_16x16x32_bf16 v[76:79], v[148:151], v[140:143], v[76:79]
  ds_read_b128 v[180:183], v10 offset:25600
  v_mfma_f32_16x16x32_bf16 v[104:107], v[148:151], v[144:147], v[104:107]
  v_mfma_f32_16x16x32_bf16 v[24:27], v[152:155], v[132:135], v[24:27]
  ds_read_b128 v[184:187], v10 offset:26624
  v_mfma_f32_16x16x32_bf16 v[52:55], v[152:155], v[136:139], v[52:55]
  v_mfma_f32_16x16x32_bf16 v[80:83], v[152:155], v[140:143], v[80:83]
  ds_read_b128 v[188:191], v10 offset:27648
  v_mfma_f32_16x16x32_bf16 v[108:111], v[152:155], v[144:147], v[108:111]
  v_mfma_f32_16x16x32_bf16 v[28:31], v[156:159], v[132:135], v[28:31]
  ds_read_b128 v[192:195], v13 offset:24576
  v_mfma_f32_16x16x32_bf16 v[56:59], v[156:159], v[136:139], v[56:59]
  v_mfma_f32_16x16x32_bf16 v[84:87], v[156:159], v[140:143], v[84:87]
  ds_read_b128 v[196:199], v13 offset:25600
  v_mfma_f32_16x16x32_bf16 v[112:115], v[156:159], v[144:147], v[112:115]
  v_mfma_f32_16x16x32_bf16 v[32:35], v[160:163], v[132:135], v[32:35]
  ds_read_b128 v[200:203], v13 offset:26624
  v_mfma_f32_16x16x32_bf16 v[60:63], v[160:163], v[136:139], v[60:63]
  v_mfma_f32_16x16x32_bf16 v[88:91], v[160:163], v[140:143], v[88:91]
  ds_read_b128 v[204:207], v13 offset:27648
  v_mfma_f32_16x16x32_bf16 v[116:119], v[160:163], v[144:147], v[116:119]
  v_mfma_f32_16x16x32_bf16 v[36:39], v[164:167], v[132:135], v[36:39]
  ds_read_b128 v[208:211], v13 offset:28672
  v_mfma_f32_16x16x32_bf16 v[64:67], v[164:167], v[136:139], v[64:67]
  v_mfma_f32_16x16x32_bf16 v[92:95], v[164:167], v[140:143], v[92:95]
  ds_read_b128 v[212:215], v13 offset:29696
  v_mfma_f32_16x16x32_bf16 v[120:123], v[164:167], v[144:147], v[120:123]
  v_mfma_f32_16x16x32_bf16 v[40:43], v[168:171], v[132:135], v[40:43]
  ds_read_b128 v[216:219], v16 offset:24576
  v_mfma_f32_16x16x32_bf16 v[68:71], v[168:171], v[136:139], v[68:71]
  v_mfma_f32_16x16x32_bf16 v[96:99], v[168:171], v[140:143], v[96:99]
  v_mfma_f32_16x16x32_bf16 v[124:127], v[168:171], v[144:147], v[124:127]
  v_mfma_f32_16x16x32_bf16 v[44:47], v[172:175], v[132:135], v[44:47]
  v_mfma_f32_16x16x32_bf16 v[72:75], v[172:175], v[136:139], v[72:75]
  v_mfma_f32_16x16x32_bf16 v[100:103], v[172:175], v[140:143], v[100:103]
  v_mfma_f32_16x16x32_bf16 v[128:131], v[172:175], v[144:147], v[128:131]
  s_waitcnt lgkmcnt(0)
  s_nop 0
  v_mfma_f32_16x16x32_bf16 v[20:23], v[192:195], v[176:179], v[20:23]
  v_mfma_f32_16x16x32_bf16 v[48:51], v[192:195], v[180:183], v[48:51]
  v_mfma_f32_16x16x32_bf16 v[76:79], v[192:195], v[184:187], v[76:79]
  v_mfma_f32_16x16x32_bf16 v[104:107], v[192:195], v[188:191], v[104:107]
  v_mfma_f32_16x16x32_bf16 v[24:27], v[196:199], v[176:179], v[24:27]
  v_mfma_f32_16x16x32_bf16 v[52:55], v[196:199], v[180:183], v[52:55]
  v_mfma_f32_16x16x32_bf16 v[80:83], v[196:199], v[184:187], v[80:83]
  v_mfma_f32_16x16x32_bf16 v[108:111], v[196:199], v[188:191], v[108:111]
  v_mfma_f32_16x16x32_bf16 v[28:31], v[200:203], v[176:179], v[28:31]
  v_mfma_f32_16x16x32_bf16 v[56:59], v[200:203], v[180:183], v[56:59]
  v_mfma_f32_16x16x32_bf16 v[84:87], v[200:203], v[184:187], v[84:87]
  v_mfma_f32_16x16x32_bf16 v[112:115], v[200:203], v[188:191], v[112:115]
  v_mfma_f32_16x16x32_bf16 v[32:35], v[204:207], v[176:179], v[32:35]
  v_mfma_f32_16x16x32_bf16 v[60:63], v[204:207], v[180:183], v[60:63]
  v_mfma_f32_16x16x32_bf16 v[88:91], v[204:207], v[184:187], v[88:91]
  v_mfma_f32_16x16x32_bf16 v[116:119], v[204:207], v[188:191], v[116:119]
  v_mfma_f32_16x16x32_bf16 v[36:39], v[208:211], v[176:179], v[36:39]
  v_mfma_f32_16x16x32_bf16 v[64:67], v[208:211], v[180:183], v[64:67]
  v_mfma_f32_16x16x32_bf16 v[92:95], v[208:211], v[184:187], v[92:95]
  v_mfma_f32_16x16x32_bf16 v[120:123], v[208:211], v[188:191], v[120:123]
  v_mfma_f32_16x16x32_bf16 v[40:43], v[212:215], v[176:179], v[40:43]
  v_mfma_f32_16x16x32_bf16 v[68:71], v[212:215], v[180:183], v[68:71]
  v_mfma_f32_16x16x32_bf16 v[96:99], v[212:215], v[184:187], v[96:99]
  v_mfma_f32_16x16x32_bf16 v[124:127], v[212:215], v[188:191], v[124:127]
  v_mfma_f32_16x16x32_bf16 v[44:47], v[216:219], v[176:179], v[44:47]
  v_mfma_f32_16x16x32_bf16 v[72:75], v[216:219], v[180:183], v[72:75]
  v_mfma_f32_16x16x32_bf16 v[100:103], v[216:219], v[184:187], v[100:103]
  v_mfma_f32_16x16x32_bf16 v[128:131], v[216:219], v[188:191], v[128:131]
  s_barrier
  v_lshlrev_b32 v4, 4, v2
  s_lshr_b32 s43, s10, 1
  s_lshl_b32 s43, s43, 10
  s_add_u32 s43, s43, 148480
  v_add_u32_e64 v4, s43, v4
  ds_read_b128 v[160:163], v4 offset:0
  ds_read_b128 v[164:167], v4 offset:256
  ds_read_b128 v[168:171], v4 offset:512
  ds_read_b128 v[172:175], v4 offset:768
  v_lshlrev_b32 v5, 4, v3
  s_lshl_b32 s43, s48, 9
  s_add_u32 s43, s43, 147456
  v_add_u32 v4, s43, v5
  s_lshl_b32 s43, s48, 6
  s_add_u32 s43, s43, 147840
  v_add_u32_e64 v5, s43, v5
  ds_read_b128 v[176:179], v4 offset:0
  ds_read_b128 v[180:183], v4 offset:64
  ds_read_b128 v[184:187], v4 offset:128
  ds_read_b128 v[188:191], v4 offset:192
  ds_read_b128 v[192:195], v4 offset:256
  ds_read_b128 v[196:199], v4 offset:320
  ds_read_b128 v[200:203], v5
  s_mul_i32 s43, s38, 114688
  s_mul_i32 s44, s37, 7168
  s_add_u32 s43, s43, s44
  s_mul_i32 s44, s48, 229376
  s_add_u32 s39, s43, s44
  s_add_u32 s39, s39, 3072
  s_add_u32 s40, s39, 114688
  s_lshl_b32 s44, s48, 12
  s_add_u32 s43, s43, s44
  s_add_u32 s44, s43, 114688
  s_add_u32 s45, s44, 114688
  s_add_u32 s46, s45, 114688
  s_lshr_b32 s41, s10, 1
  s_lshl_b32 s41, s41, 12
  s_add_u32 s41, s41, 152576
  v_add_u32 v10, s41, v7
  s_lshl_b32 s42, s48, 3
  v_add_u32 v9, s42, v10
  s_lshl_b32 s42, s48, 11
  v_add_u32 v10, s42, v10
  s_waitcnt lgkmcnt(0)
  v_pk_fma_f32 v[20:21], v[176:177], v[160:161], v[20:21] op_sel:[0,0,0] op_sel_hi:[1,0,1] neg_lo:[1,0,0] neg_hi:[1,0,0]
  v_pk_fma_f32 v[22:23], v[178:179], v[160:161], v[22:23] op_sel:[0,0,0] op_sel_hi:[1,0,1] neg_lo:[1,0,0] neg_hi:[1,0,0]
  v_pk_fma_f32 v[24:25], v[180:181], v[160:161], v[24:25] op_sel:[0,0,0] op_sel_hi:[1,0,1] neg_lo:[1,0,0] neg_hi:[1,0,0]
  v_pk_fma_f32 v[26:27], v[182:183], v[160:161], v[26:27] op_sel:[0,0,0] op_sel_hi:[1,0,1] neg_lo:[1,0,0] neg_hi:[1,0,0]
  v_pk_mul_f32 v[132:133], v[20:21], v[20:21]
  v_pk_mul_f32 v[136:137], v[22:23], v[22:23]
  v_pk_mul_f32 v[140:141], v[24:25], v[24:25]
  v_pk_mul_f32 v[144:145], v[26:27], v[26:27]
  v_pk_fma_f32 v[132:133], v[132:133], v[162:163], v[162:163] op_sel:[0,1,0] op_sel_hi:[1,1,0]
  v_pk_fma_f32 v[136:137], v[136:137], v[162:163], v[162:163] op_sel:[0,1,0] op_sel_hi:[1,1,0]
  v_pk_fma_f32 v[140:141], v[140:141], v[162:163], v[162:163] op_sel:[0,1,0] op_sel_hi:[1,1,0]
  v_pk_fma_f32 v[144:145], v[144:145], v[162:163], v[162:163] op_sel:[0,1,0] op_sel_hi:[1,1,0]
  v_pk_mul_f32 v[132:133], v[20:21], v[132:133]
  v_pk_mul_f32 v[136:137], v[22:23], v[136:137]
  v_pk_mul_f32 v[140:141], v[24:25], v[140:141]
  v_pk_mul_f32 v[144:145], v[26:27], v[144:145]
  v_exp_f32 v134, v132
  v_exp_f32 v138, v136
  v_exp_f32 v142, v140
  v_exp_f32 v146, v144
  v_exp_f32 v135, v133
  v_exp_f32 v139, v137
  v_exp_f32 v143, v141
  v_exp_f32 v147, v145
  v_pk_fma_f32 v[134:135], v[134:135], v[160:161], v[160:161] op_sel:[0,1,1] op_sel_hi:[1,1,1]
  v_pk_fma_f32 v[138:139], v[138:139], v[160:161], v[160:161] op_sel:[0,1,1] op_sel_hi:[1,1,1]
  v_pk_fma_f32 v[142:143], v[142:143], v[160:161], v[160:161] op_sel:[0,1,1] op_sel_hi:[1,1,1]
  v_pk_fma_f32 v[146:147], v[146:147], v[160:161], v[160:161] op_sel:[0,1,1] op_sel_hi:[1,1,1]
  v_rcp_f32 v132, v134
  v_rcp_f32 v136, v138
  v_rcp_f32 v140, v142
  v_rcp_f32 v144, v146
  v_rcp_f32 v133, v135
  v_rcp_f32 v137, v139
  v_rcp_f32 v141, v143
  v_rcp_f32 v145, v147
  v_pk_mul_f32 v[20:21], v[20:21], v[132:133]
  v_pk_mul_f32 v[22:23], v[22:23], v[136:137]
  v_pk_mul_f32 v[24:25], v[24:25], v[140:141]
  v_pk_mul_f32 v[26:27], v[26:27], v[144:145]
  v_cvt_pk_bf16_f32 v148, v20, v21
  v_cvt_pk_bf16_f32 v149, v22, v23
  v_cvt_pk_bf16_f32 v150, v24, v25
  v_cvt_pk_bf16_f32 v151, v26, v27
  buffer_store_dwordx4 v[148:151], v7, s[32:35], s43 offen offset:0 sc1
  v_pk_fma_f32 v[48:49], v[176:177], v[164:165], v[48:49] op_sel:[0,0,0] op_sel_hi:[1,0,1] neg_lo:[1,0,0] neg_hi:[1,0,0]
  v_pk_fma_f32 v[50:51], v[178:179], v[164:165], v[50:51] op_sel:[0,0,0] op_sel_hi:[1,0,1] neg_lo:[1,0,0] neg_hi:[1,0,0]
  v_pk_fma_f32 v[52:53], v[180:181], v[164:165], v[52:53] op_sel:[0,0,0] op_sel_hi:[1,0,1] neg_lo:[1,0,0] neg_hi:[1,0,0]
  v_pk_fma_f32 v[54:55], v[182:183], v[164:165], v[54:55] op_sel:[0,0,0] op_sel_hi:[1,0,1] neg_lo:[1,0,0] neg_hi:[1,0,0]
  v_pk_mul_f32 v[132:133], v[48:49], v[48:49]
  v_pk_mul_f32 v[136:137], v[50:51], v[50:51]
  v_pk_mul_f32 v[140:141], v[52:53], v[52:53]
  v_pk_mul_f32 v[144:145], v[54:55], v[54:55]
  v_pk_fma_f32 v[132:133], v[132:133], v[166:167], v[166:167] op_sel:[0,1,0] op_sel_hi:[1,1,0]
  v_pk_fma_f32 v[136:137], v[136:137], v[166:167], v[166:167] op_sel:[0,1,0] op_sel_hi:[1,1,0]
  v_pk_fma_f32 v[140:141], v[140:141], v[166:167], v[166:167] op_sel:[0,1,0] op_sel_hi:[1,1,0]
  v_pk_fma_f32 v[144:145], v[144:145], v[166:167], v[166:167] op_sel:[0,1,0] op_sel_hi:[1,1,0]
  v_pk_mul_f32 v[132:133], v[48:49], v[132:133]
  v_pk_mul_f32 v[136:137], v[50:51], v[136:137]
  v_pk_mul_f32 v[140:141], v[52:53], v[140:141]
  v_pk_mul_f32 v[144:145], v[54:55], v[144:145]
  v_exp_f32 v134, v132
  v_exp_f32 v138, v136
  v_exp_f32 v142, v140
  v_exp_f32 v146, v144
  v_exp_f32 v135, v133
  v_exp_f32 v139, v137
  v_exp_f32 v143, v141
  v_exp_f32 v147, v145
  v_pk_fma_f32 v[134:135], v[134:135], v[164:165], v[164:165] op_sel:[0,1,1] op_sel_hi:[1,1,1]
  v_pk_fma_f32 v[138:139], v[138:139], v[164:165], v[164:165] op_sel:[0,1,1] op_sel_hi:[1,1,1]
  v_pk_fma_f32 v[142:143], v[142:143], v[164:165], v[164:165] op_sel:[0,1,1] op_sel_hi:[1,1,1]
  v_pk_fma_f32 v[146:147], v[146:147], v[164:165], v[164:165] op_sel:[0,1,1] op_sel_hi:[1,1,1]
  v_rcp_f32 v132, v134
  v_rcp_f32 v136, v138
  v_rcp_f32 v140, v142
  v_rcp_f32 v144, v146
  v_rcp_f32 v133, v135
  v_rcp_f32 v137, v139
  v_rcp_f32 v141, v143
  v_rcp_f32 v145, v147
  v_pk_mul_f32 v[48:49], v[48:49], v[132:133]
  v_pk_mul_f32 v[50:51], v[50:51], v[136:137]
  v_pk_mul_f32 v[52:53], v[52:53], v[140:141]
  v_pk_mul_f32 v[54:55], v[54:55], v[144:145]
  v_cvt_pk_bf16_f32 v152, v48, v49
  v_cvt_pk_bf16_f32 v153, v50, v51
  v_cvt_pk_bf16_f32 v154, v52, v53
  v_cvt_pk_bf16_f32 v155, v54, v55
  buffer_store_dwordx4 v[152:155], v7, s[32:35], s44 offen offset:0 sc1
  v_pk_fma_f32 v[76:77], v[176:177], v[168:169], v[76:77] op_sel:[0,0,0] op_sel_hi:[1,0,1] neg_lo:[1,0,0] neg_hi:[1,0,0]
  v_pk_fma_f32 v[78:79], v[178:179], v[168:169], v[78:79] op_sel:[0,0,0] op_sel_hi:[1,0,1] neg_lo:[1,0,0] neg_hi:[1,0,0]
  v_pk_fma_f32 v[80:81], v[180:181], v[168:169], v[80:81] op_sel:[0,0,0] op_sel_hi:[1,0,1] neg_lo:[1,0,0] neg_hi:[1,0,0]
  v_pk_fma_f32 v[82:83], v[182:183], v[168:169], v[82:83] op_sel:[0,0,0] op_sel_hi:[1,0,1] neg_lo:[1,0,0] neg_hi:[1,0,0]
  v_pk_mul_f32 v[132:133], v[76:77], v[76:77]
  v_pk_mul_f32 v[136:137], v[78:79], v[78:79]
  v_pk_mul_f32 v[140:141], v[80:81], v[80:81]
  v_pk_mul_f32 v[144:145], v[82:83], v[82:83]
  v_pk_fma_f32 v[132:133], v[132:133], v[170:171], v[170:171] op_sel:[0,1,0] op_sel_hi:[1,1,0]
  v_pk_fma_f32 v[136:137], v[136:137], v[170:171], v[170:171] op_sel:[0,1,0] op_sel_hi:[1,1,0]
  v_pk_fma_f32 v[140:141], v[140:141], v[170:171], v[170:171] op_sel:[0,1,0] op_sel_hi:[1,1,0]
  v_pk_fma_f32 v[144:145], v[144:145], v[170:171], v[170:171] op_sel:[0,1,0] op_sel_hi:[1,1,0]
  v_pk_mul_f32 v[132:133], v[76:77], v[132:133]
  v_pk_mul_f32 v[136:137], v[78:79], v[136:137]
  v_pk_mul_f32 v[140:141], v[80:81], v[140:141]
  v_pk_mul_f32 v[144:145], v[82:83], v[144:145]
  v_exp_f32 v134, v132
  v_exp_f32 v138, v136
  v_exp_f32 v142, v140
  v_exp_f32 v146, v144
  v_exp_f32 v135, v133
  v_exp_f32 v139, v137
  v_exp_f32 v143, v141
  v_exp_f32 v147, v145
  v_pk_fma_f32 v[134:135], v[134:135], v[168:169], v[168:169] op_sel:[0,1,1] op_sel_hi:[1,1,1]
  v_pk_fma_f32 v[138:139], v[138:139], v[168:169], v[168:169] op_sel:[0,1,1] op_sel_hi:[1,1,1]
  v_pk_fma_f32 v[142:143], v[142:143], v[168:169], v[168:169] op_sel:[0,1,1] op_sel_hi:[1,1,1]
  v_pk_fma_f32 v[146:147], v[146:147], v[168:169], v[168:169] op_sel:[0,1,1] op_sel_hi:[1,1,1]
  v_rcp_f32 v132, v134
  v_rcp_f32 v136, v138
  v_rcp_f32 v140, v142
  v_rcp_f32 v144, v146
  v_rcp_f32 v133, v135
  v_rcp_f32 v137, v139
  v_rcp_f32 v141, v143
  v_rcp_f32 v145, v147
  v_pk_mul_f32 v[76:77], v[76:77], v[132:133]
  v_pk_mul_f32 v[78:79], v[78:79], v[136:137]
  v_pk_mul_f32 v[80:81], v[80:81], v[140:141]
  v_pk_mul_f32 v[82:83], v[82:83], v[144:145]
  v_cvt_pk_bf16_f32 v156, v76, v77
  v_cvt_pk_bf16_f32 v157, v78, v79
  v_cvt_pk_bf16_f32 v158, v80, v81
  v_cvt_pk_bf16_f32 v159, v82, v83
  buffer_store_dwordx4 v[156:159], v7, s[32:35], s45 offen offset:0 sc1
  v_pk_fma_f32 v[104:105], v[176:177], v[172:173], v[104:105] op_sel:[0,0,0] op_sel_hi:[1,0,1] neg_lo:[1,0,0] neg_hi:[1,0,0]
  v_pk_fma_f32 v[106:107], v[178:179], v[172:173], v[106:107] op_sel:[0,0,0] op_sel_hi:[1,0,1] neg_lo:[1,0,0] neg_hi:[1,0,0]
  v_pk_fma_f32 v[108:109], v[180:181], v[172:173], v[108:109] op_sel:[0,0,0] op_sel_hi:[1,0,1] neg_lo:[1,0,0] neg_hi:[1,0,0]
  v_pk_fma_f32 v[110:111], v[182:183], v[172:173], v[110:111] op_sel:[0,0,0] op_sel_hi:[1,0,1] neg_lo:[1,0,0] neg_hi:[1,0,0]
  v_pk_mul_f32 v[132:133], v[104:105], v[104:105]
  v_pk_mul_f32 v[136:137], v[106:107], v[106:107]
  v_pk_mul_f32 v[140:141], v[108:109], v[108:109]
  v_pk_mul_f32 v[144:145], v[110:111], v[110:111]
  v_pk_fma_f32 v[132:133], v[132:133], v[174:175], v[174:175] op_sel:[0,1,0] op_sel_hi:[1,1,0]
  v_pk_fma_f32 v[136:137], v[136:137], v[174:175], v[174:175] op_sel:[0,1,0] op_sel_hi:[1,1,0]
  v_pk_fma_f32 v[140:141], v[140:141], v[174:175], v[174:175] op_sel:[0,1,0] op_sel_hi:[1,1,0]
  v_pk_fma_f32 v[144:145], v[144:145], v[174:175], v[174:175] op_sel:[0,1,0] op_sel_hi:[1,1,0]
  v_pk_mul_f32 v[132:133], v[104:105], v[132:133]
  v_pk_mul_f32 v[136:137], v[106:107], v[136:137]
  v_pk_mul_f32 v[140:141], v[108:109], v[140:141]
  v_pk_mul_f32 v[144:145], v[110:111], v[144:145]
  v_exp_f32 v134, v132
  v_exp_f32 v138, v136
  v_exp_f32 v142, v140
  v_exp_f32 v146, v144
  v_exp_f32 v135, v133
  v_exp_f32 v139, v137
  v_exp_f32 v143, v141
  v_exp_f32 v147, v145
  v_pk_fma_f32 v[134:135], v[134:135], v[172:173], v[172:173] op_sel:[0,1,1] op_sel_hi:[1,1,1]
  v_pk_fma_f32 v[138:139], v[138:139], v[172:173], v[172:173] op_sel:[0,1,1] op_sel_hi:[1,1,1]
  v_pk_fma_f32 v[142:143], v[142:143], v[172:173], v[172:173] op_sel:[0,1,1] op_sel_hi:[1,1,1]
  v_pk_fma_f32 v[146:147], v[146:147], v[172:173], v[172:173] op_sel:[0,1,1] op_sel_hi:[1,1,1]
  v_rcp_f32 v132, v134
  v_rcp_f32 v136, v138
  v_rcp_f32 v140, v142
  v_rcp_f32 v144, v146
  v_rcp_f32 v133, v135
  v_rcp_f32 v137, v139
  v_rcp_f32 v141, v143
  v_rcp_f32 v145, v147
  v_pk_mul_f32 v[104:105], v[104:105], v[132:133]
  v_pk_mul_f32 v[106:107], v[106:107], v[136:137]
  v_pk_mul_f32 v[108:109], v[108:109], v[140:141]
  v_pk_mul_f32 v[110:111], v[110:111], v[144:145]
  v_cvt_pk_bf16_f32 v148, v104, v105
  v_cvt_pk_bf16_f32 v149, v106, v107
  v_cvt_pk_bf16_f32 v150, v108, v109
  v_cvt_pk_bf16_f32 v151, v110, v111
  buffer_store_dwordx4 v[148:151], v7, s[32:35], s46 offen offset:0 sc1
  v_pk_fma_f32 v[44:45], v[200:201], v[160:161], v[44:45] op_sel:[0,0,0] op_sel_hi:[1,0,1] neg_lo:[1,0,0] neg_hi:[1,0,0]
  v_pk_fma_f32 v[46:47], v[202:203], v[160:161], v[46:47] op_sel:[0,0,0] op_sel_hi:[1,0,1] neg_lo:[1,0,0] neg_hi:[1,0,0]
  v_pk_fma_f32 v[72:73], v[200:201], v[164:165], v[72:73] op_sel:[0,0,0] op_sel_hi:[1,0,1] neg_lo:[1,0,0] neg_hi:[1,0,0]
  v_pk_fma_f32 v[74:75], v[202:203], v[164:165], v[74:75] op_sel:[0,0,0] op_sel_hi:[1,0,1] neg_lo:[1,0,0] neg_hi:[1,0,0]
  v_pk_mul_f32 v[132:133], v[44:45], v[44:45]
  v_pk_mul_f32 v[136:137], v[46:47], v[46:47]
  v_pk_mul_f32 v[140:141], v[72:73], v[72:73]
  v_pk_mul_f32 v[144:145], v[74:75], v[74:75]
  v_pk_fma_f32 v[132:133], v[132:133], v[162:163], v[162:163] op_sel:[0,1,0] op_sel_hi:[1,1,0]
  v_pk_fma_f32 v[136:137], v[136:137], v[162:163], v[162:163] op_sel:[0,1,0] op_sel_hi:[1,1,0]
  v_pk_fma_f32 v[140:141], v[140:141], v[166:167], v[166:167] op_sel:[0,1,0] op_sel_hi:[1,1,0]
  v_pk_fma_f32 v[144:145], v[144:145], v[166:167], v[166:167] op_sel:[0,1,0] op_sel_hi:[1,1,0]
  v_pk_mul_f32 v[132:133], v[44:45], v[132:133]
  v_pk_mul_f32 v[136:137], v[46:47], v[136:137]
  v_pk_mul_f32 v[140:141], v[72:73], v[140:141]
  v_pk_mul_f32 v[144:145], v[74:75], v[144:145]
  v_exp_f32 v134, v132
  v_exp_f32 v138, v136
  v_exp_f32 v142, v140
  v_exp_f32 v146, v144
  v_exp_f32 v135, v133
  v_exp_f32 v139, v137
  v_exp_f32 v143, v141
  v_exp_f32 v147, v145
  v_pk_fma_f32 v[134:135], v[134:135], v[160:161], v[160:161] op_sel:[0,1,1] op_sel_hi:[1,1,1]
  v_pk_fma_f32 v[138:139], v[138:139], v[160:161], v[160:161] op_sel:[0,1,1] op_sel_hi:[1,1,1]
  v_pk_fma_f32 v[142:143], v[142:143], v[164:165], v[164:165] op_sel:[0,1,1] op_sel_hi:[1,1,1]
  v_pk_fma_f32 v[146:147], v[146:147], v[164:165], v[164:165] op_sel:[0,1,1] op_sel_hi:[1,1,1]
  v_rcp_f32 v132, v134
  v_rcp_f32 v136, v138
  v_rcp_f32 v140, v142
  v_rcp_f32 v144, v146
  v_rcp_f32 v133, v135
  v_rcp_f32 v137, v139
  v_rcp_f32 v141, v143
  v_rcp_f32 v145, v147
  v_pk_mul_f32 v[44:45], v[44:45], v[132:133]
  v_pk_mul_f32 v[46:47], v[46:47], v[136:137]
  v_pk_mul_f32 v[72:73], v[72:73], v[140:141]
  v_pk_mul_f32 v[74:75], v[74:75], v[144:145]
  v_cvt_pk_bf16_f32 v152, v44, v45
  v_cvt_pk_bf16_f32 v153, v46, v47
  v_cvt_pk_bf16_f32 v154, v72, v73
  v_cvt_pk_bf16_f32 v155, v74, v75
  ds_write_b64 v9, v[152:153] offset:0
  ds_write_b64 v9, v[154:155] offset:1024
  v_pk_fma_f32 v[100:101], v[200:201], v[168:169], v[100:101] op_sel:[0,0,0] op_sel_hi:[1,0,1] neg_lo:[1,0,0] neg_hi:[1,0,0]
  v_pk_fma_f32 v[102:103], v[202:203], v[168:169], v[102:103] op_sel:[0,0,0] op_sel_hi:[1,0,1] neg_lo:[1,0,0] neg_hi:[1,0,0]
  v_pk_fma_f32 v[128:129], v[200:201], v[172:173], v[128:129] op_sel:[0,0,0] op_sel_hi:[1,0,1] neg_lo:[1,0,0] neg_hi:[1,0,0]
  v_pk_fma_f32 v[130:131], v[202:203], v[172:173], v[130:131] op_sel:[0,0,0] op_sel_hi:[1,0,1] neg_lo:[1,0,0] neg_hi:[1,0,0]
  v_pk_mul_f32 v[132:133], v[100:101], v[100:101]
  v_pk_mul_f32 v[136:137], v[102:103], v[102:103]
  v_pk_mul_f32 v[140:141], v[128:129], v[128:129]
  v_pk_mul_f32 v[144:145], v[130:131], v[130:131]
  v_pk_fma_f32 v[132:133], v[132:133], v[170:171], v[170:171] op_sel:[0,1,0] op_sel_hi:[1,1,0]
  v_pk_fma_f32 v[136:137], v[136:137], v[170:171], v[170:171] op_sel:[0,1,0] op_sel_hi:[1,1,0]
  v_pk_fma_f32 v[140:141], v[140:141], v[174:175], v[174:175] op_sel:[0,1,0] op_sel_hi:[1,1,0]
  v_pk_fma_f32 v[144:145], v[144:145], v[174:175], v[174:175] op_sel:[0,1,0] op_sel_hi:[1,1,0]
  v_pk_mul_f32 v[132:133], v[100:101], v[132:133]
  v_pk_mul_f32 v[136:137], v[102:103], v[136:137]
  v_pk_mul_f32 v[140:141], v[128:129], v[140:141]
  v_pk_mul_f32 v[144:145], v[130:131], v[144:145]
  v_exp_f32 v134, v132
  v_exp_f32 v138, v136
  v_exp_f32 v142, v140
  v_exp_f32 v146, v144
  v_exp_f32 v135, v133
  v_exp_f32 v139, v137
  v_exp_f32 v143, v141
  v_exp_f32 v147, v145
  v_pk_fma_f32 v[134:135], v[134:135], v[168:169], v[168:169] op_sel:[0,1,1] op_sel_hi:[1,1,1]
  v_pk_fma_f32 v[138:139], v[138:139], v[168:169], v[168:169] op_sel:[0,1,1] op_sel_hi:[1,1,1]
  v_pk_fma_f32 v[142:143], v[142:143], v[172:173], v[172:173] op_sel:[0,1,1] op_sel_hi:[1,1,1]
  v_pk_fma_f32 v[146:147], v[146:147], v[172:173], v[172:173] op_sel:[0,1,1] op_sel_hi:[1,1,1]
  v_rcp_f32 v132, v134
  v_rcp_f32 v136, v138
  v_rcp_f32 v140, v142
  v_rcp_f32 v144, v146
  v_rcp_f32 v133, v135
  v_rcp_f32 v137, v139
  v_rcp_f32 v141, v143
  v_rcp_f32 v145, v147
  v_pk_mul_f32 v[100:101], v[100:101], v[132:133]
  v_pk_mul_f32 v[102:103], v[102:103], v[136:137]
  v_pk_mul_f32 v[128:129], v[128:129], v[140:141]
  v_pk_mul_f32 v[130:131], v[130:131], v[144:145]
  v_cvt_pk_bf16_f32 v156, v100, v101
  v_cvt_pk_bf16_f32 v157, v102, v103
  v_cvt_pk_bf16_f32 v158, v128, v129
  v_cvt_pk_bf16_f32 v159, v130, v131
  ds_write_b64 v9, v[156:157] offset:2048
  ds_write_b64 v9, v[158:159] offset:3072
  s_waitcnt lgkmcnt(0)
  v_mov_b32 v4, 151580
  s_mov_b64 exec, 1
  ds_add_u32 v4, v8
  s_mov_b64 exec, -1
  s_nop 0
  v_pk_fma_f32 v[28:29], v[184:185], v[160:161], v[28:29] op_sel:[0,0,0] op_sel_hi:[1,0,1] neg_lo:[1,0,0] neg_hi:[1,0,0]
  v_pk_fma_f32 v[30:31], v[186:187], v[160:161], v[30:31] op_sel:[0,0,0] op_sel_hi:[1,0,1] neg_lo:[1,0,0] neg_hi:[1,0,0]
  v_pk_fma_f32 v[32:33], v[188:189], v[160:161], v[32:33] op_sel:[0,0,0] op_sel_hi:[1,0,1] neg_lo:[1,0,0] neg_hi:[1,0,0]
  v_pk_fma_f32 v[34:35], v[190:191], v[160:161], v[34:35] op_sel:[0,0,0] op_sel_hi:[1,0,1] neg_lo:[1,0,0] neg_hi:[1,0,0]
  v_pk_mul_f32 v[132:133], v[28:29], v[28:29]
  v_pk_mul_f32 v[136:137], v[30:31], v[30:31]
  v_pk_mul_f32 v[140:141], v[32:33], v[32:33]
  v_pk_mul_f32 v[144:145], v[34:35], v[34:35]
  v_pk_fma_f32 v[132:133], v[132:133], v[162:163], v[162:163] op_sel:[0,1,0] op_sel_hi:[1,1,0]
  v_pk_fma_f32 v[136:137], v[136:137], v[162:163], v[162:163] op_sel:[0,1,0] op_sel_hi:[1,1,0]
  v_pk_fma_f32 v[140:141], v[140:141], v[162:163], v[162:163] op_sel:[0,1,0] op_sel_hi:[1,1,0]
  v_pk_fma_f32 v[144:145], v[144:145], v[162:163], v[162:163] op_sel:[0,1,0] op_sel_hi:[1,1,0]
  v_pk_mul_f32 v[132:133], v[28:29], v[132:133]
  v_pk_mul_f32 v[136:137], v[30:31], v[136:137]
  v_pk_mul_f32 v[140:141], v[32:33], v[140:141]
  v_pk_mul_f32 v[144:145], v[34:35], v[144:145]
  v_exp_f32 v134, v132
  v_exp_f32 v138, v136
  v_exp_f32 v142, v140
  v_exp_f32 v146, v144
  v_exp_f32 v135, v133
  v_exp_f32 v139, v137
  v_exp_f32 v143, v141
  v_exp_f32 v147, v145
  v_pk_fma_f32 v[134:135], v[134:135], v[160:161], v[160:161] op_sel:[0,1,1] op_sel_hi:[1,1,1]
  v_pk_fma_f32 v[138:139], v[138:139], v[160:161], v[160:161] op_sel:[0,1,1] op_sel_hi:[1,1,1]
  v_pk_fma_f32 v[142:143], v[142:143], v[160:161], v[160:161] op_sel:[0,1,1] op_sel_hi:[1,1,1]
  v_pk_fma_f32 v[146:147], v[146:147], v[160:161], v[160:161] op_sel:[0,1,1] op_sel_hi:[1,1,1]
  v_rcp_f32 v132, v134
  v_rcp_f32 v136, v138
  v_rcp_f32 v140, v142
  v_rcp_f32 v144, v146
  v_rcp_f32 v133, v135
  v_rcp_f32 v137, v139
  v_rcp_f32 v141, v143
  v_rcp_f32 v145, v147
  v_pk_mul_f32 v[28:29], v[28:29], v[132:133]
  v_pk_mul_f32 v[30:31], v[30:31], v[136:137]
  v_pk_mul_f32 v[32:33], v[32:33], v[140:141]
  v_pk_mul_f32 v[34:35], v[34:35], v[144:145]
  v_cvt_pk_bf16_f32 v148, v28, v29
  v_cvt_pk_bf16_f32 v149, v30, v31
  v_cvt_pk_bf16_f32 v150, v32, v33
  v_cvt_pk_bf16_f32 v151, v34, v35
  buffer_store_dwordx4 v[148:151], v7, s[32:35], s43 offen offset:1024 sc1
  v_pk_fma_f32 v[56:57], v[184:185], v[164:165], v[56:57] op_sel:[0,0,0] op_sel_hi:[1,0,1] neg_lo:[1,0,0] neg_hi:[1,0,0]
  v_pk_fma_f32 v[58:59], v[186:187], v[164:165], v[58:59] op_sel:[0,0,0] op_sel_hi:[1,0,1] neg_lo:[1,0,0] neg_hi:[1,0,0]
  v_pk_fma_f32 v[60:61], v[188:189], v[164:165], v[60:61] op_sel:[0,0,0] op_sel_hi:[1,0,1] neg_lo:[1,0,0] neg_hi:[1,0,0]
  v_pk_fma_f32 v[62:63], v[190:191], v[164:165], v[62:63] op_sel:[0,0,0] op_sel_hi:[1,0,1] neg_lo:[1,0,0] neg_hi:[1,0,0]
  v_pk_mul_f32 v[132:133], v[56:57], v[56:57]
  v_pk_mul_f32 v[136:137], v[58:59], v[58:59]
  v_pk_mul_f32 v[140:141], v[60:61], v[60:61]
  v_pk_mul_f32 v[144:145], v[62:63], v[62:63]
  v_pk_fma_f32 v[132:133], v[132:133], v[166:167], v[166:167] op_sel:[0,1,0] op_sel_hi:[1,1,0]
  v_pk_fma_f32 v[136:137], v[136:137], v[166:167], v[166:167] op_sel:[0,1,0] op_sel_hi:[1,1,0]
  v_pk_fma_f32 v[140:141], v[140:141], v[166:167], v[166:167] op_sel:[0,1,0] op_sel_hi:[1,1,0]
  v_pk_fma_f32 v[144:145], v[144:145], v[166:167], v[166:167] op_sel:[0,1,0] op_sel_hi:[1,1,0]
  v_pk_mul_f32 v[132:133], v[56:57], v[132:133]
  v_pk_mul_f32 v[136:137], v[58:59], v[136:137]
  v_pk_mul_f32 v[140:141], v[60:61], v[140:141]
  v_pk_mul_f32 v[144:145], v[62:63], v[144:145]
  v_exp_f32 v134, v132
  v_exp_f32 v138, v136
  v_exp_f32 v142, v140
  v_exp_f32 v146, v144
  v_exp_f32 v135, v133
  v_exp_f32 v139, v137
  v_exp_f32 v143, v141
  v_exp_f32 v147, v145
  v_pk_fma_f32 v[134:135], v[134:135], v[164:165], v[164:165] op_sel:[0,1,1] op_sel_hi:[1,1,1]
  v_pk_fma_f32 v[138:139], v[138:139], v[164:165], v[164:165] op_sel:[0,1,1] op_sel_hi:[1,1,1]
  v_pk_fma_f32 v[142:143], v[142:143], v[164:165], v[164:165] op_sel:[0,1,1] op_sel_hi:[1,1,1]
  v_pk_fma_f32 v[146:147], v[146:147], v[164:165], v[164:165] op_sel:[0,1,1] op_sel_hi:[1,1,1]
  v_rcp_f32 v132, v134
  v_rcp_f32 v136, v138
  v_rcp_f32 v140, v142
  v_rcp_f32 v144, v146
  v_rcp_f32 v133, v135
  v_rcp_f32 v137, v139
  v_rcp_f32 v141, v143
  v_rcp_f32 v145, v147
  v_pk_mul_f32 v[56:57], v[56:57], v[132:133]
  v_pk_mul_f32 v[58:59], v[58:59], v[136:137]
  v_pk_mul_f32 v[60:61], v[60:61], v[140:141]
  v_pk_mul_f32 v[62:63], v[62:63], v[144:145]
  v_cvt_pk_bf16_f32 v152, v56, v57
  v_cvt_pk_bf16_f32 v153, v58, v59
  v_cvt_pk_bf16_f32 v154, v60, v61
  v_cvt_pk_bf16_f32 v155, v62, v63
  buffer_store_dwordx4 v[152:155], v7, s[32:35], s44 offen offset:1024 sc1
  v_pk_fma_f32 v[84:85], v[184:185], v[168:169], v[84:85] op_sel:[0,0,0] op_sel_hi:[1,0,1] neg_lo:[1,0,0] neg_hi:[1,0,0]
  v_pk_fma_f32 v[86:87], v[186:187], v[168:169], v[86:87] op_sel:[0,0,0] op_sel_hi:[1,0,1] neg_lo:[1,0,0] neg_hi:[1,0,0]
  v_pk_fma_f32 v[88:89], v[188:189], v[168:169], v[88:89] op_sel:[0,0,0] op_sel_hi:[1,0,1] neg_lo:[1,0,0] neg_hi:[1,0,0]
  v_pk_fma_f32 v[90:91], v[190:191], v[168:169], v[90:91] op_sel:[0,0,0] op_sel_hi:[1,0,1] neg_lo:[1,0,0] neg_hi:[1,0,0]
  v_pk_mul_f32 v[132:133], v[84:85], v[84:85]
  v_pk_mul_f32 v[136:137], v[86:87], v[86:87]
  v_pk_mul_f32 v[140:141], v[88:89], v[88:89]
  v_pk_mul_f32 v[144:145], v[90:91], v[90:91]
  v_pk_fma_f32 v[132:133], v[132:133], v[170:171], v[170:171] op_sel:[0,1,0] op_sel_hi:[1,1,0]
  v_pk_fma_f32 v[136:137], v[136:137], v[170:171], v[170:171] op_sel:[0,1,0] op_sel_hi:[1,1,0]
  v_pk_fma_f32 v[140:141], v[140:141], v[170:171], v[170:171] op_sel:[0,1,0] op_sel_hi:[1,1,0]
  v_pk_fma_f32 v[144:145], v[144:145], v[170:171], v[170:171] op_sel:[0,1,0] op_sel_hi:[1,1,0]
  v_pk_mul_f32 v[132:133], v[84:85], v[132:133]
  v_pk_mul_f32 v[136:137], v[86:87], v[136:137]
  v_pk_mul_f32 v[140:141], v[88:89], v[140:141]
  v_pk_mul_f32 v[144:145], v[90:91], v[144:145]
  v_exp_f32 v134, v132
  v_exp_f32 v138, v136
  v_exp_f32 v142, v140
  v_exp_f32 v146, v144
  v_exp_f32 v135, v133
  v_exp_f32 v139, v137
  v_exp_f32 v143, v141
  v_exp_f32 v147, v145
  v_pk_fma_f32 v[134:135], v[134:135], v[168:169], v[168:169] op_sel:[0,1,1] op_sel_hi:[1,1,1]
  v_pk_fma_f32 v[138:139], v[138:139], v[168:169], v[168:169] op_sel:[0,1,1] op_sel_hi:[1,1,1]
  v_pk_fma_f32 v[142:143], v[142:143], v[168:169], v[168:169] op_sel:[0,1,1] op_sel_hi:[1,1,1]
  v_pk_fma_f32 v[146:147], v[146:147], v[168:169], v[168:169] op_sel:[0,1,1] op_sel_hi:[1,1,1]
  v_rcp_f32 v132, v134
  v_rcp_f32 v136, v138
  v_rcp_f32 v140, v142
  v_rcp_f32 v144, v146
  v_rcp_f32 v133, v135
  v_rcp_f32 v137, v139
  v_rcp_f32 v141, v143
  v_rcp_f32 v145, v147
  v_pk_mul_f32 v[84:85], v[84:85], v[132:133]
  v_pk_mul_f32 v[86:87], v[86:87], v[136:137]
  v_pk_mul_f32 v[88:89], v[88:89], v[140:141]
  v_pk_mul_f32 v[90:91], v[90:91], v[144:145]
  v_cvt_pk_bf16_f32 v156, v84, v85
  v_cvt_pk_bf16_f32 v157, v86, v87
  v_cvt_pk_bf16_f32 v158, v88, v89
  v_cvt_pk_bf16_f32 v159, v90, v91
  buffer_store_dwordx4 v[156:159], v7, s[32:35], s45 offen offset:1024 sc1
  v_pk_fma_f32 v[112:113], v[184:185], v[172:173], v[112:113] op_sel:[0,0,0] op_sel_hi:[1,0,1] neg_lo:[1,0,0] neg_hi:[1,0,0]
  v_pk_fma_f32 v[114:115], v[186:187], v[172:173], v[114:115] op_sel:[0,0,0] op_sel_hi:[1,0,1] neg_lo:[1,0,0] neg_hi:[1,0,0]
  v_pk_fma_f32 v[116:117], v[188:189], v[172:173], v[116:117] op_sel:[0,0,0] op_sel_hi:[1,0,1] neg_lo:[1,0,0] neg_hi:[1,0,0]
  v_pk_fma_f32 v[118:119], v[190:191], v[172:173], v[118:119] op_sel:[0,0,0] op_sel_hi:[1,0,1] neg_lo:[1,0,0] neg_hi:[1,0,0]
  v_pk_mul_f32 v[132:133], v[112:113], v[112:113]
  v_pk_mul_f32 v[136:137], v[114:115], v[114:115]
  v_pk_mul_f32 v[140:141], v[116:117], v[116:117]
  v_pk_mul_f32 v[144:145], v[118:119], v[118:119]
  v_pk_fma_f32 v[132:133], v[132:133], v[174:175], v[174:175] op_sel:[0,1,0] op_sel_hi:[1,1,0]
  v_pk_fma_f32 v[136:137], v[136:137], v[174:175], v[174:175] op_sel:[0,1,0] op_sel_hi:[1,1,0]
  v_pk_fma_f32 v[140:141], v[140:141], v[174:175], v[174:175] op_sel:[0,1,0] op_sel_hi:[1,1,0]
  v_pk_fma_f32 v[144:145], v[144:145], v[174:175], v[174:175] op_sel:[0,1,0] op_sel_hi:[1,1,0]
  v_pk_mul_f32 v[132:133], v[112:113], v[132:133]
  v_pk_mul_f32 v[136:137], v[114:115], v[136:137]
  v_pk_mul_f32 v[140:141], v[116:117], v[140:141]
  v_pk_mul_f32 v[144:145], v[118:119], v[144:145]
  v_exp_f32 v134, v132
  v_exp_f32 v138, v136
  v_exp_f32 v142, v140
  v_exp_f32 v146, v144
  v_exp_f32 v135, v133
  v_exp_f32 v139, v137
  v_exp_f32 v143, v141
  v_exp_f32 v147, v145
  v_pk_fma_f32 v[134:135], v[134:135], v[172:173], v[172:173] op_sel:[0,1,1] op_sel_hi:[1,1,1]
  v_pk_fma_f32 v[138:139], v[138:139], v[172:173], v[172:173] op_sel:[0,1,1] op_sel_hi:[1,1,1]
  v_pk_fma_f32 v[142:143], v[142:143], v[172:173], v[172:173] op_sel:[0,1,1] op_sel_hi:[1,1,1]
  v_pk_fma_f32 v[146:147], v[146:147], v[172:173], v[172:173] op_sel:[0,1,1] op_sel_hi:[1,1,1]
  v_rcp_f32 v132, v134
  v_rcp_f32 v136, v138
  v_rcp_f32 v140, v142
  v_rcp_f32 v144, v146
  v_rcp_f32 v133, v135
  v_rcp_f32 v137, v139
  v_rcp_f32 v141, v143
  v_rcp_f32 v145, v147
  v_pk_mul_f32 v[112:113], v[112:113], v[132:133]
  v_pk_mul_f32 v[114:115], v[114:115], v[136:137]
  v_pk_mul_f32 v[116:117], v[116:117], v[140:141]
  v_pk_mul_f32 v[118:119], v[118:119], v[144:145]
  v_cvt_pk_bf16_f32 v148, v112, v113
  v_cvt_pk_bf16_f32 v149, v114, v115
  v_cvt_pk_bf16_f32 v150, v116, v117
  v_cvt_pk_bf16_f32 v151, v118, v119
  buffer_store_dwordx4 v[148:151], v7, s[32:35], s46 offen offset:1024 sc1
  v_mov_b32 v4, 151580
  s_mov_b32 s42, 0x10000
.Lsw_mixer_kernelh:
  ds_read_b32 v5, v4
  s_sub_u32 s42, s42, 1
  s_waitcnt lgkmcnt(0)
  v_readfirstlane_b32 s41, v5
  s_nop 0
  s_cmp_ge_u32 s41, 4
  s_cselect_b32 s42, 0, s42
  s_cmp_lg_u32 s42, 0
  s_cbranch_scc1 .Lsw_mixer_kernelh
  ds_read_b128 v[176:179], v10 offset:0
  ds_read_b128 v[180:183], v10 offset:1024
  s_waitcnt lgkmcnt(0)
  s_nop 0
  buffer_store_dwordx4 v[176:179], v7, s[32:35], s39 offen sc1
  buffer_store_dwordx4 v[180:183], v7, s[32:35], s40 offen sc1
  v_pk_fma_f32 v[36:37], v[192:193], v[160:161], v[36:37] op_sel:[0,0,0] op_sel_hi:[1,0,1] neg_lo:[1,0,0] neg_hi:[1,0,0]
  v_pk_fma_f32 v[38:39], v[194:195], v[160:161], v[38:39] op_sel:[0,0,0] op_sel_hi:[1,0,1] neg_lo:[1,0,0] neg_hi:[1,0,0]
  v_pk_fma_f32 v[40:41], v[196:197], v[160:161], v[40:41] op_sel:[0,0,0] op_sel_hi:[1,0,1] neg_lo:[1,0,0] neg_hi:[1,0,0]
  v_pk_fma_f32 v[42:43], v[198:199], v[160:161], v[42:43] op_sel:[0,0,0] op_sel_hi:[1,0,1] neg_lo:[1,0,0] neg_hi:[1,0,0]
  v_pk_mul_f32 v[132:133], v[36:37], v[36:37]
  v_pk_mul_f32 v[136:137], v[38:39], v[38:39]
  v_pk_mul_f32 v[140:141], v[40:41], v[40:41]
  v_pk_mul_f32 v[144:145], v[42:43], v[42:43]
  v_pk_fma_f32 v[132:133], v[132:133], v[162:163], v[162:163] op_sel:[0,1,0] op_sel_hi:[1,1,0]
  v_pk_fma_f32 v[136:137], v[136:137], v[162:163], v[162:163] op_sel:[0,1,0] op_sel_hi:[1,1,0]
  v_pk_fma_f32 v[140:141], v[140:141], v[162:163], v[162:163] op_sel:[0,1,0] op_sel_hi:[1,1,0]
  v_pk_fma_f32 v[144:145], v[144:145], v[162:163], v[162:163] op_sel:[0,1,0] op_sel_hi:[1,1,0]
  v_pk_mul_f32 v[132:133], v[36:37], v[132:133]
  v_pk_mul_f32 v[136:137], v[38:39], v[136:137]
  v_pk_mul_f32 v[140:141], v[40:41], v[140:141]
  v_pk_mul_f32 v[144:145], v[42:43], v[144:145]
  v_exp_f32 v134, v132
  v_exp_f32 v138, v136
  v_exp_f32 v142, v140
  v_exp_f32 v146, v144
  v_exp_f32 v135, v133
  v_exp_f32 v139, v137
  v_exp_f32 v143, v141
  v_exp_f32 v147, v145
  v_pk_fma_f32 v[134:135], v[134:135], v[160:161], v[160:161] op_sel:[0,1,1] op_sel_hi:[1,1,1]
  v_pk_fma_f32 v[138:139], v[138:139], v[160:161], v[160:161] op_sel:[0,1,1] op_sel_hi:[1,1,1]
  v_pk_fma_f32 v[142:143], v[142:143], v[160:161], v[160:161] op_sel:[0,1,1] op_sel_hi:[1,1,1]
  v_pk_fma_f32 v[146:147], v[146:147], v[160:161], v[160:161] op_sel:[0,1,1] op_sel_hi:[1,1,1]
  v_rcp_f32 v132, v134
  v_rcp_f32 v136, v138
  v_rcp_f32 v140, v142
  v_rcp_f32 v144, v146
  v_rcp_f32 v133, v135
  v_rcp_f32 v137, v139
  v_rcp_f32 v141, v143
  v_rcp_f32 v145, v147
  v_pk_mul_f32 v[36:37], v[36:37], v[132:133]
  v_pk_mul_f32 v[38:39], v[38:39], v[136:137]
  v_pk_mul_f32 v[40:41], v[40:41], v[140:141]
  v_pk_mul_f32 v[42:43], v[42:43], v[144:145]
  v_cvt_pk_bf16_f32 v152, v36, v37
  v_cvt_pk_bf16_f32 v153, v38, v39
  v_cvt_pk_bf16_f32 v154, v40, v41
  v_cvt_pk_bf16_f32 v155, v42, v43
  buffer_store_dwordx4 v[152:155], v7, s[32:35], s43 offen offset:2048 sc1
  v_pk_fma_f32 v[64:65], v[192:193], v[164:165], v[64:65] op_sel:[0,0,0] op_sel_hi:[1,0,1] neg_lo:[1,0,0] neg_hi:[1,0,0]
  v_pk_fma_f32 v[66:67], v[194:195], v[164:165], v[66:67] op_sel:[0,0,0] op_sel_hi:[1,0,1] neg_lo:[1,0,0] neg_hi:[1,0,0]
  v_pk_fma_f32 v[68:69], v[196:197], v[164:165], v[68:69] op_sel:[0,0,0] op_sel_hi:[1,0,1] neg_lo:[1,0,0] neg_hi:[1,0,0]
  v_pk_fma_f32 v[70:71], v[198:199], v[164:165], v[70:71] op_sel:[0,0,0] op_sel_hi:[1,0,1] neg_lo:[1,0,0] neg_hi:[1,0,0]
  v_pk_mul_f32 v[132:133], v[64:65], v[64:65]
  v_pk_mul_f32 v[136:137], v[66:67], v[66:67]
  v_pk_mul_f32 v[140:141], v[68:69], v[68:69]
  v_pk_mul_f32 v[144:145], v[70:71], v[70:71]
  v_pk_fma_f32 v[132:133], v[132:133], v[166:167], v[166:167] op_sel:[0,1,0] op_sel_hi:[1,1,0]
  v_pk_fma_f32 v[136:137], v[136:137], v[166:167], v[166:167] op_sel:[0,1,0] op_sel_hi:[1,1,0]
  v_pk_fma_f32 v[140:141], v[140:141], v[166:167], v[166:167] op_sel:[0,1,0] op_sel_hi:[1,1,0]
  v_pk_fma_f32 v[144:145], v[144:145], v[166:167], v[166:167] op_sel:[0,1,0] op_sel_hi:[1,1,0]
  v_pk_mul_f32 v[132:133], v[64:65], v[132:133]
  v_pk_mul_f32 v[136:137], v[66:67], v[136:137]
  v_pk_mul_f32 v[140:141], v[68:69], v[140:141]
  v_pk_mul_f32 v[144:145], v[70:71], v[144:145]
  v_exp_f32 v134, v132
  v_exp_f32 v138, v136
  v_exp_f32 v142, v140
  v_exp_f32 v146, v144
  v_exp_f32 v135, v133
  v_exp_f32 v139, v137
  v_exp_f32 v143, v141
  v_exp_f32 v147, v145
  v_pk_fma_f32 v[134:135], v[134:135], v[164:165], v[164:165] op_sel:[0,1,1] op_sel_hi:[1,1,1]
  v_pk_fma_f32 v[138:139], v[138:139], v[164:165], v[164:165] op_sel:[0,1,1] op_sel_hi:[1,1,1]
  v_pk_fma_f32 v[142:143], v[142:143], v[164:165], v[164:165] op_sel:[0,1,1] op_sel_hi:[1,1,1]
  v_pk_fma_f32 v[146:147], v[146:147], v[164:165], v[164:165] op_sel:[0,1,1] op_sel_hi:[1,1,1]
  v_rcp_f32 v132, v134
  v_rcp_f32 v136, v138
  v_rcp_f32 v140, v142
  v_rcp_f32 v144, v146
  v_rcp_f32 v133, v135
  v_rcp_f32 v137, v139
  v_rcp_f32 v141, v143
  v_rcp_f32 v145, v147
  v_pk_mul_f32 v[64:65], v[64:65], v[132:133]
  v_pk_mul_f32 v[66:67], v[66:67], v[136:137]
  v_pk_mul_f32 v[68:69], v[68:69], v[140:141]
  v_pk_mul_f32 v[70:71], v[70:71], v[144:145]
  v_cvt_pk_bf16_f32 v156, v64, v65
  v_cvt_pk_bf16_f32 v157, v66, v67
  v_cvt_pk_bf16_f32 v158, v68, v69
  v_cvt_pk_bf16_f32 v159, v70, v71
  buffer_store_dwordx4 v[156:159], v7, s[32:35], s44 offen offset:2048 sc1
  v_pk_fma_f32 v[92:93], v[192:193], v[168:169], v[92:93] op_sel:[0,0,0] op_sel_hi:[1,0,1] neg_lo:[1,0,0] neg_hi:[1,0,0]
  v_pk_fma_f32 v[94:95], v[194:195], v[168:169], v[94:95] op_sel:[0,0,0] op_sel_hi:[1,0,1] neg_lo:[1,0,0] neg_hi:[1,0,0]
  v_pk_fma_f32 v[96:97], v[196:197], v[168:169], v[96:97] op_sel:[0,0,0] op_sel_hi:[1,0,1] neg_lo:[1,0,0] neg_hi:[1,0,0]
  v_pk_fma_f32 v[98:99], v[198:199], v[168:169], v[98:99] op_sel:[0,0,0] op_sel_hi:[1,0,1] neg_lo:[1,0,0] neg_hi:[1,0,0]
  v_pk_mul_f32 v[132:133], v[92:93], v[92:93]
  v_pk_mul_f32 v[136:137], v[94:95], v[94:95]
  v_pk_mul_f32 v[140:141], v[96:97], v[96:97]
  v_pk_mul_f32 v[144:145], v[98:99], v[98:99]
  v_pk_fma_f32 v[132:133], v[132:133], v[170:171], v[170:171] op_sel:[0,1,0] op_sel_hi:[1,1,0]
  v_pk_fma_f32 v[136:137], v[136:137], v[170:171], v[170:171] op_sel:[0,1,0] op_sel_hi:[1,1,0]
  v_pk_fma_f32 v[140:141], v[140:141], v[170:171], v[170:171] op_sel:[0,1,0] op_sel_hi:[1,1,0]
  v_pk_fma_f32 v[144:145], v[144:145], v[170:171], v[170:171] op_sel:[0,1,0] op_sel_hi:[1,1,0]
  v_pk_mul_f32 v[132:133], v[92:93], v[132:133]
  v_pk_mul_f32 v[136:137], v[94:95], v[136:137]
  v_pk_mul_f32 v[140:141], v[96:97], v[140:141]
  v_pk_mul_f32 v[144:145], v[98:99], v[144:145]
  v_exp_f32 v134, v132
  v_exp_f32 v138, v136
  v_exp_f32 v142, v140
  v_exp_f32 v146, v144
  v_exp_f32 v135, v133
  v_exp_f32 v139, v137
  v_exp_f32 v143, v141
  v_exp_f32 v147, v145
  v_pk_fma_f32 v[134:135], v[134:135], v[168:169], v[168:169] op_sel:[0,1,1] op_sel_hi:[1,1,1]
  v_pk_fma_f32 v[138:139], v[138:139], v[168:169], v[168:169] op_sel:[0,1,1] op_sel_hi:[1,1,1]
  v_pk_fma_f32 v[142:143], v[142:143], v[168:169], v[168:169] op_sel:[0,1,1] op_sel_hi:[1,1,1]
  v_pk_fma_f32 v[146:147], v[146:147], v[168:169], v[168:169] op_sel:[0,1,1] op_sel_hi:[1,1,1]
  v_rcp_f32 v132, v134
  v_rcp_f32 v136, v138
  v_rcp_f32 v140, v142
  v_rcp_f32 v144, v146
  v_rcp_f32 v133, v135
  v_rcp_f32 v137, v139
  v_rcp_f32 v141, v143
  v_rcp_f32 v145, v147
  v_pk_mul_f32 v[92:93], v[92:93], v[132:133]
  v_pk_mul_f32 v[94:95], v[94:95], v[136:137]
  v_pk_mul_f32 v[96:97], v[96:97], v[140:141]
  v_pk_mul_f32 v[98:99], v[98:99], v[144:145]
  v_cvt_pk_bf16_f32 v148, v92, v93
  v_cvt_pk_bf16_f32 v149, v94, v95
  v_cvt_pk_bf16_f32 v150, v96, v97
  v_cvt_pk_bf16_f32 v151, v98, v99
  buffer_store_dwordx4 v[148:151], v7, s[32:35], s45 offen offset:2048 sc1
  v_pk_fma_f32 v[120:121], v[192:193], v[172:173], v[120:121] op_sel:[0,0,0] op_sel_hi:[1,0,1] neg_lo:[1,0,0] neg_hi:[1,0,0]
  v_pk_fma_f32 v[122:123], v[194:195], v[172:173], v[122:123] op_sel:[0,0,0] op_sel_hi:[1,0,1] neg_lo:[1,0,0] neg_hi:[1,0,0]
  v_pk_fma_f32 v[124:125], v[196:197], v[172:173], v[124:125] op_sel:[0,0,0] op_sel_hi:[1,0,1] neg_lo:[1,0,0] neg_hi:[1,0,0]
  v_pk_fma_f32 v[126:127], v[198:199], v[172:173], v[126:127] op_sel:[0,0,0] op_sel_hi:[1,0,1] neg_lo:[1,0,0] neg_hi:[1,0,0]
  v_pk_mul_f32 v[132:133], v[120:121], v[120:121]
  v_pk_mul_f32 v[136:137], v[122:123], v[122:123]
  v_pk_mul_f32 v[140:141], v[124:125], v[124:125]
  v_pk_mul_f32 v[144:145], v[126:127], v[126:127]
  v_pk_fma_f32 v[132:133], v[132:133], v[174:175], v[174:175] op_sel:[0,1,0] op_sel_hi:[1,1,0]
  v_pk_fma_f32 v[136:137], v[136:137], v[174:175], v[174:175] op_sel:[0,1,0] op_sel_hi:[1,1,0]
  v_pk_fma_f32 v[140:141], v[140:141], v[174:175], v[174:175] op_sel:[0,1,0] op_sel_hi:[1,1,0]
  v_pk_fma_f32 v[144:145], v[144:145], v[174:175], v[174:175] op_sel:[0,1,0] op_sel_hi:[1,1,0]
  v_pk_mul_f32 v[132:133], v[120:121], v[132:133]
  v_pk_mul_f32 v[136:137], v[122:123], v[136:137]
  v_pk_mul_f32 v[140:141], v[124:125], v[140:141]
  v_pk_mul_f32 v[144:145], v[126:127], v[144:145]
  v_exp_f32 v134, v132
  v_exp_f32 v138, v136
  v_exp_f32 v142, v140
  v_exp_f32 v146, v144
  v_exp_f32 v135, v133
  v_exp_f32 v139, v137
  v_exp_f32 v143, v141
  v_exp_f32 v147, v145
  v_pk_fma_f32 v[134:135], v[134:135], v[172:173], v[172:173] op_sel:[0,1,1] op_sel_hi:[1,1,1]
  v_pk_fma_f32 v[138:139], v[138:139], v[172:173], v[172:173] op_sel:[0,1,1] op_sel_hi:[1,1,1]
  v_pk_fma_f32 v[142:143], v[142:143], v[172:173], v[172:173] op_sel:[0,1,1] op_sel_hi:[1,1,1]
  v_pk_fma_f32 v[146:147], v[146:147], v[172:173], v[172:173] op_sel:[0,1,1] op_sel_hi:[1,1,1]
  v_rcp_f32 v132, v134
  v_rcp_f32 v136, v138
  v_rcp_f32 v140, v142
  v_rcp_f32 v144, v146
  v_rcp_f32 v133, v135
  v_rcp_f32 v137, v139
  v_rcp_f32 v141, v143
  v_rcp_f32 v145, v147
  v_pk_mul_f32 v[120:121], v[120:121], v[132:133]
  v_pk_mul_f32 v[122:123], v[122:123], v[136:137]
  v_pk_mul_f32 v[124:125], v[124:125], v[140:141]
  v_pk_mul_f32 v[126:127], v[126:127], v[144:145]
  v_cvt_pk_bf16_f32 v152, v120, v121
  v_cvt_pk_bf16_f32 v153, v122, v123
  v_cvt_pk_bf16_f32 v154, v124, v125
  v_cvt_pk_bf16_f32 v155, v126, v127
  buffer_store_dwordx4 v[152:155], v7, s[32:35], s46 offen offset:2048 sc1
  s_waitcnt vmcnt(0) lgkmcnt(0)
  s_barrier
  s_cmp_lg_u32 s10, 3
  s_cbranch_scc1 .Lmixer_kernel_sig3
  s_lshl_b32 s43, s36, 12
  s_lshl_b32 s47, s37, 2
  s_add_u32 s43, s43, s47
  v_lshlrev_b32 v4, 8, v1
  s_add_u32 s43, s43, 212992
  s_mov_b32 exec_lo, 0xffff
  s_mov_b32 exec_hi, 0
  buffer_store_dword v8, v4, s[12:15], s43 offen sc1
  s_mov_b64 exec, -1
.Lmixer_kernel_sig3:
  s_and_b32 s43, s2, 7
  s_lshr_b32 s44, s2, 3
  s_lshr_b32 s36, s43, 2
  s_lshl_b32 s36, s36, 3
  s_lshr_b32 s45, s44, 2
  s_add_u32 s36, s36, s45
  s_and_b32 s37, s43, 2
  s_lshl_b32 s37, s37, 1
  s_and_b32 s45, s44, 3
  s_add_u32 s37, s37, s45
  s_lshl_b32 s37, s37, 1
  s_and_b32 s45, s2, 1
  s_add_u32 s37, s37, s45
  s_lshr_b32 s45, s10, 1
  s_and_b32 s48, s10, 1
  s_and_b32 s46, s2, 1
  s_lshl_b32 s45, s45, 1
  s_add_u32 s45, s45, s46
  s_lshl_b32 s38, s36, 2
  s_add_u32 s38, s38, s45
  s_lshl_b32 s38, s38, 1
  s_lshl_b32 s45, s45, 12
  s_add_u32 s45, s45, 16384
  v_add_u32 v9, s45, v7
  v_xor_b32 v15, 4096, v9
  s_lshl_b32 s43, s48, 12
  v_add_u32 v12, s43, v7
  s_and_b32 s37, s37, 14
  s_add_u32 s37, s37, s48
  s_nop 0
  v_add_u32 v10, 65536, v9
  v_add_u32 v13, 65536, v12
  v_add_u32 v16, 65536, v15
  v_mov_b32 v20, 0
  v_mov_b32 v21, 0
  v_mov_b32 v22, 0
  v_mov_b32 v23, 0
  v_mov_b32 v24, 0
  v_mov_b32 v25, 0
  v_mov_b32 v26, 0
  v_mov_b32 v27, 0
  v_mov_b32 v28, 0
  v_mov_b32 v29, 0
  v_mov_b32 v30, 0
  v_mov_b32 v31, 0
  v_mov_b32 v32, 0
  v_mov_b32 v33, 0
  v_mov_b32 v34, 0
  v_mov_b32 v35, 0
  v_mov_b32 v36, 0
  v_mov_b32 v37, 0
  v_mov_b32 v38, 0
  v_mov_b32 v39, 0
  v_mov_b32 v40, 0
  v_mov_b32 v41, 0
  v_mov_b32 v42, 0
  v_mov_b32 v43, 0
  v_mov_b32 v44, 0
  v_mov_b32 v45, 0
  v_mov_b32 v46, 0
  v_mov_b32 v47, 0
  v_mov_b32 v48, 0
  v_mov_b32 v49, 0
  v_mov_b32 v50, 0
  v_mov_b32 v51, 0
  v_mov_b32 v52, 0
  v_mov_b32 v53, 0
  v_mov_b32 v54, 0
  v_mov_b32 v55, 0
  v_mov_b32 v56, 0
  v_mov_b32 v57, 0
  v_mov_b32 v58, 0
  v_mov_b32 v59, 0
  v_mov_b32 v60, 0
  v_mov_b32 v61, 0
  v_mov_b32 v62, 0
  v_mov_b32 v63, 0
  v_mov_b32 v64, 0
  v_mov_b32 v65, 0
  v_mov_b32 v66, 0
  v_mov_b32 v67, 0
  v_mov_b32 v68, 0
  v_mov_b32 v69, 0
  v_mov_b32 v70, 0
  v_mov_b32 v71, 0
  v_mov_b32 v72, 0
  v_mov_b32 v73, 0
  v_mov_b32 v74, 0
  v_mov_b32 v75, 0
  v_mov_b32 v76, 0
  v_mov_b32 v77, 0
  v_mov_b32 v78, 0
  v_mov_b32 v79, 0
  v_mov_b32 v80, 0
  v_mov_b32 v81, 0
  v_mov_b32 v82, 0
  v_mov_b32 v83, 0
  s_mov_b32 s32, s8
  s_mov_b32 s33, s9
  s_mov_b32 s34, 0x400000
  s_mov_b32 s35, 0x20000
  s_barrier
  s_barrier
  ds_read_b128 v[84:87], v10 offset:32768
  ds_read_b128 v[88:91], v10 offset:34816
  ds_read_b128 v[92:95], v16 offset:32768
  ds_read_b128 v[96:99], v16 offset:34816
  ds_read_b128 v[100:103], v13 offset:32768
  ds_read_b128 v[104:107], v13 offset:33792
  ds_read_b128 v[108:111], v13 offset:34816
  ds_read_b128 v[112:115], v13 offset:35840
  ds_read_b128 v[116:119], v10 offset:33792
  ds_read_b128 v[120:123], v10 offset:35840
  ds_read_b128 v[124:127], v16 offset:33792
  ds_read_b128 v[128:131], v16 offset:35840
  ds_read_b128 v[132:135], v13 offset:40960
  ds_read_b128 v[136:139], v13 offset:41984
  ds_read_b128 v[140:143], v13 offset:43008
  ds_read_b128 v[144:147], v13 offset:44032
  s_mov_b32 s11, 6
  s_nop 0
.Lmixer_kernel_c4:
  s_waitcnt lgkmcnt(0)
  s_barrier
  v_mfma_f32_16x16x32_bf16 v[20:23], v[100:103], v[84:87], v[20:23]
  ds_read_b128 v[148:151], v9 offset:0
  v_mfma_f32_16x16x32_bf16 v[36:39], v[100:103], v[88:91], v[36:39]
  ds_read_b128 v[152:155], v9 offset:2048
  v_mfma_f32_16x16x32_bf16 v[52:55], v[100:103], v[92:95], v[52:55]
  v_mfma_f32_16x16x32_bf16 v[68:71], v[100:103], v[96:99], v[68:71]
  ds_read_b128 v[156:159], v15 offset:0
  v_mfma_f32_16x16x32_bf16 v[24:27], v[104:107], v[84:87], v[24:27]
  ds_read_b128 v[160:163], v15 offset:2048
  v_mfma_f32_16x16x32_bf16 v[40:43], v[104:107], v[88:91], v[40:43]
  v_mfma_f32_16x16x32_bf16 v[56:59], v[104:107], v[92:95], v[56:59]
  ds_read_b128 v[164:167], v12 offset:0
  v_mfma_f32_16x16x32_bf16 v[72:75], v[104:107], v[96:99], v[72:75]
  ds_read_b128 v[168:171], v12 offset:1024
  v_mfma_f32_16x16x32_bf16 v[28:31], v[108:111], v[84:87], v[28:31]
  v_mfma_f32_16x16x32_bf16 v[44:47], v[108:111], v[88:91], v[44:47]
  ds_read_b128 v[172:175], v12 offset:2048
  v_mfma_f32_16x16x32_bf16 v[60:63], v[108:111], v[92:95], v[60:63]
  ds_read_b128 v[176:179], v12 offset:3072
  v_mfma_f32_16x16x32_bf16 v[76:79], v[108:111], v[96:99], v[76:79]
  v_mfma_f32_16x16x32_bf16 v[32:35], v[112:115], v[84:87], v[32:35]
  ds_read_b128 v[180:183], v9 offset:1024
  v_mfma_f32_16x16x32_bf16 v[48:51], v[112:115], v[88:91], v[48:51]
  ds_read_b128 v[184:187], v9 offset:3072
  v_mfma_f32_16x16x32_bf16 v[64:67], v[112:115], v[92:95], v[64:67]
  v_mfma_f32_16x16x32_bf16 v[80:83], v[112:115], v[96:99], v[80:83]
  ds_read_b128 v[188:191], v15 offset:1024
  v_mfma_f32_16x16x32_bf16 v[20:23], v[132:135], v[116:119], v[20:23]
  ds_read_b128 v[192:195], v15 offset:3072
  v_mfma_f32_16x16x32_bf16 v[36:39], v[132:135], v[120:123], v[36:39]
  v_mfma_f32_16x16x32_bf16 v[52:55], v[132:135], v[124:127], v[52:55]
  ds_read_b128 v[196:199], v12 offset:8192
  v_mfma_f32_16x16x32_bf16 v[68:71], v[132:135], v[128:131], v[68:71]
  ds_read_b128 v[200:203], v12 offset:9216
  v_mfma_f32_16x16x32_bf16 v[24:27], v[136:139], v[116:119], v[24:27]
  v_mfma_f32_16x16x32_bf16 v[40:43], v[136:139], v[120:123], v[40:43]
  ds_read_b128 v[204:207], v12 offset:10240
  v_mfma_f32_16x16x32_bf16 v[56:59], v[136:139], v[124:127], v[56:59]
  ds_read_b128 v[208:211], v12 offset:11264
  v_mfma_f32_16x16x32_bf16 v[72:75], v[136:139], v[128:131], v[72:75]
  v_mfma_f32_16x16x32_bf16 v[28:31], v[140:143], v[116:119], v[28:31]
  v_mfma_f32_16x16x32_bf16 v[44:47], v[140:143], v[120:123], v[44:47]
  v_mfma_f32_16x16x32_bf16 v[60:63], v[140:143], v[124:127], v[60:63]
  v_mfma_f32_16x16x32_bf16 v[76:79], v[140:143], v[128:131], v[76:79]
  v_mfma_f32_16x16x32_bf16 v[32:35], v[144:147], v[116:119], v[32:35]
  v_mfma_f32_16x16x32_bf16 v[48:51], v[144:147], v[120:123], v[48:51]
  v_mfma_f32_16x16x32_bf16 v[64:67], v[144:147], v[124:127], v[64:67]
  v_mfma_f32_16x16x32_bf16 v[80:83], v[144:147], v[128:131], v[80:83]
  s_waitcnt lgkmcnt(0)
  s_barrier
  v_mfma_f32_16x16x32_bf16 v[20:23], v[164:167], v[148:151], v[20:23]
  ds_read_b128 v[84:87], v9 offset:32768
  v_mfma_f32_16x16x32_bf16 v[36:39], v[164:167], v[152:155], v[36:39]
  ds_read_b128 v[88:91], v9 offset:34816
  v_mfma_f32_16x16x32_bf16 v[52:55], v[164:167], v[156:159], v[52:55]
  v_mfma_f32_16x16x32_bf16 v[68:71], v[164:167], v[160:163], v[68:71]
  ds_read_b128 v[92:95], v15 offset:32768
  v_mfma_f32_16x16x32_bf16 v[24:27], v[168:171], v[148:151], v[24:27]
  ds_read_b128 v[96:99], v15 offset:34816
  v_mfma_f32_16x16x32_bf16 v[40:43], v[168:171], v[152:155], v[40:43]
  v_mfma_f32_16x16x32_bf16 v[56:59], v[168:171], v[156:159], v[56:59]
  ds_read_b128 v[100:103], v12 offset:32768
  v_mfma_f32_16x16x32_bf16 v[72:75], v[168:171], v[160:163], v[72:75]
  ds_read_b128 v[104:107], v12 offset:33792
  v_mfma_f32_16x16x32_bf16 v[28:31], v[172:175], v[148:151], v[28:31]
  v_mfma_f32_16x16x32_bf16 v[44:47], v[172:175], v[152:155], v[44:47]
  ds_read_b128 v[108:111], v12 offset:34816
  v_mfma_f32_16x16x32_bf16 v[60:63], v[172:175], v[156:159], v[60:63]
  ds_read_b128 v[112:115], v12 offset:35840
  v_mfma_f32_16x16x32_bf16 v[76:79], v[172:175], v[160:163], v[76:79]
  v_mfma_f32_16x16x32_bf16 v[32:35], v[176:179], v[148:151], v[32:35]
  ds_read_b128 v[116:119], v9 offset:33792
  v_mfma_f32_16x16x32_bf16 v[48:51], v[176:179], v[152:155], v[48:51]
  ds_read_b128 v[120:123], v9 offset:35840
  v_mfma_f32_16x16x32_bf16 v[64:67], v[176:179], v[156:159], v[64:67]
  v_mfma_f32_16x16x32_bf16 v[80:83], v[176:179], v[160:163], v[80:83]
  ds_read_b128 v[124:127], v15 offset:33792
  v_mfma_f32_16x16x32_bf16 v[20:23], v[196:199], v[180:183], v[20:23]
  ds_read_b128 v[128:131], v15 offset:35840
  v_mfma_f32_16x16x32_bf16 v[36:39], v[196:199], v[184:187], v[36:39]
  v_mfma_f32_16x16x32_bf16 v[52:55], v[196:199], v[188:191], v[52:55]
  ds_read_b128 v[132:135], v12 offset:40960
  v_mfma_f32_16x16x32_bf16 v[68:71], v[196:199], v[192:195], v[68:71]
  ds_read_b128 v[136:139], v12 offset:41984
  v_mfma_f32_16x16x32_bf16 v[24:27], v[200:203], v[180:183], v[24:27]
  v_mfma_f32_16x16x32_bf16 v[40:43], v[200:203], v[184:187], v[40:43]
  ds_read_b128 v[140:143], v12 offset:43008
  v_mfma_f32_16x16x32_bf16 v[56:59], v[200:203], v[188:191], v[56:59]
  ds_read_b128 v[144:147], v12 offset:44032
  v_mfma_f32_16x16x32_bf16 v[72:75], v[200:203], v[192:195], v[72:75]
  v_mfma_f32_16x16x32_bf16 v[28:31], v[204:207], v[180:183], v[28:31]
  v_mfma_f32_16x16x32_bf16 v[44:47], v[204:207], v[184:187], v[44:47]
  v_mfma_f32_16x16x32_bf16 v[60:63], v[204:207], v[188:191], v[60:63]
  v_mfma_f32_16x16x32_bf16 v[76:79], v[204:207], v[192:195], v[76:79]
  v_mfma_f32_16x16x32_bf16 v[32:35], v[208:211], v[180:183], v[32:35]
  v_mfma_f32_16x16x32_bf16 v[48:51], v[208:211], v[184:187], v[48:51]
  v_mfma_f32_16x16x32_bf16 v[64:67], v[208:211], v[188:191], v[64:67]
  v_mfma_f32_16x16x32_bf16 v[80:83], v[208:211], v[192:195], v[80:83]
  s_waitcnt lgkmcnt(0)
  s_barrier
  v_mfma_f32_16x16x32_bf16 v[20:23], v[100:103], v[84:87], v[20:23]
  ds_read_b128 v[148:151], v10 offset:0
  v_mfma_f32_16x16x32_bf16 v[36:39], v[100:103], v[88:91], v[36:39]
  ds_read_b128 v[152:155], v10 offset:2048
  v_mfma_f32_16x16x32_bf16 v[52:55], v[100:103], v[92:95], v[52:55]
  v_mfma_f32_16x16x32_bf16 v[68:71], v[100:103], v[96:99], v[68:71]
  ds_read_b128 v[156:159], v16 offset:0
  v_mfma_f32_16x16x32_bf16 v[24:27], v[104:107], v[84:87], v[24:27]
  ds_read_b128 v[160:163], v16 offset:2048
  v_mfma_f32_16x16x32_bf16 v[40:43], v[104:107], v[88:91], v[40:43]
  v_mfma_f32_16x16x32_bf16 v[56:59], v[104:107], v[92:95], v[56:59]
  ds_read_b128 v[164:167], v13 offset:0
  v_mfma_f32_16x16x32_bf16 v[72:75], v[104:107], v[96:99], v[72:75]
  ds_read_b128 v[168:171], v13 offset:1024
  v_mfma_f32_16x16x32_bf16 v[28:31], v[108:111], v[84:87], v[28:31]
  v_mfma_f32_16x16x32_bf16 v[44:47], v[108:111], v[88:91], v[44:47]
  ds_read_b128 v[172:175], v13 offset:2048
  v_mfma_f32_16x16x32_bf16 v[60:63], v[108:111], v[92:95], v[60:63]
  ds_read_b128 v[176:179], v13 offset:3072
  v_mfma_f32_16x16x32_bf16 v[76:79], v[108:111], v[96:99], v[76:79]
  v_mfma_f32_16x16x32_bf16 v[32:35], v[112:115], v[84:87], v[32:35]
  ds_read_b128 v[180:183], v10 offset:1024
  v_mfma_f32_16x16x32_bf16 v[48:51], v[112:115], v[88:91], v[48:51]
  ds_read_b128 v[184:187], v10 offset:3072
  v_mfma_f32_16x16x32_bf16 v[64:67], v[112:115], v[92:95], v[64:67]
  v_mfma_f32_16x16x32_bf16 v[80:83], v[112:115], v[96:99], v[80:83]
  ds_read_b128 v[188:191], v16 offset:1024
  v_mfma_f32_16x16x32_bf16 v[20:23], v[132:135], v[116:119], v[20:23]
  ds_read_b128 v[192:195], v16 offset:3072
  v_mfma_f32_16x16x32_bf16 v[36:39], v[132:135], v[120:123], v[36:39]
  v_mfma_f32_16x16x32_bf16 v[52:55], v[132:135], v[124:127], v[52:55]
  ds_read_b128 v[196:199], v13 offset:8192
  v_mfma_f32_16x16x32_bf16 v[68:71], v[132:135], v[128:131], v[68:71]
  ds_read_b128 v[200:203], v13 offset:9216
  v_mfma_f32_16x16x32_bf16 v[24:27], v[136:139], v[116:119], v[24:27]
  v_mfma_f32_16x16x32_bf16 v[40:43], v[136:139], v[120:123], v[40:43]
  ds_read_b128 v[204:207], v13 offset:10240
  v_mfma_f32_16x16x32_bf16 v[56:59], v[136:139], v[124:127], v[56:59]
  ds_read_b128 v[208:211], v13 offset:11264
  v_mfma_f32_16x16x32_bf16 v[72:75], v[136:139], v[128:131], v[72:75]
  v_mfma_f32_16x16x32_bf16 v[28:31], v[140:143], v[116:119], v[28:31]
  v_mfma_f32_16x16x32_bf16 v[44:47], v[140:143], v[120:123], v[44:47]
  v_mfma_f32_16x16x32_bf16 v[60:63], v[140:143], v[124:127], v[60:63]
  v_mfma_f32_16x16x32_bf16 v[76:79], v[140:143], v[128:131], v[76:79]
  v_mfma_f32_16x16x32_bf16 v[32:35], v[144:147], v[116:119], v[32:35]
  v_mfma_f32_16x16x32_bf16 v[48:51], v[144:147], v[120:123], v[48:51]
  v_mfma_f32_16x16x32_bf16 v[64:67], v[144:147], v[124:127], v[64:67]
  v_mfma_f32_16x16x32_bf16 v[80:83], v[144:147], v[128:131], v[80:83]
  s_waitcnt lgkmcnt(0)
  s_barrier
  v_mfma_f32_16x16x32_bf16 v[20:23], v[164:167], v[148:151], v[20:23]
  ds_read_b128 v[84:87], v10 offset:32768
  v_mfma_f32_16x16x32_bf16 v[36:39], v[164:167], v[152:155], v[36:39]
  ds_read_b128 v[88:91], v10 offset:34816
  v_mfma_f32_16x16x32_bf16 v[52:55], v[164:167], v[156:159], v[52:55]
  v_mfma_f32_16x16x32_bf16 v[68:71], v[164:167], v[160:163], v[68:71]
  ds_read_b128 v[92:95], v16 offset:32768
  v_mfma_f32_16x16x32_bf16 v[24:27], v[168:171], v[148:151], v[24:27]
  ds_read_b128 v[96:99], v16 offset:34816
  v_mfma_f32_16x16x32_bf16 v[40:43], v[168:171], v[152:155], v[40:43]
  v_mfma_f32_16x16x32_bf16 v[56:59], v[168:171], v[156:159], v[56:59]
  ds_read_b128 v[100:103], v13 offset:32768
  v_mfma_f32_16x16x32_bf16 v[72:75], v[168:171], v[160:163], v[72:75]
  ds_read_b128 v[104:107], v13 offset:33792
  v_mfma_f32_16x16x32_bf16 v[28:31], v[172:175], v[148:151], v[28:31]
  v_mfma_f32_16x16x32_bf16 v[44:47], v[172:175], v[152:155], v[44:47]
  ds_read_b128 v[108:111], v13 offset:34816
  v_mfma_f32_16x16x32_bf16 v[60:63], v[172:175], v[156:159], v[60:63]
  ds_read_b128 v[112:115], v13 offset:35840
  v_mfma_f32_16x16x32_bf16 v[76:79], v[172:175], v[160:163], v[76:79]
  v_mfma_f32_16x16x32_bf16 v[32:35], v[176:179], v[148:151], v[32:35]
  ds_read_b128 v[116:119], v10 offset:33792
  v_mfma_f32_16x16x32_bf16 v[48:51], v[176:179], v[152:155], v[48:51]
  ds_read_b128 v[120:123], v10 offset:35840
  v_mfma_f32_16x16x32_bf16 v[64:67], v[176:179], v[156:159], v[64:67]
  v_mfma_f32_16x16x32_bf16 v[80:83], v[176:179], v[160:163], v[80:83]
  ds_read_b128 v[124:127], v16 offset:33792
  v_mfma_f32_16x16x32_bf16 v[20:23], v[196:199], v[180:183], v[20:23]
  ds_read_b128 v[128:131], v16 offset:35840
  v_mfma_f32_16x16x32_bf16 v[36:39], v[196:199], v[184:187], v[36:39]
  v_mfma_f32_16x16x32_bf16 v[52:55], v[196:199], v[188:191], v[52:55]
  ds_read_b128 v[132:135], v13 offset:40960
  v_mfma_f32_16x16x32_bf16 v[68:71], v[196:199], v[192:195], v[68:71]
  ds_read_b128 v[136:139], v13 offset:41984
  v_mfma_f32_16x16x32_bf16 v[24:27], v[200:203], v[180:183], v[24:27]
  v_mfma_f32_16x16x32_bf16 v[40:43], v[200:203], v[184:187], v[40:43]
  ds_read_b128 v[140:143], v13 offset:43008
  v_mfma_f32_16x16x32_bf16 v[56:59], v[200:203], v[188:191], v[56:59]
  ds_read_b128 v[144:147], v13 offset:44032
  v_mfma_f32_16x16x32_bf16 v[72:75], v[200:203], v[192:195], v[72:75]
  v_mfma_f32_16x16x32_bf16 v[28:31], v[204:207], v[180:183], v[28:31]
  v_mfma_f32_16x16x32_bf16 v[44:47], v[204:207], v[184:187], v[44:47]
  v_mfma_f32_16x16x32_bf16 v[60:63], v[204:207], v[188:191], v[60:63]
  v_mfma_f32_16x16x32_bf16 v[76:79], v[204:207], v[192:195], v[76:79]
  v_mfma_f32_16x16x32_bf16 v[32:35], v[208:211], v[180:183], v[32:35]
  v_mfma_f32_16x16x32_bf16 v[48:51], v[208:211], v[184:187], v[48:51]
  v_mfma_f32_16x16x32_bf16 v[64:67], v[208:211], v[188:191], v[64:67]
  v_mfma_f32_16x16x32_bf16 v[80:83], v[208:211], v[192:195], v[80:83]
  s_sub_u32 s11, s11, 1
  s_cmp_lg_u32 s11, 0
  s_cbranch_scc1 .Lmixer_kernel_c4
  s_waitcnt lgkmcnt(0)
  s_barrier
  s_nop 0
  v_mfma_f32_16x16x32_bf16 v[20:23], v[100:103], v[84:87], v[20:23]
  ds_read_b128 v[148:151], v9 offset:0
  v_mfma_f32_16x16x32_bf16 v[36:39], v[100:103], v[88:91], v[36:39]
  ds_read_b128 v[152:155], v9 offset:2048
  v_mfma_f32_16x16x32_bf16 v[52:55], v[100:103], v[92:95], v[52:55]
  v_mfma_f32_16x16x32_bf16 v[68:71], v[100:103], v[96:99], v[68:71]
  ds_read_b128 v[156:159], v15 offset:0
  v_mfma_f32_16x16x32_bf16 v[24:27], v[104:107], v[84:87], v[24:27]
  ds_read_b128 v[160:163], v15 offset:2048
  v_mfma_f32_16x16x32_bf16 v[40:43], v[104:107], v[88:91], v[40:43]
  v_mfma_f32_16x16x32_bf16 v[56:59], v[104:107], v[92:95], v[56:59]
  ds_read_b128 v[164:167], v12 offset:0
  v_mfma_f32_16x16x32_bf16 v[72:75], v[104:107], v[96:99], v[72:75]
  ds_read_b128 v[168:171], v12 offset:1024
  v_mfma_f32_16x16x32_bf16 v[28:31], v[108:111], v[84:87], v[28:31]
  v_mfma_f32_16x16x32_bf16 v[44:47], v[108:111], v[88:91], v[44:47]
  ds_read_b128 v[172:175], v12 offset:2048
  v_mfma_f32_16x16x32_bf16 v[60:63], v[108:111], v[92:95], v[60:63]
  ds_read_b128 v[176:179], v12 offset:3072
  v_mfma_f32_16x16x32_bf16 v[76:79], v[108:111], v[96:99], v[76:79]
  v_mfma_f32_16x16x32_bf16 v[32:35], v[112:115], v[84:87], v[32:35]
  ds_read_b128 v[180:183], v9 offset:1024
  v_mfma_f32_16x16x32_bf16 v[48:51], v[112:115], v[88:91], v[48:51]
  ds_read_b128 v[184:187], v9 offset:3072
  v_mfma_f32_16x16x32_bf16 v[64:67], v[112:115], v[92:95], v[64:67]
  v_mfma_f32_16x16x32_bf16 v[80:83], v[112:115], v[96:99], v[80:83]
  ds_read_b128 v[188:191], v15 offset:1024
  v_mfma_f32_16x16x32_bf16 v[20:23], v[132:135], v[116:119], v[20:23]
  ds_read_b128 v[192:195], v15 offset:3072
  v_mfma_f32_16x16x32_bf16 v[36:39], v[132:135], v[120:123], v[36:39]
  v_mfma_f32_16x16x32_bf16 v[52:55], v[132:135], v[124:127], v[52:55]
  ds_read_b128 v[196:199], v12 offset:8192
  v_mfma_f32_16x16x32_bf16 v[68:71], v[132:135], v[128:131], v[68:71]
  ds_read_b128 v[200:203], v12 offset:9216
  v_mfma_f32_16x16x32_bf16 v[24:27], v[136:139], v[116:119], v[24:27]
  v_mfma_f32_16x16x32_bf16 v[40:43], v[136:139], v[120:123], v[40:43]
  ds_read_b128 v[204:207], v12 offset:10240
  v_mfma_f32_16x16x32_bf16 v[56:59], v[136:139], v[124:127], v[56:59]
  ds_read_b128 v[208:211], v12 offset:11264
  v_mfma_f32_16x16x32_bf16 v[72:75], v[136:139], v[128:131], v[72:75]
  v_mfma_f32_16x16x32_bf16 v[28:31], v[140:143], v[116:119], v[28:31]
  v_mfma_f32_16x16x32_bf16 v[44:47], v[140:143], v[120:123], v[44:47]
  v_mfma_f32_16x16x32_bf16 v[60:63], v[140:143], v[124:127], v[60:63]
  v_mfma_f32_16x16x32_bf16 v[76:79], v[140:143], v[128:131], v[76:79]
  v_mfma_f32_16x16x32_bf16 v[32:35], v[144:147], v[116:119], v[32:35]
  v_mfma_f32_16x16x32_bf16 v[48:51], v[144:147], v[120:123], v[48:51]
  v_mfma_f32_16x16x32_bf16 v[64:67], v[144:147], v[124:127], v[64:67]
  v_mfma_f32_16x16x32_bf16 v[80:83], v[144:147], v[128:131], v[80:83]
  s_waitcnt lgkmcnt(0)
  s_barrier
  v_mfma_f32_16x16x32_bf16 v[20:23], v[164:167], v[148:151], v[20:23]
  ds_read_b128 v[84:87], v9 offset:32768
  v_mfma_f32_16x16x32_bf16 v[36:39], v[164:167], v[152:155], v[36:39]
  ds_read_b128 v[88:91], v9 offset:34816
  v_mfma_f32_16x16x32_bf16 v[52:55], v[164:167], v[156:159], v[52:55]
  v_mfma_f32_16x16x32_bf16 v[68:71], v[164:167], v[160:163], v[68:71]
  ds_read_b128 v[92:95], v15 offset:32768
  v_mfma_f32_16x16x32_bf16 v[24:27], v[168:171], v[148:151], v[24:27]
  ds_read_b128 v[96:99], v15 offset:34816
  v_mfma_f32_16x16x32_bf16 v[40:43], v[168:171], v[152:155], v[40:43]
  v_mfma_f32_16x16x32_bf16 v[56:59], v[168:171], v[156:159], v[56:59]
  ds_read_b128 v[100:103], v12 offset:32768
  v_mfma_f32_16x16x32_bf16 v[72:75], v[168:171], v[160:163], v[72:75]
  ds_read_b128 v[104:107], v12 offset:33792
  v_mfma_f32_16x16x32_bf16 v[28:31], v[172:175], v[148:151], v[28:31]
  v_mfma_f32_16x16x32_bf16 v[44:47], v[172:175], v[152:155], v[44:47]
  ds_read_b128 v[108:111], v12 offset:34816
  v_mfma_f32_16x16x32_bf16 v[60:63], v[172:175], v[156:159], v[60:63]
  ds_read_b128 v[112:115], v12 offset:35840
  v_mfma_f32_16x16x32_bf16 v[76:79], v[172:175], v[160:163], v[76:79]
  v_mfma_f32_16x16x32_bf16 v[32:35], v[176:179], v[148:151], v[32:35]
  ds_read_b128 v[116:119], v9 offset:33792
  v_mfma_f32_16x16x32_bf16 v[48:51], v[176:179], v[152:155], v[48:51]
  ds_read_b128 v[120:123], v9 offset:35840
  v_mfma_f32_16x16x32_bf16 v[64:67], v[176:179], v[156:159], v[64:67]
  v_mfma_f32_16x16x32_bf16 v[80:83], v[176:179], v[160:163], v[80:83]
  ds_read_b128 v[124:127], v15 offset:33792
  v_mfma_f32_16x16x32_bf16 v[20:23], v[196:199], v[180:183], v[20:23]
  ds_read_b128 v[128:131], v15 offset:35840
  v_mfma_f32_16x16x32_bf16 v[36:39], v[196:199], v[184:187], v[36:39]
  v_mfma_f32_16x16x32_bf16 v[52:55], v[196:199], v[188:191], v[52:55]
  ds_read_b128 v[132:135], v12 offset:40960
  v_mfma_f32_16x16x32_bf16 v[68:71], v[196:199], v[192:195], v[68:71]
  ds_read_b128 v[136:139], v12 offset:41984
  v_mfma_f32_16x16x32_bf16 v[24:27], v[200:203], v[180:183], v[24:27]
  v_mfma_f32_16x16x32_bf16 v[40:43], v[200:203], v[184:187], v[40:43]
  ds_read_b128 v[140:143], v12 offset:43008
  v_mfma_f32_16x16x32_bf16 v[56:59], v[200:203], v[188:191], v[56:59]
  ds_read_b128 v[144:147], v12 offset:44032
  v_mfma_f32_16x16x32_bf16 v[72:75], v[200:203], v[192:195], v[72:75]
  v_mfma_f32_16x16x32_bf16 v[28:31], v[204:207], v[180:183], v[28:31]
  v_mfma_f32_16x16x32_bf16 v[44:47], v[204:207], v[184:187], v[44:47]
  v_mfma_f32_16x16x32_bf16 v[60:63], v[204:207], v[188:191], v[60:63]
  s_lshl_b32 s43, s38, 15
  v_mfma_f32_16x16x32_bf16 v[76:79], v[204:207], v[192:195], v[76:79]
  s_lshl_b32 s44, s37, 11
  v_mfma_f32_16x16x32_bf16 v[32:35], v[208:211], v[180:183], v[32:35]
  s_add_u32 s43, s43, s44
  s_nop 0
  v_mfma_f32_16x16x32_bf16 v[48:51], v[208:211], v[184:187], v[48:51]
  s_add_u32 s44, s43, 32768
  v_mfma_f32_16x16x32_bf16 v[64:67], v[208:211], v[188:191], v[64:67]
  v_mfma_f32_16x16x32_bf16 v[80:83], v[208:211], v[192:195], v[80:83]
  s_waitcnt lgkmcnt(0)
  s_barrier
  v_mfma_f32_16x16x32_bf16 v[20:23], v[100:103], v[84:87], v[20:23]
  ds_read_b128 v[148:151], v10 offset:0
  v_mfma_f32_16x16x32_bf16 v[36:39], v[100:103], v[88:91], v[36:39]
  ds_read_b128 v[152:155], v10 offset:2048
  v_mfma_f32_16x16x32_bf16 v[52:55], v[100:103], v[92:95], v[52:55]
  v_mfma_f32_16x16x32_bf16 v[68:71], v[100:103], v[96:99], v[68:71]
  ds_read_b128 v[156:159], v16 offset:0
  v_mfma_f32_16x16x32_bf16 v[24:27], v[104:107], v[84:87], v[24:27]
  ds_read_b128 v[160:163], v16 offset:2048
  v_mfma_f32_16x16x32_bf16 v[40:43], v[104:107], v[88:91], v[40:43]
  v_mfma_f32_16x16x32_bf16 v[56:59], v[104:107], v[92:95], v[56:59]
  ds_read_b128 v[164:167], v13 offset:0
  v_mfma_f32_16x16x32_bf16 v[72:75], v[104:107], v[96:99], v[72:75]
  ds_read_b128 v[168:171], v13 offset:1024
  v_mfma_f32_16x16x32_bf16 v[28:31], v[108:111], v[84:87], v[28:31]
  v_mfma_f32_16x16x32_bf16 v[44:47], v[108:111], v[88:91], v[44:47]
  ds_read_b128 v[172:175], v13 offset:2048
  v_mfma_f32_16x16x32_bf16 v[60:63], v[108:111], v[92:95], v[60:63]
  ds_read_b128 v[176:179], v13 offset:3072
  v_mfma_f32_16x16x32_bf16 v[76:79], v[108:111], v[96:99], v[76:79]
  v_mfma_f32_16x16x32_bf16 v[32:35], v[112:115], v[84:87], v[32:35]
  ds_read_b128 v[180:183], v10 offset:1024
  v_mfma_f32_16x16x32_bf16 v[48:51], v[112:115], v[88:91], v[48:51]
  ds_read_b128 v[184:187], v10 offset:3072
  v_mfma_f32_16x16x32_bf16 v[64:67], v[112:115], v[92:95], v[64:67]
  v_mfma_f32_16x16x32_bf16 v[80:83], v[112:115], v[96:99], v[80:83]
  ds_read_b128 v[188:191], v16 offset:1024
  v_mfma_f32_16x16x32_bf16 v[20:23], v[132:135], v[116:119], v[20:23]
  ds_read_b128 v[192:195], v16 offset:3072
  v_mfma_f32_16x16x32_bf16 v[36:39], v[132:135], v[120:123], v[36:39]
  v_mfma_f32_16x16x32_bf16 v[52:55], v[132:135], v[124:127], v[52:55]
  ds_read_b128 v[196:199], v13 offset:8192
  v_mfma_f32_16x16x32_bf16 v[68:71], v[132:135], v[128:131], v[68:71]
  ds_read_b128 v[200:203], v13 offset:9216
  v_mfma_f32_16x16x32_bf16 v[24:27], v[136:139], v[116:119], v[24:27]
  v_mfma_f32_16x16x32_bf16 v[40:43], v[136:139], v[120:123], v[40:43]
  ds_read_b128 v[204:207], v13 offset:10240
  v_mfma_f32_16x16x32_bf16 v[56:59], v[136:139], v[124:127], v[56:59]
  ds_read_b128 v[208:211], v13 offset:11264
  v_mfma_f32_16x16x32_bf16 v[72:75], v[136:139], v[128:131], v[72:75]
  v_mfma_f32_16x16x32_bf16 v[28:31], v[140:143], v[116:119], v[28:31]
  v_mfma_f32_16x16x32_bf16 v[44:47], v[140:143], v[120:123], v[44:47]
  v_mfma_f32_16x16x32_bf16 v[60:63], v[140:143], v[124:127], v[60:63]
  v_mfma_f32_16x16x32_bf16 v[76:79], v[140:143], v[128:131], v[76:79]
  v_mfma_f32_16x16x32_bf16 v[32:35], v[144:147], v[116:119], v[32:35]
  v_mfma_f32_16x16x32_bf16 v[48:51], v[144:147], v[120:123], v[48:51]
  v_mfma_f32_16x16x32_bf16 v[64:67], v[144:147], v[124:127], v[64:67]
  v_mfma_f32_16x16x32_bf16 v[80:83], v[144:147], v[128:131], v[80:83]
  s_waitcnt lgkmcnt(0)
  s_nop 0
  v_mfma_f32_16x16x32_bf16 v[20:23], v[164:167], v[148:151], v[20:23]
  v_mfma_f32_16x16x32_bf16 v[36:39], v[164:167], v[152:155], v[36:39]
  v_mfma_f32_16x16x32_bf16 v[52:55], v[164:167], v[156:159], v[52:55]
  v_mfma_f32_16x16x32_bf16 v[68:71], v[164:167], v[160:163], v[68:71]
  v_mfma_f32_16x16x32_bf16 v[24:27], v[168:171], v[148:151], v[24:27]
  v_mfma_f32_16x16x32_bf16 v[40:43], v[168:171], v[152:155], v[40:43]
  v_mfma_f32_16x16x32_bf16 v[56:59], v[168:171], v[156:159], v[56:59]
  v_mfma_f32_16x16x32_bf16 v[72:75], v[168:171], v[160:163], v[72:75]
  v_mfma_f32_16x16x32_bf16 v[28:31], v[172:175], v[148:151], v[28:31]
  v_mfma_f32_16x16x32_bf16 v[44:47], v[172:175], v[152:155], v[44:47]
  v_mfma_f32_16x16x32_bf16 v[60:63], v[172:175], v[156:159], v[60:63]
  v_mfma_f32_16x16x32_bf16 v[76:79], v[172:175], v[160:163], v[76:79]
  v_mfma_f32_16x16x32_bf16 v[32:35], v[176:179], v[148:151], v[32:35]
  v_mfma_f32_16x16x32_bf16 v[48:51], v[176:179], v[152:155], v[48:51]
  v_mfma_f32_16x16x32_bf16 v[64:67], v[176:179], v[156:159], v[64:67]
  v_mfma_f32_16x16x32_bf16 v[80:83], v[176:179], v[160:163], v[80:83]
  v_mfma_f32_16x16x32_bf16 v[20:23], v[196:199], v[180:183], v[20:23]
  v_mfma_f32_16x16x32_bf16 v[36:39], v[196:199], v[184:187], v[36:39]
  v_mfma_f32_16x16x32_bf16 v[52:55], v[196:199], v[188:191], v[52:55]
  v_mfma_f32_16x16x32_bf16 v[68:71], v[196:199], v[192:195], v[68:71]
  v_mfma_f32_16x16x32_bf16 v[24:27], v[200:203], v[180:183], v[24:27]
  v_mfma_f32_16x16x32_bf16 v[40:43], v[200:203], v[184:187], v[40:43]
  v_mfma_f32_16x16x32_bf16 v[56:59], v[200:203], v[188:191], v[56:59]
  v_mfma_f32_16x16x32_bf16 v[72:75], v[200:203], v[192:195], v[72:75]
  v_mfma_f32_16x16x32_bf16 v[28:31], v[204:207], v[180:183], v[28:31]
  v_mfma_f32_16x16x32_bf16 v[44:47], v[204:207], v[184:187], v[44:47]
  v_mfma_f32_16x16x32_bf16 v[60:63], v[204:207], v[188:191], v[60:63]
  v_mfma_f32_16x16x32_bf16 v[76:79], v[204:207], v[192:195], v[76:79]
  v_mfma_f32_16x16x32_bf16 v[32:35], v[208:211], v[180:183], v[32:35]
  v_mfma_f32_16x16x32_bf16 v[48:51], v[208:211], v[184:187], v[48:51]
  v_mfma_f32_16x16x32_bf16 v[64:67], v[208:211], v[188:191], v[64:67]
  v_mfma_f32_16x16x32_bf16 v[80:83], v[208:211], v[192:195], v[80:83]
  s_add_u32 s16, s4, 0x5000000
  s_addc_u32 s17, s5, 0
  s_mov_b32 s18, 0x800000
  s_mov_b32 s19, 0x20000
  s_lshl_b32 s45, s2, 2
  s_add_u32 s45, s45, s10
  s_lshl_b32 s46, s45, 13
  s_add_u32 s39, s46, 4096
  v_cvt_pk_bf16_f32 v148, v52, v53
  v_cvt_pk_bf16_f32 v149, v54, v55
  v_cvt_pk_bf16_f32 v150, v56, v57
  v_cvt_pk_bf16_f32 v151, v58, v59
  buffer_store_dwordx4 v[148:151], v7, s[16:19], s46 offen offset:0 sc1
  v_cvt_pk_bf16_f32 v152, v60, v61
  v_cvt_pk_bf16_f32 v153, v62, v63
  v_cvt_pk_bf16_f32 v154, v64, v65
  v_cvt_pk_bf16_f32 v155, v66, v67
  buffer_store_dwordx4 v[152:155], v7, s[16:19], s46 offen offset:1024 sc1
  v_cvt_pk_bf16_f32 v156, v68, v69
  v_cvt_pk_bf16_f32 v157, v70, v71
  v_cvt_pk_bf16_f32 v158, v72, v73
  v_cvt_pk_bf16_f32 v159, v74, v75
  buffer_store_dwordx4 v[156:159], v7, s[16:19], s46 offen offset:2048 sc1
  v_cvt_pk_bf16_f32 v160, v76, v77
  v_cvt_pk_bf16_f32 v161, v78, v79
  v_cvt_pk_bf16_f32 v162, v80, v81
  v_cvt_pk_bf16_f32 v163, v82, v83
  buffer_store_dwordx4 v[160:163], v7, s[16:19], s46 offen offset:3072 sc1
  s_xor_b32 s40, s2, 1
  s_lshl_b32 s40, s40, 7
  s_lshl_b32 s41, s10, 2
  s_add_u32 s40, s40, s41
  s_add_u32 s40, s40, 278528
  s_lshl_b32 s42, s2, 7
  s_add_u32 s42, s42, s41
  s_add_u32 s42, s42, 278528
  v_mov_b32 v4, 0
  v_mov_b32 v9, s42
  s_waitcnt vmcnt(0)
  s_mov_b64 exec, 1
  buffer_store_dword v8, v4, s[12:15], s40 offen sc1
  s_mov_b64 exec, -1
  s_xor_b32 s46, s46, 32768
  s_add_u32 s39, s46, 4096
  v_lshlrev_b32 v84, 16, v224
  v_and_b32 v85, 0xffff0000, v224
  v_lshlrev_b32 v116, 16, v240
  v_and_b32 v117, 0xffff0000, v240
  v_lshlrev_b32 v86, 16, v225
  v_and_b32 v87, 0xffff0000, v225
  v_lshlrev_b32 v118, 16, v241
  v_and_b32 v119, 0xffff0000, v241
  v_lshlrev_b32 v88, 16, v226
  v_and_b32 v89, 0xffff0000, v226
  v_lshlrev_b32 v120, 16, v242
  v_and_b32 v121, 0xffff0000, v242
  v_lshlrev_b32 v90, 16, v227
  v_and_b32 v91, 0xffff0000, v227
  v_lshlrev_b32 v122, 16, v243
  v_and_b32 v123, 0xffff0000, v243
  v_lshlrev_b32 v92, 16, v228
  v_and_b32 v93, 0xffff0000, v228
  v_lshlrev_b32 v124, 16, v244
  v_and_b32 v125, 0xffff0000, v244
  v_lshlrev_b32 v94, 16, v229
  v_and_b32 v95, 0xffff0000, v229
  v_lshlrev_b32 v126, 16, v245
  v_and_b32 v127, 0xffff0000, v245
  v_lshlrev_b32 v96, 16, v230
  v_and_b32 v97, 0xffff0000, v230
  v_lshlrev_b32 v128, 16, v246
  v_and_b32 v129, 0xffff0000, v246
  v_lshlrev_b32 v98, 16, v231
  v_and_b32 v99, 0xffff0000, v231
  v_lshlrev_b32 v130, 16, v247
  v_and_b32 v131, 0xffff0000, v247
  v_lshlrev_b32 v100, 16, v232
  v_and_b32 v101, 0xffff0000, v232
  v_lshlrev_b32 v132, 16, v248
  v_and_b32 v133, 0xffff0000, v248
  v_lshlrev_b32 v102, 16, v233
  v_and_b32 v103, 0xffff0000, v233
  v_lshlrev_b32 v134, 16, v249
  v_and_b32 v135, 0xffff0000, v249
  v_lshlrev_b32 v104, 16, v234
  v_and_b32 v105, 0xffff0000, v234
  v_lshlrev_b32 v136, 16, v250
  v_and_b32 v137, 0xffff0000, v250
  v_lshlrev_b32 v106, 16, v235
  v_and_b32 v107, 0xffff0000, v235
  v_lshlrev_b32 v138, 16, v251
  v_and_b32 v139, 0xffff0000, v251
  v_lshlrev_b32 v108, 16, v236
  v_and_b32 v109, 0xffff0000, v236
  v_lshlrev_b32 v140, 16, v252
  v_and_b32 v141, 0xffff0000, v252
  v_lshlrev_b32 v110, 16, v237
  v_and_b32 v111, 0xffff0000, v237
  v_lshlrev_b32 v142, 16, v253
  v_and_b32 v143, 0xffff0000, v253
  v_lshlrev_b32 v112, 16, v238
  v_and_b32 v113, 0xffff0000, v238
  v_lshlrev_b32 v144, 16, v254
  v_and_b32 v145, 0xffff0000, v254
  v_lshlrev_b32 v114, 16, v239
  v_and_b32 v115, 0xffff0000, v239
  v_lshlrev_b32 v146, 16, v255
  v_and_b32 v147, 0xffff0000, v255
  s_mov_b32 s47, 32768
  s_mov_b32 exec_lo, 0x1
  s_mov_b32 exec_hi, 0x0
  s_nop 0
.Lpoll_x4:
  buffer_load_dword v5, v9, s[12:15], 0 offen sc1
  s_sub_u32 s47, s47, 1
  s_waitcnt vmcnt(0)
  v_cmp_lt_u32 vcc, v5, v8
  s_nop 0
  s_cmp_eq_u64 vcc, 0
  s_cselect_b32 s47, 0, s47
  s_cmp_lg_u32 s47, 0
  s_cbranch_scc0 .Lpolled_x4
  s_branch .Lpoll_x4
.Lpolled_x4:
  s_mov_b64 exec, -1
  buffer_load_dwordx4 v[148:151], v7, s[16:19], s46 offen offset:0 sc1
  buffer_load_dwordx4 v[152:155], v7, s[16:19], s46 offen offset:1024 sc1
  buffer_load_dwordx4 v[156:159], v7, s[16:19], s46 offen offset:2048 sc1
  buffer_load_dwordx4 v[160:163], v7, s[16:19], s46 offen offset:3072 sc1
  s_waitcnt vmcnt(3)
  v_lshlrev_b32 v164, 16, v148
  v_and_b32 v165, 0xffff0000, v148
  v_lshlrev_b32 v166, 16, v149
  v_and_b32 v167, 0xffff0000, v149
  v_lshlrev_b32 v168, 16, v150
  v_and_b32 v169, 0xffff0000, v150
  v_lshlrev_b32_e64 v170, 16, v151
  v_and_b32 v171, 0xffff0000, v151
  v_pk_add_f32 v[20:21], v[20:21], v[164:165]
  v_pk_add_f32 v[22:23], v[22:23], v[166:167]
  v_pk_add_f32 v[24:25], v[24:25], v[168:169]
  v_pk_add_f32 v[26:27], v[26:27], v[170:171]
  s_waitcnt vmcnt(2)
  v_lshlrev_b32 v164, 16, v152
  v_and_b32 v165, 0xffff0000, v152
  v_lshlrev_b32 v166, 16, v153
  v_and_b32 v167, 0xffff0000, v153
  v_lshlrev_b32 v168, 16, v154
  v_and_b32 v169, 0xffff0000, v154
  v_lshlrev_b32_e64 v170, 16, v155
  v_and_b32 v171, 0xffff0000, v155
  v_pk_add_f32 v[28:29], v[28:29], v[164:165]
  v_pk_add_f32 v[30:31], v[30:31], v[166:167]
  v_pk_add_f32 v[32:33], v[32:33], v[168:169]
  v_pk_add_f32 v[34:35], v[34:35], v[170:171]
  s_waitcnt vmcnt(1)
  v_lshlrev_b32 v164, 16, v156
  v_and_b32 v165, 0xffff0000, v156
  v_lshlrev_b32 v166, 16, v157
  v_and_b32 v167, 0xffff0000, v157
  v_lshlrev_b32 v168, 16, v158
  v_and_b32 v169, 0xffff0000, v158
  v_lshlrev_b32_e64 v170, 16, v159
  v_and_b32 v171, 0xffff0000, v159
  v_pk_add_f32 v[36:37], v[36:37], v[164:165]
  v_pk_add_f32 v[38:39], v[38:39], v[166:167]
  v_pk_add_f32 v[40:41], v[40:41], v[168:169]
  v_pk_add_f32 v[42:43], v[42:43], v[170:171]
  s_waitcnt vmcnt(0)
  v_lshlrev_b32 v164, 16, v160
  v_and_b32 v165, 0xffff0000, v160
  v_lshlrev_b32 v166, 16, v161
  v_and_b32 v167, 0xffff0000, v161
  v_lshlrev_b32 v168, 16, v162
  v_and_b32 v169, 0xffff0000, v162
  v_lshlrev_b32_e64 v170, 16, v163
  v_and_b32 v171, 0xffff0000, v163
  v_pk_add_f32 v[44:45], v[44:45], v[164:165]
  v_pk_add_f32 v[46:47], v[46:47], v[166:167]
  v_pk_add_f32 v[48:49], v[48:49], v[168:169]
  v_pk_add_f32 v[50:51], v[50:51], v[170:171]
  s_waitcnt vmcnt(0)
  s_lshl_b32 s41, s10, 12
  s_add_u32 s41, s41, 0
  v_lshrrev_b32 v4, 1, v3
  v_xor_b32 v4, v4, v2
  v_and_b32 v4, 7, v4
  v_lshlrev_b32 v4, 4, v4
  v_lshl_add_u32 v4, v2, 7, v4
  v_and_b32 v5, 1, v3
  v_lshl_add_u32 v4, v5, 3, v4
  v_add_u32 v212, s41, v4
  v_xor_b32 v213, 32, v212
  v_xor_b32 v214, 64, v212
  v_xor_b32 v215, 96, v212
  v_lshrrev_b32 v4, 3, v1
  v_xor_b32 v5, v4, v1
  v_and_b32 v5, 7, v5
  v_lshlrev_b32 v5, 4, v5
  v_lshl_add_u32 v216, v4, 7, v5
  v_add_u32 v216, s41, v216
  v_and_b32 v5, 7, v1
  v_lshlrev_b32 v5, 4, v5
  v_lshl_add_u32 v217, v4, 11, v5
  s_lshl_b32 s43, s38, 15
  s_lshl_b32 s44, s37, 7
  s_add_u32 s43, s43, s44
  s_nop 0
  v_cvt_pk_bf16_f32 v20, v20, v21
  v_cvt_pk_bf16_f32 v22, v22, v23
  v_cvt_pk_bf16_f32 v24, v24, v25
  v_cvt_pk_bf16_f32 v26, v26, v27
  v_and_b32 v21, 0xffff0000, v20
  v_and_b32 v23, 0xffff0000, v22
  v_and_b32 v25, 0xffff0000, v24
  v_and_b32 v27, 0xffff0000, v26
  v_lshlrev_b32 v20, 16, v20
  v_lshlrev_b32 v22, 16, v22
  v_lshlrev_b32 v24, 16, v24
  v_lshlrev_b32 v26, 16, v26
  v_pk_add_f32 v[20:21], v[20:21], v[84:85]
  v_pk_add_f32 v[22:23], v[22:23], v[86:87]
  v_pk_add_f32 v[24:25], v[24:25], v[88:89]
  v_pk_add_f32 v[26:27], v[26:27], v[90:91]
  v_cvt_pk_bf16_f32 v20, v20, v21
  v_cvt_pk_bf16_f32 v22, v22, v23
  v_cvt_pk_bf16_f32 v24, v24, v25
  v_cvt_pk_bf16_f32 v26, v26, v27
  v_and_b32 v21, 0xffff0000, v20
  v_and_b32 v23, 0xffff0000, v22
  v_and_b32 v25, 0xffff0000, v24
  v_and_b32 v27, 0xffff0000, v26
  v_lshlrev_b32 v20, 16, v20
  v_lshlrev_b32 v22, 16, v22
  v_lshlrev_b32 v24, 16, v24
  v_lshlrev_b32 v26, 16, v26
  v_pk_add_f32 v[20:21], v[20:21], v[116:117]
  v_pk_add_f32 v[22:23], v[22:23], v[118:119]
  v_pk_add_f32 v[24:25], v[24:25], v[120:121]
  v_pk_add_f32 v[26:27], v[26:27], v[122:123]
  v_cvt_pk_bf16_f32 v224, v20, v21
  v_cvt_pk_bf16_f32 v225, v22, v23
  v_cvt_pk_bf16_f32 v226, v24, v25
  v_cvt_pk_bf16_f32 v227, v26, v27
  ds_write_b64 v212, v[224:225] offset:0
  ds_write_b64 v213, v[226:227] offset:0
  v_cvt_pk_bf16_f32 v28, v28, v29
  v_cvt_pk_bf16_f32 v30, v30, v31
  v_cvt_pk_bf16_f32 v32, v32, v33
  v_cvt_pk_bf16_f32 v34, v34, v35
  v_and_b32 v29, 0xffff0000, v28
  v_and_b32 v31, 0xffff0000, v30
  v_and_b32 v33, 0xffff0000, v32
  v_and_b32 v35, 0xffff0000, v34
  v_lshlrev_b32 v28, 16, v28
  v_lshlrev_b32 v30, 16, v30
  v_lshlrev_b32 v32, 16, v32
  v_lshlrev_b32 v34, 16, v34
  v_pk_add_f32 v[28:29], v[28:29], v[92:93]
  v_pk_add_f32 v[30:31], v[30:31], v[94:95]
  v_pk_add_f32 v[32:33], v[32:33], v[96:97]
  v_pk_add_f32 v[34:35], v[34:35], v[98:99]
  v_cvt_pk_bf16_f32 v28, v28, v29
  v_cvt_pk_bf16_f32 v30, v30, v31
  v_cvt_pk_bf16_f32 v32, v32, v33
  v_cvt_pk_bf16_f32 v34, v34, v35
  v_and_b32 v29, 0xffff0000, v28
  v_and_b32 v31, 0xffff0000, v30
  v_and_b32 v33, 0xffff0000, v32
  v_and_b32 v35, 0xffff0000, v34
  v_lshlrev_b32 v28, 16, v28
  v_lshlrev_b32 v30, 16, v30
  v_lshlrev_b32 v32, 16, v32
  v_lshlrev_b32 v34, 16, v34
  v_pk_add_f32 v[28:29], v[28:29], v[124:125]
  v_pk_add_f32 v[30:31], v[30:31], v[126:127]
  v_pk_add_f32 v[32:33], v[32:33], v[128:129]
  v_pk_add_f32 v[34:35], v[34:35], v[130:131]
  v_cvt_pk_bf16_f32 v228, v28, v29
  v_cvt_pk_bf16_f32 v229, v30, v31
  v_cvt_pk_bf16_f32 v230, v32, v33
  v_cvt_pk_bf16_f32 v231, v34, v35
  ds_write_b64 v214, v[228:229] offset:0
  ds_write_b64 v215, v[230:231] offset:0
  v_cvt_pk_bf16_f32 v36, v36, v37
  v_cvt_pk_bf16_f32 v38, v38, v39
  v_cvt_pk_bf16_f32 v40, v40, v41
  v_cvt_pk_bf16_f32 v42, v42, v43
  v_and_b32 v37, 0xffff0000, v36
  v_and_b32 v39, 0xffff0000, v38
  v_and_b32 v41, 0xffff0000, v40
  v_and_b32 v43, 0xffff0000, v42
  v_lshlrev_b32 v36, 16, v36
  v_lshlrev_b32 v38, 16, v38
  v_lshlrev_b32 v40, 16, v40
  v_lshlrev_b32 v42, 16, v42
  v_pk_add_f32 v[36:37], v[36:37], v[100:101]
  v_pk_add_f32 v[38:39], v[38:39], v[102:103]
  v_pk_add_f32 v[40:41], v[40:41], v[104:105]
  v_pk_add_f32 v[42:43], v[42:43], v[106:107]
  v_cvt_pk_bf16_f32 v36, v36, v37
  v_cvt_pk_bf16_f32 v38, v38, v39
  v_cvt_pk_bf16_f32 v40, v40, v41
  v_cvt_pk_bf16_f32 v42, v42, v43
  v_and_b32 v37, 0xffff0000, v36
  v_and_b32 v39, 0xffff0000, v38
  v_and_b32 v41, 0xffff0000, v40
  v_and_b32 v43, 0xffff0000, v42
  v_lshlrev_b32 v36, 16, v36
  v_lshlrev_b32 v38, 16, v38
  v_lshlrev_b32 v40, 16, v40
  v_lshlrev_b32 v42, 16, v42
  v_pk_add_f32 v[36:37], v[36:37], v[132:133]
  v_pk_add_f32 v[38:39], v[38:39], v[134:135]
  v_pk_add_f32 v[40:41], v[40:41], v[136:137]
  v_pk_add_f32 v[42:43], v[42:43], v[138:139]
  v_cvt_pk_bf16_f32 v232, v36, v37
  v_cvt_pk_bf16_f32 v233, v38, v39
  v_cvt_pk_bf16_f32 v234, v40, v41
  v_cvt_pk_bf16_f32 v235, v42, v43
  ds_write_b64 v212, v[232:233] offset:2048
  ds_write_b64 v213, v[234:235] offset:2048
  v_cvt_pk_bf16_f32 v44, v44, v45
  v_cvt_pk_bf16_f32 v46, v46, v47
  v_cvt_pk_bf16_f32 v48, v48, v49
  v_cvt_pk_bf16_f32 v50, v50, v51
  v_and_b32 v45, 0xffff0000, v44
  v_and_b32 v47, 0xffff0000, v46
  v_and_b32 v49, 0xffff0000, v48
  v_and_b32 v51, 0xffff0000, v50
  v_lshlrev_b32 v44, 16, v44
  v_lshlrev_b32 v46, 16, v46
  v_lshlrev_b32 v48, 16, v48
  v_lshlrev_b32 v50, 16, v50
  v_pk_add_f32 v[44:45], v[44:45], v[108:109]
  v_pk_add_f32 v[46:47], v[46:47], v[110:111]
  v_pk_add_f32 v[48:49], v[48:49], v[112:113]
  v_pk_add_f32 v[50:51], v[50:51], v[114:115]
  v_cvt_pk_bf16_f32 v44, v44, v45
  v_cvt_pk_bf16_f32 v46, v46, v47
  v_cvt_pk_bf16_f32 v48, v48, v49
  v_cvt_pk_bf16_f32 v50, v50, v51
  v_and_b32 v45, 0xffff0000, v44
  v_and_b32 v47, 0xffff0000, v46
  v_and_b32 v49, 0xffff0000, v48
  v_and_b32 v51, 0xffff0000, v50
  v_lshlrev_b32 v44, 16, v44
  v_lshlrev_b32 v46, 16, v46
  v_lshlrev_b32 v48, 16, v48
  v_lshlrev_b32 v50, 16, v50
  v_pk_add_f32 v[44:45], v[44:45], v[140:141]
  v_pk_add_f32 v[46:47], v[46:47], v[142:143]
  v_pk_add_f32 v[48:49], v[48:49], v[144:145]
  v_pk_add_f32 v[50:51], v[50:51], v[146:147]
  v_cvt_pk_bf16_f32 v236, v44, v45
  v_cvt_pk_bf16_f32 v237, v46, v47
  v_cvt_pk_bf16_f32 v238, v48, v49
  v_cvt_pk_bf16_f32 v239, v50, v51
  ds_write_b64 v214, v[236:237] offset:2048
  ds_write_b64 v215, v[238:239] offset:2048
  s_waitcnt lgkmcnt(0)
  s_nop 0
  ds_read_b128 v[196:199], v216 offset:0
  ds_read_b128 v[200:203], v216 offset:1024
  ds_read_b128 v[204:207], v216 offset:2048
  ds_read_b128 v[208:211], v216 offset:3072
  s_waitcnt lgkmcnt(3)
  buffer_store_dwordx4 v[196:199], v217, s[32:35], s43 offen sc1
  s_add_u32 s43, s43, 16384
  s_waitcnt lgkmcnt(2)
  buffer_store_dwordx4 v[200:203], v217, s[32:35], s43 offen sc1
  s_add_u32 s43, s43, 16384
  s_waitcnt lgkmcnt(1)
  buffer_store_dwordx4 v[204:207], v217, s[32:35], s43 offen sc1
  s_add_u32 s43, s43, 16384
  s_waitcnt lgkmcnt(0)
  buffer_store_dwordx4 v[208:211], v217, s[32:35], s43 offen sc1
  s_endpgm
.Lmixer_kernel_prod:
  s_sub_u32 s10, s10, 4
  v_mov_b32 v4, 151552
  v_mov_b32_e64 v5, 0
  ds_write_b32 v4, v5 offset:0
  ds_write_b32 v4, v5 offset:4
  ds_write_b32 v4, v5 offset:8
  ds_write_b32 v4, v5 offset:12
  ds_write_b32 v4, v5 offset:16
  ds_write_b32 v4, v5 offset:20
  ds_write_b32 v4, v5 offset:24
  ds_write_b32 v4, v5 offset:28
  s_waitcnt lgkmcnt(0)
  s_add_u32 s12, s4, 0x2bb0000
  s_addc_u32 s13, s5, 0
  s_mov_b32 s14, 0x4c000
  s_mov_b32 s15, 0x20000
  s_cmp_ge_u32 s2, 32
  s_cbranch_scc1 .Lprep_m1_1
  s_load_dwordx2 s[6:7], s[0:1], 48
  s_add_u32 s62, s2, 192
  s_mul_hi_u32 s60, s62, 306783379
  s_mul_i32 s63, s60, 14
  s_sub_u32 s49, s62, s63
  s_lshl_b32 s49, s49, 2
  s_mov_b32 s65, 12288
  s_mov_b32 s66, 1
  s_add_u32 s49, s49, s10
  s_nop 0
  s_mov_b32 s8, 7168
  s_mov_b32 s9, 224
  s_mov_b32 s48, 4194304
  s_mov_b32 s34, 7340032
  s_mul_i32 s61, s60, 18432
  s_lshl_b32 s63, s49, 8
  s_add_u32 s61, s61, s63
  s_add_u32 s61, s61, 4096
  s_branch .Lprep_m1_go
.Lprep_m1_1:
  s_cmp_ge_u32 s2, 96
  s_cbranch_scc1 .Lprep_m1_2
  s_load_dwordx2 s[6:7], s[0:1], 40
  s_sub_u32 s62, s2, 32
  s_lshr_b32 s60, s62, 2
  s_and_b32 s49, s62, 3
  s_lshl_b32 s49, s49, 2
  s_add_u32 s65, s49, 64
  s_lshl_b32 s65, s65, 7
  s_mov_b32 s66, 15
  s_add_u32 s49, s49, s10
  s_mov_b32 s8, 2048
  s_mov_b32 s9, 64
  s_mov_b32 s48, 2097152
  s_mov_b32 s34, 2097152
  s_mov_b32 s61, 0x40000000
  s_branch .Lprep_m1_go
.Lprep_m1_2:
  s_load_dwordx2 s[6:7], s[0:1], 48
  s_mov_b32 s60, 0
  s_mov_b32 s49, 0
  s_mov_b32 s8, 0
  s_mov_b32 s9, 0
  s_mov_b32 s48, 0x40000000
  s_mov_b32 s34, 0
  s_mov_b32 s61, 0x40000000
  s_mov_b32 s65, 0x40000000
  s_mov_b32 s66, 1
.Lprep_m1_go:
  v_lshrrev_b32 v87, 3, v1
  v_mul_u32_u24 v86, s8, v87
  v_lshlrev_b32 v87, 1, v3
  v_xor_b32 v87, v87, v1
  v_and_b32 v87, 7, v87
  v_lshl_add_u32 v86, v87, 4, v86
  s_mul_i32 s62, s60, s8
  s_lshl_b32 s62, s62, 6
  s_lshl_b32 s63, s49, 7
  s_add_u32 s62, s62, s63
  s_lshl_b32 s8, s8, 3
  s_add_u32 s64, s10, 0
  s_cmp_ge_u32 s64, 6
  s_cselect_b32 s63, 6, 0
  s_sub_u32 s64, s64, s63
  s_mul_i32 s64, s64, 24576
  s_add_u32 s64, s64, 16384
  v_lshrrev_b32 v87, 2, v2
  v_lshl_add_u32 v87, v3, 2, v87
  v_bfe_u32 v88, v87, 1, 2
  v_lshlrev_b32 v88, 1, v88
  v_lshlrev_b32 v87, 7, v87
  v_and_b32 v89, 1, v1
  v_lshl_add_u32 v87, v89, 3, v87
  v_bfe_u32 v89, v1, 1, 1
  v_xor_b32 v88, v88, v89
  v_lshl_add_u32 v87, v88, 4, v87
  v_add_u32 v90, s64, v87
  v_xor_b32 v91, 32, v90
  v_xor_b32 v92, 64, v90
  v_xor_b32 v93, 96, v90
  v_mov_b32 v128, 0x3f803f80
  v_mov_b32 v129, 0x3f803f80
  v_mov_b32 v130, 0x3f803f80
  v_mov_b32 v131, 0x3f803f80
  s_waitcnt lgkmcnt(0)
  s_mov_b32 s32, s6
  s_mov_b32 s33, s7
  s_mov_b32 s35, 0x20000
  s_add_u32 s56, s4, 0x3800000
  s_addc_u32 s57, s5, 0
  s_mov_b32 s58, 0x1200000
  s_mov_b32 s59, 0x20000
  s_add_u32 m0, s64, 0
  s_nop 0
  buffer_load_dwordx4 v86, s[32:35], s62 offen nt lds
  s_add_u32 s62, s62, s8
  s_add_u32 m0, s64, 1024
  s_nop 0
  buffer_load_dwordx4 v86, s[32:35], s62 offen nt lds
  s_add_u32 s62, s62, s8
  s_add_u32 m0, s64, 2048
  s_nop 0
  buffer_load_dwordx4 v86, s[32:35], s62 offen nt lds
  s_add_u32 s62, s62, s8
  s_add_u32 m0, s64, 3072
  s_nop 0
  buffer_load_dwordx4 v86, s[32:35], s62 offen nt lds
  s_add_u32 s62, s62, s8
  s_add_u32 m0, s64, 4096
  s_nop 0
  buffer_load_dwordx4 v86, s[32:35], s62 offen nt lds
  s_add_u32 s62, s62, s8
  s_add_u32 m0, s64, 5120
  s_nop 0
  buffer_load_dwordx4 v86, s[32:35], s62 offen nt lds
  s_add_u32 s62, s62, s8
  s_add_u32 m0, s64, 6144
  s_nop 0
  buffer_load_dwordx4 v86, s[32:35], s62 offen nt lds
  s_add_u32 s62, s62, s8
  s_add_u32 m0, s64, 7168
  s_nop 0
  buffer_load_dwordx4 v86, s[32:35], s62 offen nt lds
  s_barrier
  s_getpc_b64 s[52:53]
.Lpm_mixer_kernel:
  s_sub_u32 s52, s52, .Lpm_mixer_kernel-mixer_kernel
  s_subb_u32 s53, s53, 0
  s_nop 0
  s_mov_b32 s54, .Lmixer_kernel_end-mixer_kernel
  s_mov_b32 s55, 0x20000
  v_and_b32 v84, 0xff, v0
  v_lshlrev_b32_e64 v84, 7, v84
  v_add_u32 v85, 0x8000, v84
  buffer_load_dword v6, v84, s[52:55], 0 offen
  buffer_load_dword v6, v85, s[52:55], 0 offen
  s_waitcnt vmcnt(0)
  s_lshl_b32 s62, s60, 1
  s_mul_i32 s62, s62, s9
  s_lshl_b32 s63, s49, 2
  s_add_u32 s62, s62, s63
  s_lshl_b32 s62, s62, 10
  s_add_u32 s62, s62, s48
  s_lshl_b32 s63, s9, 10
  s_add_u32 s63, s63, s62
  s_nop 0
  ds_read_b64_tr_b16 v[96:97], v90 offset:0
  ds_read_b64_tr_b16 v[98:99], v90 offset:2048
  ds_read_b64_tr_b16 v[100:101], v91 offset:0
  ds_read_b64_tr_b16 v[102:103], v91 offset:2048
  ds_read_b64_tr_b16 v[104:105], v92 offset:0
  ds_read_b64_tr_b16 v[106:107], v92 offset:2048
  ds_read_b64_tr_b16 v[108:109], v93 offset:0
  ds_read_b64_tr_b16 v[110:111], v93 offset:2048
  s_waitcnt lgkmcnt(0)
  s_nop 0
  v_mfma_f32_16x16x32_bf16 v[132:135], v[96:99], v[128:131], 0
  v_mfma_f32_16x16x32_bf16 v[136:139], v[100:103], v[128:131], 0
  v_mfma_f32_16x16x32_bf16 v[140:143], v[104:107], v[128:131], 0
  v_mfma_f32_16x16x32_bf16 v[144:147], v[108:111], v[128:131], 0
  ds_read_b64_tr_b16 v[112:113], v90 offset:4096
  ds_read_b64_tr_b16 v[114:115], v90 offset:6144
  ds_read_b64_tr_b16 v[116:117], v91 offset:4096
  ds_read_b64_tr_b16 v[118:119], v91 offset:6144
  ds_read_b64_tr_b16 v[120:121], v92 offset:4096
  ds_read_b64_tr_b16 v[122:123], v92 offset:6144
  ds_read_b64_tr_b16 v[124:125], v93 offset:4096
  ds_read_b64_tr_b16 v[126:127], v93 offset:6144
  s_waitcnt lgkmcnt(0)
  s_nop 0
  v_mfma_f32_16x16x32_bf16 v[132:135], v[112:115], v[128:131], v[132:135]
  v_mfma_f32_16x16x32_bf16 v[136:139], v[116:119], v[128:131], v[136:139]
  v_mfma_f32_16x16x32_bf16 v[140:143], v[120:123], v[128:131], v[140:143]
  v_mfma_f32_16x16x32_bf16 v[144:147], v[124:127], v[128:131], v[144:147]
  s_add_u32 s32, s4, 0x2b60000
  s_addc_u32 s33, s5, 0
  s_mov_b32 s34, 0x48000
  s_mov_b32 s35, 0x20000
  v_lshlrev_b32 v87, 4, v3
  v_lshl_add_u32 v87, v2, 6, v87
  v_cmp_eq_u32 vcc, 1, v2
  s_nop 1
  v_cndmask_b32 v132, v132, v136, vcc
  v_cndmask_b32 v133, v133, v137, vcc
  v_cndmask_b32 v134, v134, v138, vcc
  v_cndmask_b32 v135, v135, v139, vcc
  v_cmp_eq_u32 vcc, 2, v2
  s_nop 1
  v_cndmask_b32 v132, v132, v140, vcc
  v_cndmask_b32 v133, v133, v141, vcc
  v_cndmask_b32 v134, v134, v142, vcc
  v_cndmask_b32 v135, v135, v143, vcc
  v_cmp_eq_u32 vcc, 3, v2
  s_nop 1
  v_cndmask_b32 v132, v132, v144, vcc
  v_cndmask_b32 v133, v133, v145, vcc
  v_cndmask_b32 v134, v134, v146, vcc
  v_cndmask_b32 v135, v135, v147, vcc
  s_mov_b32 exec_lo, 0x000f000f
  s_mov_b32 exec_hi, 0x000f000f
  buffer_store_dwordx4 v[132:135], v87, s[32:35], s61 offen sc1
  s_mov_b64 exec, -1
  s_nop 0
  buffer_store_dwordx4 v[96:99], v7, s[56:59], s62 offen offset:0 sc1
  buffer_store_dwordx4 v[100:103], v7, s[56:59], s62 offen offset:1024 sc1
  buffer_store_dwordx4 v[104:107], v7, s[56:59], s62 offen offset:2048 sc1
  buffer_store_dwordx4 v[108:111], v7, s[56:59], s62 offen offset:3072 sc1
  buffer_store_dwordx4 v[112:115], v7, s[56:59], s63 offen offset:0 sc1
  buffer_store_dwordx4 v[116:119], v7, s[56:59], s63 offen offset:1024 sc1
  buffer_store_dwordx4 v[120:123], v7, s[56:59], s63 offen offset:2048 sc1
  buffer_store_dwordx4 v[124:127], v7, s[56:59], s63 offen offset:3072 sc1
  s_waitcnt vmcnt(0)
  v_mov_b32 v4, 151568
  s_mov_b64 exec, 1
  ds_add_rtn_u32 v5, v4, v8
  s_waitcnt lgkmcnt(0)
  s_mov_b64 exec, -1
  v_readfirstlane_b32 s47, v5
  s_nop 0
  s_cmp_lg_u32 s47, 3
  s_cbranch_scc1 .Lmixer_kernel_ps4
  v_lshlrev_b32 v4, 7, v1
  s_mov_b32 exec_lo, s66
  s_mov_b32 exec_hi, 0
  buffer_atomic_add v8, v4, s[12:15], s65 offen sc1
  s_mov_b64 exec, -1
.Lmixer_kernel_ps4:
  s_and_b32 s43, s2, 7
  s_lshr_b32 s44, s2, 3
  s_lshr_b32 s36, s43, 2
  s_lshl_b32 s36, s36, 3
  s_lshr_b32 s45, s44, 2
  s_add_u32 s36, s36, s45
  s_and_b32 s37, s43, 2
  s_lshl_b32 s37, s37, 1
  s_and_b32 s45, s44, 3
  s_add_u32 s37, s37, s45
  s_lshl_b32 s37, s37, 1
  s_and_b32 s45, s2, 1
  s_add_u32 s37, s37, s45
  s_lshl_b32 s38, s36, 3
  s_and_b32 s45, s10, 2
  s_and_b32 s46, s2, 1
  s_add_u32 s45, s45, s46
  s_lshl_b32 s45, s45, 1
  s_add_u32 s38, s38, s45
  s_and_b32 s45, s10, 1
  s_add_u32 s38, s38, s45
  s_mul_i32 s45, s38, 32768
  v_add_u32 v9, s45, v7
  v_add_u32 v10, 32768, v9
  s_lshl_b32 s41, s10, 12
  s_and_b32 s44, s2, 1
  s_mul_i32 s40, s44, 0
  s_lshr_b32 s43, s10, 1
  s_lshl_b32 s43, s43, 16
  s_add_u32 s40, s40, s43
  s_and_b32 s43, s10, 1
  s_lshl_b32 s43, s43, 12
  s_add_u32 s40, s40, s43
  s_lshr_b32 s43, s37, 1
  s_lshl_b32 s43, s43, 13
  s_add_u32 s40, s40, s43
  s_lshl_b32 s42, s10, 11
  s_add_u32 s42, s42, 16384
  s_mul_i32 s39, s44, 57344
  s_mov_b32 s39, 0
  s_add_u32 s16, s4, 0x1100000
  s_addc_u32 s17, s5, 0
  s_nop 0
  s_mov_b32 s18, 0x400000
  s_mov_b32 s19, 0x20000
  s_add_u32 s20, s4, 0x3800000
  s_addc_u32 s21, s5, 0
  s_mov_b32 s22, 0x200000
  s_mov_b32 s23, 0x20000
  s_add_u32 m0, s41, 0
  s_nop 0
  s_nop 0
  buffer_load_dwordx4 v7, s[20:23], s40 offen offset:0 sc1 lds
  buffer_load_dwordx4 v7, s[20:23], s40 offen offset:1024 sc1 lds
  buffer_load_dwordx4 v7, s[20:23], s40 offen offset:2048 sc1 lds
  buffer_load_dwordx4 v7, s[20:23], s40 offen offset:3072 sc1 lds
  s_add_u32 s40, s40, 131072
  s_add_u32 m0, s41, 24576
  s_nop 0
  s_nop 0
  buffer_load_dwordx4 v7, s[20:23], s40 offen offset:0 sc1 lds
  buffer_load_dwordx4 v7, s[20:23], s40 offen offset:1024 sc1 lds
  buffer_load_dwordx4 v7, s[20:23], s40 offen offset:2048 sc1 lds
  buffer_load_dwordx4 v7, s[20:23], s40 offen offset:3072 sc1 lds
  s_add_u32 s40, s40, 131072
  s_add_u32 m0, s41, 49152
  s_nop 0
  s_nop 0
  buffer_load_dwordx4 v7, s[20:23], s40 offen offset:0 sc1 lds
  buffer_load_dwordx4 v7, s[20:23], s40 offen offset:1024 sc1 lds
  buffer_load_dwordx4 v7, s[20:23], s40 offen offset:2048 sc1 lds
  buffer_load_dwordx4 v7, s[20:23], s40 offen offset:3072 sc1 lds
  s_add_u32 s40, s40, 131072
  s_add_u32 m0, s41, 73728
  s_nop 0
  s_nop 0
  buffer_load_dwordx4 v7, s[20:23], s40 offen offset:0 sc1 lds
  buffer_load_dwordx4 v7, s[20:23], s40 offen offset:1024 sc1 lds
  buffer_load_dwordx4 v7, s[20:23], s40 offen offset:2048 sc1 lds
  buffer_load_dwordx4 v7, s[20:23], s40 offen offset:3072 sc1 lds
  s_add_u32 s40, s40, 131072
  s_cmp_lg_u32 s10, 0
  s_cbranch_scc1 .Lmixer_kernel_np1
  s_lshl_b32 s43, s36, 4
  s_add_u32 s43, s43, s37
  s_lshl_b32 s43, s43, 8
  s_add_u32 s43, s43, 16384
  v_lshl_add_u32 v60, v1, 2, s43
  s_and_b32 s43, s2, 1
  s_lshl_b32 s43, s43, 2
  v_lshrrev_b32 v61, 2, v1
  v_lshlrev_b32 v61, 3, v61
  v_and_b32 v4, 3, v1
  v_add3_u32 v61, v61, v4, s43
  v_sub_u32 v61, v61, v1
  v_lshl_add_u32 v60, v61, 2, v60
  v_mov_b32 v61, 1
  s_mov_b32 s47, 32768
  s_mov_b32 exec_lo, 0xff
  s_mov_b32 exec_hi, 0x0
  s_nop 0
.Lpoll_a1:
  buffer_load_dword v62, v60, s[12:15], 0 offen sc1
  s_sub_u32 s47, s47, 1
  s_waitcnt vmcnt(0)
  v_cmp_lt_u32 vcc, v62, v61
  s_nop 0
  s_cmp_eq_u64 vcc, 0
  s_cselect_b32 s47, 0, s47
  s_cmp_lg_u32 s47, 0
  s_cbranch_scc0 .Lpolled_a1
  s_branch .Lpoll_a1
.Lpolled_a1:
  s_mov_b64 exec, -1
.Lmixer_kernel_np1:
  s_barrier
  s_add_u32 m0, s42, 0
  s_nop 0
  s_nop 0
  buffer_load_dwordx4 v9, s[16:19], s39 offen offset:0 sc1 lds
  buffer_load_dwordx4 v9, s[16:19], s39 offen offset:1024 sc1 lds
  s_add_u32 s39, s39, 2048
  s_add_u32 m0, s42, 24576
  s_nop 0
  s_nop 0
  buffer_load_dwordx4 v9, s[16:19], s39 offen offset:0 sc1 lds
  buffer_load_dwordx4 v9, s[16:19], s39 offen offset:1024 sc1 lds
  s_add_u32 s39, s39, 2048
  s_add_u32 m0, s42, 49152
  s_nop 0
  s_nop 0
  buffer_load_dwordx4 v9, s[16:19], s39 offen offset:0 sc1 lds
  buffer_load_dwordx4 v9, s[16:19], s39 offen offset:1024 sc1 lds
  s_add_u32 s39, s39, 2048
  s_add_u32 m0, s42, 73728
  s_nop 0
  s_nop 0
  buffer_load_dwordx4 v9, s[16:19], s39 offen offset:0 sc1 lds
  buffer_load_dwordx4 v9, s[16:19], s39 offen offset:1024 sc1 lds
  s_add_u32 s39, s39, 2048
  s_add_u32 s28, s4, 0x2b60000
  s_addc_u32 s29, s5, 0
  s_mov_b32 s30, 0x48000
  s_mov_b32 s31, 0x20000
  s_waitcnt vmcnt(6)
  s_barrier
  s_add_u32 m0, s41, 98304
  s_nop 0
  buffer_load_dwordx4 v7, s[20:23], s40 offen offset:0 sc1 lds
  buffer_load_dwordx4 v7, s[20:23], s40 offen offset:1024 sc1 lds
  buffer_load_dwordx4 v7, s[20:23], s40 offen offset:2048 sc1 lds
  buffer_load_dwordx4 v7, s[20:23], s40 offen offset:3072 sc1 lds
  s_add_u32 s40, s40, 131072
  s_add_u32 m0, s42, 98304
  s_nop 0
  s_nop 0
  buffer_load_dwordx4 v9, s[16:19], s39 offen offset:0 sc1 lds
  buffer_load_dwordx4 v9, s[16:19], s39 offen offset:1024 sc1 lds
  s_add_u32 s39, s39, 2048
  s_waitcnt vmcnt(10)
  s_barrier
  s_add_u32 m0, s41, 122880
  s_nop 0
  s_nop 0
  buffer_load_dwordx4 v7, s[20:23], s40 offen offset:0 sc1 lds
  buffer_load_dwordx4 v7, s[20:23], s40 offen offset:1024 sc1 lds
  buffer_load_dwordx4 v7, s[20:23], s40 offen offset:2048 sc1 lds
  buffer_load_dwordx4 v7, s[20:23], s40 offen offset:3072 sc1 lds
  s_add_u32 s40, s40, 131072
  s_add_u32 m0, s42, 122880
  s_nop 0
  s_nop 0
  buffer_load_dwordx4 v9, s[16:19], s39 offen offset:0 sc1 lds
  buffer_load_dwordx4 v9, s[16:19], s39 offen offset:1024 sc1 lds
  s_add_u32 s39, s39, 2048
  s_waitcnt vmcnt(14)
  s_barrier
  s_add_u32 m0, s41, 0
  s_nop 0
  buffer_load_dwordx4 v7, s[20:23], s40 offen offset:0 sc1 lds
  buffer_load_dwordx4 v7, s[20:23], s40 offen offset:1024 sc1 lds
  buffer_load_dwordx4 v7, s[20:23], s40 offen offset:2048 sc1 lds
  buffer_load_dwordx4 v7, s[20:23], s40 offen offset:3072 sc1 lds
  s_add_u32 s40, s40, 131072
  s_add_u32 m0, s42, 0
  s_nop 0
  buffer_load_dwordx4 v9, s[16:19], s39 offen offset:0 sc1 lds
  buffer_load_dwordx4 v9, s[16:19], s39 offen offset:1024 sc1 lds
  s_add_u32 s39, s39, 2048
  s_waitcnt vmcnt(18)
  s_barrier
  s_add_u32 m0, s41, 24576
  s_nop 0
  s_nop 0
  buffer_load_dwordx4 v7, s[20:23], s40 offen offset:0 sc1 lds
  buffer_load_dwordx4 v7, s[20:23], s40 offen offset:1024 sc1 lds
  buffer_load_dwordx4 v7, s[20:23], s40 offen offset:2048 sc1 lds
  buffer_load_dwordx4 v7, s[20:23], s40 offen offset:3072 sc1 lds
  s_add_u32 s40, s40, 131072
  s_add_u32 m0, s42, 24576
  s_nop 0
  s_nop 0
  buffer_load_dwordx4 v9, s[16:19], s39 offen offset:0 sc1 lds
  buffer_load_dwordx4 v9, s[16:19], s39 offen offset:1024 sc1 lds
  s_add_u32 s39, s39, 2048
  s_waitcnt vmcnt(18)
  s_barrier
  s_add_u32 m0, s41, 49152
  s_nop 0
  s_nop 0
  buffer_load_dwordx4 v7, s[20:23], s40 offen offset:0 sc1 lds
  buffer_load_dwordx4 v7, s[20:23], s40 offen offset:1024 sc1 lds
  buffer_load_dwordx4 v7, s[20:23], s40 offen offset:2048 sc1 lds
  buffer_load_dwordx4 v7, s[20:23], s40 offen offset:3072 sc1 lds
  s_add_u32 s40, s40, 131072
  s_add_u32 m0, s42, 49152
  s_nop 0
  s_nop 0
  buffer_load_dwordx4 v9, s[16:19], s39 offen offset:0 sc1 lds
  buffer_load_dwordx4 v9, s[16:19], s39 offen offset:1024 sc1 lds
  s_add_u32 s39, s39, 2048
  s_waitcnt vmcnt(18)
  s_barrier
  s_add_u32 m0, s41, 73728
  s_nop 0
  s_nop 0
  buffer_load_dwordx4 v7, s[20:23], s40 offen offset:0 sc1 lds
  buffer_load_dwordx4 v7, s[20:23], s40 offen offset:1024 sc1 lds
  buffer_load_dwordx4 v7, s[20:23], s40 offen offset:2048 sc1 lds
  buffer_load_dwordx4 v7, s[20:23], s40 offen offset:3072 sc1 lds
  s_add_u32 s40, s40, 131072
  s_add_u32 m0, s42, 73728
  s_nop 0
  s_nop 0
  buffer_load_dwordx4 v9, s[16:19], s39 offen offset:0 sc1 lds
  buffer_load_dwordx4 v9, s[16:19], s39 offen offset:1024 sc1 lds
  s_add_u32 s39, s39, 2048
  s_waitcnt vmcnt(18)
  s_barrier
  s_add_u32 m0, s41, 98304
  s_nop 0
  s_nop 0
  buffer_load_dwordx4 v7, s[20:23], s40 offen offset:0 sc1 lds
  buffer_load_dwordx4 v7, s[20:23], s40 offen offset:1024 sc1 lds
  buffer_load_dwordx4 v7, s[20:23], s40 offen offset:2048 sc1 lds
  buffer_load_dwordx4 v7, s[20:23], s40 offen offset:3072 sc1 lds
  s_add_u32 s40, s40, 131072
  s_add_u32 m0, s42, 98304
  s_nop 0
  s_nop 0
  buffer_load_dwordx4 v9, s[16:19], s39 offen offset:0 sc1 lds
  buffer_load_dwordx4 v9, s[16:19], s39 offen offset:1024 sc1 lds
  s_add_u32 s39, s39, 2048
  s_waitcnt vmcnt(18)
  s_barrier
  s_add_u32 m0, s41, 122880
  s_nop 0
  s_nop 0
  buffer_load_dwordx4 v7, s[20:23], s40 offen offset:0 sc1 lds
  buffer_load_dwordx4 v7, s[20:23], s40 offen offset:1024 sc1 lds
  buffer_load_dwordx4 v7, s[20:23], s40 offen offset:2048 sc1 lds
  buffer_load_dwordx4 v7, s[20:23], s40 offen offset:3072 sc1 lds
  s_add_u32 s40, s40, 131072
  s_add_u32 m0, s42, 122880
  s_nop 0
  s_nop 0
  buffer_load_dwordx4 v9, s[16:19], s39 offen offset:0 sc1 lds
  buffer_load_dwordx4 v9, s[16:19], s39 offen offset:1024 sc1 lds
  s_add_u32 s39, s39, 2048
  s_waitcnt vmcnt(18)
  s_barrier
  s_add_u32 m0, s41, 0
  s_nop 0
  buffer_load_dwordx4 v7, s[20:23], s40 offen offset:0 sc1 lds
  buffer_load_dwordx4 v7, s[20:23], s40 offen offset:1024 sc1 lds
  buffer_load_dwordx4 v7, s[20:23], s40 offen offset:2048 sc1 lds
  buffer_load_dwordx4 v7, s[20:23], s40 offen offset:3072 sc1 lds
  s_add_u32 s40, s40, 131072
  s_add_u32 m0, s42, 0
  s_nop 0
  buffer_load_dwordx4 v9, s[16:19], s39 offen offset:0 sc1 lds
  buffer_load_dwordx4 v9, s[16:19], s39 offen offset:1024 sc1 lds
  s_add_u32 s39, s39, 2048
  s_waitcnt vmcnt(18)
  s_barrier
  s_add_u32 m0, s41, 24576
  s_nop 0
  s_nop 0
  buffer_load_dwordx4 v7, s[20:23], s40 offen offset:0 sc1 lds
  buffer_load_dwordx4 v7, s[20:23], s40 offen offset:1024 sc1 lds
  buffer_load_dwordx4 v7, s[20:23], s40 offen offset:2048 sc1 lds
  buffer_load_dwordx4 v7, s[20:23], s40 offen offset:3072 sc1 lds
  s_add_u32 s40, s40, 131072
  s_add_u32 m0, s42, 24576
  s_nop 0
  s_nop 0
  buffer_load_dwordx4 v9, s[16:19], s39 offen offset:0 sc1 lds
  buffer_load_dwordx4 v9, s[16:19], s39 offen offset:1024 sc1 lds
  s_add_u32 s39, s39, 2048
  s_and_b32 s43, s2, 2
  s_lshl_b32 s43, s43, 1
  s_bfe_u32 s44, s2, 0x20003
  s_add_u32 s43, s43, s44
  s_lshl_b32 s43, s43, 1
  s_add_u32 s43, s43, 64
  v_add_u32 v60, s43, v1
  v_lshlrev_b32 v60, 7, v60
  v_mov_b32 v61, 16
  s_cmp_eq_u32 s10, 0
  s_cselect_b32 s43, 0, 0x40000000
  s_mov_b32 exec_lo, 3
  s_mov_b32 exec_hi, 0
  buffer_load_dword v62, v60, s[12:15], s43 offen sc1
  s_mov_b64 exec, -1
  s_waitcnt vmcnt(19)
  s_barrier
  s_add_u32 m0, s41, 49152
  s_nop 0
  buffer_load_dwordx4 v7, s[20:23], s40 offen offset:0 sc1 lds
  buffer_load_dwordx4 v7, s[20:23], s40 offen offset:1024 sc1 lds
  buffer_load_dwordx4 v7, s[20:23], s40 offen offset:2048 sc1 lds
  buffer_load_dwordx4 v7, s[20:23], s40 offen offset:3072 sc1 lds
  s_add_u32 s40, s40, 131072
  s_add_u32 m0, s42, 49152
  s_nop 0
  s_nop 0
  buffer_load_dwordx4 v9, s[16:19], s39 offen offset:0 sc1 lds
  buffer_load_dwordx4 v9, s[16:19], s39 offen offset:1024 sc1 lds
  s_add_u32 s39, s39, 2048
  s_waitcnt vmcnt(19)
  s_barrier
  s_add_u32 m0, s41, 73728
  s_nop 0
  s_nop 0
  buffer_load_dwordx4 v7, s[20:23], s40 offen offset:0 sc1 lds
  buffer_load_dwordx4 v7, s[20:23], s40 offen offset:1024 sc1 lds
  buffer_load_dwordx4 v7, s[20:23], s40 offen offset:2048 sc1 lds
  buffer_load_dwordx4 v7, s[20:23], s40 offen offset:3072 sc1 lds
  s_add_u32 s40, s40, 131072
  s_add_u32 m0, s42, 73728
  s_nop 0
  s_nop 0
  buffer_load_dwordx4 v9, s[16:19], s39 offen offset:0 sc1 lds
  buffer_load_dwordx4 v9, s[16:19], s39 offen offset:1024 sc1 lds
  s_add_u32 s39, s39, 2048
  s_lshr_b32 s44, s37, 1
  s_lshl_b32 s44, s44, 9
  s_mul_i32 s45, s10, 73728
  s_add_u32 s44, s44, s45
  s_nop 0
  buffer_load_dwordx4 v[44:47], v7, s[28:31], s44 offen sc1
  s_add_u32 s44, s44, 18432
  buffer_load_dwordx4 v[48:51], v7, s[28:31], s44 offen sc1
  s_add_u32 s44, s44, 18432
  buffer_load_dwordx4 v[52:55], v7, s[28:31], s44 offen sc1
  s_add_u32 s44, s44, 18432
  buffer_load_dwordx4 v[56:59], v7, s[28:31], s44 offen sc1
  s_waitcnt vmcnt(23)
  s_barrier
  s_cmp_lg_u32 s10, 0
  s_cbranch_scc1 .Lmixer_kernel_wr1
  s_waitcnt vmcnt(16)
  s_mov_b32 exec_lo, 3
  s_mov_b32 exec_hi, 0
  v_cmp_lt_u32 vcc, v62, v61
  s_mov_b64 exec, -1
  s_cmp_eq_u64 vcc, 0
  s_cbranch_scc1 .Lmixer_kernel_wr1
  s_mov_b32 s47, 32768
  s_mov_b32 exec_lo, 0x3
  s_mov_b32 exec_hi, 0x0
  s_nop 0
.Lpoll_w1:
  buffer_load_dword v62, v60, s[12:15], 0 offen sc1
  s_sub_u32 s47, s47, 1
  s_waitcnt vmcnt(0)
  v_cmp_lt_u32 vcc, v62, v61
  s_nop 0
  s_cmp_eq_u64 vcc, 0
  s_cselect_b32 s47, 0, s47
  s_cmp_lg_u32 s47, 0
  s_cbranch_scc0 .Lpolled_w1
  s_branch .Lpoll_w1
.Lpolled_w1:
  s_mov_b64 exec, -1
.Lmixer_kernel_wr1:
  s_waitcnt vmcnt(17)
  s_barrier
  s_waitcnt lgkmcnt(0)
  s_waitcnt vmcnt(10)
  s_barrier
  s_waitcnt vmcnt(0)
  v_add_f32 v44, v44, v48
  v_add_f32 v45, v45, v49
  v_add_f32 v46, v46, v50
  v_add_f32 v47, v47, v51
  v_add_f32 v52, v52, v56
  v_add_f32 v53, v53, v57
  v_add_f32 v54, v54, v58
  v_add_f32 v55, v55, v59
  v_add_f32 v44, v44, v52
  v_add_f32 v45, v45, v53
  v_add_f32 v46, v46, v54
  v_add_f32 v47, v47, v55
  s_lshl_b32 s44, s10, 10
  s_add_u32 s44, s44, 152576
  v_add_u32 v4, s44, v7
  ds_write_b128 v4, v[44:47]
  s_waitcnt lgkmcnt(0)
  s_waitcnt vmcnt(4)
  s_barrier
  s_cmp_lg_u32 s10, 0
  s_cbranch_scc1 .Lmixer_kernel_cs1
  s_nop 0
  v_add_u32 v4, 152576, v7
  ds_read_b128 v[44:47], v4 offset:0
  ds_read_b128 v[48:51], v4 offset:1024
  ds_read_b128 v[52:55], v4 offset:2048
  ds_read_b128 v[56:59], v4 offset:3072
  s_waitcnt lgkmcnt(0)
  v_add_f32 v44, v44, v48
  v_add_f32 v45, v45, v49
  v_add_f32 v46, v46, v50
  v_add_f32 v47, v47, v51
  v_add_f32 v52, v52, v56
  v_add_f32 v53, v53, v57
  v_add_f32 v54, v54, v58
  v_add_f32 v55, v55, v59
  v_add_f32 v44, v44, v52
  v_add_f32 v45, v45, v53
  v_add_f32 v46, v46, v54
  v_add_f32 v47, v47, v55
  v_add_u32 v4, 147456, v7
  ds_write_b128 v4, v[44:47]
.Lmixer_kernel_cs1:
  s_waitcnt lgkmcnt(0)
  s_barrier
  s_and_b32 s43, s2, 7
  s_lshr_b32 s44, s2, 3
  s_lshr_b32 s36, s43, 2
  s_lshl_b32 s36, s36, 3
  s_lshr_b32 s45, s44, 2
  s_add_u32 s36, s36, s45
  s_and_b32 s37, s43, 2
  s_lshl_b32 s37, s37, 1
  s_and_b32 s45, s44, 3
  s_add_u32 s37, s37, s45
  s_lshl_b32 s37, s37, 1
  s_and_b32 s45, s2, 1
  s_add_u32 s37, s37, s45
  s_lshl_b32 s38, s36, 3
  s_and_b32 s45, s10, 2
  s_and_b32 s46, s2, 1
  s_add_u32 s45, s45, s46
  s_lshl_b32 s45, s45, 1
  s_add_u32 s38, s38, s45
  s_and_b32 s45, s10, 1
  s_add_u32 s38, s38, s45
  s_lshl_b32 s45, s38, 4
  v_add_u32 v4, s45, v2
  v_lshlrev_b32 v63, 8, v3
  s_movk_i32 s46, 2048
  v_add_u32 v64, -1, v4
  v_lshrrev_b32 v9, 4, v64
  v_lshl_add_u32 v9, v9, 15, v63
  v_and_b32 v5, 15, v64
  v_lshl_add_u32 v9, v5, 4, v9
  v_cmp_gt_u32 vcc, s46, v64
  v_mov_b32 v5, 0x40000000
  s_nop 0
  v_cndmask_b32 v9, v5, v9, vcc
  v_add_u32 v64, 1, v4
  v_lshrrev_b32 v11, 4, v64
  v_lshl_add_u32 v11, v11, 15, v63
  v_and_b32 v5, 15, v64
  v_lshl_add_u32 v11, v5, 4, v11
  v_cmp_gt_u32 vcc, s46, v64
  v_mov_b32 v5, 0x40000000
  s_nop 0
  v_cndmask_b32 v11, v5, v11, vcc
  v_add_u32 v64, -2, v4
  v_lshrrev_b32 v13, 4, v64
  v_lshl_add_u32 v13, v13, 15, v63
  v_and_b32 v5, 15, v64
  v_lshl_add_u32 v13, v5, 4, v13
  v_cmp_gt_u32 vcc, s46, v64
  v_mov_b32 v5, 0x40000000
  s_nop 0
  v_cndmask_b32 v13, v5, v13, vcc
  v_add_u32 v64, 2, v4
  v_lshrrev_b32 v15, 4, v64
  v_lshl_add_u32 v15, v15, 15, v63
  v_and_b32 v5, 15, v64
  v_lshl_add_u32 v15, v5, 4, v15
  v_cmp_gt_u32 vcc, s46, v64
  v_mov_b32 v5, 0x40000000
  s_nop 0
  v_cndmask_b32 v15, v5, v15, vcc
  s_lshl_b32 s41, s10, 12
  s_and_b32 s44, s2, 1
  s_mul_i32 s40, s44, 0
  s_lshr_b32 s43, s10, 1
  s_lshl_b32 s43, s43, 16
  s_add_u32 s40, s40, s43
  s_and_b32 s43, s10, 1
  s_lshl_b32 s43, s43, 12
  s_add_u32 s40, s40, s43
  s_lshr_b32 s43, s37, 1
  s_lshl_b32 s43, s43, 13
  s_add_u32 s40, s40, s43
  s_lshl_b32 s42, s10, 11
  s_add_u32 s42, s42, 16384
  s_mul_i32 s39, s44, 57344
  s_mov_b32 s39, 0
  s_add_u32 s16, s4, 0x1500000
  s_addc_u32 s17, s5, 0
  s_nop 0
  s_mov_b32 s18, 0x400000
  s_mov_b32 s19, 0x20000
  s_add_u32 s20, s4, 0x3a00000
  s_addc_u32 s21, s5, 0
  s_mov_b32 s22, 0x200000
  s_mov_b32 s23, 0x20000
  s_barrier
  s_add_u32 m0, s41, 98304
  s_nop 0
  s_nop 0
  buffer_load_dwordx4 v7, s[20:23], s40 offen offset:0 sc1 lds
  buffer_load_dwordx4 v7, s[20:23], s40 offen offset:1024 sc1 lds
  buffer_load_dwordx4 v7, s[20:23], s40 offen offset:2048 sc1 lds
  buffer_load_dwordx4 v7, s[20:23], s40 offen offset:3072 sc1 lds
  s_add_u32 s40, s40, 131072
  s_add_u32 m0, s41, 122880
  s_nop 0
  s_nop 0
  buffer_load_dwordx4 v7, s[20:23], s40 offen offset:0 sc1 lds
  buffer_load_dwordx4 v7, s[20:23], s40 offen offset:1024 sc1 lds
  buffer_load_dwordx4 v7, s[20:23], s40 offen offset:2048 sc1 lds
  buffer_load_dwordx4 v7, s[20:23], s40 offen offset:3072 sc1 lds
  s_add_u32 s40, s40, 131072
  s_add_u32 m0, s41, 0
  s_nop 0
  buffer_load_dwordx4 v7, s[20:23], s40 offen offset:0 sc1 lds
  buffer_load_dwordx4 v7, s[20:23], s40 offen offset:1024 sc1 lds
  buffer_load_dwordx4 v7, s[20:23], s40 offen offset:2048 sc1 lds
  buffer_load_dwordx4 v7, s[20:23], s40 offen offset:3072 sc1 lds
  s_add_u32 s40, s40, 131072
  s_add_u32 m0, s41, 24576
  s_nop 0
  s_nop 0
  buffer_load_dwordx4 v7, s[20:23], s40 offen offset:0 sc1 lds
  buffer_load_dwordx4 v7, s[20:23], s40 offen offset:1024 sc1 lds
  buffer_load_dwordx4 v7, s[20:23], s40 offen offset:2048 sc1 lds
  buffer_load_dwordx4 v7, s[20:23], s40 offen offset:3072 sc1 lds
  s_add_u32 s40, s40, 131072
  s_cmp_lg_u32 s10, 0
  s_cbranch_scc1 .Lmixer_kernel_np2
  s_lshl_b32 s43, s36, 4
  s_add_u32 s43, s43, s37
  s_lshl_b32 s43, s43, 8
  s_add_u32 s43, s43, 81920
  v_lshl_add_u32 v60, v1, 2, s43
  s_add_u32 s43, s36, -1
  v_add_u32 v61, s43, v3
  v_cmp_gt_u32 vcc, 16, v61
  s_nop 1
  v_cndmask_b32 v61, 0, 1, vcc
  s_mov_b32 s47, 32768
  s_mov_b32 exec_lo, 0xffffffff
  s_mov_b32 exec_hi, 0xffff
.Lpoll_a2:
  buffer_load_dword v62, v60, s[12:15], 0 offen sc1
  s_sub_u32 s47, s47, 1
  s_waitcnt vmcnt(0)
  v_cmp_lt_u32 vcc, v62, v61
  s_nop 0
  s_cmp_eq_u64 vcc, 0
  s_cselect_b32 s47, 0, s47
  s_cmp_lg_u32 s47, 0
  s_cbranch_scc0 .Lpolled_a2
  s_branch .Lpoll_a2
.Lpolled_a2:
  s_mov_b64 exec, -1
.Lmixer_kernel_np2:
  s_barrier
  s_add_u32 m0, s42, 98304
  s_nop 0
  buffer_load_dwordx4 v9, s[16:19], s39 offen offset:0  lds
  buffer_load_dwordx4 v9, s[16:19], s39 offen offset:1024  lds
  s_add_u32 s39, s39, 2048
  s_add_u32 m0, s42, 122880
  s_nop 0
  s_nop 0
  buffer_load_dwordx4 v9, s[16:19], s39 offen offset:0  lds
  buffer_load_dwordx4 v9, s[16:19], s39 offen offset:1024  lds
  s_add_u32 s39, s39, 2048
  s_add_u32 m0, s42, 0
  s_nop 0
  buffer_load_dwordx4 v9, s[16:19], s39 offen offset:0  lds
  buffer_load_dwordx4 v9, s[16:19], s39 offen offset:1024  lds
  s_add_u32 s39, s39, 2048
  s_add_u32 m0, s42, 24576
  s_nop 0
  s_nop 0
  buffer_load_dwordx4 v9, s[16:19], s39 offen offset:0  lds
  buffer_load_dwordx4 v9, s[16:19], s39 offen offset:1024  lds
  s_add_u32 s39, s39, 2048
  s_waitcnt vmcnt(6)
  s_barrier
  s_add_u32 m0, s41, 49152
  s_nop 0
  s_nop 0
  buffer_load_dwordx4 v7, s[20:23], s40 offen offset:0 sc1 lds
  buffer_load_dwordx4 v7, s[20:23], s40 offen offset:1024 sc1 lds
  buffer_load_dwordx4 v7, s[20:23], s40 offen offset:2048 sc1 lds
  buffer_load_dwordx4 v7, s[20:23], s40 offen offset:3072 sc1 lds
  s_add_u32 s40, s40, 131072
  s_add_u32 m0, s42, 49152
  s_nop 0
  s_nop 0
  buffer_load_dwordx4 v11, s[16:19], s39 offen offset:0  lds
  buffer_load_dwordx4 v11, s[16:19], s39 offen offset:1024  lds
  s_add_u32 s39, s39, 2048
  s_waitcnt vmcnt(10)
  s_barrier
  s_add_u32 m0, s41, 73728
  s_nop 0
  s_nop 0
  buffer_load_dwordx4 v7, s[20:23], s40 offen offset:0 sc1 lds
  buffer_load_dwordx4 v7, s[20:23], s40 offen offset:1024 sc1 lds
  buffer_load_dwordx4 v7, s[20:23], s40 offen offset:2048 sc1 lds
  buffer_load_dwordx4 v7, s[20:23], s40 offen offset:3072 sc1 lds
  s_add_u32 s40, s40, 131072
  s_add_u32 m0, s42, 73728
  s_nop 0
  s_nop 0
  buffer_load_dwordx4 v11, s[16:19], s39 offen offset:0  lds
  buffer_load_dwordx4 v11, s[16:19], s39 offen offset:1024  lds
  s_add_u32 s39, s39, 2048
  s_waitcnt vmcnt(14)
  s_barrier
  s_add_u32 m0, s41, 98304
  s_nop 0
  s_nop 0
  buffer_load_dwordx4 v7, s[20:23], s40 offen offset:0 sc1 lds
  buffer_load_dwordx4 v7, s[20:23], s40 offen offset:1024 sc1 lds
  buffer_load_dwordx4 v7, s[20:23], s40 offen offset:2048 sc1 lds
  buffer_load_dwordx4 v7, s[20:23], s40 offen offset:3072 sc1 lds
  s_add_u32 s40, s40, 131072
  s_add_u32 m0, s42, 98304
  s_nop 0
  s_nop 0
  buffer_load_dwordx4 v11, s[16:19], s39 offen offset:0  lds
  buffer_load_dwordx4 v11, s[16:19], s39 offen offset:1024  lds
  s_add_u32 s39, s39, 2048
  s_waitcnt vmcnt(18)
  s_barrier
  s_add_u32 m0, s41, 122880
  s_nop 0
  s_nop 0
  buffer_load_dwordx4 v7, s[20:23], s40 offen offset:0 sc1 lds
  buffer_load_dwordx4 v7, s[20:23], s40 offen offset:1024 sc1 lds
  buffer_load_dwordx4 v7, s[20:23], s40 offen offset:2048 sc1 lds
  buffer_load_dwordx4 v7, s[20:23], s40 offen offset:3072 sc1 lds
  s_add_u32 s40, s40, 131072
  s_add_u32 m0, s42, 122880
  s_nop 0
  s_nop 0
  buffer_load_dwordx4 v11, s[16:19], s39 offen offset:0  lds
  buffer_load_dwordx4 v11, s[16:19], s39 offen offset:1024  lds
  s_add_u32 s39, s39, 2048
  s_waitcnt vmcnt(18)
  s_barrier
  s_add_u32 m0, s41, 0
  s_nop 0
  buffer_load_dwordx4 v7, s[20:23], s40 offen offset:0 sc1 lds
  buffer_load_dwordx4 v7, s[20:23], s40 offen offset:1024 sc1 lds
  buffer_load_dwordx4 v7, s[20:23], s40 offen offset:2048 sc1 lds
  buffer_load_dwordx4 v7, s[20:23], s40 offen offset:3072 sc1 lds
  s_add_u32 s40, s40, 131072
  s_add_u32 m0, s42, 0
  s_nop 0
  buffer_load_dwordx4 v13, s[16:19], s39 offen offset:0  lds
  buffer_load_dwordx4 v13, s[16:19], s39 offen offset:1024  lds
  s_add_u32 s39, s39, 2048
  s_waitcnt vmcnt(18)
  s_barrier
  s_add_u32 m0, s41, 24576
  s_nop 0
  s_nop 0
  buffer_load_dwordx4 v7, s[20:23], s40 offen offset:0 sc1 lds
  buffer_load_dwordx4 v7, s[20:23], s40 offen offset:1024 sc1 lds
  buffer_load_dwordx4 v7, s[20:23], s40 offen offset:2048 sc1 lds
  buffer_load_dwordx4 v7, s[20:23], s40 offen offset:3072 sc1 lds
  s_add_u32 s40, s40, 131072
  s_add_u32 m0, s42, 24576
  s_nop 0
  s_nop 0
  buffer_load_dwordx4 v13, s[16:19], s39 offen offset:0  lds
  buffer_load_dwordx4 v13, s[16:19], s39 offen offset:1024  lds
  s_add_u32 s39, s39, 2048
  s_waitcnt vmcnt(18)
  s_barrier
  s_add_u32 m0, s41, 49152
  s_nop 0
  s_nop 0
  buffer_load_dwordx4 v7, s[20:23], s40 offen offset:0 sc1 lds
  buffer_load_dwordx4 v7, s[20:23], s40 offen offset:1024 sc1 lds
  buffer_load_dwordx4 v7, s[20:23], s40 offen offset:2048 sc1 lds
  buffer_load_dwordx4 v7, s[20:23], s40 offen offset:3072 sc1 lds
  s_add_u32 s40, s40, 131072
  s_add_u32 m0, s42, 49152
  s_nop 0
  s_nop 0
  buffer_load_dwordx4 v13, s[16:19], s39 offen offset:0  lds
  buffer_load_dwordx4 v13, s[16:19], s39 offen offset:1024  lds
  s_add_u32 s39, s39, 2048
  s_waitcnt vmcnt(18)
  s_barrier
  s_add_u32 m0, s41, 73728
  s_nop 0
  s_nop 0
  buffer_load_dwordx4 v7, s[20:23], s40 offen offset:0 sc1 lds
  buffer_load_dwordx4 v7, s[20:23], s40 offen offset:1024 sc1 lds
  buffer_load_dwordx4 v7, s[20:23], s40 offen offset:2048 sc1 lds
  buffer_load_dwordx4 v7, s[20:23], s40 offen offset:3072 sc1 lds
  s_add_u32 s40, s40, 131072
  s_add_u32 m0, s42, 73728
  s_nop 0
  s_nop 0
  buffer_load_dwordx4 v13, s[16:19], s39 offen offset:0  lds
  buffer_load_dwordx4 v13, s[16:19], s39 offen offset:1024  lds
  s_add_u32 s39, s39, 2048
  s_waitcnt vmcnt(18)
  s_barrier
  s_add_u32 m0, s41, 98304
  s_nop 0
  s_nop 0
  buffer_load_dwordx4 v7, s[20:23], s40 offen offset:0 sc1 lds
  buffer_load_dwordx4 v7, s[20:23], s40 offen offset:1024 sc1 lds
  buffer_load_dwordx4 v7, s[20:23], s40 offen offset:2048 sc1 lds
  buffer_load_dwordx4 v7, s[20:23], s40 offen offset:3072 sc1 lds
  s_add_u32 s40, s40, 131072
  s_add_u32 m0, s42, 98304
  s_nop 0
  s_nop 0
  buffer_load_dwordx4 v15, s[16:19], s39 offen offset:0  lds
  buffer_load_dwordx4 v15, s[16:19], s39 offen offset:1024  lds
  s_add_u32 s39, s39, 2048
  s_waitcnt vmcnt(18)
  s_barrier
  s_add_u32 m0, s41, 122880
  s_nop 0
  s_nop 0
  buffer_load_dwordx4 v7, s[20:23], s40 offen offset:0 sc1 lds
  buffer_load_dwordx4 v7, s[20:23], s40 offen offset:1024 sc1 lds
  buffer_load_dwordx4 v7, s[20:23], s40 offen offset:2048 sc1 lds
  buffer_load_dwordx4 v7, s[20:23], s40 offen offset:3072 sc1 lds
  s_add_u32 s40, s40, 131072
  s_add_u32 m0, s42, 122880
  s_nop 0
  s_nop 0
  buffer_load_dwordx4 v15, s[16:19], s39 offen offset:0  lds
  buffer_load_dwordx4 v15, s[16:19], s39 offen offset:1024  lds
  s_add_u32 s39, s39, 2048
  v_mov_b32 v60, 12288
  v_mov_b32 v61, 32
  s_cmp_eq_u32 s10, 0
  s_cselect_b32 s43, 0, 0x40000000
  s_mov_b32 exec_lo, 1
  s_mov_b32 exec_hi, 0
  buffer_load_dword v62, v60, s[12:15], s43 offen sc1
  s_mov_b64 exec, -1
  s_waitcnt vmcnt(19)
  s_barrier
  s_add_u32 m0, s41, 0
  s_nop 0
  buffer_load_dwordx4 v7, s[20:23], s40 offen offset:0 sc1 lds
  buffer_load_dwordx4 v7, s[20:23], s40 offen offset:1024 sc1 lds
  buffer_load_dwordx4 v7, s[20:23], s40 offen offset:2048 sc1 lds
  buffer_load_dwordx4 v7, s[20:23], s40 offen offset:3072 sc1 lds
  s_add_u32 s40, s40, 131072
  s_add_u32 m0, s42, 0
  s_nop 0
  buffer_load_dwordx4 v15, s[16:19], s39 offen offset:0  lds
  buffer_load_dwordx4 v15, s[16:19], s39 offen offset:1024  lds
  s_add_u32 s39, s39, 2048
  s_add_u32 s24, s4, 0x1100000
  s_addc_u32 s25, s5, 0
  s_nop 0
  s_mov_b32 s26, 0x400000
  s_mov_b32 s27, 0x20000
  s_add_u32 s28, s4, 0x2b00000
  s_addc_u32 s29, s5, 0
  s_mov_b32 s30, 0x8000
  s_mov_b32 s31, 0x20000
  s_and_b32 s45, s38, -2
  s_and_b32 s44, s37, 14
  s_and_b32 s46, s10, 1
  s_add_u32 s44, s44, s46
  s_lshl_b32 s43, s45, 15
  s_lshl_b32 s44, s44, 11
  s_add_u32 s43, s43, s44
  s_add_u32 s44, s43, 32768
  v_lshlrev_b32 v4, 4, v2
  s_lshl_b32 s45, s45, 8
  buffer_load_dwordx2 v[36:37], v4, s[28:31], s45 offen offset:8 sc1
  buffer_load_dwordx4 v[20:23], v7, s[24:27], s43 offen offset:0 sc1
  buffer_load_dwordx4 v[24:27], v7, s[24:27], s43 offen offset:1024 sc1
  buffer_load_dwordx2 v[38:39], v4, s[28:31], s45 offen offset:264 sc1
  buffer_load_dwordx4 v[28:31], v7, s[24:27], s44 offen offset:0 sc1
  buffer_load_dwordx4 v[32:35], v7, s[24:27], s44 offen offset:1024 sc1
  s_waitcnt vmcnt(25)
  s_barrier
  s_add_u32 m0, s41, 24576
  s_nop 0
  s_nop 0
  buffer_load_dwordx4 v7, s[20:23], s40 offen offset:0 sc1 lds
  buffer_load_dwordx4 v7, s[20:23], s40 offen offset:1024 sc1 lds
  buffer_load_dwordx4 v7, s[20:23], s40 offen offset:2048 sc1 lds
  buffer_load_dwordx4 v7, s[20:23], s40 offen offset:3072 sc1 lds
  s_add_u32 s40, s40, 131072
  s_add_u32 m0, s42, 24576
  s_nop 0
  s_nop 0
  buffer_load_dwordx4 v15, s[16:19], s39 offen offset:0  lds
  buffer_load_dwordx4 v15, s[16:19], s39 offen offset:1024  lds
  s_add_u32 s39, s39, 2048
  s_waitcnt vmcnt(25)
  s_barrier
  s_waitcnt vmcnt(6)
  v_lshlrev_b32 v44, 16, v20
  v_lshlrev_b32 v46, 16, v21
  v_lshlrev_b32 v48, 16, v22
  v_lshlrev_b32_e64 v50, 16, v23
  v_and_b32 v45, 0xffff0000, v20
  v_and_b32 v47, 0xffff0000, v21
  v_and_b32 v49, 0xffff0000, v22
  v_and_b32 v51, 0xffff0000, v23
  v_sub_f32 v44, v44, v36
  v_sub_f32 v46, v46, v36
  v_sub_f32 v48, v48, v36
  v_sub_f32 v50, v50, v36
  v_sub_f32 v45, v45, v36
  v_sub_f32 v47, v47, v36
  v_sub_f32 v49, v49, v36
  v_sub_f32 v51, v51, v36
  v_cvt_pk_bf16_f32 v68, v44, v45
  v_cvt_pk_bf16_f32 v69, v46, v47
  v_cvt_pk_bf16_f32 v70, v48, v49
  v_cvt_pk_bf16_f32 v71, v50, v51
  v_lshlrev_b32 v44, 16, v68
  v_lshlrev_b32 v46, 16, v69
  v_lshlrev_b32 v48, 16, v70
  v_lshlrev_b32 v50, 16, v71
  v_and_b32 v45, 0xffff0000, v68
  v_and_b32 v47, 0xffff0000, v69
  v_and_b32 v49, 0xffff0000, v70
  v_and_b32 v51, 0xffff0000, v71
  v_mul_f32 v44, v44, v37
  v_mul_f32 v46, v46, v37
  v_mul_f32 v48, v48, v37
  v_mul_f32 v50, v50, v37
  v_mul_f32 v45, v45, v37
  v_mul_f32 v47, v47, v37
  v_mul_f32 v49, v49, v37
  v_mul_f32 v51, v51, v37
  v_cvt_pk_bf16_f32 v68, v44, v45
  v_cvt_pk_bf16_f32 v69, v46, v47
  v_cvt_pk_bf16_f32 v70, v48, v49
  v_cvt_pk_bf16_f32 v71, v50, v51
  s_cmp_lg_u32 s10, 0
  s_cbranch_scc1 .Lmixer_kernel_wr2
  s_waitcnt vmcnt(18)
  s_mov_b32 exec_lo, 1
  s_mov_b32 exec_hi, 0
  v_cmp_lt_u32 vcc, v62, v61
  s_mov_b64 exec, -1
  s_cmp_eq_u64 vcc, 0
  s_cbranch_scc1 .Lmixer_kernel_wr2
  s_mov_b32 s47, 32768
  s_mov_b32 exec_lo, 0x1
  s_mov_b32 exec_hi, 0x0
  s_nop 0
.Lpoll_w2:
  buffer_load_dword v62, v60, s[12:15], 0 offen sc1
  s_sub_u32 s47, s47, 1
  s_waitcnt vmcnt(0)
  v_cmp_lt_u32 vcc, v62, v61
  s_nop 0
  s_cmp_eq_u64 vcc, 0
  s_cselect_b32 s47, 0, s47
  s_cmp_lg_u32 s47, 0
  s_cbranch_scc0 .Lpolled_w2
  s_branch .Lpoll_w2
.Lpolled_w2:
  s_mov_b64 exec, -1
.Lmixer_kernel_wr2:
  s_waitcnt vmcnt(19)
  s_barrier
  v_lshlrev_b32 v44, 16, v24
  v_lshlrev_b32 v46, 16, v25
  v_lshlrev_b32 v48, 16, v26
  v_lshlrev_b32 v50, 16, v27
  v_and_b32 v45, 0xffff0000, v24
  v_and_b32 v47, 0xffff0000, v25
  v_and_b32 v49, 0xffff0000, v26
  v_and_b32 v51, 0xffff0000, v27
  v_sub_f32 v44, v44, v36
  v_sub_f32 v46, v46, v36
  v_sub_f32 v48, v48, v36
  v_sub_f32 v50, v50, v36
  v_sub_f32 v45, v45, v36
  v_sub_f32 v47, v47, v36
  v_sub_f32 v49, v49, v36
  v_sub_f32 v51, v51, v36
  v_cvt_pk_bf16_f32 v72, v44, v45
  v_cvt_pk_bf16_f32 v73, v46, v47
  v_cvt_pk_bf16_f32 v74, v48, v49
  v_cvt_pk_bf16_f32 v75, v50, v51
  v_lshlrev_b32 v44, 16, v72
  v_lshlrev_b32 v46, 16, v73
  v_lshlrev_b32 v48, 16, v74
  v_lshlrev_b32 v50, 16, v75
  v_and_b32 v45, 0xffff0000, v72
  v_and_b32 v47, 0xffff0000, v73
  v_and_b32 v49, 0xffff0000, v74
  v_and_b32 v51, 0xffff0000, v75
  v_mul_f32 v44, v44, v37
  v_mul_f32 v46, v46, v37
  v_mul_f32 v48, v48, v37
  v_mul_f32 v50, v50, v37
  v_mul_f32 v45, v45, v37
  v_mul_f32 v47, v47, v37
  v_mul_f32 v49, v49, v37
  v_mul_f32 v51, v51, v37
  v_cvt_pk_bf16_f32 v72, v44, v45
  v_cvt_pk_bf16_f32 v73, v46, v47
  v_cvt_pk_bf16_f32 v74, v48, v49
  v_cvt_pk_bf16_f32 v75, v50, v51
  s_waitcnt vmcnt(12)
  s_barrier
  v_lshlrev_b32 v44, 16, v28
  v_lshlrev_b32 v46, 16, v29
  v_lshlrev_b32 v48, 16, v30
  v_lshlrev_b32 v50, 16, v31
  v_and_b32 v45, 0xffff0000, v28
  v_and_b32 v47, 0xffff0000, v29
  v_and_b32 v49, 0xffff0000, v30
  v_and_b32 v51, 0xffff0000, v31
  v_sub_f32 v44, v44, v38
  v_sub_f32 v46, v46, v38
  v_sub_f32 v48, v48, v38
  v_sub_f32 v50, v50, v38
  v_sub_f32 v45, v45, v38
  v_sub_f32 v47, v47, v38
  v_sub_f32 v49, v49, v38
  v_sub_f32 v51, v51, v38
  v_cvt_pk_bf16_f32 v76, v44, v45
  v_cvt_pk_bf16_f32 v77, v46, v47
  v_cvt_pk_bf16_f32 v78, v48, v49
  v_cvt_pk_bf16_f32 v79, v50, v51
  v_lshlrev_b32 v44, 16, v76
  v_lshlrev_b32 v46, 16, v77
  v_lshlrev_b32 v48, 16, v78
  v_lshlrev_b32 v50, 16, v79
  v_and_b32 v45, 0xffff0000, v76
  v_and_b32 v47, 0xffff0000, v77
  v_and_b32 v49, 0xffff0000, v78
  v_and_b32 v51, 0xffff0000, v79
  v_mul_f32 v44, v44, v39
  v_mul_f32 v46, v46, v39
  v_mul_f32 v48, v48, v39
  v_mul_f32 v50, v50, v39
  v_mul_f32 v45, v45, v39
  v_mul_f32 v47, v47, v39
  v_mul_f32 v49, v49, v39
  v_mul_f32 v51, v51, v39
  v_cvt_pk_bf16_f32 v76, v44, v45
  v_cvt_pk_bf16_f32 v77, v46, v47
  v_cvt_pk_bf16_f32 v78, v48, v49
  v_cvt_pk_bf16_f32 v79, v50, v51
  v_lshlrev_b32 v44, 16, v32
  v_lshlrev_b32 v46, 16, v33
  v_lshlrev_b32 v48, 16, v34
  v_lshlrev_b32 v50, 16, v35
  v_and_b32 v45, 0xffff0000, v32
  v_and_b32 v47, 0xffff0000, v33
  v_and_b32 v49, 0xffff0000, v34
  v_and_b32 v51, 0xffff0000, v35
  v_sub_f32 v44, v44, v38
  v_sub_f32 v46, v46, v38
  v_sub_f32 v48, v48, v38
  v_sub_f32 v50, v50, v38
  v_sub_f32 v45, v45, v38
  v_sub_f32 v47, v47, v38
  v_sub_f32 v49, v49, v38
  v_sub_f32 v51, v51, v38
  v_cvt_pk_bf16_f32 v80, v44, v45
  v_cvt_pk_bf16_f32 v81, v46, v47
  v_cvt_pk_bf16_f32 v82, v48, v49
  v_cvt_pk_bf16_f32 v83, v50, v51
  v_lshlrev_b32 v44, 16, v80
  v_lshlrev_b32 v46, 16, v81
  v_lshlrev_b32 v48, 16, v82
  v_lshlrev_b32 v50, 16, v83
  v_and_b32 v45, 0xffff0000, v80
  v_and_b32 v47, 0xffff0000, v81
  v_and_b32 v49, 0xffff0000, v82
  v_and_b32 v51, 0xffff0000, v83
  v_mul_f32 v44, v44, v39
  v_mul_f32 v46, v46, v39
  v_mul_f32 v48, v48, v39
  v_mul_f32 v50, v50, v39
  v_mul_f32 v45, v45, v39
  v_mul_f32 v47, v47, v39
  v_mul_f32 v49, v49, v39
  v_mul_f32 v51, v51, v39
  v_cvt_pk_bf16_f32 v80, v44, v45
  v_cvt_pk_bf16_f32 v81, v46, v47
  v_cvt_pk_bf16_f32 v82, v48, v49
  v_cvt_pk_bf16_f32 v83, v50, v51
  s_waitcnt vmcnt(0)
  s_barrier
  s_mul_i32 s45, s10, 24576
  s_add_u32 s45, s45, 63488
  v_add_u32_e64 v40, s45, v7
  ds_write_b128 v40, v[68:71] offset:0
  ds_write_b128 v40, v[72:75] offset:1024
  ds_write_b128 v40, v[76:79] offset:2048
  ds_write_b128 v40, v[80:83] offset:3072
  ds_write_b128 v40, v[20:23] offset:4096
  ds_write_b128 v40, v[24:27] offset:5120
  ds_write_b128 v40, v[28:31] offset:6144
  ds_write_b128 v40, v[32:35] offset:7168
  s_waitcnt lgkmcnt(0)
  s_barrier
  s_cmp_ge_u32 s2, 224
  s_cbranch_scc1 .Lprep_m4_1
  s_load_dwordx2 s[6:7], s[0:1], 56
  s_add_u32 s62, s2, 0
  s_lshr_b32 s60, s62, 2
  s_and_b32 s49, s62, 3
  s_lshl_b32 s49, s49, 2
  s_add_u32 s65, s49, 80
  s_lshl_b32 s65, s65, 7
  s_mov_b32 s66, 15
  s_add_u32 s49, s49, s10
  s_mov_b32 s8, 2048
  s_mov_b32 s9, 64
  s_mov_b32 s48, 11534336
  s_mov_b32 s34, 7340032
  s_mov_b32 s61, 0x40000000
  s_branch .Lprep_m4_go
.Lprep_m4_1:
  s_load_dwordx2 s[6:7], s[0:1], 56
  s_mov_b32 s60, 0
  s_mov_b32 s49, 0
  s_mov_b32 s8, 0
  s_mov_b32 s9, 0
  s_mov_b32 s48, 0x40000000
  s_mov_b32 s34, 0
  s_mov_b32 s61, 0x40000000
  s_mov_b32 s65, 0x40000000
  s_mov_b32 s66, 1
.Lprep_m4_go:
  v_lshrrev_b32 v87, 3, v1
  v_mul_u32_u24 v86, s8, v87
  v_lshlrev_b32 v87, 1, v3
  v_xor_b32 v87, v87, v1
  v_and_b32 v87, 7, v87
  v_lshl_add_u32 v86, v87, 4, v86
  s_mul_i32 s62, s60, s8
  s_lshl_b32 s62, s62, 6
  s_lshl_b32 s63, s49, 7
  s_add_u32 s62, s62, s63
  s_lshl_b32 s8, s8, 3
  s_lshl_b32 s64, s10, 11
  s_add_u32 s64, s64, 152576
  v_lshrrev_b32 v87, 2, v2
  v_lshl_add_u32 v87, v3, 2, v87
  v_bfe_u32 v88, v87, 1, 2
  v_lshlrev_b32 v88, 1, v88
  v_lshlrev_b32 v87, 7, v87
  v_and_b32 v89, 1, v1
  v_lshl_add_u32 v87, v89, 3, v87
  v_bfe_u32 v89, v1, 1, 1
  v_xor_b32 v88, v88, v89
  v_lshl_add_u32 v87, v88, 4, v87
  v_add_u32 v90, s64, v87
  v_xor_b32 v91, 32, v90
  v_xor_b32 v92, 64, v90
  v_xor_b32 v93, 96, v90
  s_waitcnt lgkmcnt(0)
  s_mov_b32 s32, s6
  s_mov_b32 s33, s7
  s_mov_b32 s35, 0x20000
  s_add_u32 s56, s4, 0x3800000
  s_addc_u32 s57, s5, 0
  s_mov_b32 s58, 0x1200000
  s_mov_b32 s59, 0x20000
  s_and_b32 s43, s2, 7
  s_lshr_b32 s44, s2, 3
  s_lshr_b32 s36, s43, 2
  s_lshl_b32 s36, s36, 3
  s_lshr_b32 s45, s44, 2
  s_add_u32 s36, s36, s45
  s_and_b32 s37, s43, 3
  s_lshl_b32 s37, s37, 2
  s_and_b32 s45, s44, 3
  s_add_u32 s37, s37, s45
  s_lshl_b32 s38, s36, 3
  s_lshl_b32 s45, s10, 1
  s_add_u32 s38, s38, s45
  s_mul_i32 s45, s38, 32768
  v_add_u32 v9, s45, v7
  v_add_u32 v10, 31744, v9
  s_lshl_b32 s43, s10, 2
  s_cmp_eq_u32 s10, 3
  s_cselect_b32 s43, 11, s43
  s_lshl_b32 s41, s43, 10
  s_mul_i32 s40, s37, 14336
  s_add_u32 s40, s40, s41
  s_lshl_b32 s42, s10, 11
  s_add_u32 s42, s42, 14336
  s_mov_b32 s39, 0
  s_add_u32 s16, s4, 0x1900000
  s_addc_u32 s17, s5, 0
  s_nop 0
  s_mov_b32 s18, 0x400000
  s_mov_b32 s19, 0x20000
  s_add_u32 s20, s4, 0x3c00000
  s_addc_u32 s21, s5, 0
  s_mov_b32 s22, 0x700000
  s_mov_b32 s23, 0x20000
  s_cmp_ge_u32 s10, 2
  s_cbranch_scc1 .Lmixer_kernel_v3
  s_barrier
  s_add_u32 m0, s41, 49152
  s_nop 0
  s_nop 0
  buffer_load_dwordx4 v7, s[20:23], s40 offen offset:0 sc1 lds
  buffer_load_dwordx4 v7, s[20:23], s40 offen offset:1024 sc1 lds
  buffer_load_dwordx4 v7, s[20:23], s40 offen offset:2048 sc1 lds
  buffer_load_dwordx4 v7, s[20:23], s40 offen offset:3072 sc1 lds
  s_add_u32 s40, s40, 229376
  s_add_u32 m0, s41, 73728
  s_nop 0
  s_nop 0
  buffer_load_dwordx4 v7, s[20:23], s40 offen offset:0 sc1 lds
  buffer_load_dwordx4 v7, s[20:23], s40 offen offset:1024 sc1 lds
  buffer_load_dwordx4 v7, s[20:23], s40 offen offset:2048 sc1 lds
  buffer_load_dwordx4 v7, s[20:23], s40 offen offset:3072 sc1 lds
  s_add_u32 s40, s40, 229376
  s_add_u32 m0, s41, 98304
  s_nop 0
  s_nop 0
  buffer_load_dwordx4 v7, s[20:23], s40 offen offset:0 sc1 lds
  buffer_load_dwordx4 v7, s[20:23], s40 offen offset:1024 sc1 lds
  buffer_load_dwordx4 v7, s[20:23], s40 offen offset:2048 sc1 lds
  buffer_load_dwordx4 v7, s[20:23], s40 offen offset:3072 sc1 lds
  s_add_u32 s40, s40, 229376
  s_add_u32 m0, s41, 122880
  s_nop 0
  s_nop 0
  buffer_load_dwordx4 v7, s[20:23], s40 offen offset:0 sc1 lds
  buffer_load_dwordx4 v7, s[20:23], s40 offen offset:1024 sc1 lds
  buffer_load_dwordx4 v7, s[20:23], s40 offen offset:2048 sc1 lds
  buffer_load_dwordx4 v7, s[20:23], s40 offen offset:3072 sc1 lds
  s_add_u32 s40, s40, 229376
  s_cmp_lg_u32 s10, 0
  s_cbranch_scc1 .Lmixer_kernel_np3a
  s_lshl_b32 s43, s36, 4
  s_add_u32 s43, s43, s37
  s_lshl_b32 s43, s43, 8
  s_add_u32 s43, s43, 147456
  v_lshl_add_u32 v60, v1, 2, s43
  v_mov_b32 v61, 1
  s_mov_b32 s47, 32768
  s_mov_b32 exec_lo, 0xffff
  s_mov_b32 exec_hi, 0x0
  s_nop 0
.Lpoll_a3a:
  buffer_load_dword v62, v60, s[12:15], 0 offen sc1
  s_sub_u32 s47, s47, 1
  s_waitcnt vmcnt(0)
  v_cmp_lt_u32 vcc, v62, v61
  s_nop 0
  s_cmp_eq_u64 vcc, 0
  s_cselect_b32 s47, 0, s47
  s_cmp_lg_u32 s47, 0
  s_cbranch_scc0 .Lpolled_a3a
  s_branch .Lpoll_a3a
.Lpolled_a3a:
  s_mov_b64 exec, -1
.Lmixer_kernel_np3a:
  s_barrier
  s_add_u32 m0, s42, 49152
  s_nop 0
  buffer_load_dwordx4 v9, s[16:19], s39 offen offset:0 sc1 lds
  buffer_load_dwordx4 v10, s[16:19], s39 offen offset:1024 sc1 lds
  s_add_u32 s39, s39, 1024
  s_add_u32 m0, s42, 73728
  s_nop 0
  s_nop 0
  buffer_load_dwordx4 v9, s[16:19], s39 offen offset:0 sc1 lds
  buffer_load_dwordx4 v10, s[16:19], s39 offen offset:1024 sc1 lds
  s_add_u32 s39, s39, 1024
  s_add_u32 m0, s42, 98304
  s_nop 0
  s_nop 0
  buffer_load_dwordx4 v9, s[16:19], s39 offen offset:0 sc1 lds
  buffer_load_dwordx4 v10, s[16:19], s39 offen offset:1024 sc1 lds
  s_add_u32 s39, s39, 1024
  s_add_u32 m0, s42, 122880
  s_nop 0
  s_nop 0
  buffer_load_dwordx4 v9, s[16:19], s39 offen offset:0 sc1 lds
  buffer_load_dwordx4 v10, s[16:19], s39 offen offset:1024 sc1 lds
  s_add_u32 s39, s39, 1024
  s_add_u32 s24, s4, 0x2b10000
  s_addc_u32 s25, s5, 0
  s_mov_b32 s26, 0x40000
  s_mov_b32 s27, 0x20000
  v_lshlrev_b32 v40, 12, v3
  v_lshl_add_u32 v40, v2, 3, v40
  s_add_u32 s28, s4, 0x2b60000
  s_addc_u32 s29, s5, 0
  s_mov_b32 s30, 0x48000
  s_mov_b32 s31, 0x20000
  s_waitcnt vmcnt(6)
  s_barrier
  s_add_u32 m0, s41, 0
  s_nop 0
  s_nop 0
  buffer_load_dwordx4 v7, s[20:23], s40 offen offset:0 sc1 lds
  buffer_load_dwordx4 v7, s[20:23], s40 offen offset:1024 sc1 lds
  buffer_load_dwordx4 v7, s[20:23], s40 offen offset:2048 sc1 lds
  buffer_load_dwordx4 v7, s[20:23], s40 offen offset:3072 sc1 lds
  s_add_u32 s40, s40, 229376
  s_add_u32 m0, s42, 0
  s_nop 0
  buffer_load_dwordx4 v9, s[16:19], s39 offen offset:0 sc1 lds
  buffer_load_dwordx4 v10, s[16:19], s39 offen offset:1024 sc1 lds
  s_add_u32 s39, s39, 1024
  s_waitcnt vmcnt(10)
  s_barrier
  s_add_u32 m0, s41, 24576
  s_nop 0
  s_nop 0
  buffer_load_dwordx4 v7, s[20:23], s40 offen offset:0 sc1 lds
  buffer_load_dwordx4 v7, s[20:23], s40 offen offset:1024 sc1 lds
  buffer_load_dwordx4 v7, s[20:23], s40 offen offset:2048 sc1 lds
  buffer_load_dwordx4 v7, s[20:23], s40 offen offset:3072 sc1 lds
  s_add_u32 s40, s40, 229376
  s_add_u32 m0, s42, 24576
  s_nop 0
  s_nop 0
  buffer_load_dwordx4 v9, s[16:19], s39 offen offset:0 sc1 lds
  buffer_load_dwordx4 v10, s[16:19], s39 offen offset:1024 sc1 lds
  s_add_u32 s39, s39, 1024
  s_waitcnt vmcnt(14)
  s_barrier
  s_add_u32 m0, s41, 49152
  s_nop 0
  s_nop 0
  buffer_load_dwordx4 v7, s[20:23], s40 offen offset:0 sc1 lds
  buffer_load_dwordx4 v7, s[20:23], s40 offen offset:1024 sc1 lds
  buffer_load_dwordx4 v7, s[20:23], s40 offen offset:2048 sc1 lds
  buffer_load_dwordx4 v7, s[20:23], s40 offen offset:3072 sc1 lds
  s_add_u32 s40, s40, 229376
  s_add_u32 m0, s42, 49152
  s_nop 0
  s_nop 0
  buffer_load_dwordx4 v9, s[16:19], s39 offen offset:0 sc1 lds
  buffer_load_dwordx4 v10, s[16:19], s39 offen offset:1024 sc1 lds
  s_add_u32 s39, s39, 1024
  s_waitcnt vmcnt(18)
  s_barrier
  s_add_u32 m0, s41, 73728
  s_nop 0
  s_nop 0
  buffer_load_dwordx4 v7, s[20:23], s40 offen offset:0 sc1 lds
  buffer_load_dwordx4 v7, s[20:23], s40 offen offset:1024 sc1 lds
  buffer_load_dwordx4 v7, s[20:23], s40 offen offset:2048 sc1 lds
  buffer_load_dwordx4 v7, s[20:23], s40 offen offset:3072 sc1 lds
  s_add_u32 s40, s40, 229376
  s_add_u32 m0, s42, 73728
  s_nop 0
  s_nop 0
  buffer_load_dwordx4 v9, s[16:19], s39 offen offset:0 sc1 lds
  buffer_load_dwordx4 v10, s[16:19], s39 offen offset:1024 sc1 lds
  s_add_u32 s39, s39, 1024
  s_waitcnt vmcnt(18)
  s_barrier
  s_add_u32 m0, s41, 98304
  s_nop 0
  s_nop 0
  buffer_load_dwordx4 v7, s[20:23], s40 offen offset:0 sc1 lds
  buffer_load_dwordx4 v7, s[20:23], s40 offen offset:1024 sc1 lds
  buffer_load_dwordx4 v7, s[20:23], s40 offen offset:2048 sc1 lds
  buffer_load_dwordx4 v7, s[20:23], s40 offen offset:3072 sc1 lds
  s_add_u32 s40, s40, 229376
  s_add_u32 m0, s42, 98304
  s_nop 0
  s_nop 0
  buffer_load_dwordx4 v9, s[16:19], s39 offen offset:0 sc1 lds
  buffer_load_dwordx4 v10, s[16:19], s39 offen offset:1024 sc1 lds
  s_add_u32 s39, s39, 1024
  s_waitcnt vmcnt(18)
  s_barrier
  s_add_u32 m0, s41, 122880
  s_nop 0
  s_nop 0
  buffer_load_dwordx4 v7, s[20:23], s40 offen offset:0 sc1 lds
  buffer_load_dwordx4 v7, s[20:23], s40 offen offset:1024 sc1 lds
  buffer_load_dwordx4 v7, s[20:23], s40 offen offset:2048 sc1 lds
  buffer_load_dwordx4 v7, s[20:23], s40 offen offset:3072 sc1 lds
  s_add_u32 s40, s40, 229376
  s_add_u32 m0, s42, 122880
  s_nop 0
  s_nop 0
  buffer_load_dwordx4 v9, s[16:19], s39 offen offset:0 sc1 lds
  buffer_load_dwordx4 v10, s[16:19], s39 offen offset:1024 sc1 lds
  s_add_u32 s39, s39, 1024
  buffer_load_dwordx4 v[96:99], v86, s[32:35], s62 offen nt
  s_add_u32 s62, s62, s8
  buffer_load_dwordx4 v[100:103], v86, s[32:35], s62 offen nt
  s_add_u32 s62, s62, s8
  buffer_load_dwordx4 v[104:107], v86, s[32:35], s62 offen nt
  s_add_u32 s62, s62, s8
  buffer_load_dwordx4 v[108:111], v86, s[32:35], s62 offen nt
  s_add_u32 s62, s62, s8
  buffer_load_dwordx4 v[112:115], v86, s[32:35], s62 offen nt
  s_add_u32 s62, s62, s8
  buffer_load_dwordx4 v[116:119], v86, s[32:35], s62 offen nt
  s_add_u32 s62, s62, s8
  buffer_load_dwordx4 v[120:123], v86, s[32:35], s62 offen nt
  s_add_u32 s62, s62, s8
  buffer_load_dwordx4 v[124:127], v86, s[32:35], s62 offen nt
  s_waitcnt vmcnt(26)
  s_barrier
  s_add_u32 m0, s41, 0
  s_nop 0
  s_nop 0
  buffer_load_dwordx4 v7, s[20:23], s40 offen offset:0 sc1 lds
  buffer_load_dwordx4 v7, s[20:23], s40 offen offset:1024 sc1 lds
  buffer_load_dwordx4 v7, s[20:23], s40 offen offset:2048 sc1 lds
  buffer_load_dwordx4 v7, s[20:23], s40 offen offset:3072 sc1 lds
  s_add_u32 s40, s40, 229376
  s_add_u32 m0, s42, 0
  s_nop 0
  buffer_load_dwordx4 v9, s[16:19], s39 offen offset:0 sc1 lds
  buffer_load_dwordx4 v10, s[16:19], s39 offen offset:1024 sc1 lds
  s_add_u32 s39, s39, 1024
  s_waitcnt vmcnt(26)
  s_barrier
  s_add_u32 m0, s41, 24576
  s_nop 0
  s_nop 0
  buffer_load_dwordx4 v7, s[20:23], s40 offen offset:0 sc1 lds
  buffer_load_dwordx4 v7, s[20:23], s40 offen offset:1024 sc1 lds
  buffer_load_dwordx4 v7, s[20:23], s40 offen offset:2048 sc1 lds
  buffer_load_dwordx4 v7, s[20:23], s40 offen offset:3072 sc1 lds
  s_add_u32 s40, s40, 229376
  s_add_u32 m0, s42, 24576
  s_nop 0
  s_nop 0
  buffer_load_dwordx4 v9, s[16:19], s39 offen offset:0 sc1 lds
  buffer_load_dwordx4 v10, s[16:19], s39 offen offset:1024 sc1 lds
  s_add_u32 s39, s39, 1024
  s_waitcnt vmcnt(26)
  s_barrier
  s_add_u32 m0, s41, 49152
  s_nop 0
  s_nop 0
  buffer_load_dwordx4 v7, s[20:23], s40 offen offset:0 sc1 lds
  buffer_load_dwordx4 v7, s[20:23], s40 offen offset:1024 sc1 lds
  buffer_load_dwordx4 v7, s[20:23], s40 offen offset:2048 sc1 lds
  buffer_load_dwordx4 v7, s[20:23], s40 offen offset:3072 sc1 lds
  s_add_u32 s40, s40, 229376
  s_add_u32 m0, s42, 49152
  s_nop 0
  s_nop 0
  buffer_load_dwordx4 v9, s[16:19], s39 offen offset:0 sc1 lds
  buffer_load_dwordx4 v10, s[16:19], s39 offen offset:1024 sc1 lds
  s_add_u32 s39, s39, 1024
  s_waitcnt vmcnt(26)
  s_barrier
  s_add_u32 m0, s41, 73728
  s_nop 0
  s_nop 0
  buffer_load_dwordx4 v7, s[20:23], s40 offen offset:0 sc1 lds
  buffer_load_dwordx4 v7, s[20:23], s40 offen offset:1024 sc1 lds
  buffer_load_dwordx4 v7, s[20:23], s40 offen offset:2048 sc1 lds
  buffer_load_dwordx4 v7, s[20:23], s40 offen offset:3072 sc1 lds
  s_add_u32 s40, s40, 229376
  s_add_u32 m0, s42, 73728
  s_nop 0
  s_nop 0
  buffer_load_dwordx4 v9, s[16:19], s39 offen offset:0 sc1 lds
  buffer_load_dwordx4 v10, s[16:19], s39 offen offset:1024 sc1 lds
  s_add_u32 s39, s39, 1024
  s_waitcnt vmcnt(18)
  s_barrier
  s_add_u32 m0, s41, 98304
  s_nop 0
  s_nop 0
  buffer_load_dwordx4 v7, s[20:23], s40 offen offset:0 sc1 lds
  buffer_load_dwordx4 v7, s[20:23], s40 offen offset:1024 sc1 lds
  buffer_load_dwordx4 v7, s[20:23], s40 offen offset:2048 sc1 lds
  buffer_load_dwordx4 v7, s[20:23], s40 offen offset:3072 sc1 lds
  s_add_u32 s40, s40, 229376
  s_add_u32 m0, s42, 98304
  s_nop 0
  s_nop 0
  buffer_load_dwordx4 v9, s[16:19], s39 offen offset:0 sc1 lds
  buffer_load_dwordx4 v10, s[16:19], s39 offen offset:1024 sc1 lds
  s_add_u32 s39, s39, 1024
  s_waitcnt vmcnt(30)
  v_add_u32 v89, s64, v7
  s_lshl_b32 s62, s60, 1
  s_mul_i32 s62, s62, s9
  s_lshl_b32 s63, s49, 2
  s_add_u32 s62, s62, s63
  s_lshl_b32 s62, s62, 10
  s_add_u32 s62, s62, s48
  s_lshl_b32 s63, s9, 10
  s_add_u32 s63, s63, s62
  s_waitcnt lgkmcnt(0)
  ds_write_b128 v89, v[96:99] offset:0
  ds_write_b128 v89, v[100:103] offset:1024
  s_waitcnt vmcnt(18)
  s_barrier
  s_waitcnt lgkmcnt(0)
  ds_read_b64_tr_b16 v[148:149], v90
  ds_read_b64_tr_b16 v[152:153], v91
  ds_read_b64_tr_b16 v[156:157], v92
  ds_read_b64_tr_b16 v[160:161], v93
  s_add_u32 m0, s41, 122880
  s_nop 0
  s_nop 0
  buffer_load_dwordx4 v7, s[20:23], s40 offen offset:0 sc1 lds
  buffer_load_dwordx4 v7, s[20:23], s40 offen offset:1024 sc1 lds
  buffer_load_dwordx4 v7, s[20:23], s40 offen offset:2048 sc1 lds
  buffer_load_dwordx4 v7, s[20:23], s40 offen offset:3072 sc1 lds
  s_add_u32 s40, s40, 229376
  s_add_u32 m0, s42, 122880
  s_nop 0
  s_nop 0
  buffer_load_dwordx4 v9, s[16:19], s39 offen offset:0 sc1 lds
  buffer_load_dwordx4 v10, s[16:19], s39 offen offset:1024 sc1 lds
  s_add_u32 s39, s39, 1024
  s_waitcnt lgkmcnt(0)
  ds_write_b128 v89, v[104:107] offset:0
  ds_write_b128 v89, v[108:111] offset:1024
  s_waitcnt vmcnt(18)
  s_barrier
  s_waitcnt lgkmcnt(0)
  ds_read_b64_tr_b16 v[150:151], v90
  ds_read_b64_tr_b16 v[154:155], v91
  ds_read_b64_tr_b16 v[158:159], v92
  ds_read_b64_tr_b16 v[162:163], v93
  s_add_u32 m0, s41, 0
  s_nop 0
  buffer_load_dwordx4 v7, s[20:23], s40 offen offset:0 sc1 lds
  buffer_load_dwordx4 v7, s[20:23], s40 offen offset:1024 sc1 lds
  buffer_load_dwordx4 v7, s[20:23], s40 offen offset:2048 sc1 lds
  buffer_load_dwordx4 v7, s[20:23], s40 offen offset:3072 sc1 lds
  s_add_u32 s40, s40, 229376
  s_add_u32 m0, s42, 0
  s_nop 0
  buffer_load_dwordx4 v9, s[16:19], s39 offen offset:0 sc1 lds
  buffer_load_dwordx4 v10, s[16:19], s39 offen offset:1024 sc1 lds
  s_add_u32 s39, s39, 1024
  s_waitcnt lgkmcnt(0)
  ds_write_b128 v89, v[112:115] offset:0
  ds_write_b128 v89, v[116:119] offset:1024
  s_waitcnt vmcnt(18)
  s_barrier
  s_waitcnt lgkmcnt(0)
  ds_read_b64_tr_b16 v[164:165], v90
  ds_read_b64_tr_b16 v[168:169], v91
  ds_read_b64_tr_b16 v[172:173], v92
  ds_read_b64_tr_b16 v[176:177], v93
  s_add_u32 m0, s41, 24576
  s_nop 0
  s_nop 0
  buffer_load_dwordx4 v7, s[20:23], s40 offen offset:0 sc1 lds
  buffer_load_dwordx4 v7, s[20:23], s40 offen offset:1024 sc1 lds
  buffer_load_dwordx4 v7, s[20:23], s40 offen offset:2048 sc1 lds
  buffer_load_dwordx4 v7, s[20:23], s40 offen offset:3072 sc1 lds
  s_add_u32 s40, s40, 229376
  s_add_u32 m0, s42, 24576
  s_nop 0
  s_nop 0
  buffer_load_dwordx4 v9, s[16:19], s39 offen offset:0 sc1 lds
  buffer_load_dwordx4 v10, s[16:19], s39 offen offset:1024 sc1 lds
  s_add_u32 s39, s39, 1024
  s_waitcnt lgkmcnt(0)
  ds_write_b128 v89, v[120:123] offset:0
  ds_write_b128 v89, v[124:127] offset:1024
  s_waitcnt vmcnt(18)
  s_barrier
  s_waitcnt lgkmcnt(0)
  ds_read_b64_tr_b16 v[166:167], v90
  ds_read_b64_tr_b16 v[170:171], v91
  ds_read_b64_tr_b16 v[174:175], v92
  ds_read_b64_tr_b16 v[178:179], v93
  s_add_u32 m0, s41, 49152
  s_nop 0
  s_nop 0
  buffer_load_dwordx4 v7, s[20:23], s40 offen offset:0 sc1 lds
  buffer_load_dwordx4 v7, s[20:23], s40 offen offset:1024 sc1 lds
  buffer_load_dwordx4 v7, s[20:23], s40 offen offset:2048 sc1 lds
  buffer_load_dwordx4 v7, s[20:23], s40 offen offset:3072 sc1 lds
  s_add_u32 s40, s40, 229376
  s_add_u32 m0, s42, 49152
  s_nop 0
  s_nop 0
  buffer_load_dwordx4 v9, s[16:19], s39 offen offset:0 sc1 lds
  buffer_load_dwordx4 v10, s[16:19], s39 offen offset:1024 sc1 lds
  s_add_u32 s39, s39, 1024
  s_waitcnt lgkmcnt(0)
  buffer_store_dwordx4 v[148:151], v7, s[56:59], s62 offen offset:0 sc1
  buffer_store_dwordx4 v[152:155], v7, s[56:59], s62 offen offset:1024 sc1
  s_waitcnt vmcnt(20)
  s_barrier
  s_add_u32 m0, s41, 73728
  s_nop 0
  buffer_load_dwordx4 v7, s[20:23], s40 offen offset:0 sc1 lds
  buffer_load_dwordx4 v7, s[20:23], s40 offen offset:1024 sc1 lds
  buffer_load_dwordx4 v7, s[20:23], s40 offen offset:2048 sc1 lds
  buffer_load_dwordx4 v7, s[20:23], s40 offen offset:3072 sc1 lds
  s_add_u32 s40, s40, 229376
  s_add_u32 m0, s42, 73728
  s_nop 0
  s_nop 0
  buffer_load_dwordx4 v9, s[16:19], s39 offen offset:0 sc1 lds
  buffer_load_dwordx4 v10, s[16:19], s39 offen offset:1024 sc1 lds
  s_add_u32 s39, s39, 1024
  buffer_store_dwordx4 v[156:159], v7, s[56:59], s62 offen offset:2048 sc1
  buffer_store_dwordx4 v[160:163], v7, s[56:59], s62 offen offset:3072 sc1
  s_waitcnt vmcnt(22)
  s_barrier
  s_add_u32 m0, s41, 98304
  s_nop 0
  s_nop 0
  buffer_load_dwordx4 v7, s[20:23], s40 offen offset:0 sc1 lds
  buffer_load_dwordx4 v7, s[20:23], s40 offen offset:1024 sc1 lds
  buffer_load_dwordx4 v7, s[20:23], s40 offen offset:2048 sc1 lds
  buffer_load_dwordx4 v7, s[20:23], s40 offen offset:3072 sc1 lds
  s_add_u32 s40, s40, 229376
  s_add_u32 m0, s42, 98304
  s_nop 0
  s_nop 0
  buffer_load_dwordx4 v9, s[16:19], s39 offen offset:0 sc1 lds
  buffer_load_dwordx4 v10, s[16:19], s39 offen offset:1024 sc1 lds
  s_add_u32 s39, s39, 1024
  buffer_store_dwordx4 v[164:167], v7, s[56:59], s63 offen offset:0 sc1
  buffer_store_dwordx4 v[168:171], v7, s[56:59], s63 offen offset:1024 sc1
  s_waitcnt vmcnt(24)
  s_barrier
  s_add_u32 m0, s41, 122880
  s_nop 0
  s_nop 0
  buffer_load_dwordx4 v7, s[20:23], s40 offen offset:0 sc1 lds
  buffer_load_dwordx4 v7, s[20:23], s40 offen offset:1024 sc1 lds
  buffer_load_dwordx4 v7, s[20:23], s40 offen offset:2048 sc1 lds
  buffer_load_dwordx4 v7, s[20:23], s40 offen offset:3072 sc1 lds
  s_add_u32 s40, s40, 229376
  s_add_u32 m0, s42, 122880
  s_nop 0
  s_nop 0
  buffer_load_dwordx4 v9, s[16:19], s39 offen offset:0 sc1 lds
  buffer_load_dwordx4 v10, s[16:19], s39 offen offset:1024 sc1 lds
  s_add_u32 s39, s39, 1024
  buffer_store_dwordx4 v[172:175], v7, s[56:59], s63 offen offset:2048 sc1
  buffer_store_dwordx4 v[176:179], v7, s[56:59], s63 offen offset:3072 sc1
  s_waitcnt vmcnt(26)
  s_barrier
  s_add_u32 m0, s41, 0
  s_nop 0
  buffer_load_dwordx4 v7, s[20:23], s40 offen offset:0 sc1 lds
  buffer_load_dwordx4 v7, s[20:23], s40 offen offset:1024 sc1 lds
  buffer_load_dwordx4 v7, s[20:23], s40 offen offset:2048 sc1 lds
  buffer_load_dwordx4 v7, s[20:23], s40 offen offset:3072 sc1 lds
  s_add_u32 s40, s40, 229376
  s_add_u32 m0, s42, 0
  s_nop 0
  buffer_load_dwordx4 v9, s[16:19], s39 offen offset:0 sc1 lds
  buffer_load_dwordx4 v10, s[16:19], s39 offen offset:1024 sc1 lds
  s_add_u32 s39, s39, 1024
  s_waitcnt vmcnt(24)
  s_barrier
  s_add_u32 m0, s41, 24576
  s_nop 0
  s_nop 0
  buffer_load_dwordx4 v7, s[20:23], s40 offen offset:0 sc1 lds
  buffer_load_dwordx4 v7, s[20:23], s40 offen offset:1024 sc1 lds
  buffer_load_dwordx4 v7, s[20:23], s40 offen offset:2048 sc1 lds
  buffer_load_dwordx4 v7, s[20:23], s40 offen offset:3072 sc1 lds
  s_add_u32 s40, s40, 229376
  s_add_u32 m0, s42, 24576
  s_nop 0
  s_nop 0
  buffer_load_dwordx4 v9, s[16:19], s39 offen offset:0 sc1 lds
  buffer_load_dwordx4 v10, s[16:19], s39 offen offset:1024 sc1 lds
  s_add_u32 s39, s39, 1024
  s_waitcnt vmcnt(22)
  s_barrier
  s_add_u32 m0, s41, 49152
  s_nop 0
  s_nop 0
  buffer_load_dwordx4 v7, s[20:23], s40 offen offset:0 sc1 lds
  buffer_load_dwordx4 v7, s[20:23], s40 offen offset:1024 sc1 lds
  buffer_load_dwordx4 v7, s[20:23], s40 offen offset:2048 sc1 lds
  buffer_load_dwordx4 v7, s[20:23], s40 offen offset:3072 sc1 lds
  s_add_u32 s40, s40, 229376
  s_add_u32 m0, s42, 49152
  s_nop 0
  s_nop 0
  buffer_load_dwordx4 v9, s[16:19], s39 offen offset:0 sc1 lds
  buffer_load_dwordx4 v10, s[16:19], s39 offen offset:1024 sc1 lds
  s_add_u32 s39, s39, 1024
  s_waitcnt vmcnt(20)
  s_barrier
  s_add_u32 m0, s41, 73728
  s_nop 0
  s_nop 0
  buffer_load_dwordx4 v7, s[20:23], s40 offen offset:0 sc1 lds
  buffer_load_dwordx4 v7, s[20:23], s40 offen offset:1024 sc1 lds
  buffer_load_dwordx4 v7, s[20:23], s40 offen offset:2048 sc1 lds
  buffer_load_dwordx4 v7, s[20:23], s40 offen offset:3072 sc1 lds
  s_add_u32 s40, s40, 229376
  s_add_u32 m0, s42, 73728
  s_nop 0
  s_nop 0
  buffer_load_dwordx4 v9, s[16:19], s39 offen offset:0 sc1 lds
  buffer_load_dwordx4 v10, s[16:19], s39 offen offset:1024 sc1 lds
  s_add_u32 s39, s39, 1024
  s_waitcnt vmcnt(18)
  s_barrier
  s_add_u32 m0, s41, 98304
  s_nop 0
  s_nop 0
  buffer_load_dwordx4 v7, s[20:23], s40 offen offset:0 sc1 lds
  buffer_load_dwordx4 v7, s[20:23], s40 offen offset:1024 sc1 lds
  buffer_load_dwordx4 v7, s[20:23], s40 offen offset:2048 sc1 lds
  buffer_load_dwordx4 v7, s[20:23], s40 offen offset:3072 sc1 lds
  s_add_u32 s40, s40, 229376
  s_add_u32 m0, s42, 98304
  s_nop 0
  s_nop 0
  buffer_load_dwordx4 v9, s[16:19], s39 offen offset:0 sc1 lds
  buffer_load_dwordx4 v10, s[16:19], s39 offen offset:1024 sc1 lds
  s_add_u32 s39, s39, 1024
  v_mov_b32 v4, 151576
  s_mov_b64 exec, 1
  ds_add_rtn_u32 v5, v4, v8
  s_waitcnt lgkmcnt(0)
  s_mov_b64 exec, -1
  v_readfirstlane_b32 s47, v5
  s_nop 0
  s_cmp_lg_u32 s47, 3
  s_cbranch_scc1 .Lmixer_kernel_ps63a
  v_lshlrev_b32 v4, 7, v1
  s_mov_b32 exec_lo, s66
  s_mov_b32 exec_hi, 0
  buffer_atomic_add v8, v4, s[12:15], s65 offen sc1
  s_mov_b64 exec, -1
.Lmixer_kernel_ps63a:
  s_waitcnt vmcnt(18)
  s_barrier
  s_add_u32 m0, s41, 122880
  s_nop 0
  buffer_load_dwordx4 v7, s[20:23], s40 offen offset:0 sc1 lds
  buffer_load_dwordx4 v7, s[20:23], s40 offen offset:1024 sc1 lds
  buffer_load_dwordx4 v7, s[20:23], s40 offen offset:2048 sc1 lds
  buffer_load_dwordx4 v7, s[20:23], s40 offen offset:3072 sc1 lds
  s_add_u32 s40, s40, 229376
  s_add_u32 m0, s42, 122880
  s_nop 0
  s_nop 0
  buffer_load_dwordx4 v9, s[16:19], s39 offen offset:0 sc1 lds
  buffer_load_dwordx4 v10, s[16:19], s39 offen offset:1024 sc1 lds
  s_add_u32 s39, s39, 1024
  s_waitcnt vmcnt(18)
  s_barrier
  s_add_u32 m0, s41, 0
  s_nop 0
  buffer_load_dwordx4 v7, s[20:23], s40 offen offset:0 sc1 lds
  buffer_load_dwordx4 v7, s[20:23], s40 offen offset:1024 sc1 lds
  buffer_load_dwordx4 v7, s[20:23], s40 offen offset:2048 sc1 lds
  buffer_load_dwordx4 v7, s[20:23], s40 offen offset:3072 sc1 lds
  s_add_u32 s40, s40, 229376
  s_add_u32 m0, s42, 0
  s_nop 0
  buffer_load_dwordx4 v9, s[16:19], s39 offen offset:0 sc1 lds
  buffer_load_dwordx4 v10, s[16:19], s39 offen offset:1024 sc1 lds
  s_add_u32 s39, s39, 1024
  s_waitcnt vmcnt(18)
  s_barrier
  s_add_u32 m0, s41, 24576
  s_nop 0
  s_nop 0
  buffer_load_dwordx4 v7, s[20:23], s40 offen offset:0 sc1 lds
  buffer_load_dwordx4 v7, s[20:23], s40 offen offset:1024 sc1 lds
  buffer_load_dwordx4 v7, s[20:23], s40 offen offset:2048 sc1 lds
  buffer_load_dwordx4 v7, s[20:23], s40 offen offset:3072 sc1 lds
  s_add_u32 s40, s40, 229376
  s_add_u32 m0, s42, 24576
  s_nop 0
  s_nop 0
  buffer_load_dwordx4 v9, s[16:19], s39 offen offset:0 sc1 lds
  buffer_load_dwordx4 v10, s[16:19], s39 offen offset:1024 sc1 lds
  s_add_u32 s39, s39, 1024
  s_waitcnt vmcnt(18)
  s_barrier
  s_add_u32 m0, s41, 49152
  s_nop 0
  s_nop 0
  buffer_load_dwordx4 v7, s[20:23], s40 offen offset:0 sc1 lds
  buffer_load_dwordx4 v7, s[20:23], s40 offen offset:1024 sc1 lds
  buffer_load_dwordx4 v7, s[20:23], s40 offen offset:2048 sc1 lds
  buffer_load_dwordx4 v7, s[20:23], s40 offen offset:3072 sc1 lds
  s_add_u32 s40, s40, 229376
  s_add_u32 m0, s42, 49152
  s_nop 0
  s_nop 0
  buffer_load_dwordx4 v9, s[16:19], s39 offen offset:0 sc1 lds
  buffer_load_dwordx4 v10, s[16:19], s39 offen offset:1024 sc1 lds
  s_add_u32 s39, s39, 1024
  s_waitcnt vmcnt(18)
  s_barrier
  s_add_u32 m0, s41, 73728
  s_nop 0
  s_nop 0
  buffer_load_dwordx4 v7, s[20:23], s40 offen offset:0 sc1 lds
  buffer_load_dwordx4 v7, s[20:23], s40 offen offset:1024 sc1 lds
  buffer_load_dwordx4 v7, s[20:23], s40 offen offset:2048 sc1 lds
  buffer_load_dwordx4 v7, s[20:23], s40 offen offset:3072 sc1 lds
  s_add_u32 s40, s40, 229376
  s_add_u32 m0, s42, 73728
  s_nop 0
  s_nop 0
  buffer_load_dwordx4 v9, s[16:19], s39 offen offset:0 sc1 lds
  buffer_load_dwordx4 v10, s[16:19], s39 offen offset:1024 sc1 lds
  s_add_u32 s39, s39, 1024
  s_lshl_b32 s43, s36, 14
  s_lshl_b32 s44, s10, 8
  s_add_u32 s43, s43, s44
  s_nop 0
  buffer_load_dwordx2 v[20:21], v40, s[24:27], s43 offen offset:0 sc1
  buffer_load_dwordx2 v[22:23], v40, s[24:27], s43 offen offset:1024 sc1
  buffer_load_dwordx2 v[24:25], v40, s[24:27], s43 offen offset:2048 sc1
  buffer_load_dwordx2 v[26:27], v40, s[24:27], s43 offen offset:3072 sc1
  buffer_load_dwordx2 v[28:29], v40, s[24:27], s43 offen offset:128 sc1
  buffer_load_dwordx2 v[30:31], v40, s[24:27], s43 offen offset:1152 sc1
  buffer_load_dwordx2 v[32:33], v40, s[24:27], s43 offen offset:2176 sc1
  buffer_load_dwordx2 v[34:35], v40, s[24:27], s43 offen offset:3200 sc1
  s_mul_i32 s44, s37, 896
  s_add_u32 s44, s44, 4096
  s_mul_i32 s45, s10, 73728
  s_add_u32 s44, s44, s45
  s_nop 0
  buffer_load_dwordx4 v[44:47], v7, s[28:31], s44 offen sc1
  s_add_u32 s44, s44, 18432
  buffer_load_dwordx4 v[48:51], v7, s[28:31], s44 offen sc1
  s_add_u32 s44, s44, 18432
  buffer_load_dwordx4 v[52:55], v7, s[28:31], s44 offen sc1
  s_add_u32 s44, s44, 18432
  buffer_load_dwordx4 v[56:59], v7, s[28:31], s44 offen sc1
  s_and_b32 s43, s2, 2
  s_lshl_b32 s43, s43, 1
  s_bfe_u32 s44, s2, 0x20003
  s_add_u32 s43, s43, s44
  s_lshl_b32 s43, s43, 1
  s_add_u32 s43, s43, 80
  v_add_u32 v60, s43, v1
  v_lshlrev_b32 v60, 7, v60
  v_mov_b32 v61, 56
  s_cmp_eq_u32 s10, 0
  s_cselect_b32 s43, 0, 0x40000000
  s_mov_b32 exec_lo, 3
  s_mov_b32 exec_hi, 0
  buffer_load_dword v62, v60, s[12:15], s43 offen sc1
  s_mov_b64 exec, -1
  s_waitcnt vmcnt(31)
  s_barrier
  s_waitcnt vmcnt(25)
  s_barrier
  s_waitcnt vmcnt(1)
  v_add_f32 v20, v20, v22
  v_add_f32 v21, v21, v23
  v_add_f32 v24, v24, v26
  v_add_f32 v25, v25, v27
  v_add_f32 v20, v20, v24
  v_add_f32 v21, v21, v25
  v_add_f32 v28, v28, v30
  v_add_f32 v29, v29, v31
  v_add_f32 v32, v32, v34
  v_add_f32 v33, v33, v35
  v_add_f32 v28, v28, v32
  v_add_f32 v29, v29, v33
  s_nop 0
  v_permlane32_swap_b32 v20, v28
  v_permlane32_swap_b32 v21, v29
  v_add_f32 v20, v20, v28
  v_add_f32 v21, v21, v29
  s_nop 1
  v_permlane16_swap_b32 v20, v21
  v_add_f32 v20, v20, v21
  v_mov_b32 v21, v20
  s_nop 1
  v_permlane16_swap_b32 v20, v21
  v_mul_f32 v20, 0x3a800000, v20
  v_mul_f32 v21, 0x3a800000, v21
  v_fma_f32 v4, -v20, v20, v21
  v_max_f32_e64 v4, 0, v4
  v_cvt_pk_bf16_f32 v36, v20, v20
  v_and_b32 v36, 0xffff0000, v36
  v_cvt_pk_bf16_f32 v4, v4, v4
  v_and_b32 v4, 0xffff0000, v4
  v_add_f32 v4, 0x3727c5ac, v4
  v_cvt_pk_bf16_f32 v4, v4, v4
  v_and_b32 v4, 0xffff0000, v4
  v_sqrt_f32 v4, v4
  s_nop 0
  v_cvt_pk_bf16_f32 v37, v4, v4
  v_and_b32 v37, 0xffff0000, v37
  v_rcp_f32 v5, v37
  s_nop 0
  v_mul_f32 v38, 0xc0135761, v5
  v_mul_f32 v4, v5, v5
  v_mul_f32 v4, v4, v5
  v_mul_f32 v39, 0xbdd2d3e8, v4
  v_lshrrev_b32 v4, 1, v3
  v_lshl_add_u32 v4, v4, 4, v2
  s_lshl_b32 s43, s10, 5
  v_add_u32 v4, s43, v4
  v_lshlrev_b32 v4, 4, v4
  v_add_u32 v4, 148480, v4
  ds_write_b128 v4, v[36:39]
  s_waitcnt lgkmcnt(0)
  s_waitcnt vmcnt(19)
  s_barrier
  s_waitcnt vmcnt(1)
  v_add_f32 v44, v44, v48
  v_add_f32 v45, v45, v49
  v_add_f32 v46, v46, v50
  v_add_f32 v47, v47, v51
  v_add_f32 v52, v52, v56
  v_add_f32 v53, v53, v57
  v_add_f32 v54, v54, v58
  v_add_f32 v55, v55, v59
  v_add_f32 v44, v44, v52
  v_add_f32 v45, v45, v53
  v_add_f32 v46, v46, v54
  v_add_f32 v47, v47, v55
  s_lshl_b32 s44, s10, 10
  s_add_u32 s44, s44, 152576
  v_add_u32 v4, s44, v7
  ds_write_b128 v4, v[44:47]
  s_waitcnt lgkmcnt(0)
  s_cmp_lg_u32 s10, 0
  s_cbranch_scc1 .Lmixer_kernel_wr3a
  s_waitcnt vmcnt(0)
  s_mov_b32 exec_lo, 3
  s_mov_b32 exec_hi, 0
  v_cmp_lt_u32 vcc, v62, v61
  s_mov_b64 exec, -1
  s_cmp_eq_u64 vcc, 0
  s_cbranch_scc1 .Lmixer_kernel_wr3a
  s_mov_b32 s47, 32768
  s_mov_b32 exec_lo, 0x3
  s_mov_b32 exec_hi, 0x0
.Lpoll_w3a:
  buffer_load_dword v62, v60, s[12:15], 0 offen sc1
  s_sub_u32 s47, s47, 1
  s_waitcnt vmcnt(0)
  v_cmp_lt_u32 vcc, v62, v61
  s_nop 0
  s_cmp_eq_u64 vcc, 0
  s_cselect_b32 s47, 0, s47
  s_cmp_lg_u32 s47, 0
  s_cbranch_scc0 .Lpolled_w3a
  s_branch .Lpoll_w3a
.Lpolled_w3a:
  s_mov_b64 exec, -1
.Lmixer_kernel_wr3a:
  s_waitcnt vmcnt(13)
  s_barrier
  s_cmp_lg_u32 s10, 0
  s_cbranch_scc1 .Lmixer_kernel_cs3a
  v_add_u32 v4, 152576, v7
  ds_read_b128 v[44:47], v4 offset:0
  ds_read_b128 v[48:51], v4 offset:1024
  ds_read_b128 v[52:55], v4 offset:2048
  ds_read_b128 v[56:59], v4 offset:3072
  s_waitcnt lgkmcnt(0)
  v_add_f32 v44, v44, v48
  v_add_f32 v45, v45, v49
  v_add_f32 v46, v46, v50
  v_add_f32 v47, v47, v51
  v_add_f32 v52, v52, v56
  v_add_f32 v53, v53, v57
  v_add_f32 v54, v54, v58
  v_add_f32 v55, v55, v59
  v_add_f32 v44, v44, v52
  v_add_f32 v45, v45, v53
  v_add_f32 v46, v46, v54
  v_add_f32 v47, v47, v55
  v_add_u32 v4, 147456, v7
  ds_write_b128 v4, v[44:47]
.Lmixer_kernel_cs3a:
  s_waitcnt lgkmcnt(0)
  s_barrier
  s_branch .Lmixer_kernel_v3end
.Lmixer_kernel_v3:
  s_barrier
  s_add_u32 m0, s41, 49152
  s_nop 0
  buffer_load_dwordx4 v7, s[20:23], s40 offen offset:0 sc1 lds
  buffer_load_dwordx4 v7, s[20:23], s40 offen offset:1024 sc1 lds
  buffer_load_dwordx4 v7, s[20:23], s40 offen offset:2048 sc1 lds
  s_add_u32 s40, s40, 229376
  s_add_u32 m0, s41, 73728
  s_nop 0
  s_nop 0
  buffer_load_dwordx4 v7, s[20:23], s40 offen offset:0 sc1 lds
  buffer_load_dwordx4 v7, s[20:23], s40 offen offset:1024 sc1 lds
  buffer_load_dwordx4 v7, s[20:23], s40 offen offset:2048 sc1 lds
  s_add_u32 s40, s40, 229376
  s_add_u32 m0, s41, 98304
  s_nop 0
  s_nop 0
  buffer_load_dwordx4 v7, s[20:23], s40 offen offset:0 sc1 lds
  buffer_load_dwordx4 v7, s[20:23], s40 offen offset:1024 sc1 lds
  buffer_load_dwordx4 v7, s[20:23], s40 offen offset:2048 sc1 lds
  s_add_u32 s40, s40, 229376
  s_add_u32 m0, s41, 122880
  s_nop 0
  s_nop 0
  buffer_load_dwordx4 v7, s[20:23], s40 offen offset:0 sc1 lds
  buffer_load_dwordx4 v7, s[20:23], s40 offen offset:1024 sc1 lds
  buffer_load_dwordx4 v7, s[20:23], s40 offen offset:2048 sc1 lds
  s_add_u32 s40, s40, 229376
  s_cmp_lg_u32 s10, 0
  s_cbranch_scc1 .Lmixer_kernel_np3b
  s_lshl_b32 s43, s36, 4
  s_add_u32 s43, s43, s37
  s_lshl_b32 s43, s43, 8
  s_add_u32 s43, s43, 147456
  v_lshl_add_u32 v60, v1, 2, s43
  v_mov_b32 v61, 1
  s_mov_b32 s47, 32768
  s_mov_b32 exec_lo, 0xffff
  s_mov_b32 exec_hi, 0x0
  s_nop 0
.Lpoll_a3b:
  buffer_load_dword v62, v60, s[12:15], 0 offen sc1
  s_sub_u32 s47, s47, 1
  s_waitcnt vmcnt(0)
  v_cmp_lt_u32 vcc, v62, v61
  s_nop 0
  s_cmp_eq_u64 vcc, 0
  s_cselect_b32 s47, 0, s47
  s_cmp_lg_u32 s47, 0
  s_cbranch_scc0 .Lpolled_a3b
  s_branch .Lpoll_a3b
.Lpolled_a3b:
  s_mov_b64 exec, -1
.Lmixer_kernel_np3b:
  s_barrier
  s_add_u32 m0, s42, 49152
  s_nop 0
  buffer_load_dwordx4 v9, s[16:19], s39 offen offset:0 sc1 lds
  buffer_load_dwordx4 v10, s[16:19], s39 offen offset:1024 sc1 lds
  s_add_u32 s39, s39, 1024
  s_add_u32 m0, s42, 73728
  s_nop 0
  s_nop 0
  buffer_load_dwordx4 v9, s[16:19], s39 offen offset:0 sc1 lds
  buffer_load_dwordx4 v10, s[16:19], s39 offen offset:1024 sc1 lds
  s_add_u32 s39, s39, 1024
  s_add_u32 m0, s42, 98304
  s_nop 0
  s_nop 0
  buffer_load_dwordx4 v9, s[16:19], s39 offen offset:0 sc1 lds
  buffer_load_dwordx4 v10, s[16:19], s39 offen offset:1024 sc1 lds
  s_add_u32 s39, s39, 1024
  s_add_u32 m0, s42, 122880
  s_nop 0
  s_nop 0
  buffer_load_dwordx4 v9, s[16:19], s39 offen offset:0 sc1 lds
  buffer_load_dwordx4 v10, s[16:19], s39 offen offset:1024 sc1 lds
  s_add_u32 s39, s39, 1024
  s_add_u32 s24, s4, 0x2b10000
  s_addc_u32 s25, s5, 0
  s_mov_b32 s26, 0x40000
  s_mov_b32 s27, 0x20000
  v_lshlrev_b32 v40, 12, v3
  v_lshl_add_u32 v40, v2, 3, v40
  s_add_u32 s28, s4, 0x2b60000
  s_addc_u32 s29, s5, 0
  s_mov_b32 s30, 0x48000
  s_mov_b32 s31, 0x20000
  s_waitcnt vmcnt(6)
  s_barrier
  s_add_u32 m0, s41, 0
  s_nop 0
  s_nop 0
  buffer_load_dwordx4 v7, s[20:23], s40 offen offset:0 sc1 lds
  buffer_load_dwordx4 v7, s[20:23], s40 offen offset:1024 sc1 lds
  buffer_load_dwordx4 v7, s[20:23], s40 offen offset:2048 sc1 lds
  s_add_u32 s40, s40, 229376
  s_add_u32 m0, s42, 0
  s_nop 0
  buffer_load_dwordx4 v9, s[16:19], s39 offen offset:0 sc1 lds
  buffer_load_dwordx4 v10, s[16:19], s39 offen offset:1024 sc1 lds
  s_add_u32 s39, s39, 1024
  s_waitcnt vmcnt(9)
  s_barrier
  s_add_u32 m0, s41, 24576
  s_nop 0
  s_nop 0
  buffer_load_dwordx4 v7, s[20:23], s40 offen offset:0 sc1 lds
  buffer_load_dwordx4 v7, s[20:23], s40 offen offset:1024 sc1 lds
  buffer_load_dwordx4 v7, s[20:23], s40 offen offset:2048 sc1 lds
  s_add_u32 s40, s40, 229376
  s_add_u32 m0, s42, 24576
  s_nop 0
  s_nop 0
  buffer_load_dwordx4 v9, s[16:19], s39 offen offset:0 sc1 lds
  buffer_load_dwordx4 v10, s[16:19], s39 offen offset:1024 sc1 lds
  s_add_u32 s39, s39, 1024
  s_waitcnt vmcnt(12)
  s_barrier
  s_add_u32 m0, s41, 49152
  s_nop 0
  s_nop 0
  buffer_load_dwordx4 v7, s[20:23], s40 offen offset:0 sc1 lds
  buffer_load_dwordx4 v7, s[20:23], s40 offen offset:1024 sc1 lds
  buffer_load_dwordx4 v7, s[20:23], s40 offen offset:2048 sc1 lds
  s_add_u32 s40, s40, 229376
  s_add_u32 m0, s42, 49152
  s_nop 0
  s_nop 0
  buffer_load_dwordx4 v9, s[16:19], s39 offen offset:0 sc1 lds
  buffer_load_dwordx4 v10, s[16:19], s39 offen offset:1024 sc1 lds
  s_add_u32 s39, s39, 1024
  s_waitcnt vmcnt(15)
  s_barrier
  s_add_u32 m0, s41, 73728
  s_nop 0
  s_nop 0
  buffer_load_dwordx4 v7, s[20:23], s40 offen offset:0 sc1 lds
  buffer_load_dwordx4 v7, s[20:23], s40 offen offset:1024 sc1 lds
  buffer_load_dwordx4 v7, s[20:23], s40 offen offset:2048 sc1 lds
  s_add_u32 s40, s40, 229376
  s_add_u32 m0, s42, 73728
  s_nop 0
  s_nop 0
  buffer_load_dwordx4 v9, s[16:19], s39 offen offset:0 sc1 lds
  buffer_load_dwordx4 v10, s[16:19], s39 offen offset:1024 sc1 lds
  s_add_u32 s39, s39, 1024
  s_waitcnt vmcnt(15)
  s_barrier
  s_add_u32 m0, s41, 98304
  s_nop 0
  s_nop 0
  buffer_load_dwordx4 v7, s[20:23], s40 offen offset:0 sc1 lds
  buffer_load_dwordx4 v7, s[20:23], s40 offen offset:1024 sc1 lds
  buffer_load_dwordx4 v7, s[20:23], s40 offen offset:2048 sc1 lds
  s_add_u32 s40, s40, 229376
  s_add_u32 m0, s42, 98304
  s_nop 0
  s_nop 0
  buffer_load_dwordx4 v9, s[16:19], s39 offen offset:0 sc1 lds
  buffer_load_dwordx4 v10, s[16:19], s39 offen offset:1024 sc1 lds
  s_add_u32 s39, s39, 1024
  s_waitcnt vmcnt(15)
  s_barrier
  s_add_u32 m0, s41, 122880
  s_nop 0
  s_nop 0
  buffer_load_dwordx4 v7, s[20:23], s40 offen offset:0 sc1 lds
  buffer_load_dwordx4 v7, s[20:23], s40 offen offset:1024 sc1 lds
  buffer_load_dwordx4 v7, s[20:23], s40 offen offset:2048 sc1 lds
  s_add_u32 s40, s40, 229376
  s_add_u32 m0, s42, 122880
  s_nop 0
  s_nop 0
  buffer_load_dwordx4 v9, s[16:19], s39 offen offset:0 sc1 lds
  buffer_load_dwordx4 v10, s[16:19], s39 offen offset:1024 sc1 lds
  s_add_u32 s39, s39, 1024
  buffer_load_dwordx4 v[96:99], v86, s[32:35], s62 offen nt
  s_add_u32 s62, s62, s8
  buffer_load_dwordx4 v[100:103], v86, s[32:35], s62 offen nt
  s_add_u32 s62, s62, s8
  buffer_load_dwordx4 v[104:107], v86, s[32:35], s62 offen nt
  s_add_u32 s62, s62, s8
  buffer_load_dwordx4 v[108:111], v86, s[32:35], s62 offen nt
  s_add_u32 s62, s62, s8
  buffer_load_dwordx4 v[112:115], v86, s[32:35], s62 offen nt
  s_add_u32 s62, s62, s8
  buffer_load_dwordx4 v[116:119], v86, s[32:35], s62 offen nt
  s_add_u32 s62, s62, s8
  buffer_load_dwordx4 v[120:123], v86, s[32:35], s62 offen nt
  s_add_u32 s62, s62, s8
  buffer_load_dwordx4 v[124:127], v86, s[32:35], s62 offen nt
  s_waitcnt vmcnt(23)
  s_barrier
  s_add_u32 m0, s41, 0
  s_nop 0
  s_nop 0
  buffer_load_dwordx4 v7, s[20:23], s40 offen offset:0 sc1 lds
  buffer_load_dwordx4 v7, s[20:23], s40 offen offset:1024 sc1 lds
  buffer_load_dwordx4 v7, s[20:23], s40 offen offset:2048 sc1 lds
  s_add_u32 s40, s40, 229376
  s_add_u32 m0, s42, 0
  s_nop 0
  buffer_load_dwordx4 v9, s[16:19], s39 offen offset:0 sc1 lds
  buffer_load_dwordx4 v10, s[16:19], s39 offen offset:1024 sc1 lds
  s_add_u32 s39, s39, 1024
  s_waitcnt vmcnt(23)
  s_barrier
  s_add_u32 m0, s41, 24576
  s_nop 0
  s_nop 0
  buffer_load_dwordx4 v7, s[20:23], s40 offen offset:0 sc1 lds
  buffer_load_dwordx4 v7, s[20:23], s40 offen offset:1024 sc1 lds
  buffer_load_dwordx4 v7, s[20:23], s40 offen offset:2048 sc1 lds
  s_add_u32 s40, s40, 229376
  s_add_u32 m0, s42, 24576
  s_nop 0
  s_nop 0
  buffer_load_dwordx4 v9, s[16:19], s39 offen offset:0 sc1 lds
  buffer_load_dwordx4 v10, s[16:19], s39 offen offset:1024 sc1 lds
  s_add_u32 s39, s39, 1024
  s_waitcnt vmcnt(23)
  s_barrier
  s_add_u32 m0, s41, 49152
  s_nop 0
  s_nop 0
  buffer_load_dwordx4 v7, s[20:23], s40 offen offset:0 sc1 lds
  buffer_load_dwordx4 v7, s[20:23], s40 offen offset:1024 sc1 lds
  buffer_load_dwordx4 v7, s[20:23], s40 offen offset:2048 sc1 lds
  s_add_u32 s40, s40, 229376
  s_add_u32 m0, s42, 49152
  s_nop 0
  s_nop 0
  buffer_load_dwordx4 v9, s[16:19], s39 offen offset:0 sc1 lds
  buffer_load_dwordx4 v10, s[16:19], s39 offen offset:1024 sc1 lds
  s_add_u32 s39, s39, 1024
  s_waitcnt vmcnt(23)
  s_barrier
  s_add_u32 m0, s41, 73728
  s_nop 0
  s_nop 0
  buffer_load_dwordx4 v7, s[20:23], s40 offen offset:0 sc1 lds
  buffer_load_dwordx4 v7, s[20:23], s40 offen offset:1024 sc1 lds
  buffer_load_dwordx4 v7, s[20:23], s40 offen offset:2048 sc1 lds
  s_add_u32 s40, s40, 229376
  s_add_u32 m0, s42, 73728
  s_nop 0
  s_nop 0
  buffer_load_dwordx4 v9, s[16:19], s39 offen offset:0 sc1 lds
  buffer_load_dwordx4 v10, s[16:19], s39 offen offset:1024 sc1 lds
  s_add_u32 s39, s39, 1024
  s_waitcnt vmcnt(15)
  s_barrier
  s_add_u32 m0, s41, 98304
  s_nop 0
  s_nop 0
  buffer_load_dwordx4 v7, s[20:23], s40 offen offset:0 sc1 lds
  buffer_load_dwordx4 v7, s[20:23], s40 offen offset:1024 sc1 lds
  buffer_load_dwordx4 v7, s[20:23], s40 offen offset:2048 sc1 lds
  s_add_u32 s40, s40, 229376
  s_add_u32 m0, s42, 98304
  s_nop 0
  s_nop 0
  buffer_load_dwordx4 v9, s[16:19], s39 offen offset:0 sc1 lds
  buffer_load_dwordx4 v10, s[16:19], s39 offen offset:1024 sc1 lds
  s_add_u32 s39, s39, 1024
  s_waitcnt vmcnt(25)
  v_add_u32 v89, s64, v7
  s_lshl_b32 s62, s60, 1
  s_mul_i32 s62, s62, s9
  s_lshl_b32 s63, s49, 2
  s_add_u32 s62, s62, s63
  s_lshl_b32 s62, s62, 10
  s_add_u32 s62, s62, s48
  s_lshl_b32 s63, s9, 10
  s_add_u32 s63, s63, s62
  s_waitcnt lgkmcnt(0)
  ds_write_b128 v89, v[96:99] offset:0
  ds_write_b128 v89, v[100:103] offset:1024
  s_waitcnt vmcnt(15)
  s_barrier
  s_waitcnt lgkmcnt(0)
  ds_read_b64_tr_b16 v[148:149], v90
  ds_read_b64_tr_b16 v[152:153], v91
  ds_read_b64_tr_b16 v[156:157], v92
  ds_read_b64_tr_b16 v[160:161], v93
  s_add_u32 m0, s41, 122880
  s_nop 0
  s_nop 0
  buffer_load_dwordx4 v7, s[20:23], s40 offen offset:0 sc1 lds
  buffer_load_dwordx4 v7, s[20:23], s40 offen offset:1024 sc1 lds
  buffer_load_dwordx4 v7, s[20:23], s40 offen offset:2048 sc1 lds
  s_add_u32 s40, s40, 229376
  s_add_u32 m0, s42, 122880
  s_nop 0
  s_nop 0
  buffer_load_dwordx4 v9, s[16:19], s39 offen offset:0 sc1 lds
  buffer_load_dwordx4 v10, s[16:19], s39 offen offset:1024 sc1 lds
  s_add_u32 s39, s39, 1024
  s_waitcnt lgkmcnt(0)
  ds_write_b128 v89, v[104:107] offset:0
  ds_write_b128 v89, v[108:111] offset:1024
  s_waitcnt vmcnt(15)
  s_barrier
  s_waitcnt lgkmcnt(0)
  ds_read_b64_tr_b16 v[150:151], v90
  ds_read_b64_tr_b16 v[154:155], v91
  ds_read_b64_tr_b16 v[158:159], v92
  ds_read_b64_tr_b16 v[162:163], v93
  s_add_u32 m0, s41, 0
  s_nop 0
  buffer_load_dwordx4 v7, s[20:23], s40 offen offset:0 sc1 lds
  buffer_load_dwordx4 v7, s[20:23], s40 offen offset:1024 sc1 lds
  buffer_load_dwordx4 v7, s[20:23], s40 offen offset:2048 sc1 lds
  s_add_u32 s40, s40, 229376
  s_add_u32 m0, s42, 0
  s_nop 0
  buffer_load_dwordx4 v9, s[16:19], s39 offen offset:0 sc1 lds
  buffer_load_dwordx4 v10, s[16:19], s39 offen offset:1024 sc1 lds
  s_add_u32 s39, s39, 1024
  s_waitcnt lgkmcnt(0)
  ds_write_b128 v89, v[112:115] offset:0
  ds_write_b128 v89, v[116:119] offset:1024
  s_waitcnt vmcnt(15)
  s_barrier
  s_waitcnt lgkmcnt(0)
  ds_read_b64_tr_b16 v[164:165], v90
  ds_read_b64_tr_b16 v[168:169], v91
  ds_read_b64_tr_b16 v[172:173], v92
  ds_read_b64_tr_b16 v[176:177], v93
  s_add_u32 m0, s41, 24576
  s_nop 0
  s_nop 0
  buffer_load_dwordx4 v7, s[20:23], s40 offen offset:0 sc1 lds
  buffer_load_dwordx4 v7, s[20:23], s40 offen offset:1024 sc1 lds
  buffer_load_dwordx4 v7, s[20:23], s40 offen offset:2048 sc1 lds
  s_add_u32 s40, s40, 229376
  s_add_u32 m0, s42, 24576
  s_nop 0
  s_nop 0
  buffer_load_dwordx4 v9, s[16:19], s39 offen offset:0 sc1 lds
  buffer_load_dwordx4 v10, s[16:19], s39 offen offset:1024 sc1 lds
  s_add_u32 s39, s39, 1024
  s_waitcnt lgkmcnt(0)
  ds_write_b128 v89, v[120:123] offset:0
  ds_write_b128 v89, v[124:127] offset:1024
  s_waitcnt vmcnt(15)
  s_barrier
  s_waitcnt lgkmcnt(0)
  ds_read_b64_tr_b16 v[166:167], v90
  ds_read_b64_tr_b16 v[170:171], v91
  ds_read_b64_tr_b16 v[174:175], v92
  ds_read_b64_tr_b16 v[178:179], v93
  s_add_u32 m0, s41, 49152
  s_nop 0
  s_nop 0
  buffer_load_dwordx4 v7, s[20:23], s40 offen offset:0 sc1 lds
  buffer_load_dwordx4 v7, s[20:23], s40 offen offset:1024 sc1 lds
  buffer_load_dwordx4 v7, s[20:23], s40 offen offset:2048 sc1 lds
  s_add_u32 s40, s40, 229376
  s_add_u32 m0, s42, 49152
  s_nop 0
  s_nop 0
  buffer_load_dwordx4 v9, s[16:19], s39 offen offset:0 sc1 lds
  buffer_load_dwordx4 v10, s[16:19], s39 offen offset:1024 sc1 lds
  s_add_u32 s39, s39, 1024
  s_waitcnt lgkmcnt(0)
  buffer_store_dwordx4 v[148:151], v7, s[56:59], s62 offen offset:0 sc1
  buffer_store_dwordx4 v[152:155], v7, s[56:59], s62 offen offset:1024 sc1
  s_waitcnt vmcnt(17)
  s_barrier
  s_add_u32 m0, s41, 73728
  s_nop 0
  buffer_load_dwordx4 v7, s[20:23], s40 offen offset:0 sc1 lds
  buffer_load_dwordx4 v7, s[20:23], s40 offen offset:1024 sc1 lds
  buffer_load_dwordx4 v7, s[20:23], s40 offen offset:2048 sc1 lds
  s_add_u32 s40, s40, 229376
  s_add_u32 m0, s42, 73728
  s_nop 0
  s_nop 0
  buffer_load_dwordx4 v9, s[16:19], s39 offen offset:0 sc1 lds
  buffer_load_dwordx4 v10, s[16:19], s39 offen offset:1024 sc1 lds
  s_add_u32 s39, s39, 1024
  buffer_store_dwordx4 v[156:159], v7, s[56:59], s62 offen offset:2048 sc1
  buffer_store_dwordx4 v[160:163], v7, s[56:59], s62 offen offset:3072 sc1
  s_waitcnt vmcnt(19)
  s_barrier
  s_add_u32 m0, s41, 98304
  s_nop 0
  s_nop 0
  buffer_load_dwordx4 v7, s[20:23], s40 offen offset:0 sc1 lds
  buffer_load_dwordx4 v7, s[20:23], s40 offen offset:1024 sc1 lds
  buffer_load_dwordx4 v7, s[20:23], s40 offen offset:2048 sc1 lds
  s_add_u32 s40, s40, 229376
  s_add_u32 m0, s42, 98304
  s_nop 0
  s_nop 0
  buffer_load_dwordx4 v9, s[16:19], s39 offen offset:0 sc1 lds
  buffer_load_dwordx4 v10, s[16:19], s39 offen offset:1024 sc1 lds
  s_add_u32 s39, s39, 1024
  buffer_store_dwordx4 v[164:167], v7, s[56:59], s63 offen offset:0 sc1
  buffer_store_dwordx4 v[168:171], v7, s[56:59], s63 offen offset:1024 sc1
  s_waitcnt vmcnt(21)
  s_barrier
  s_add_u32 m0, s41, 122880
  s_nop 0
  s_nop 0
  buffer_load_dwordx4 v7, s[20:23], s40 offen offset:0 sc1 lds
  buffer_load_dwordx4 v7, s[20:23], s40 offen offset:1024 sc1 lds
  buffer_load_dwordx4 v7, s[20:23], s40 offen offset:2048 sc1 lds
  s_add_u32 s40, s40, 229376
  s_add_u32 m0, s42, 122880
  s_nop 0
  s_nop 0
  buffer_load_dwordx4 v9, s[16:19], s39 offen offset:0 sc1 lds
  buffer_load_dwordx4 v10, s[16:19], s39 offen offset:1024 sc1 lds
  s_add_u32 s39, s39, 1024
  buffer_store_dwordx4 v[172:175], v7, s[56:59], s63 offen offset:2048 sc1
  buffer_store_dwordx4 v[176:179], v7, s[56:59], s63 offen offset:3072 sc1
  s_waitcnt vmcnt(23)
  s_barrier
  s_add_u32 m0, s41, 0
  s_nop 0
  buffer_load_dwordx4 v7, s[20:23], s40 offen offset:0 sc1 lds
  buffer_load_dwordx4 v7, s[20:23], s40 offen offset:1024 sc1 lds
  buffer_load_dwordx4 v7, s[20:23], s40 offen offset:2048 sc1 lds
  s_add_u32 s40, s40, 229376
  s_add_u32 m0, s42, 0
  s_nop 0
  buffer_load_dwordx4 v9, s[16:19], s39 offen offset:0 sc1 lds
  buffer_load_dwordx4 v10, s[16:19], s39 offen offset:1024 sc1 lds
  s_add_u32 s39, s39, 1024
  s_waitcnt vmcnt(21)
  s_barrier
  s_add_u32 m0, s41, 24576
  s_nop 0
  s_nop 0
  buffer_load_dwordx4 v7, s[20:23], s40 offen offset:0 sc1 lds
  buffer_load_dwordx4 v7, s[20:23], s40 offen offset:1024 sc1 lds
  buffer_load_dwordx4 v7, s[20:23], s40 offen offset:2048 sc1 lds
  s_add_u32 s40, s40, 229376
  s_add_u32 m0, s42, 24576
  s_nop 0
  s_nop 0
  buffer_load_dwordx4 v9, s[16:19], s39 offen offset:0 sc1 lds
  buffer_load_dwordx4 v10, s[16:19], s39 offen offset:1024 sc1 lds
  s_add_u32 s39, s39, 1024
  s_waitcnt vmcnt(19)
  s_barrier
  s_add_u32 m0, s41, 49152
  s_nop 0
  s_nop 0
  buffer_load_dwordx4 v7, s[20:23], s40 offen offset:0 sc1 lds
  buffer_load_dwordx4 v7, s[20:23], s40 offen offset:1024 sc1 lds
  buffer_load_dwordx4 v7, s[20:23], s40 offen offset:2048 sc1 lds
  s_add_u32 s40, s40, 229376
  s_add_u32 m0, s42, 49152
  s_nop 0
  s_nop 0
  buffer_load_dwordx4 v9, s[16:19], s39 offen offset:0 sc1 lds
  buffer_load_dwordx4 v10, s[16:19], s39 offen offset:1024 sc1 lds
  s_add_u32 s39, s39, 1024
  s_waitcnt vmcnt(17)
  s_barrier
  s_add_u32 m0, s41, 73728
  s_nop 0
  s_nop 0
  buffer_load_dwordx4 v7, s[20:23], s40 offen offset:0 sc1 lds
  buffer_load_dwordx4 v7, s[20:23], s40 offen offset:1024 sc1 lds
  buffer_load_dwordx4 v7, s[20:23], s40 offen offset:2048 sc1 lds
  s_add_u32 s40, s40, 229376
  s_add_u32 m0, s42, 73728
  s_nop 0
  s_nop 0
  buffer_load_dwordx4 v9, s[16:19], s39 offen offset:0 sc1 lds
  buffer_load_dwordx4 v10, s[16:19], s39 offen offset:1024 sc1 lds
  s_add_u32 s39, s39, 1024
  s_waitcnt vmcnt(15)
  s_barrier
  s_add_u32 m0, s41, 98304
  s_nop 0
  s_nop 0
  buffer_load_dwordx4 v7, s[20:23], s40 offen offset:0 sc1 lds
  buffer_load_dwordx4 v7, s[20:23], s40 offen offset:1024 sc1 lds
  buffer_load_dwordx4 v7, s[20:23], s40 offen offset:2048 sc1 lds
  s_add_u32 s40, s40, 229376
  s_add_u32 m0, s42, 98304
  s_nop 0
  s_nop 0
  buffer_load_dwordx4 v9, s[16:19], s39 offen offset:0 sc1 lds
  buffer_load_dwordx4 v10, s[16:19], s39 offen offset:1024 sc1 lds
  s_add_u32 s39, s39, 1024
  v_mov_b32 v4, 151576
  s_mov_b64 exec, 1
  ds_add_rtn_u32 v5, v4, v8
  s_waitcnt lgkmcnt(0)
  s_mov_b64 exec, -1
  v_readfirstlane_b32 s47, v5
  s_nop 0
  s_cmp_lg_u32 s47, 3
  s_cbranch_scc1 .Lmixer_kernel_ps63b
  v_lshlrev_b32 v4, 7, v1
  s_mov_b32 exec_lo, s66
  s_mov_b32 exec_hi, 0
  buffer_atomic_add v8, v4, s[12:15], s65 offen sc1
  s_mov_b64 exec, -1
.Lmixer_kernel_ps63b:
  s_waitcnt vmcnt(15)
  s_barrier
  s_add_u32 m0, s41, 122880
  s_nop 0
  buffer_load_dwordx4 v7, s[20:23], s40 offen offset:0 sc1 lds
  buffer_load_dwordx4 v7, s[20:23], s40 offen offset:1024 sc1 lds
  buffer_load_dwordx4 v7, s[20:23], s40 offen offset:2048 sc1 lds
  s_add_u32 s40, s40, 229376
  s_add_u32 m0, s42, 122880
  s_nop 0
  s_nop 0
  buffer_load_dwordx4 v9, s[16:19], s39 offen offset:0 sc1 lds
  buffer_load_dwordx4 v10, s[16:19], s39 offen offset:1024 sc1 lds
  s_add_u32 s39, s39, 1024
  s_waitcnt vmcnt(15)
  s_barrier
  s_add_u32 m0, s41, 0
  s_nop 0
  buffer_load_dwordx4 v7, s[20:23], s40 offen offset:0 sc1 lds
  buffer_load_dwordx4 v7, s[20:23], s40 offen offset:1024 sc1 lds
  buffer_load_dwordx4 v7, s[20:23], s40 offen offset:2048 sc1 lds
  s_add_u32 s40, s40, 229376
  s_add_u32 m0, s42, 0
  s_nop 0
  buffer_load_dwordx4 v9, s[16:19], s39 offen offset:0 sc1 lds
  buffer_load_dwordx4 v10, s[16:19], s39 offen offset:1024 sc1 lds
  s_add_u32 s39, s39, 1024
  s_waitcnt vmcnt(15)
  s_barrier
  s_add_u32 m0, s41, 24576
  s_nop 0
  s_nop 0
  buffer_load_dwordx4 v7, s[20:23], s40 offen offset:0 sc1 lds
  buffer_load_dwordx4 v7, s[20:23], s40 offen offset:1024 sc1 lds
  buffer_load_dwordx4 v7, s[20:23], s40 offen offset:2048 sc1 lds
  s_add_u32 s40, s40, 229376
  s_add_u32 m0, s42, 24576
  s_nop 0
  s_nop 0
  buffer_load_dwordx4 v9, s[16:19], s39 offen offset:0 sc1 lds
  buffer_load_dwordx4 v10, s[16:19], s39 offen offset:1024 sc1 lds
  s_add_u32 s39, s39, 1024
  s_waitcnt vmcnt(15)
  s_barrier
  s_add_u32 m0, s41, 49152
  s_nop 0
  s_nop 0
  buffer_load_dwordx4 v7, s[20:23], s40 offen offset:0 sc1 lds
  buffer_load_dwordx4 v7, s[20:23], s40 offen offset:1024 sc1 lds
  buffer_load_dwordx4 v7, s[20:23], s40 offen offset:2048 sc1 lds
  s_add_u32 s40, s40, 229376
  s_add_u32 m0, s42, 49152
  s_nop 0
  s_nop 0
  buffer_load_dwordx4 v9, s[16:19], s39 offen offset:0 sc1 lds
  buffer_load_dwordx4 v10, s[16:19], s39 offen offset:1024 sc1 lds
  s_add_u32 s39, s39, 1024
  s_waitcnt vmcnt(15)
  s_barrier
  s_add_u32 m0, s41, 73728
  s_nop 0
  s_nop 0
  buffer_load_dwordx4 v7, s[20:23], s40 offen offset:0 sc1 lds
  buffer_load_dwordx4 v7, s[20:23], s40 offen offset:1024 sc1 lds
  buffer_load_dwordx4 v7, s[20:23], s40 offen offset:2048 sc1 lds
  s_add_u32 s40, s40, 229376
  s_add_u32 m0, s42, 73728
  s_nop 0
  s_nop 0
  buffer_load_dwordx4 v9, s[16:19], s39 offen offset:0 sc1 lds
  buffer_load_dwordx4 v10, s[16:19], s39 offen offset:1024 sc1 lds
  s_add_u32 s39, s39, 1024
  s_lshl_b32 s43, s36, 14
  s_lshl_b32 s44, s10, 8
  s_add_u32 s43, s43, s44
  s_nop 0
  buffer_load_dwordx2 v[20:21], v40, s[24:27], s43 offen offset:0 sc1
  buffer_load_dwordx2 v[22:23], v40, s[24:27], s43 offen offset:1024 sc1
  buffer_load_dwordx2 v[24:25], v40, s[24:27], s43 offen offset:2048 sc1
  buffer_load_dwordx2 v[26:27], v40, s[24:27], s43 offen offset:3072 sc1
  buffer_load_dwordx2 v[28:29], v40, s[24:27], s43 offen offset:128 sc1
  buffer_load_dwordx2 v[30:31], v40, s[24:27], s43 offen offset:1152 sc1
  buffer_load_dwordx2 v[32:33], v40, s[24:27], s43 offen offset:2176 sc1
  buffer_load_dwordx2 v[34:35], v40, s[24:27], s43 offen offset:3200 sc1
  s_mul_i32 s44, s37, 896
  s_add_u32 s44, s44, 4096
  s_mul_i32 s45, s10, 73728
  s_add_u32 s44, s44, s45
  s_nop 0
  buffer_load_dwordx4 v[44:47], v7, s[28:31], s44 offen sc1
  s_add_u32 s44, s44, 18432
  buffer_load_dwordx4 v[48:51], v7, s[28:31], s44 offen sc1
  s_add_u32 s44, s44, 18432
  buffer_load_dwordx4 v[52:55], v7, s[28:31], s44 offen sc1
  s_add_u32 s44, s44, 18432
  buffer_load_dwordx4 v[56:59], v7, s[28:31], s44 offen sc1
  s_and_b32 s43, s2, 2
  s_lshl_b32 s43, s43, 1
  s_bfe_u32 s44, s2, 0x20003
  s_add_u32 s43, s43, s44
  s_lshl_b32 s43, s43, 1
  s_add_u32 s43, s43, 80
  v_add_u32 v60, s43, v1
  v_lshlrev_b32 v60, 7, v60
  v_mov_b32 v61, 56
  s_cmp_eq_u32 s10, 0
  s_cselect_b32 s43, 0, 0x40000000
  s_mov_b32 exec_lo, 3
  s_mov_b32 exec_hi, 0
  buffer_load_dword v62, v60, s[12:15], s43 offen sc1
  s_mov_b64 exec, -1
  s_waitcnt vmcnt(28)
  s_barrier
  s_waitcnt vmcnt(23)
  s_barrier
  s_waitcnt vmcnt(1)
  v_add_f32 v20, v20, v22
  v_add_f32 v21, v21, v23
  v_add_f32 v24, v24, v26
  v_add_f32 v25, v25, v27
  v_add_f32 v20, v20, v24
  v_add_f32 v21, v21, v25
  v_add_f32 v28, v28, v30
  v_add_f32 v29, v29, v31
  v_add_f32 v32, v32, v34
  v_add_f32 v33, v33, v35
  v_add_f32 v28, v28, v32
  v_add_f32 v29, v29, v33
  s_nop 0
  v_permlane32_swap_b32 v20, v28
  v_permlane32_swap_b32 v21, v29
  v_add_f32 v20, v20, v28
  v_add_f32 v21, v21, v29
  s_nop 1
  v_permlane16_swap_b32 v20, v21
  v_add_f32 v20, v20, v21
  v_mov_b32 v21, v20
  s_nop 1
  v_permlane16_swap_b32 v20, v21
  v_mul_f32 v20, 0x3a800000, v20
  v_mul_f32 v21, 0x3a800000, v21
  v_fma_f32 v4, -v20, v20, v21
  v_max_f32_e64 v4, 0, v4
  v_cvt_pk_bf16_f32 v36, v20, v20
  v_and_b32 v36, 0xffff0000, v36
  v_cvt_pk_bf16_f32 v4, v4, v4
  v_and_b32 v4, 0xffff0000, v4
  v_add_f32 v4, 0x3727c5ac, v4
  v_cvt_pk_bf16_f32 v4, v4, v4
  v_and_b32 v4, 0xffff0000, v4
  v_sqrt_f32 v4, v4
  s_nop 0
  v_cvt_pk_bf16_f32 v37, v4, v4
  v_and_b32 v37, 0xffff0000, v37
  v_rcp_f32 v5, v37
  s_nop 0
  v_mul_f32 v38, 0xc0135761, v5
  v_mul_f32 v4, v5, v5
  v_mul_f32 v4, v4, v5
  v_mul_f32 v39, 0xbdd2d3e8, v4
  v_lshrrev_b32 v4, 1, v3
  v_lshl_add_u32 v4, v4, 4, v2
  s_lshl_b32 s43, s10, 5
  v_add_u32 v4, s43, v4
  v_lshlrev_b32 v4, 4, v4
  v_add_u32 v4, 148480, v4
  ds_write_b128 v4, v[36:39]
  s_waitcnt lgkmcnt(0)
  s_waitcnt vmcnt(18)
  s_barrier
  s_waitcnt vmcnt(1)
  v_add_f32 v44, v44, v48
  v_add_f32 v45, v45, v49
  v_add_f32 v46, v46, v50
  v_add_f32 v47, v47, v51
  v_add_f32 v52, v52, v56
  v_add_f32 v53, v53, v57
  v_add_f32 v54, v54, v58
  v_add_f32 v55, v55, v59
  v_add_f32 v44, v44, v52
  v_add_f32 v45, v45, v53
  v_add_f32 v46, v46, v54
  v_add_f32 v47, v47, v55
  s_lshl_b32 s44, s10, 10
  s_add_u32 s44, s44, 152576
  v_add_u32 v4, s44, v7
  ds_write_b128 v4, v[44:47]
  s_waitcnt lgkmcnt(0)
  s_cmp_lg_u32 s10, 0
  s_cbranch_scc1 .Lmixer_kernel_wr3b
  s_waitcnt vmcnt(0)
  s_mov_b32 exec_lo, 3
  s_mov_b32 exec_hi, 0
  v_cmp_lt_u32 vcc, v62, v61
  s_mov_b64 exec, -1
  s_cmp_eq_u64 vcc, 0
  s_cbranch_scc1 .Lmixer_kernel_wr3b
  s_mov_b32 s47, 32768
  s_mov_b32 exec_lo, 0x3
  s_mov_b32 exec_hi, 0x0
.Lpoll_w3b:
  buffer_load_dword v62, v60, s[12:15], 0 offen sc1
  s_sub_u32 s47, s47, 1
  s_waitcnt vmcnt(0)
  v_cmp_lt_u32 vcc, v62, v61
  s_nop 0
  s_cmp_eq_u64 vcc, 0
  s_cselect_b32 s47, 0, s47
  s_cmp_lg_u32 s47, 0
  s_cbranch_scc0 .Lpolled_w3b
  s_branch .Lpoll_w3b
.Lpolled_w3b:
  s_mov_b64 exec, -1
.Lmixer_kernel_wr3b:
  s_waitcnt vmcnt(13)
  s_barrier
  s_cmp_lg_u32 s10, 0
  s_cbranch_scc1 .Lmixer_kernel_cs3b
  v_add_u32 v4, 152576, v7
  ds_read_b128 v[44:47], v4 offset:0
  ds_read_b128 v[48:51], v4 offset:1024
  ds_read_b128 v[52:55], v4 offset:2048
  ds_read_b128 v[56:59], v4 offset:3072
  s_waitcnt lgkmcnt(0)
  v_add_f32 v44, v44, v48
  v_add_f32 v45, v45, v49
  v_add_f32 v46, v46, v50
  v_add_f32 v47, v47, v51
  v_add_f32 v52, v52, v56
  v_add_f32 v53, v53, v57
  v_add_f32 v54, v54, v58
  v_add_f32 v55, v55, v59
  v_add_f32 v44, v44, v52
  v_add_f32 v45, v45, v53
  v_add_f32 v46, v46, v54
  v_add_f32 v47, v47, v55
  v_add_u32 v4, 147456, v7
  ds_write_b128 v4, v[44:47]
.Lmixer_kernel_cs3b:
  s_waitcnt lgkmcnt(0)
  s_barrier
.Lmixer_kernel_v3end:
  s_and_b32 s43, s2, 7
  s_lshr_b32 s44, s2, 3
  s_lshr_b32 s36, s43, 2
  s_lshl_b32 s36, s36, 3
  s_lshr_b32 s45, s44, 2
  s_add_u32 s36, s36, s45
  s_and_b32 s37, s43, 2
  s_lshl_b32 s37, s37, 1
  s_and_b32 s45, s44, 3
  s_add_u32 s37, s37, s45
  s_lshl_b32 s37, s37, 1
  s_and_b32 s45, s2, 1
  s_add_u32 s37, s37, s45
  s_lshl_b32 s38, s36, 3
  s_lshl_b32 s45, s10, 1
  s_add_u32 s38, s38, s45
  s_mul_i32 s45, s38, 114688
  v_add_u32 v9, s45, v7
  v_add_u32 v10, 114688, v9
  s_lshl_b32 s41, s10, 12
  s_and_b32 s44, s2, 1
  s_mul_i32 s40, s44, 3670016
  s_lshr_b32 s43, s10, 1
  s_lshl_b32 s43, s43, 16
  s_add_u32 s40, s40, s43
  s_and_b32 s43, s10, 1
  s_lshl_b32 s43, s43, 12
  s_add_u32 s40, s40, s43
  s_lshr_b32 s43, s37, 1
  s_lshl_b32 s43, s43, 13
  s_add_u32 s40, s40, s43
  s_lshl_b32 s42, s10, 12
  s_add_u32 s42, s42, 16384
  s_mul_i32 s39, s44, 57344
  s_add_u32 s16, s4, 0x1d00000
  s_addc_u32 s17, s5, 0
  s_nop 0
  s_mov_b32 s18, 0xe00000
  s_mov_b32 s19, 0x20000
  s_add_u32 s20, s4, 0x4300000
  s_addc_u32 s21, s5, 0
  s_mov_b32 s22, 0x700000
  s_mov_b32 s23, 0x20000
  s_barrier
  s_add_u32 m0, s41, 98304
  s_nop 0
  s_nop 0
  buffer_load_dwordx4 v7, s[20:23], s40 offen offset:0 sc1 lds
  buffer_load_dwordx4 v7, s[20:23], s40 offen offset:1024 sc1 lds
  buffer_load_dwordx4 v7, s[20:23], s40 offen offset:2048 sc1 lds
  buffer_load_dwordx4 v7, s[20:23], s40 offen offset:3072 sc1 lds
  s_add_u32 s40, s40, 131072
  s_add_u32 m0, s41, 0
  s_nop 0
  buffer_load_dwordx4 v7, s[20:23], s40 offen offset:0 sc1 lds
  buffer_load_dwordx4 v7, s[20:23], s40 offen offset:1024 sc1 lds
  buffer_load_dwordx4 v7, s[20:23], s40 offen offset:2048 sc1 lds
  buffer_load_dwordx4 v7, s[20:23], s40 offen offset:3072 sc1 lds
  s_add_u32 s40, s40, 131072
  s_add_u32 m0, s41, 32768
  s_nop 0
  s_nop 0
  buffer_load_dwordx4 v7, s[20:23], s40 offen offset:0 sc1 lds
  buffer_load_dwordx4 v7, s[20:23], s40 offen offset:1024 sc1 lds
  buffer_load_dwordx4 v7, s[20:23], s40 offen offset:2048 sc1 lds
  buffer_load_dwordx4 v7, s[20:23], s40 offen offset:3072 sc1 lds
  s_add_u32 s40, s40, 131072
  s_cmp_lg_u32 s10, 0
  s_cbranch_scc1 .Lmixer_kernel_np4
  s_lshl_b32 s43, s36, 4
  s_add_u32 s43, s43, s37
  s_lshl_b32 s43, s43, 8
  s_add_u32 s43, s43, 212992
  v_lshl_add_u32 v60, v1, 2, s43
  s_and_b32 s43, s2, 1
  s_lshl_b32 s43, s43, 5
  v_add_u32 v60, s43, v60
  v_mov_b32 v61, 1
  s_mov_b32 s47, 32768
  s_mov_b32 exec_lo, 0xff
  s_mov_b32 exec_hi, 0x0
.Lpoll_a4:
  buffer_load_dword v62, v60, s[12:15], 0 offen sc1
  s_sub_u32 s47, s47, 1
  s_waitcnt vmcnt(0)
  v_cmp_lt_u32 vcc, v62, v61
  s_nop 0
  s_cmp_eq_u64 vcc, 0
  s_cselect_b32 s47, 0, s47
  s_cmp_lg_u32 s47, 0
  s_cbranch_scc0 .Lpolled_a4
  s_branch .Lpoll_a4
.Lpolled_a4:
  s_mov_b64 exec, -1
.Lmixer_kernel_np4:
  s_barrier
  s_add_u32 m0, s42, 98304
  s_nop 0
  buffer_load_dwordx4 v9, s[16:19], s39 offen offset:0 sc1 lds
  buffer_load_dwordx4 v9, s[16:19], s39 offen offset:1024 sc1 lds
  s_add_u32 m0, s42, 100352
  s_nop 0
  s_nop 0
  buffer_load_dwordx4 v10, s[16:19], s39 offen offset:0 sc1 lds
  buffer_load_dwordx4 v10, s[16:19], s39 offen offset:1024 sc1 lds
  s_add_u32 s39, s39, 2048
  s_add_u32 m0, s42, 0
  s_nop 0
  buffer_load_dwordx4 v9, s[16:19], s39 offen offset:0 sc1 lds
  buffer_load_dwordx4 v9, s[16:19], s39 offen offset:1024 sc1 lds
  s_add_u32 m0, s42, 2048
  s_nop 0
  s_nop 0
  buffer_load_dwordx4 v10, s[16:19], s39 offen offset:0 sc1 lds
  buffer_load_dwordx4 v10, s[16:19], s39 offen offset:1024 sc1 lds
  s_add_u32 s39, s39, 2048
  s_add_u32 m0, s42, 32768
  s_nop 0
  s_nop 0
  buffer_load_dwordx4 v9, s[16:19], s39 offen offset:0 sc1 lds
  buffer_load_dwordx4 v9, s[16:19], s39 offen offset:1024 sc1 lds
  s_add_u32 m0, s42, 34816
  s_nop 0
  s_nop 0
  buffer_load_dwordx4 v10, s[16:19], s39 offen offset:0 sc1 lds
  buffer_load_dwordx4 v10, s[16:19], s39 offen offset:1024 sc1 lds
  s_add_u32 s39, s39, 2048
  s_waitcnt vmcnt(8)
  s_barrier
  s_add_u32 m0, s41, 65536
  s_nop 0
  s_nop 0
  buffer_load_dwordx4 v7, s[20:23], s40 offen offset:0 sc1 lds
  buffer_load_dwordx4 v7, s[20:23], s40 offen offset:1024 sc1 lds
  buffer_load_dwordx4 v7, s[20:23], s40 offen offset:2048 sc1 lds
  buffer_load_dwordx4 v7, s[20:23], s40 offen offset:3072 sc1 lds
  s_add_u32 s40, s40, 131072
  s_add_u32 m0, s42, 65536
  s_nop 0
  s_nop 0
  buffer_load_dwordx4 v9, s[16:19], s39 offen offset:0 sc1 lds
  buffer_load_dwordx4 v9, s[16:19], s39 offen offset:1024 sc1 lds
  s_add_u32 m0, s42, 67584
  s_nop 0
  s_nop 0
  buffer_load_dwordx4 v10, s[16:19], s39 offen offset:0 sc1 lds
  buffer_load_dwordx4 v10, s[16:19], s39 offen offset:1024 sc1 lds
  s_add_u32 s39, s39, 2048
  s_waitcnt vmcnt(12)
  s_barrier
  s_add_u32 m0, s41, 98304
  s_nop 0
  s_nop 0
  buffer_load_dwordx4 v7, s[20:23], s40 offen offset:0 sc1 lds
  buffer_load_dwordx4 v7, s[20:23], s40 offen offset:1024 sc1 lds
  buffer_load_dwordx4 v7, s[20:23], s40 offen offset:2048 sc1 lds
  buffer_load_dwordx4 v7, s[20:23], s40 offen offset:3072 sc1 lds
  s_add_u32 s40, s40, 131072
  s_add_u32 m0, s42, 98304
  s_nop 0
  s_nop 0
  buffer_load_dwordx4 v9, s[16:19], s39 offen offset:0 sc1 lds
  buffer_load_dwordx4 v9, s[16:19], s39 offen offset:1024 sc1 lds
  s_add_u32 m0, s42, 100352
  s_nop 0
  s_nop 0
  buffer_load_dwordx4 v10, s[16:19], s39 offen offset:0 sc1 lds
  buffer_load_dwordx4 v10, s[16:19], s39 offen offset:1024 sc1 lds
  s_add_u32 s39, s39, 2048
  s_waitcnt vmcnt(16)
  s_barrier
  s_mov_b32 s11, 5
  s_nop 0
.Lmixer_kernel_p4:
  s_add_u32 m0, s41, 0
  s_nop 0
  buffer_load_dwordx4 v7, s[20:23], s40 offen offset:0 sc1 lds
  buffer_load_dwordx4 v7, s[20:23], s40 offen offset:1024 sc1 lds
  buffer_load_dwordx4 v7, s[20:23], s40 offen offset:2048 sc1 lds
  buffer_load_dwordx4 v7, s[20:23], s40 offen offset:3072 sc1 lds
  s_add_u32 s40, s40, 131072
  s_add_u32 m0, s42, 0
  s_nop 0
  buffer_load_dwordx4 v9, s[16:19], s39 offen offset:0 sc1 lds
  buffer_load_dwordx4 v9, s[16:19], s39 offen offset:1024 sc1 lds
  s_add_u32 m0, s42, 2048
  s_nop 0
  s_nop 0
  buffer_load_dwordx4 v10, s[16:19], s39 offen offset:0 sc1 lds
  buffer_load_dwordx4 v10, s[16:19], s39 offen offset:1024 sc1 lds
  s_add_u32 s39, s39, 2048
  s_waitcnt vmcnt(16)
  s_barrier
  s_add_u32 m0, s41, 32768
  s_nop 0
  s_nop 0
  buffer_load_dwordx4 v7, s[20:23], s40 offen offset:0 sc1 lds
  buffer_load_dwordx4 v7, s[20:23], s40 offen offset:1024 sc1 lds
  buffer_load_dwordx4 v7, s[20:23], s40 offen offset:2048 sc1 lds
  buffer_load_dwordx4 v7, s[20:23], s40 offen offset:3072 sc1 lds
  s_add_u32 s40, s40, 131072
  s_add_u32 m0, s42, 32768
  s_nop 0
  s_nop 0
  buffer_load_dwordx4 v9, s[16:19], s39 offen offset:0 sc1 lds
  buffer_load_dwordx4 v9, s[16:19], s39 offen offset:1024 sc1 lds
  s_add_u32 m0, s42, 34816
  s_nop 0
  s_nop 0
  buffer_load_dwordx4 v10, s[16:19], s39 offen offset:0 sc1 lds
  buffer_load_dwordx4 v10, s[16:19], s39 offen offset:1024 sc1 lds
  s_add_u32 s39, s39, 2048
  s_waitcnt vmcnt(16)
  s_barrier
  s_add_u32 m0, s41, 65536
  s_nop 0
  s_nop 0
  buffer_load_dwordx4 v7, s[20:23], s40 offen offset:0 sc1 lds
  buffer_load_dwordx4 v7, s[20:23], s40 offen offset:1024 sc1 lds
  buffer_load_dwordx4 v7, s[20:23], s40 offen offset:2048 sc1 lds
  buffer_load_dwordx4 v7, s[20:23], s40 offen offset:3072 sc1 lds
  s_add_u32 s40, s40, 131072
  s_add_u32 m0, s42, 65536
  s_nop 0
  s_nop 0
  buffer_load_dwordx4 v9, s[16:19], s39 offen offset:0 sc1 lds
  buffer_load_dwordx4 v9, s[16:19], s39 offen offset:1024 sc1 lds
  s_add_u32 m0, s42, 67584
  s_nop 0
  s_nop 0
  buffer_load_dwordx4 v10, s[16:19], s39 offen offset:0 sc1 lds
  buffer_load_dwordx4 v10, s[16:19], s39 offen offset:1024 sc1 lds
  s_add_u32 s39, s39, 2048
  s_waitcnt vmcnt(16)
  s_barrier
  s_add_u32 m0, s41, 98304
  s_nop 0
  s_nop 0
  buffer_load_dwordx4 v7, s[20:23], s40 offen offset:0 sc1 lds
  buffer_load_dwordx4 v7, s[20:23], s40 offen offset:1024 sc1 lds
  buffer_load_dwordx4 v7, s[20:23], s40 offen offset:2048 sc1 lds
  buffer_load_dwordx4 v7, s[20:23], s40 offen offset:3072 sc1 lds
  s_add_u32 s40, s40, 131072
  s_add_u32 m0, s42, 98304
  s_nop 0
  s_nop 0
  buffer_load_dwordx4 v9, s[16:19], s39 offen offset:0 sc1 lds
  buffer_load_dwordx4 v9, s[16:19], s39 offen offset:1024 sc1 lds
  s_add_u32 m0, s42, 100352
  s_nop 0
  s_nop 0
  buffer_load_dwordx4 v10, s[16:19], s39 offen offset:0 sc1 lds
  buffer_load_dwordx4 v10, s[16:19], s39 offen offset:1024 sc1 lds
  s_add_u32 s39, s39, 2048
  s_waitcnt vmcnt(16)
  s_barrier
  s_sub_u32 s11, s11, 1
  s_cmp_lg_u32 s11, 0
  s_cbranch_scc1 .Lmixer_kernel_p4
  s_add_u32 m0, s41, 0
  s_nop 0
  s_nop 0
  buffer_load_dwordx4 v7, s[20:23], s40 offen offset:0 sc1 lds
  buffer_load_dwordx4 v7, s[20:23], s40 offen offset:1024 sc1 lds
  buffer_load_dwordx4 v7, s[20:23], s40 offen offset:2048 sc1 lds
  buffer_load_dwordx4 v7, s[20:23], s40 offen offset:3072 sc1 lds
  s_add_u32 s40, s40, 131072
  s_add_u32 m0, s42, 0
  s_nop 0
  buffer_load_dwordx4 v9, s[16:19], s39 offen offset:0 sc1 lds
  buffer_load_dwordx4 v9, s[16:19], s39 offen offset:1024 sc1 lds
  s_add_u32 m0, s42, 2048
  s_nop 0
  s_nop 0
  buffer_load_dwordx4 v10, s[16:19], s39 offen offset:0 sc1 lds
  buffer_load_dwordx4 v10, s[16:19], s39 offen offset:1024 sc1 lds
  s_add_u32 s39, s39, 2048
  s_waitcnt vmcnt(16)
  s_barrier
  s_add_u32 m0, s41, 32768
  s_nop 0
  s_nop 0
  buffer_load_dwordx4 v7, s[20:23], s40 offen offset:0 sc1 lds
  buffer_load_dwordx4 v7, s[20:23], s40 offen offset:1024 sc1 lds
  buffer_load_dwordx4 v7, s[20:23], s40 offen offset:2048 sc1 lds
  buffer_load_dwordx4 v7, s[20:23], s40 offen offset:3072 sc1 lds
  s_add_u32 s40, s40, 131072
  s_add_u32 m0, s42, 32768
  s_nop 0
  s_nop 0
  buffer_load_dwordx4 v9, s[16:19], s39 offen offset:0 sc1 lds
  buffer_load_dwordx4 v9, s[16:19], s39 offen offset:1024 sc1 lds
  s_add_u32 m0, s42, 34816
  s_nop 0
  s_nop 0
  buffer_load_dwordx4 v10, s[16:19], s39 offen offset:0 sc1 lds
  buffer_load_dwordx4 v10, s[16:19], s39 offen offset:1024 sc1 lds
  s_add_u32 s39, s39, 2048
  s_waitcnt vmcnt(16)
  s_barrier
  s_add_u32 m0, s41, 65536
  s_nop 0
  s_nop 0
  buffer_load_dwordx4 v7, s[20:23], s40 offen offset:0 sc1 lds
  buffer_load_dwordx4 v7, s[20:23], s40 offen offset:1024 sc1 lds
  buffer_load_dwordx4 v7, s[20:23], s40 offen offset:2048 sc1 lds
  buffer_load_dwordx4 v7, s[20:23], s40 offen offset:3072 sc1 lds
  s_add_u32 s40, s40, 131072
  s_add_u32 m0, s42, 65536
  s_nop 0
  s_nop 0
  buffer_load_dwordx4 v9, s[16:19], s39 offen offset:0 sc1 lds
  buffer_load_dwordx4 v9, s[16:19], s39 offen offset:1024 sc1 lds
  s_add_u32 m0, s42, 67584
  s_nop 0
  s_nop 0
  buffer_load_dwordx4 v10, s[16:19], s39 offen offset:0 sc1 lds
  buffer_load_dwordx4 v10, s[16:19], s39 offen offset:1024 sc1 lds
  s_add_u32 s39, s39, 2048
  s_waitcnt vmcnt(16)
  s_barrier
  s_waitcnt vmcnt(8)
  s_barrier
  s_waitcnt vmcnt(0)
  s_barrier
.Lmixer_kernel_done:
  s_endpgm
.Lmixer_kernel_end:
.size mixer_kernel, .Lmixer_kernel_end - mixer_kernel
.p2align 8
.type fft_tables,@object
fft_tables:
.long 0x3f80,0x3f80,0x3f80,0x3f80,0x3f80,0x3ec43f6d,0x3f353f35,0x3f6d3ec4
.long 0x3f80,0x3f353f35,0x3f800000,0x3f35bf35,0x3f80,0x3f6d3ec4,0x3f35bf35,0xbec4bf6d
.long 0x3f80,0x3f800000,0xbf80,0xbf800000,0x3f80,0x3f6dbec4,0xbf35bf35,0xbec43f6d
.long 0x3f80,0x3f35bf35,0xbf800000,0x3f353f35,0x3f80,0x3ec4bf6d,0xbf353f35,0x3f6dbec4
.long 0x3f80,0xbf80,0x3f80,0xbf80,0x3f80,0xbec4bf6d,0x3f353f35,0xbf6dbec4
.long 0x3f80,0xbf35bf35,0x3f800000,0xbf353f35,0x3f80,0xbf6dbec4,0x3f35bf35,0x3ec43f6d
.long 0x3f80,0xbf800000,0xbf80,0x3f800000,0x3f80,0xbf6d3ec4,0xbf35bf35,0x3ec4bf6d
.long 0x3f80,0xbf353f35,0xbf800000,0xbf35bf35,0x3f80,0xbec43f6d,0xbf353f35,0xbf6d3ec4
.long 0x3f80,0x3f80,0x3f80,0x3f80,0x3f800000,0x3f6dbec4,0x3f35bf35,0x3ec4bf6d
.long 0xbf80,0xbf35bf35,0xbf800000,0xbf353f35,0xbf800000,0xbec43f6d,0x3f353f35,0x3f6dbec4
.long 0x3f80,0x3f800000,0xbf80,0xbf800000,0x3f800000,0xbec4bf6d,0xbf353f35,0x3f6d3ec4
.long 0xbf80,0xbf353f35,0x3f800000,0xbf35bf35,0xbf800000,0x3f6d3ec4,0xbf35bf35,0x3ec43f6d
.long 0x3f80,0xbf80,0x3f80,0xbf80,0x3f800000,0xbf6d3ec4,0x3f35bf35,0xbec43f6d
.long 0xbf80,0x3f353f35,0xbf800000,0x3f35bf35,0xbf800000,0x3ec4bf6d,0x3f353f35,0xbf6d3ec4
.long 0x3f80,0xbf800000,0xbf80,0x3f800000,0x3f800000,0x3ec43f6d,0xbf353f35,0xbf6dbec4
.long 0xbf80,0x3f35bf35,0x3f800000,0x3f353f35,0xbf800000,0xbf6dbec4,0xbf35bf35,0xbec4bf6d
.long 0x3f80,0x3f80,0x3f80,0x3f80,0xbf80,0xbec4bf6d,0xbf35bf35,0xbf6dbec4
.long 0x3f80,0x3f353f35,0x3f800000,0x3f35bf35,0xbf80,0xbf6dbec4,0xbf353f35,0x3ec43f6d
.long 0x3f80,0x3f800000,0xbf80,0xbf800000,0xbf80,0xbf6d3ec4,0x3f353f35,0x3ec4bf6d
.long 0x3f80,0x3f35bf35,0xbf800000,0x3f353f35,0xbf80,0xbec43f6d,0x3f35bf35,0xbf6d3ec4
.long 0x3f80,0xbf80,0x3f80,0xbf80,0xbf80,0x3ec43f6d,0xbf35bf35,0x3f6d3ec4
.long 0x3f80,0xbf35bf35,0x3f800000,0xbf353f35,0xbf80,0x3f6d3ec4,0xbf353f35,0xbec4bf6d
.long 0x3f80,0xbf800000,0xbf80,0x3f800000,0xbf80,0x3f6dbec4,0x3f353f35,0xbec43f6d
.long 0x3f80,0xbf353f35,0xbf800000,0xbf35bf35,0xbf80,0x3ec4bf6d,0x3f35bf35,0x3f6dbec4
.long 0x3f80,0x3f80,0x3f80,0x3f80,0xbf800000,0xbf6d3ec4,0xbf353f35,0xbec43f6d
.long 0xbf80,0xbf35bf35,0xbf800000,0xbf353f35,0x3f800000,0x3ec4bf6d,0xbf35bf35,0xbf6d3ec4
.long 0x3f80,0x3f800000,0xbf80,0xbf800000,0xbf800000,0x3ec43f6d,0x3f35bf35,0xbf6dbec4
.long 0xbf80,0xbf353f35,0x3f800000,0xbf35bf35,0x3f800000,0xbf6dbec4,0x3f353f35,0xbec4bf6d
.long 0x3f80,0xbf80,0x3f80,0xbf80,0xbf800000,0x3f6dbec4,0xbf353f35,0x3ec4bf6d
.long 0xbf80,0x3f353f35,0xbf800000,0x3f35bf35,0x3f800000,0xbec43f6d,0xbf35bf35,0x3f6dbec4
.long 0x3f80,0xbf800000,0xbf80,0x3f800000,0xbf800000,0xbec4bf6d,0x3f35bf35,0x3f6d3ec4
.long 0xbf80,0x3f35bf35,0x3f800000,0x3f353f35,0x3f800000,0x3f6d3ec4,0x3f353f35,0x3ec43f6d
.long 0x3f800000,0x3f800000,0x3f800000,0x3f800000,0x3f800000,0x3f6dbec4,0x3f35bf35,0x3ec4bf6d
.long 0x3f800000,0x3f35bf35,0xbf80,0xbf35bf35,0x3f800000,0x3ec4bf6d,0xbf35bf35,0xbf6d3ec4
.long 0x3f800000,0xbf80,0xbf800000,0x3f80,0x3f800000,0xbec4bf6d,0xbf353f35,0x3f6d3ec4
.long 0x3f800000,0xbf35bf35,0x3f80,0x3f35bf35,0x3f800000,0xbf6dbec4,0x3f353f35,0xbec4bf6d
.long 0x3f800000,0xbf800000,0x3f800000,0xbf800000,0x3f800000,0xbf6d3ec4,0x3f35bf35,0xbec43f6d
.long 0x3f800000,0xbf353f35,0xbf80,0x3f353f35,0x3f800000,0xbec43f6d,0xbf35bf35,0x3f6dbec4
.long 0x3f800000,0x3f80,0xbf800000,0xbf80,0x3f800000,0x3ec43f6d,0xbf353f35,0xbf6dbec4
.long 0x3f800000,0x3f353f35,0x3f80,0xbf353f35,0x3f800000,0x3f6d3ec4,0x3f353f35,0x3ec43f6d
.long 0x3f800000,0x3f800000,0x3f800000,0x3f800000,0xbf80,0xbec4bf6d,0xbf35bf35,0xbf6dbec4
.long 0xbf800000,0xbf353f35,0x3f80,0x3f353f35,0x3f80,0x3f6d3ec4,0x3f35bf35,0xbec4bf6d
.long 0x3f800000,0xbf80,0xbf800000,0x3f80,0xbf80,0xbf6d3ec4,0x3f353f35,0x3ec4bf6d
.long 0xbf800000,0x3f353f35,0xbf80,0xbf353f35,0x3f80,0x3ec4bf6d,0xbf353f35,0x3f6dbec4
.long 0x3f800000,0xbf800000,0x3f800000,0xbf800000,0xbf80,0x3ec43f6d,0xbf35bf35,0x3f6d3ec4
.long 0xbf800000,0x3f35bf35,0x3f80,0xbf35bf35,0x3f80,0xbf6dbec4,0x3f35bf35,0x3ec43f6d
.long 0x3f800000,0x3f80,0xbf800000,0xbf80,0xbf80,0x3f6dbec4,0x3f353f35,0xbec43f6d
.long 0xbf800000,0xbf35bf35,0xbf80,0x3f35bf35,0x3f80,0xbec43f6d,0xbf353f35,0xbf6d3ec4
.long 0x3f800000,0x3f800000,0x3f800000,0x3f800000,0xbf800000,0xbf6d3ec4,0xbf353f35,0xbec43f6d
.long 0x3f800000,0x3f35bf35,0xbf80,0xbf35bf35,0xbf800000,0xbec43f6d,0x3f353f35,0x3f6dbec4
.long 0x3f800000,0xbf80,0xbf800000,0x3f80,0xbf800000,0x3ec43f6d,0x3f35bf35,0xbf6dbec4
.long 0x3f800000,0xbf35bf35,0x3f80,0x3f35bf35,0xbf800000,0x3f6d3ec4,0xbf35bf35,0x3ec43f6d
.long 0x3f800000,0xbf800000,0x3f800000,0xbf800000,0xbf800000,0x3f6dbec4,0xbf353f35,0x3ec4bf6d
.long 0x3f800000,0xbf353f35,0xbf80,0x3f353f35,0xbf800000,0x3ec4bf6d,0x3f353f35,0xbf6d3ec4
.long 0x3f800000,0x3f80,0xbf800000,0xbf80,0xbf800000,0xbec4bf6d,0x3f35bf35,0x3f6d3ec4
.long 0x3f800000,0x3f353f35,0x3f80,0xbf353f35,0xbf800000,0xbf6dbec4,0xbf35bf35,0xbec4bf6d
.long 0x3f800000,0x3f800000,0x3f800000,0x3f800000,0x3f80,0x3ec43f6d,0x3f353f35,0x3f6d3ec4
.long 0xbf800000,0xbf353f35,0x3f80,0x3f353f35,0xbf80,0xbf6dbec4,0xbf353f35,0x3ec43f6d
.long 0x3f800000,0xbf80,0xbf800000,0x3f80,0x3f80,0x3f6dbec4,0xbf35bf35,0xbec43f6d
.long 0xbf800000,0x3f353f35,0xbf80,0xbf353f35,0xbf80,0xbec43f6d,0x3f35bf35,0xbf6d3ec4
.long 0x3f800000,0xbf800000,0x3f800000,0xbf800000,0x3f80,0xbec4bf6d,0x3f353f35,0xbf6dbec4
.long 0xbf800000,0x3f35bf35,0x3f80,0xbf35bf35,0xbf80,0x3f6d3ec4,0xbf353f35,0xbec4bf6d
.long 0x3f800000,0x3f80,0xbf800000,0xbf80,0x3f80,0xbf6d3ec4,0xbf35bf35,0x3ec4bf6d
.long 0xbf800000,0xbf35bf35,0xbf80,0x3f35bf35,0xbf80,0x3ec4bf6d,0x3f35bf35,0x3f6dbec4
.long 0x3f80,0x3f80,0x3f80,0x3f80,0x3f80,0x3e483f7b,0x3ec43f6d,0x3f0e3f55
.long 0x3f80,0x3ec43f6d,0x3f353f35,0x3f6d3ec4,0x3f80,0x3f0e3f55,0x3f6d3ec4,0x3f7bbe48
.long 0x3f80,0x3f353f35,0x3f800000,0x3f35bf35,0x3f80,0x3f553f0e,0x3f6dbec4,0x3e48bf7b
.long 0x3f80,0x3f6d3ec4,0x3f35bf35,0xbec4bf6d,0x3f80,0x3f7b3e48,0x3ec4bf6d,0xbf55bf0e
.long 0x3f80,0x3f800000,0xbf80,0xbf800000,0x3f80,0x3f7bbe48,0xbec4bf6d,0xbf553f0e
.long 0x3f80,0x3f6dbec4,0xbf35bf35,0xbec43f6d,0x3f80,0x3f55bf0e,0xbf6dbec4,0x3e483f7b
.long 0x3f80,0x3f35bf35,0xbf800000,0x3f353f35,0x3f80,0x3f0ebf55,0xbf6d3ec4,0x3f7b3e48
.long 0x3f80,0x3ec4bf6d,0xbf353f35,0x3f6dbec4,0x3f80,0x3e48bf7b,0xbec43f6d,0x3f0ebf55
.long 0x3f80,0x3f80,0x3f80,0x3f80,0x3f353f35,0x3f553f0e,0x3f6d3ec4,0x3f7b3e48
.long 0x3f800000,0x3f6dbec4,0x3f35bf35,0x3ec4bf6d,0x3f35bf35,0x3e48bf7b,0xbec4bf6d,0xbf55bf0e
.long 0xbf80,0xbf35bf35,0xbf800000,0xbf353f35,0xbf35bf35,0xbf7b3e48,0xbec43f6d,0x3f0e3f55
.long 0xbf800000,0xbec43f6d,0x3f353f35,0x3f6dbec4,0xbf353f35,0x3f0e3f55,0x3f6dbec4,0xbe48bf7b
.long 0x3f80,0x3f800000,0xbf80,0xbf800000,0x3f353f35,0x3f0ebf55,0xbf6dbec4,0xbe483f7b
.long 0x3f800000,0xbec4bf6d,0xbf353f35,0x3f6d3ec4,0x3f35bf35,0xbf7bbe48,0x3ec43f6d,0x3f0ebf55
.long 0xbf80,0xbf353f35,0x3f800000,0xbf35bf35,0xbf35bf35,0x3e483f7b,0x3ec4bf6d,0xbf553f0e
.long 0xbf800000,0x3f6d3ec4,0xbf35bf35,0x3ec43f6d,0xbf353f35,0x3f55bf0e,0xbf6d3ec4,0x3f7bbe48
.long 0x3f80,0x3f80,0x3f80,0x3f80,0x3f800000,0x3f7bbe48,0x3f6dbec4,0x3f55bf0e
.long 0xbf80,0xbec4bf6d,0xbf35bf35,0xbf6dbec4,0xbf800000,0xbf553f0e,0xbec43f6d,0x3e483f7b
.long 0x3f80,0x3f353f35,0x3f800000,0x3f35bf35,0x3f800000,0x3f0ebf55,0xbec4bf6d,0xbf7bbe48
.long 0xbf80,0xbf6dbec4,0xbf353f35,0x3ec43f6d,0xbf800000,0xbe483f7b,0x3f6d3ec4,0x3f0ebf55
.long 0x3f80,0x3f800000,0xbf80,0xbf800000,0x3f800000,0xbe48bf7b,0xbf6d3ec4,0x3f0e3f55
.long 0xbf80,0xbf6d3ec4,0x3f353f35,0x3ec4bf6d,0xbf800000,0x3f0e3f55,0x3ec4bf6d,0xbf7b3e48
.long 0x3f80,0x3f35bf35,0xbf800000,0x3f353f35,0x3f800000,0xbf55bf0e,0x3ec43f6d,0x3e48bf7b
.long 0xbf80,0xbec43f6d,0x3f35bf35,0xbf6d3ec4,0xbf800000,0x3f7b3e48,0xbf6dbec4,0x3f553f0e
.long 0x3f80,0x3f80,0x3f80,0x3f80,0x3f35bf35,0x3f0ebf55,0x3ec4bf6d,0x3e48bf7b
.long 0xbf800000,0xbf6d3ec4,0xbf353f35,0xbec43f6d,0x3f353f35,0x3f7b3e48,0x3f6dbec4,0x3f0ebf55
.long 0xbf80,0xbf35bf35,0xbf800000,0xbf353f35,0xbf353f35,0x3e483f7b,0x3f6d3ec4,0x3f55bf0e
.long 0x3f800000,0x3ec4bf6d,0xbf35bf35,0xbf6d3ec4,0xbf35bf35,0xbf553f0e,0x3ec43f6d,0x3f7bbe48
.long 0x3f80,0x3f800000,0xbf80,0xbf800000,0x3f35bf35,0xbf55bf0e,0xbec43f6d,0x3f7b3e48
.long 0xbf800000,0x3ec43f6d,0x3f35bf35,0xbf6dbec4,0x3f353f35,0x3e48bf7b,0xbf6d3ec4,0x3f553f0e
.long 0xbf80,0xbf353f35,0x3f800000,0xbf35bf35,0xbf353f35,0x3f7bbe48,0xbf6dbec4,0x3f0e3f55
.long 0x3f800000,0xbf6dbec4,0x3f353f35,0xbec4bf6d,0xbf35bf35,0x3f0e3f55,0xbec4bf6d,0x3e483f7b
.long 0x3f80,0x3f80,0x3f80,0x3f80,0xbf80,0xbe48bf7b,0xbec4bf6d,0xbf0ebf55
.long 0x3f80,0x3ec43f6d,0x3f353f35,0x3f6d3ec4,0xbf80,0xbf0ebf55,0xbf6dbec4,0xbf7b3e48
.long 0x3f80,0x3f353f35,0x3f800000,0x3f35bf35,0xbf80,0xbf55bf0e,0xbf6d3ec4,0xbe483f7b
.long 0x3f80,0x3f6d3ec4,0x3f35bf35,0xbec4bf6d,0xbf80,0xbf7bbe48,0xbec43f6d,0x3f553f0e
.long 0x3f80,0x3f800000,0xbf80,0xbf800000,0xbf80,0xbf7b3e48,0x3ec43f6d,0x3f55bf0e
.long 0x3f80,0x3f6dbec4,0xbf35bf35,0xbec43f6d,0xbf80,0xbf553f0e,0x3f6d3ec4,0xbe48bf7b
.long 0x3f80,0x3f35bf35,0xbf800000,0x3f353f35,0xbf80,0xbf0e3f55,0x3f6dbec4,0xbf7bbe48
.long 0x3f80,0x3ec4bf6d,0xbf353f35,0x3f6dbec4,0xbf80,0xbe483f7b,0x3ec4bf6d,0xbf0e3f55
.long 0x3f80,0x3f80,0x3f80,0x3f80,0xbf35bf35,0xbf55bf0e,0xbf6dbec4,0xbf7bbe48
.long 0x3f800000,0x3f6dbec4,0x3f35bf35,0x3ec4bf6d,0xbf353f35,0xbe483f7b,0x3ec43f6d,0x3f553f0e
.long 0xbf80,0xbf35bf35,0xbf800000,0xbf353f35,0x3f353f35,0x3f7bbe48,0x3ec4bf6d,0xbf0ebf55
.long 0xbf800000,0xbec43f6d,0x3f353f35,0x3f6dbec4,0x3f35bf35,0xbf0ebf55,0xbf6d3ec4,0x3e483f7b
.long 0x3f80,0x3f800000,0xbf80,0xbf800000,0xbf35bf35,0xbf0e3f55,0x3f6d3ec4,0x3e48bf7b
.long 0x3f800000,0xbec4bf6d,0xbf353f35,0x3f6d3ec4,0xbf353f35,0x3f7b3e48,0xbec4bf6d,0xbf0e3f55
.long 0xbf80,0xbf353f35,0x3f800000,0xbf35bf35,0x3f353f35,0xbe48bf7b,0xbec43f6d,0x3f55bf0e
.long 0xbf800000,0x3f6d3ec4,0xbf35bf35,0x3ec43f6d,0x3f35bf35,0xbf553f0e,0x3f6dbec4,0xbf7b3e48
.long 0x3f80,0x3f80,0x3f80,0x3f80,0xbf800000,0xbf7b3e48,0xbf6d3ec4,0xbf553f0e
.long 0xbf80,0xbec4bf6d,0xbf35bf35,0xbf6dbec4,0x3f800000,0x3f55bf0e,0x3ec4bf6d,0xbe48bf7b
.long 0x3f80,0x3f353f35,0x3f800000,0x3f35bf35,0xbf800000,0xbf0e3f55,0x3ec43f6d,0x3f7b3e48
.long 0xbf80,0xbf6dbec4,0xbf353f35,0x3ec43f6d,0x3f800000,0x3e48bf7b,0xbf6dbec4,0xbf0e3f55
.long 0x3f80,0x3f800000,0xbf80,0xbf800000,0xbf800000,0x3e483f7b,0x3f6dbec4,0xbf0ebf55
.long 0xbf80,0xbf6d3ec4,0x3f353f35,0x3ec4bf6d,0x3f800000,0xbf0ebf55,0xbec43f6d,0x3f7bbe48
.long 0x3f80,0x3f35bf35,0xbf800000,0x3f353f35,0xbf800000,0x3f553f0e,0xbec4bf6d,0xbe483f7b
.long 0xbf80,0xbec43f6d,0x3f35bf35,0xbf6d3ec4,0x3f800000,0xbf7bbe48,0x3f6d3ec4,0xbf55bf0e
.long 0x3f80,0x3f80,0x3f80,0x3f80,0xbf353f35,0xbf0e3f55,0xbec43f6d,0xbe483f7b
.long 0xbf800000,0xbf6d3ec4,0xbf353f35,0xbec43f6d,0xbf35bf35,0xbf7bbe48,0xbf6d3ec4,0xbf0e3f55
.long 0xbf80,0xbf35bf35,0xbf800000,0xbf353f35,0x3f35bf35,0xbe48bf7b,0xbf6dbec4,0xbf553f0e
.long 0x3f800000,0x3ec4bf6d,0xbf35bf35,0xbf6d3ec4,0x3f353f35,0x3f55bf0e,0xbec4bf6d,0xbf7b3e48
.long 0x3f80,0x3f800000,0xbf80,0xbf800000,0xbf353f35,0x3f553f0e,0x3ec4bf6d,0xbf7bbe48
.long 0xbf800000,0x3ec43f6d,0x3f35bf35,0xbf6dbec4,0xbf35bf35,0xbe483f7b,0x3f6dbec4,0xbf55bf0e
.long 0xbf80,0xbf353f35,0x3f800000,0xbf35bf35,0x3f35bf35,0xbf7b3e48,0x3f6d3ec4,0xbf0ebf55
.long 0x3f800000,0xbf6dbec4,0x3f353f35,0xbec4bf6d,0x3f353f35,0xbf0ebf55,0x3ec43f6d,0xbe48bf7b
.long 0x3f800000,0x3f800000,0x3f800000,0x3f800000,0x3f800000,0x3f7bbe48,0x3f6dbec4,0x3f55bf0e
.long 0x3f800000,0x3f6dbec4,0x3f35bf35,0x3ec4bf6d,0x3f800000,0x3f55bf0e,0x3ec4bf6d,0xbe48bf7b
.long 0x3f800000,0x3f35bf35,0xbf80,0xbf35bf35,0x3f800000,0x3f0ebf55,0xbec4bf6d,0xbf7bbe48
.long 0x3f800000,0x3ec4bf6d,0xbf35bf35,0xbf6d3ec4,0x3f800000,0x3e48bf7b,0xbf6dbec4,0xbf0e3f55
.long 0x3f800000,0xbf80,0xbf800000,0x3f80,0x3f800000,0xbe48bf7b,0xbf6d3ec4,0x3f0e3f55
.long 0x3f800000,0xbec4bf6d,0xbf353f35,0x3f6d3ec4,0x3f800000,0xbf0ebf55,0xbec43f6d,0x3f7bbe48
.long 0x3f800000,0xbf35bf35,0x3f80,0x3f35bf35,0x3f800000,0xbf55bf0e,0x3ec43f6d,0x3e48bf7b
.long 0x3f800000,0xbf6dbec4,0x3f353f35,0xbec4bf6d,0x3f800000,0xbf7bbe48,0x3f6d3ec4,0xbf55bf0e
.long 0x3f800000,0x3f800000,0x3f800000,0x3f800000,0x3f35bf35,0x3f0ebf55,0x3ec4bf6d,0x3e48bf7b
.long 0xbf80,0xbec4bf6d,0xbf35bf35,0xbf6dbec4,0xbf35bf35,0xbf7bbe48,0xbf6d3ec4,0xbf0e3f55
.long 0xbf800000,0xbf353f35,0x3f80,0x3f353f35,0xbf353f35,0x3e483f7b,0x3f6d3ec4,0x3f55bf0e
.long 0x3f80,0x3f6d3ec4,0x3f35bf35,0xbec4bf6d,0x3f353f35,0x3f55bf0e,0xbec4bf6d,0xbf7b3e48
.long 0x3f800000,0xbf80,0xbf800000,0x3f80,0x3f35bf35,0xbf55bf0e,0xbec43f6d,0x3f7b3e48
.long 0xbf80,0xbf6d3ec4,0x3f353f35,0x3ec4bf6d,0xbf35bf35,0xbe483f7b,0x3f6dbec4,0xbf55bf0e
.long 0xbf800000,0x3f353f35,0xbf80,0xbf353f35,0xbf353f35,0x3f7bbe48,0xbf6dbec4,0x3f0e3f55
.long 0x3f80,0x3ec4bf6d,0xbf353f35,0x3f6dbec4,0x3f353f35,0xbf0ebf55,0x3ec43f6d,0xbe48bf7b
.long 0x3f800000,0x3f800000,0x3f800000,0x3f800000,0xbf80,0xbe48bf7b,0xbec4bf6d,0xbf0ebf55
.long 0xbf800000,0xbf6d3ec4,0xbf353f35,0xbec43f6d,0x3f80,0x3f0e3f55,0x3f6d3ec4,0x3f7bbe48
.long 0x3f800000,0x3f35bf35,0xbf80,0xbf35bf35,0xbf80,0xbf55bf0e,0xbf6d3ec4,0xbe483f7b
.long 0xbf800000,0xbec43f6d,0x3f353f35,0x3f6dbec4,0x3f80,0x3f7b3e48,0x3ec4bf6d,0xbf55bf0e
.long 0x3f800000,0xbf80,0xbf800000,0x3f80,0xbf80,0xbf7b3e48,0x3ec43f6d,0x3f55bf0e
.long 0xbf800000,0x3ec43f6d,0x3f35bf35,0xbf6dbec4,0x3f80,0x3f55bf0e,0xbf6dbec4,0x3e483f7b
.long 0x3f800000,0xbf35bf35,0x3f80,0x3f35bf35,0xbf80,0xbf0e3f55,0x3f6dbec4,0xbf7bbe48
.long 0xbf800000,0x3f6d3ec4,0xbf35bf35,0x3ec43f6d,0x3f80,0x3e48bf7b,0xbec43f6d,0x3f0ebf55
.long 0x3f800000,0x3f800000,0x3f800000,0x3f800000,0xbf35bf35,0xbf55bf0e,0xbf6dbec4,0xbf7bbe48
.long 0x3f80,0x3ec43f6d,0x3f353f35,0x3f6d3ec4,0x3f35bf35,0x3e48bf7b,0xbec4bf6d,0xbf55bf0e
.long 0xbf800000,0xbf353f35,0x3f80,0x3f353f35,0x3f353f35,0x3f7bbe48,0x3ec4bf6d,0xbf0ebf55
.long 0xbf80,0xbf6dbec4,0xbf353f35,0x3ec43f6d,0xbf353f35,0x3f0e3f55,0x3f6dbec4,0xbe48bf7b
.long 0x3f800000,0xbf80,0xbf800000,0x3f80,0xbf35bf35,0xbf0e3f55,0x3f6d3ec4,0x3e48bf7b
.long 0x3f80,0x3f6dbec4,0xbf35bf35,0xbec43f6d,0x3f35bf35,0xbf7bbe48,0x3ec43f6d,0x3f0ebf55
.long 0xbf800000,0x3f353f35,0xbf80,0xbf353f35,0x3f353f35,0xbe48bf7b,0xbec43f6d,0x3f55bf0e
.long 0xbf80,0xbec43f6d,0x3f35bf35,0xbf6d3ec4,0xbf353f35,0x3f55bf0e,0xbf6d3ec4,0x3f7bbe48
.long 0x3f800000,0x3f800000,0x3f800000,0x3f800000,0xbf800000,0xbf7b3e48,0xbf6d3ec4,0xbf553f0e
.long 0x3f800000,0x3f6dbec4,0x3f35bf35,0x3ec4bf6d,0xbf800000,0xbf553f0e,0xbec43f6d,0x3e483f7b
.long 0x3f800000,0x3f35bf35,0xbf80,0xbf35bf35,0xbf800000,0xbf0e3f55,0x3ec43f6d,0x3f7b3e48
.long 0x3f800000,0x3ec4bf6d,0xbf35bf35,0xbf6d3ec4,0xbf800000,0xbe483f7b,0x3f6d3ec4,0x3f0ebf55
.long 0x3f800000,0xbf80,0xbf800000,0x3f80,0xbf800000,0x3e483f7b,0x3f6dbec4,0xbf0ebf55
.long 0x3f800000,0xbec4bf6d,0xbf353f35,0x3f6d3ec4,0xbf800000,0x3f0e3f55,0x3ec4bf6d,0xbf7b3e48
.long 0x3f800000,0xbf35bf35,0x3f80,0x3f35bf35,0xbf800000,0x3f553f0e,0xbec4bf6d,0xbe483f7b
.long 0x3f800000,0xbf6dbec4,0x3f353f35,0xbec4bf6d,0xbf800000,0x3f7b3e48,0xbf6dbec4,0x3f553f0e
.long 0x3f800000,0x3f800000,0x3f800000,0x3f800000,0xbf353f35,0xbf0e3f55,0xbec43f6d,0xbe483f7b
.long 0xbf80,0xbec4bf6d,0xbf35bf35,0xbf6dbec4,0x3f353f35,0x3f7b3e48,0x3f6dbec4,0x3f0ebf55
.long 0xbf800000,0xbf353f35,0x3f80,0x3f353f35,0x3f35bf35,0xbe48bf7b,0xbf6dbec4,0xbf553f0e
.long 0x3f80,0x3f6d3ec4,0x3f35bf35,0xbec4bf6d,0xbf35bf35,0xbf553f0e,0x3ec43f6d,0x3f7bbe48
.long 0x3f800000,0xbf80,0xbf800000,0x3f80,0xbf353f35,0x3f553f0e,0x3ec4bf6d,0xbf7bbe48
.long 0xbf80,0xbf6d3ec4,0x3f353f35,0x3ec4bf6d,0x3f353f35,0x3e48bf7b,0xbf6d3ec4,0x3f553f0e
.long 0xbf800000,0x3f353f35,0xbf80,0xbf353f35,0x3f35bf35,0xbf7b3e48,0x3f6d3ec4,0xbf0ebf55
.long 0x3f80,0x3ec4bf6d,0xbf353f35,0x3f6dbec4,0xbf35bf35,0x3f0e3f55,0xbec4bf6d,0x3e483f7b
.long 0x3f800000,0x3f800000,0x3f800000,0x3f800000,0x3f80,0x3e483f7b,0x3ec43f6d,0x3f0e3f55
.long 0xbf800000,0xbf6d3ec4,0xbf353f35,0xbec43f6d,0xbf80,0xbf0ebf55,0xbf6dbec4,0xbf7b3e48
.long 0x3f800000,0x3f35bf35,0xbf80,0xbf35bf35,0x3f80,0x3f553f0e,0x3f6dbec4,0x3e48bf7b
.long 0xbf800000,0xbec43f6d,0x3f353f35,0x3f6dbec4,0xbf80,0xbf7bbe48,0xbec43f6d,0x3f553f0e
.long 0x3f800000,0xbf80,0xbf800000,0x3f80,0x3f80,0x3f7bbe48,0xbec4bf6d,0xbf553f0e
.long 0xbf800000,0x3ec43f6d,0x3f35bf35,0xbf6dbec4,0xbf80,0xbf553f0e,0x3f6d3ec4,0xbe48bf7b
.long 0x3f800000,0xbf35bf35,0x3f80,0x3f35bf35,0x3f80,0x3f0ebf55,0xbf6d3ec4,0x3f7b3e48
.long 0xbf800000,0x3f6d3ec4,0xbf35bf35,0x3ec43f6d,0xbf80,0xbe483f7b,0x3ec4bf6d,0xbf0e3f55
.long 0x3f800000,0x3f800000,0x3f800000,0x3f800000,0x3f353f35,0x3f553f0e,0x3f6d3ec4,0x3f7b3e48
.long 0x3f80,0x3ec43f6d,0x3f353f35,0x3f6d3ec4,0xbf353f35,0xbe483f7b,0x3ec43f6d,0x3f553f0e
.long 0xbf800000,0xbf353f35,0x3f80,0x3f353f35,0xbf35bf35,0xbf7b3e48,0xbec43f6d,0x3f0e3f55
.long 0xbf80,0xbf6dbec4,0xbf353f35,0x3ec43f6d,0x3f35bf35,0xbf0ebf55,0xbf6d3ec4,0x3e483f7b
.long 0x3f800000,0xbf80,0xbf800000,0x3f80,0x3f353f35,0x3f0ebf55,0xbf6dbec4,0xbe483f7b
.long 0x3f80,0x3f6dbec4,0xbf35bf35,0xbec43f6d,0xbf353f35,0x3f7b3e48,0xbec4bf6d,0xbf0e3f55
.long 0xbf800000,0x3f353f35,0xbf80,0xbf353f35,0xbf35bf35,0x3e483f7b,0x3ec4bf6d,0xbf553f0e
.long 0xbf80,0xbec43f6d,0x3f35bf35,0xbf6d3ec4,0x3f35bf35,0xbf553f0e,0x3f6dbec4,0xbf7b3e48
.long 0x3f80,0xbf80,0x3f80,0xbf80,0x3f80,0xbe48bf7b,0x3ec43f6d,0xbf0ebf55
.long 0x3f80,0xbec4bf6d,0x3f353f35,0xbf6dbec4,0x3f80,0xbf0ebf55,0x3f6d3ec4,0xbf7b3e48
.long 0x3f80,0xbf35bf35,0x3f800000,0xbf353f35,0x3f80,0xbf55bf0e,0x3f6dbec4,0xbe483f7b
.long 0x3f80,0xbf6dbec4,0x3f35bf35,0x3ec43f6d,0x3f80,0xbf7bbe48,0x3ec4bf6d,0x3f553f0e
.long 0x3f80,0xbf800000,0xbf80,0x3f800000,0x3f80,0xbf7b3e48,0xbec4bf6d,0x3f55bf0e
.long 0x3f80,0xbf6d3ec4,0xbf35bf35,0x3ec4bf6d,0x3f80,0xbf553f0e,0xbf6dbec4,0xbe48bf7b
.long 0x3f80,0xbf353f35,0xbf800000,0xbf35bf35,0x3f80,0xbf0e3f55,0xbf6d3ec4,0xbf7bbe48
.long 0x3f80,0xbec43f6d,0xbf353f35,0xbf6d3ec4,0x3f80,0xbe483f7b,0xbec43f6d,0xbf0e3f55
.long 0x3f80,0xbf80,0x3f80,0xbf80,0x3f353f35,0xbf55bf0e,0x3f6d3ec4,0xbf7bbe48
.long 0x3f800000,0xbf6d3ec4,0x3f35bf35,0xbec43f6d,0x3f35bf35,0xbe483f7b,0xbec4bf6d,0x3f553f0e
.long 0xbf80,0x3f353f35,0xbf800000,0x3f35bf35,0xbf35bf35,0x3f7bbe48,0xbec43f6d,0xbf0ebf55
.long 0xbf800000,0x3ec4bf6d,0x3f353f35,0xbf6d3ec4,0xbf353f35,0xbf0ebf55,0x3f6dbec4,0x3e483f7b
.long 0x3f80,0xbf800000,0xbf80,0x3f800000,0x3f353f35,0xbf0e3f55,0xbf6dbec4,0x3e48bf7b
.long 0x3f800000,0x3ec43f6d,0xbf353f35,0xbf6dbec4,0x3f35bf35,0x3f7b3e48,0x3ec43f6d,0xbf0e3f55
.long 0xbf80,0x3f35bf35,0x3f800000,0x3f353f35,0xbf35bf35,0xbe48bf7b,0x3ec4bf6d,0x3f55bf0e
.long 0xbf800000,0xbf6dbec4,0xbf35bf35,0xbec4bf6d,0xbf353f35,0xbf553f0e,0xbf6d3ec4,0xbf7b3e48
.long 0x3f80,0xbf80,0x3f80,0xbf80,0x3f800000,0xbf7b3e48,0x3f6dbec4,0xbf553f0e
.long 0xbf80,0x3ec43f6d,0xbf35bf35,0x3f6d3ec4,0xbf800000,0x3f55bf0e,0xbec43f6d,0xbe48bf7b
.long 0x3f80,0xbf35bf35,0x3f800000,0xbf353f35,0x3f800000,0xbf0e3f55,0xbec4bf6d,0x3f7b3e48
.long 0xbf80,0x3f6d3ec4,0xbf353f35,0xbec4bf6d,0xbf800000,0x3e48bf7b,0x3f6d3ec4,0xbf0e3f55
.long 0x3f80,0xbf800000,0xbf80,0x3f800000,0x3f800000,0x3e483f7b,0xbf6d3ec4,0xbf0ebf55
.long 0xbf80,0x3f6dbec4,0x3f353f35,0xbec43f6d,0xbf800000,0xbf0ebf55,0x3ec4bf6d,0x3f7bbe48
.long 0x3f80,0xbf353f35,0xbf800000,0xbf35bf35,0x3f800000,0x3f553f0e,0x3ec43f6d,0xbe483f7b
.long 0xbf80,0x3ec4bf6d,0x3f35bf35,0x3f6dbec4,0xbf800000,0xbf7bbe48,0xbf6dbec4,0xbf55bf0e
.long 0x3f80,0xbf80,0x3f80,0xbf80,0x3f35bf35,0xbf0e3f55,0x3ec4bf6d,0xbe483f7b
.long 0xbf800000,0x3f6dbec4,0xbf353f35,0x3ec4bf6d,0x3f353f35,0xbf7bbe48,0x3f6dbec4,0xbf0e3f55
.long 0xbf80,0x3f353f35,0xbf800000,0x3f35bf35,0xbf353f35,0xbe48bf7b,0x3f6d3ec4,0xbf553f0e
.long 0x3f800000,0xbec43f6d,0xbf35bf35,0x3f6dbec4,0xbf35bf35,0x3f55bf0e,0x3ec43f6d,0xbf7b3e48
.long 0x3f80,0xbf800000,0xbf80,0x3f800000,0x3f35bf35,0x3f553f0e,0xbec43f6d,0xbf7bbe48
.long 0xbf800000,0xbec4bf6d,0x3f35bf35,0x3f6d3ec4,0x3f353f35,0xbe483f7b,0xbf6d3ec4,0xbf55bf0e
.long 0xbf80,0x3f35bf35,0x3f800000,0x3f353f35,0xbf353f35,0xbf7b3e48,0xbf6dbec4,0xbf0ebf55
.long 0x3f800000,0x3f6d3ec4,0x3f353f35,0x3ec43f6d,0xbf35bf35,0xbf0ebf55,0xbec4bf6d,0xbe48bf7b
.long 0x3f80,0xbf80,0x3f80,0xbf80,0xbf80,0x3e483f7b,0xbec4bf6d,0x3f0e3f55
.long 0x3f80,0xbec4bf6d,0x3f353f35,0xbf6dbec4,0xbf80,0x3f0e3f55,0xbf6dbec4,0x3f7bbe48
.long 0x3f80,0xbf35bf35,0x3f800000,0xbf353f35,0xbf80,0x3f553f0e,0xbf6d3ec4,0x3e48bf7b
.long 0x3f80,0xbf6dbec4,0x3f35bf35,0x3ec43f6d,0xbf80,0x3f7b3e48,0xbec43f6d,0xbf55bf0e
.long 0x3f80,0xbf800000,0xbf80,0x3f800000,0xbf80,0x3f7bbe48,0x3ec43f6d,0xbf553f0e
.long 0x3f80,0xbf6d3ec4,0xbf35bf35,0x3ec4bf6d,0xbf80,0x3f55bf0e,0x3f6d3ec4,0x3e483f7b
.long 0x3f80,0xbf353f35,0xbf800000,0xbf35bf35,0xbf80,0x3f0ebf55,0x3f6dbec4,0x3f7b3e48
.long 0x3f80,0xbec43f6d,0xbf353f35,0xbf6d3ec4,0xbf80,0x3e48bf7b,0x3ec4bf6d,0x3f0ebf55
.long 0x3f80,0xbf80,0x3f80,0xbf80,0xbf35bf35,0x3f553f0e,0xbf6dbec4,0x3f7b3e48
.long 0x3f800000,0xbf6d3ec4,0x3f35bf35,0xbec43f6d,0xbf353f35,0x3e48bf7b,0x3ec43f6d,0xbf55bf0e
.long 0xbf80,0x3f353f35,0xbf800000,0x3f35bf35,0x3f353f35,0xbf7b3e48,0x3ec4bf6d,0x3f0e3f55
.long 0xbf800000,0x3ec4bf6d,0x3f353f35,0xbf6d3ec4,0x3f35bf35,0x3f0e3f55,0xbf6d3ec4,0xbe48bf7b
.long 0x3f80,0xbf800000,0xbf80,0x3f800000,0xbf35bf35,0x3f0ebf55,0x3f6d3ec4,0xbe483f7b
.long 0x3f800000,0x3ec43f6d,0xbf353f35,0xbf6dbec4,0xbf353f35,0xbf7bbe48,0xbec4bf6d,0x3f0ebf55
.long 0xbf80,0x3f35bf35,0x3f800000,0x3f353f35,0x3f353f35,0x3e483f7b,0xbec43f6d,0xbf553f0e
.long 0xbf800000,0xbf6dbec4,0xbf35bf35,0xbec4bf6d,0x3f35bf35,0x3f55bf0e,0x3f6dbec4,0x3f7bbe48
.long 0x3f80,0xbf80,0x3f80,0xbf80,0xbf800000,0x3f7bbe48,0xbf6d3ec4,0x3f55bf0e
.long 0xbf80,0x3ec43f6d,0xbf35bf35,0x3f6d3ec4,0x3f800000,0xbf553f0e,0x3ec4bf6d,0x3e483f7b
.long 0x3f80,0xbf35bf35,0x3f800000,0xbf353f35,0xbf800000,0x3f0ebf55,0x3ec43f6d,0xbf7bbe48
.long 0xbf80,0x3f6d3ec4,0xbf353f35,0xbec4bf6d,0x3f800000,0xbe483f7b,0xbf6dbec4,0x3f0ebf55
.long 0x3f80,0xbf800000,0xbf80,0x3f800000,0xbf800000,0xbe48bf7b,0x3f6dbec4,0x3f0e3f55
.long 0xbf80,0x3f6dbec4,0x3f353f35,0xbec43f6d,0x3f800000,0x3f0e3f55,0xbec43f6d,0xbf7b3e48
.long 0x3f80,0xbf353f35,0xbf800000,0xbf35bf35,0xbf800000,0xbf55bf0e,0xbec4bf6d,0x3e48bf7b
.long 0xbf80,0x3ec4bf6d,0x3f35bf35,0x3f6dbec4,0x3f800000,0x3f7b3e48,0x3f6d3ec4,0x3f553f0e
.long 0x3f80,0xbf80,0x3f80,0xbf80,0xbf353f35,0x3f0ebf55,0xbec43f6d,0x3e48bf7b
.long 0xbf800000,0x3f6dbec4,0xbf353f35,0x3ec4bf6d,0xbf35bf35,0x3f7b3e48,0xbf6d3ec4,0x3f0ebf55
.long 0xbf80,0x3f353f35,0xbf800000,0x3f35bf35,0x3f35bf35,0x3e483f7b,0xbf6dbec4,0x3f55bf0e
.long 0x3f800000,0xbec43f6d,0xbf35bf35,0x3f6dbec4,0x3f353f35,0xbf553f0e,0xbec4bf6d,0x3f7bbe48
.long 0x3f80,0xbf800000,0xbf80,0x3f800000,0xbf353f35,0xbf55bf0e,0x3ec4bf6d,0x3f7b3e48
.long 0xbf800000,0xbec4bf6d,0x3f35bf35,0x3f6d3ec4,0xbf35bf35,0x3e48bf7b,0x3f6dbec4,0x3f553f0e
.long 0xbf80,0x3f35bf35,0x3f800000,0x3f353f35,0x3f35bf35,0x3f7bbe48,0x3f6d3ec4,0x3f0e3f55
.long 0x3f800000,0x3f6d3ec4,0x3f353f35,0x3ec43f6d,0x3f353f35,0x3f0e3f55,0x3ec43f6d,0x3e483f7b
.long 0x3f800000,0xbf800000,0x3f800000,0xbf800000,0x3f800000,0xbf7b3e48,0x3f6dbec4,0xbf553f0e
.long 0x3f800000,0xbf6d3ec4,0x3f35bf35,0xbec43f6d,0x3f800000,0xbf553f0e,0x3ec4bf6d,0x3e483f7b
.long 0x3f800000,0xbf353f35,0xbf80,0x3f353f35,0x3f800000,0xbf0e3f55,0xbec4bf6d,0x3f7b3e48
.long 0x3f800000,0xbec43f6d,0xbf35bf35,0x3f6dbec4,0x3f800000,0xbe483f7b,0xbf6dbec4,0x3f0ebf55
.long 0x3f800000,0x3f80,0xbf800000,0xbf80,0x3f800000,0x3e483f7b,0xbf6d3ec4,0xbf0ebf55
.long 0x3f800000,0x3ec43f6d,0xbf353f35,0xbf6dbec4,0x3f800000,0x3f0e3f55,0xbec43f6d,0xbf7b3e48
.long 0x3f800000,0x3f353f35,0x3f80,0xbf353f35,0x3f800000,0x3f553f0e,0x3ec43f6d,0xbe483f7b
.long 0x3f800000,0x3f6d3ec4,0x3f353f35,0x3ec43f6d,0x3f800000,0x3f7b3e48,0x3f6d3ec4,0x3f553f0e
.long 0x3f800000,0xbf800000,0x3f800000,0xbf800000,0x3f35bf35,0xbf0e3f55,0x3ec4bf6d,0xbe483f7b
.long 0xbf80,0x3ec43f6d,0xbf35bf35,0x3f6d3ec4,0xbf35bf35,0x3f7b3e48,0xbf6d3ec4,0x3f0ebf55
.long 0xbf800000,0x3f35bf35,0x3f80,0xbf35bf35,0xbf353f35,0xbe48bf7b,0x3f6d3ec4,0xbf553f0e
.long 0x3f80,0xbf6dbec4,0x3f35bf35,0x3ec43f6d,0x3f353f35,0xbf553f0e,0xbec4bf6d,0x3f7bbe48
.long 0x3f800000,0x3f80,0xbf800000,0xbf80,0x3f35bf35,0x3f553f0e,0xbec43f6d,0xbf7bbe48
.long 0xbf80,0x3f6dbec4,0x3f353f35,0xbec43f6d,0xbf35bf35,0x3e48bf7b,0x3f6dbec4,0x3f553f0e
.long 0xbf800000,0xbf35bf35,0xbf80,0x3f35bf35,0xbf353f35,0xbf7b3e48,0xbf6dbec4,0xbf0ebf55
.long 0x3f80,0xbec43f6d,0xbf353f35,0xbf6d3ec4,0x3f353f35,0x3f0e3f55,0x3ec43f6d,0x3e483f7b
.long 0x3f800000,0xbf800000,0x3f800000,0xbf800000,0xbf80,0x3e483f7b,0xbec4bf6d,0x3f0e3f55
.long 0xbf800000,0x3f6dbec4,0xbf353f35,0x3ec4bf6d,0x3f80,0xbf0ebf55,0x3f6d3ec4,0xbf7b3e48
.long 0x3f800000,0xbf353f35,0xbf80,0x3f353f35,0xbf80,0x3f553f0e,0xbf6d3ec4,0x3e48bf7b
.long 0xbf800000,0x3ec4bf6d,0x3f353f35,0xbf6d3ec4,0x3f80,0xbf7bbe48,0x3ec4bf6d,0x3f553f0e
.long 0x3f800000,0x3f80,0xbf800000,0xbf80,0xbf80,0x3f7bbe48,0x3ec43f6d,0xbf553f0e
.long 0xbf800000,0xbec4bf6d,0x3f35bf35,0x3f6d3ec4,0x3f80,0xbf553f0e,0xbf6dbec4,0xbe48bf7b
.long 0x3f800000,0x3f353f35,0x3f80,0xbf353f35,0xbf80,0x3f0ebf55,0x3f6dbec4,0x3f7b3e48
.long 0xbf800000,0xbf6dbec4,0xbf35bf35,0xbec4bf6d,0x3f80,0xbe483f7b,0xbec43f6d,0xbf0e3f55
.long 0x3f800000,0xbf800000,0x3f800000,0xbf800000,0xbf35bf35,0x3f553f0e,0xbf6dbec4,0x3f7b3e48
.long 0x3f80,0xbec4bf6d,0x3f353f35,0xbf6dbec4,0x3f35bf35,0xbe483f7b,0xbec4bf6d,0x3f553f0e
.long 0xbf800000,0x3f35bf35,0x3f80,0xbf35bf35,0x3f353f35,0xbf7b3e48,0x3ec4bf6d,0x3f0e3f55
.long 0xbf80,0x3f6d3ec4,0xbf353f35,0xbec4bf6d,0xbf353f35,0xbf0ebf55,0x3f6dbec4,0x3e483f7b
.long 0x3f800000,0x3f80,0xbf800000,0xbf80,0xbf35bf35,0x3f0ebf55,0x3f6d3ec4,0xbe483f7b
.long 0x3f80,0xbf6d3ec4,0xbf35bf35,0x3ec4bf6d,0x3f35bf35,0x3f7b3e48,0x3ec43f6d,0xbf0e3f55
.long 0xbf800000,0xbf35bf35,0xbf80,0x3f35bf35,0x3f353f35,0x3e483f7b,0xbec43f6d,0xbf553f0e
.long 0xbf80,0x3ec4bf6d,0x3f35bf35,0x3f6dbec4,0xbf353f35,0xbf553f0e,0xbf6d3ec4,0xbf7b3e48
.long 0x3f800000,0xbf800000,0x3f800000,0xbf800000,0xbf800000,0x3f7bbe48,0xbf6d3ec4,0x3f55bf0e
.long 0x3f800000,0xbf6d3ec4,0x3f35bf35,0xbec43f6d,0xbf800000,0x3f55bf0e,0xbec43f6d,0xbe48bf7b
.long 0x3f800000,0xbf353f35,0xbf80,0x3f353f35,0xbf800000,0x3f0ebf55,0x3ec43f6d,0xbf7bbe48
.long 0x3f800000,0xbec43f6d,0xbf35bf35,0x3f6dbec4,0xbf800000,0x3e48bf7b,0x3f6d3ec4,0xbf0e3f55
.long 0x3f800000,0x3f80,0xbf800000,0xbf80,0xbf800000,0xbe48bf7b,0x3f6dbec4,0x3f0e3f55
.long 0x3f800000,0x3ec43f6d,0xbf353f35,0xbf6dbec4,0xbf800000,0xbf0ebf55,0x3ec4bf6d,0x3f7bbe48
.long 0x3f800000,0x3f353f35,0x3f80,0xbf353f35,0xbf800000,0xbf55bf0e,0xbec4bf6d,0x3e48bf7b
.long 0x3f800000,0x3f6d3ec4,0x3f353f35,0x3ec43f6d,0xbf800000,0xbf7bbe48,0xbf6dbec4,0xbf55bf0e
.long 0x3f800000,0xbf800000,0x3f800000,0xbf800000,0xbf353f35,0x3f0ebf55,0xbec43f6d,0x3e48bf7b
.long 0xbf80,0x3ec43f6d,0xbf35bf35,0x3f6d3ec4,0x3f353f35,0xbf7bbe48,0x3f6dbec4,0xbf0e3f55
.long 0xbf800000,0x3f35bf35,0x3f80,0xbf35bf35,0x3f35bf35,0x3e483f7b,0xbf6dbec4,0x3f55bf0e
.long 0x3f80,0xbf6dbec4,0x3f35bf35,0x3ec43f6d,0xbf35bf35,0x3f55bf0e,0x3ec43f6d,0xbf7b3e48
.long 0x3f800000,0x3f80,0xbf800000,0xbf80,0xbf353f35,0xbf55bf0e,0x3ec4bf6d,0x3f7b3e48
.long 0xbf80,0x3f6dbec4,0x3f353f35,0xbec43f6d,0x3f353f35,0xbe483f7b,0xbf6d3ec4,0xbf55bf0e
.long 0xbf800000,0xbf35bf35,0xbf80,0x3f35bf35,0x3f35bf35,0x3f7bbe48,0x3f6d3ec4,0x3f0e3f55
.long 0x3f80,0xbec43f6d,0xbf353f35,0xbf6d3ec4,0xbf35bf35,0xbf0ebf55,0xbec4bf6d,0xbe48bf7b
.long 0x3f800000,0xbf800000,0x3f800000,0xbf800000,0x3f80,0xbe48bf7b,0x3ec43f6d,0xbf0ebf55
.long 0xbf800000,0x3f6dbec4,0xbf353f35,0x3ec4bf6d,0xbf80,0x3f0e3f55,0xbf6dbec4,0x3f7bbe48
.long 0x3f800000,0xbf353f35,0xbf80,0x3f353f35,0x3f80,0xbf55bf0e,0x3f6dbec4,0xbe483f7b
.long 0xbf800000,0x3ec4bf6d,0x3f353f35,0xbf6d3ec4,0xbf80,0x3f7b3e48,0xbec43f6d,0xbf55bf0e
.long 0x3f800000,0x3f80,0xbf800000,0xbf80,0x3f80,0xbf7b3e48,0xbec4bf6d,0x3f55bf0e
.long 0xbf800000,0xbec4bf6d,0x3f35bf35,0x3f6d3ec4,0xbf80,0x3f55bf0e,0x3f6d3ec4,0x3e483f7b
.long 0x3f800000,0x3f353f35,0x3f80,0xbf353f35,0x3f80,0xbf0e3f55,0xbf6d3ec4,0xbf7bbe48
.long 0xbf800000,0xbf6dbec4,0xbf35bf35,0xbec4bf6d,0xbf80,0x3e48bf7b,0x3ec4bf6d,0x3f0ebf55
.long 0x3f800000,0xbf800000,0x3f800000,0xbf800000,0x3f353f35,0xbf55bf0e,0x3f6d3ec4,0xbf7bbe48
.long 0x3f80,0xbec4bf6d,0x3f353f35,0xbf6dbec4,0xbf353f35,0x3e48bf7b,0x3ec43f6d,0xbf55bf0e
.long 0xbf800000,0x3f35bf35,0x3f80,0xbf35bf35,0xbf35bf35,0x3f7bbe48,0xbec43f6d,0xbf0ebf55
.long 0xbf80,0x3f6d3ec4,0xbf353f35,0xbec4bf6d,0x3f35bf35,0x3f0e3f55,0xbf6d3ec4,0xbe48bf7b
.long 0x3f800000,0x3f80,0xbf800000,0xbf80,0x3f353f35,0xbf0e3f55,0xbf6dbec4,0x3e48bf7b
.long 0x3f80,0xbf6d3ec4,0xbf35bf35,0x3ec4bf6d,0xbf353f35,0xbf7bbe48,0xbec4bf6d,0x3f0ebf55
.long 0xbf800000,0xbf35bf35,0xbf80,0x3f35bf35,0xbf35bf35,0xbe48bf7b,0x3ec4bf6d,0x3f55bf0e
.long 0xbf80,0x3ec4bf6d,0x3f35bf35,0x3f6dbec4,0x3f35bf35,0x3f55bf0e,0x3f6dbec4,0x3f7bbe48
.long 0x3f800000,0x3f800000,0x3f800000,0x3f800000,0x3f800000,0x3f7ffb11,0x3f7fec43,0x3f7fd397
.long 0x3f800000,0x3f7fec43,0x3f7fb10f,0x3f7f4e6d,0x3f800000,0x3f7fd397,0x3f7f4e6d,0x3f7e70b0
.long 0x3f800000,0x3f7fb10f,0x3f7ec46d,0x3f7d3aac,0x3f800000,0x3f7f84ab,0x3f7e1324,0x3f7baccd
.long 0x3f800000,0x3f7f4e6d,0x3f7d3aac,0x3f79c79d,0x3f800000,0x3f7f0e58,0x3f7c3b28,0x3f778bc5
.long 0x3f800000,0x3f7ec46d,0x3f7b14be,0x3f74fa0b,0x3f800000,0x3f7e70b0,0x3f79c79d,0x3f721352
.long 0x3f800000,0x3f7e1324,0x3f7853f8,0x3f6ed89e,0x3f800000,0x3f7dabcc,0x3f76ba07,0x3f6b4b0c
.long 0x3f800000,0x3f7d3aac,0x3f74fa0b,0x3f676bd8,0x3f800000,0x3f7cbfc9,0x3f731447,0x3f633c5a
.long 0x3f800000,0x3f7c3b28,0x3f710908,0x3f5ebe05,0x3f800000,0x3f7baccd,0x3f6ed89e,0x3f59f26a
.long 0x3f800000,0x3f800000,0x3f800000,0x3f800000,0x3f7fb10f,0x3f7f84ab,0x3f7f4e6d,0x3f7f0e58
.long 0x3f7ec46d,0x3f7e1324,0x3f7d3aac,0x3f7c3b28,0x3f7d3aac,0x3f7baccd,0x3f79c79d,0x3f778bc5
.long 0x3f7b14be,0x3f7853f8,0x3f74fa0b,0x3f710908,0x3f7853f8,0x3f740bdd,0x3f6ed89e,0x3f68bf3c
.long 0x3f74fa0b,0x3f6ed89e,0x3f676bd8,0x3f5ebe05,0x3f710908,0x3f68bf3c,0x3f5ebe05,0x3f531849
.long 0x3f6c835e,0x3f61c598,0x3f54db31,0x3f45e403,0x3f676bd8,0x3f59f26a,0x3f49d112,0x3f373a23
.long 0x3f61c598,0x3f514d3d,0x3f3daef9,0x3f273656,0x3f5b941a,0x3f47de65,0x3f3085bb,0x3f15f6d9
.long 0x3f54db31,0x3f3daef9,0x3f226799,0x3f039c3d,0x3f4d9f02,0x3f32c8c9,0x3f13682a,0x3ee0924f
.long 0x3f45e403,0x3f273656,0x3f039c3d,0x3eb8442a,0x3f3daef9,0x3f1b02c6,0x3ee63375,0x3e8e9a22
.long 0x3f800000,0x3f800000,0x3f800000,0x3f800000,0x3f7ec46d,0x3f7e70b0,0x3f7e1324,0x3f7dabcc
.long 0x3f7b14be,0x3f79c79d,0x3f7853f8,0x3f76ba07,0x3f74fa0b,0x3f721352,0x3f6ed89e,0x3f6b4b0c
.long 0x3f6c835e,0x3f676bd8,0x3f61c598,0x3f5b941a,0x3f61c598,0x3f59f26a,0x3f514d3d,0x3f47de65
.long 0x3f54db31,0x3f49d112,0x3f3daef9,0x3f3085bb,0x3f45e403,0x3f373a23,0x3f273656,0x3f15f6d9
.long 0x3f3504f3,0x3f226799,0x3f0e39da,0x3ef15aea,0x3f226799,0x3f0b9a6b,0x3ee63375,0x3eb263ef
.long 0x3f0e39da,0x3ee63375,0x3eac7cd4,0x3e605c13,0x3ef15aea,0x3eb263ef,0x3e605c13,0x3dafb680
.long 0x3ec3ef15,0x3e78cfcc,0x3dc8bd36,0xbd48fb30,0x3e94a031,0x3e09cf86,0xbcc90ab0,0xbe3b6ecf
.long 0x3e47c5c2,0x3cc90ab0,0xbe164083,0xbea09ae5,0x3dc8bd36,0xbdafb680,0xbe888e93,0xbee0924f
.long 0x3f800000,0x3f800000,0x3f800000,0x3f800000,0x3f7d3aac,0x3f7cbfc9,0x3f7c3b28,0x3f7baccd
.long 0x3f74fa0b,0x3f731447,0x3f710908,0x3f6ed89e,0x3f676bd8,0x3f633c5a,0x3f5ebe05,0x3f59f26a
.long 0x3f54db31,0x3f4d9f02,0x3f45e403,0x3f3daef9,0x3f3daef9,0x3f32c8c9,0x3f273656,0x3f1b02c6
.long 0x3f226799,0x3f13682a,0x3f039c3d,0x3ee63375,0x3f039c3d,0x3ee0924f,0x3eb8442a,0x3e8e9a22
.long 0x3ec3ef15,0x3e94a031,0x3e47c5c2,0x3dc8bd36,0x3e78cfcc,0x3e09cf86,0x3cc90ab0,0xbdafb680
.long 0x3dc8bd36,0xbcc90ab0,0xbe164083,0xbe888e93,0xbd48fb30,0xbe3b6ecf,0xbea09ae5,0xbee0924f
.long 0xbe47c5c2,0xbeac7cd4,0xbef15aea,0xbf187fc0,0xbeac7cd4,0xbef6e0cb,0xbf1d7fd1,0xbf3b8f3b
.long 0xbef15aea,0xbf1d7fd1,0xbf3daef9,0xbf584853,0xbf187fc0,0xbf3b8f3b,0xbf584853,0xbf6db293
.long 0x3f800000,0x3f800000,0x3f800000,0x3f800000,0x3f7b14be,0x3f7a7302,0x3f79c79d,0x3f791298
.long 0x3f6c835e,0x3f6a09a7,0x3f676bd8,0x3f64aa59,0x3f54db31,0x3f4f7a1f,0x3f49d112,0x3f43e200
.long 0x3f3504f3,0x3f2beb4a,0x3f226799,0x3f187fc0,0x3f0e39da,0x3f00e7e4,0x3ee63375,0x3ec9b953
.long 0x3ec3ef15,0x3ea09ae5,0x3e78cfcc,0x3e2f10a2,0x3e47c5c2,0x3de1bc2e,0x3cc90ab0,0xbd7b2b74
.long 0x0,0xbdc8bd36,0xbe47c5c2,0xbe94a031,0xbe47c5c2,0xbe9aa086,0xbecf7bca,0xbf00e7e4
.long 0xbec3ef15,0xbefc5d27,0xbf187fc0,0xbf3085bb,0xbf0e39da,0xbf299415,0xbf41d870,0xbf5695e5
.long 0xbf3504f3,0xbf4d9f02,0xbf61c598,0xbf710908,0xbf54db31,0xbf68bf3c,0xbf76ba07,0xbf7e70b0
.long 0xbf6c835e,0xbf79c79d,0xbf7fb10f,0xbf7e1324,0xbf7b14be,0xbf7ffb11,0xbf7c3b28,0xbf6ff573
.long 0x3f800000,0x3f800000,0x3f800000,0x3f800000,0x3f7853f8,0x3f778bc5,0x3f76ba07,0x3f75dec6
.long 0x3f61c598,0x3f5ebe05,0x3f5b941a,0x3f584853,0x3f3daef9,0x3f373a23,0x3f3085bb,0x3f299415
.long 0x3f0e39da,0x3f039c3d,0x3ef15aea,0x3edae880,0x3eac7cd4,0x3e8e9a22,0x3e605c13,0x3e22abb6
.long 0x3dc8bd36,0x3cc90ab0,0xbd48fb30,0xbdfab273,0xbe164083,0xbe6c9a7f,0xbea09ae5,0xbec9b953
.long 0xbec3ef15,0xbef15aea,0xbf0e39da,0xbf226799,0xbf187fc0,0xbf2e3bde,0xbf41d870,0xbf531849
.long 0xbf45e403,0xbf584853,0xbf676bd8,0xbf731447,0xbf676bd8,0xbf740bdd,0xbf7c3b28,0xbf7fd397
.long 0xbf7b14be,0xbf7fb10f,0xbf7ec46d,0xbf7853f8,0xbf7fb10f,0xbf7a7302,0xbf6ed89e,0xbf5d2d53
.long 0xbf74fa0b,0xbf64aa59,0xbf4d9f02,0xbf3085bb,0xbf5b941a,0xbf3fc767,0xbf1d7fd1,0xbeebcbbb
.long 0x3f800000,0x3f800000,0x3f800000,0x3f800000,0x3f74fa0b,0x3f740bdd,0x3f731447,0x3f721352
.long 0x3f54db31,0x3f514d3d,0x3f4d9f02,0x3f49d112,0x3f226799,0x3f1b02c6,0x3f13682a,0x3f0b9a6b
.long 0x3ec3ef15,0x3eac7cd4,0x3e94a031,0x3e78cfcc,0x3dc8bd36,0x3d16c32c,0xbcc90ab0,0xbdafb680
.long 0xbe47c5c2,0xbe888e93,0xbeac7cd4,0xbecf7bca,0xbef15aea,0xbf0b9a6b,0xbf1d7fd1,0xbf2e3bde
.long 0xbf3504f3,0xbf45e403,0xbf54db31,0xbf61c598,0xbf61c598,0xbf6db293,0xbf76ba07,0xbf7cbfc9
.long 0xbf7b14be,0xbf7f4e6d,0xbf7fb10f,0xbf7c3b28,0xbf7ec46d,0xbf791298,0xbf6ed89e,0xbf604621
.long 0xbf6c835e,0xbf5b941a,0xbf45e403,0xbf2beb4a,0xbf45e403,0xbf299415,0xbf08f59b,0xbec9b953
.long 0xbf0e39da,0xbecf7bca,0xbe78cfcc,0xbd96a905,0xbe94a031,0xbde1bc2e,0x3d96a905,0x3e827dc0
.long 0x3f800000,0x3f800000,0x3f800000,0x3f800000,0x3f710908,0x3f6ff573,0x3f6ed89e,0x3f6db293
.long 0x3f45e403,0x3f41d870,0x3f3daef9,0x3f396842,0x3f039c3d,0x3ef6e0cb,0x3ee63375,0x3ed53641
.long 0x3e47c5c2,0x3e164083,0x3dc8bd36,0x3d48fb30,0xbe164083,0xbe541501,0xbe888e93,0xbea68f12
.long 0xbef15aea,0xbf08f59b,0xbf187fc0,0xbf273656,0xbf3daef9,0xbf4bbbf8,0xbf584853,0xbf633c5a
.long 0xbf6c835e,0xbf74fa0b,0xbf7b14be,0xbf7ec46d,0xbf7fb10f,0xbf7f84ab,0xbf7c3b28,0xbf75dec6
.long 0xbf74fa0b,0xbf6a09a7,0xbf5b941a,0xbf49d112,0xbf4d9f02,0xbf373a23,0xbf1d7fd1,0xbf00e7e4
.long 0xbf0e39da,0xbedae880,0xbe94a031,0xbe164083,0xbe78cfcc,0xbdafb680,0x3d96a905,0x3e6c9a7f
.long 0x3dc8bd36,0x3e888e93,0x3edae880,0x3f13682a,0x3edae880,0x3f15f6d9,0x3f396842,0x3f5695e5
.long 0x0,0x0,0x0,0x0,0x0,0xbc490e90,0xbcc90ab0,0xbd16c32c
.long 0x0,0xbcc90ab0,0xbd48fb30,0xbd96a905,0x0,0xbd16c32c,0xbd96a905,0xbde1bc2e
.long 0x0,0xbd48fb30,0xbdc8bd36,0xbe164083,0x0,0xbd7b2b74,0xbdfab273,0xbe3b6ecf
.long 0x0,0xbd96a905,0xbe164083,0xbe605c13,0x0,0xbdafb680,0xbe2f10a2,0xbe827dc0
.long 0x0,0xbdc8bd36,0xbe47c5c2,0xbe94a031,0x0,0xbde1bc2e,0xbe605c13,0xbea68f12
.long 0x0,0xbdfab273,0xbe78cfcc,0xbeb8442a,0x0,0xbe09cf86,0xbe888e93,0xbec9b953
.long 0x0,0xbe164083,0xbe94a031,0xbedae880,0x0,0xbe22abb6,0xbea09ae5,0xbeebcbbb
.long 0x0,0xbe2f10a2,0xbeac7cd4,0xbefc5d27,0x0,0xbe3b6ecf,0xbeb8442a,0xbf064b82
.long 0x0,0x0,0x0,0x0,0xbd48fb30,0xbd7b2b74,0xbd96a905,0xbdafb680
.long 0xbdc8bd36,0xbdfab273,0xbe164083,0xbe2f10a2,0xbe164083,0xbe3b6ecf,0xbe605c13,0xbe827dc0
.long 0xbe47c5c2,0xbe78cfcc,0xbe94a031,0xbeac7cd4,0xbe78cfcc,0xbe9aa086,0xbeb8442a,0xbed53641
.long 0xbe94a031,0xbeb8442a,0xbedae880,0xbefc5d27,0xbeac7cd4,0xbed53641,0xbefc5d27,0xbf10d3cd
.long 0xbec3ef15,0xbef15aea,0xbf0e39da,0xbf226799,0xbedae880,0xbf064b82,0xbf1d7fd1,0xbf32c8c9
.long 0xbef15aea,0xbf13682a,0xbf2beb4a,0xbf41d870,0xbf039c3d,0xbf1ff6cb,0xbf396842,0xbf4f7a1f
.long 0xbf0e39da,0xbf2beb4a,0xbf45e403,0xbf5b941a,0xbf187fc0,0xbf373a23,0xbf514d3d,0xbf660f88
.long 0xbf226799,0xbf41d870,0xbf5b941a,0xbf6ed89e,0xbf2beb4a,0xbf4bbbf8,0xbf64aa59,0xbf75dec6
.long 0x0,0x0,0x0,0x0,0xbdc8bd36,0xbde1bc2e,0xbdfab273,0xbe09cf86
.long 0xbe47c5c2,0xbe605c13,0xbe78cfcc,0xbe888e93,0xbe94a031,0xbea68f12,0xbeb8442a,0xbec9b953
.long 0xbec3ef15,0xbedae880,0xbef15aea,0xbf039c3d,0xbef15aea,0xbf064b82,0xbf13682a,0xbf1ff6cb
.long 0xbf0e39da,0xbf1d7fd1,0xbf2beb4a,0xbf396842,0xbf226799,0xbf32c8c9,0xbf41d870,0xbf4f7a1f
.long 0xbf3504f3,0xbf45e403,0xbf54db31,0xbf61c598,0xbf45e403,0xbf5695e5,0xbf64aa59,0xbf6ff573
.long 0xbf54db31,0xbf64aa59,0xbf710908,0xbf79c79d,0xbf61c598,0xbf6ff573,0xbf79c79d,0xbf7f0e58
.long 0xbf6c835e,0xbf7853f8,0xbf7ec46d,0xbf7fb10f,0xbf74fa0b,0xbf7dabcc,0xbf7fec43,0xbf7baccd
.long 0xbf7b14be,0xbf7fec43,0xbf7d3aac,0xbf731447,0xbf7ec46d,0xbf7f0e58,0xbf76ba07,0xbf660f88
.long 0x0,0x0,0x0,0x0,0xbe164083,0xbe22abb6,0xbe2f10a2,0xbe3b6ecf
.long 0xbe94a031,0xbea09ae5,0xbeac7cd4,0xbeb8442a,0xbedae880,0xbeebcbbb,0xbefc5d27,0xbf064b82
.long 0xbf0e39da,0xbf187fc0,0xbf226799,0xbf2beb4a,0xbf2beb4a,0xbf373a23,0xbf41d870,0xbf4bbbf8
.long 0xbf45e403,0xbf514d3d,0xbf5b941a,0xbf64aa59,0xbf5b941a,0xbf660f88,0xbf6ed89e,0xbf75dec6
.long 0xbf6c835e,0xbf74fa0b,0xbf7b14be,0xbf7ec46d,0xbf7853f8,0xbf7dabcc,0xbf7fec43,0xbf7f0e58
.long 0xbf7ec46d,0xbf7fec43,0xbf7d3aac,0xbf76ba07,0xbf7fb10f,0xbf7baccd,0xbf731447,0xbf660f88
.long 0xbf7b14be,0xbf710908,0xbf61c598,0xbf4d9f02,0xbf710908,0xbf604621,0xbf49d112,0xbf2e3bde
.long 0xbf61c598,0xbf49d112,0xbf2beb4a,0xbf08f59b,0xbf4d9f02,0xbf2e3bde,0xbf08f59b,0xbebe1d4a
.long 0x0,0x0,0x0,0x0,0xbe47c5c2,0xbe541501,0xbe605c13,0xbe6c9a7f
.long 0xbec3ef15,0xbecf7bca,0xbedae880,0xbee63375,0xbf0e39da,0xbf15f6d9,0xbf1d7fd1,0xbf24d225
.long 0xbf3504f3,0xbf3daef9,0xbf45e403,0xbf4d9f02,0xbf54db31,0xbf5d2d53,0xbf64aa59,0xbf6b4b0c
.long 0xbf6c835e,0xbf731447,0xbf7853f8,0xbf7c3b28,0xbf7b14be,0xbf7e70b0,0xbf7fec43,0xbf7f84ab
.long 0xbf800000,0xbf7ec46d,0xbf7b14be,0xbf74fa0b,0xbf7b14be,0xbf740bdd,0xbf6a09a7,0xbf5d2d53
.long 0xbf6c835e,0xbf5ebe05,0xbf4d9f02,0xbf396842,0xbf54db31,0xbf3fc767,0xbf273656,0xbf0b9a6b
.long 0xbf3504f3,0xbf187fc0,0xbef15aea,0xbeac7cd4,0xbf0e39da,0xbed53641,0xbe888e93,0xbde1bc2e
.long 0xbec3ef15,0xbe605c13,0xbd48fb30,0x3dfab273,0xbe47c5c2,0xbc490e90,0x3e2f10a2,0x3eb263ef
.long 0x0,0x0,0x0,0x0,0xbe78cfcc,0xbe827dc0,0xbe888e93,0xbe8e9a22
.long 0xbef15aea,0xbefc5d27,0xbf039c3d,0xbf08f59b,0xbf2beb4a,0xbf32c8c9,0xbf396842,0xbf3fc767
.long 0xbf54db31,0xbf5b941a,0xbf61c598,0xbf676bd8,0xbf710908,0xbf75dec6,0xbf79c79d,0xbf7cbfc9
.long 0xbf7ec46d,0xbf7fec43,0xbf7fb10f,0xbf7e1324,0xbf7d3aac,0xbf791298,0xbf731447,0xbf6b4b0c
.long 0xbf6c835e,0xbf61c598,0xbf54db31,0xbf45e403,0xbf4d9f02,0xbf3b8f3b,0xbf273656,0xbf10d3cd
.long 0xbf226799,0xbf08f59b,0xbedae880,0xbea09ae5,0xbedae880,0xbe9aa086,0xbe2f10a2,0xbd16c32c
.long 0xbe47c5c2,0xbd48fb30,0x3dc8bd36,0x3e78cfcc,0x3d48fb30,0x3e541501,0x3eb8442a,0x3f00e7e4
.long 0x3e94a031,0x3ee63375,0x3f187fc0,0x3f396842,0x3f039c3d,0x3f299415,0x3f49d112,0x3f633c5a
.long 0x0,0x0,0x0,0x0,0xbe94a031,0xbe9aa086,0xbea09ae5,0xbea68f12
.long 0xbf0e39da,0xbf13682a,0xbf187fc0,0xbf1d7fd1,0xbf45e403,0xbf4bbbf8,0xbf514d3d,0xbf5695e5
.long 0xbf6c835e,0xbf710908,0xbf74fa0b,0xbf7853f8,0xbf7ec46d,0xbf7fd397,0xbf7fec43,0xbf7f0e58
.long 0xbf7b14be,0xbf76ba07,0xbf710908,0xbf6a09a7,0xbf61c598,0xbf5695e5,0xbf49d112,0xbf3b8f3b
.long 0xbf3504f3,0xbf226799,0xbf0e39da,0xbef15aea,0xbef15aea,0xbebe1d4a,0xbe888e93,0xbe22abb6
.long 0xbe47c5c2,0xbd96a905,0x3d48fb30,0x3e2f10a2,0x3dc8bd36,0x3e6c9a7f,0x3eb8442a,0x3ef6e0cb
.long 0x3ec3ef15,0x3f039c3d,0x3f226799,0x3f3daef9,0x3f226799,0x3f3fc767,0x3f584853,0x3f6b4b0c
.long 0x3f54db31,0x3f6a09a7,0x3f7853f8,0x3f7f4e6d,0x3f74fa0b,0x3f7e70b0,0x3f7f4e6d,0x3f778bc5
.long 0x0,0x0,0x0,0x0,0xbeac7cd4,0xbeb263ef,0xbeb8442a,0xbebe1d4a
.long 0xbf226799,0xbf273656,0xbf2beb4a,0xbf3085bb,0xbf5b941a,0xbf604621,0xbf64aa59,0xbf68bf3c
.long 0xbf7b14be,0xbf7d3aac,0xbf7ec46d,0xbf7fb10f,0xbf7d3aac,0xbf7a7302,0xbf76ba07,0xbf721352
.long 0xbf61c598,0xbf584853,0xbf4d9f02,0xbf41d870,0xbf2beb4a,0xbf1b02c6,0xbf08f59b,0xbeebcbbb
.long 0xbec3ef15,0xbe94a031,0xbe47c5c2,0xbdc8bd36,0xbd48fb30,0x3d7b2b74,0x3e2f10a2,0x3e8e9a22
.long 0x3e94a031,0x3ecf7bca,0x3f039c3d,0x3f1d7fd1,0x3f187fc0,0x3f32c8c9,0x3f49d112,0x3f5d2d53
.long 0x3f54db31,0x3f676bd8,0x3f74fa0b,0x3f7d3aac,0x3f7853f8,0x3f7f0e58,0x3f7f4e6d,0x3f791298
.long 0x3f7ec46d,0x3f76ba07,0x3f676bd8,0x3f514d3d,0x3f676bd8,0x3f4f7a1f,0x3f3085bb,0x3f0b9a6b
.long 0x35000000,0x35000000,0x35000000,0x35000000,0x35000000,0x34fffb11,0x34ffec43,0x34ffd397
.long 0x35000000,0x34ffec43,0x34ffb10f,0x34ff4e6d,0x35000000,0x34ffd397,0x34ff4e6d,0x34fe70b0
.long 0x35000000,0x34ffb10f,0x34fec46d,0x34fd3aac,0x35000000,0x34ff84ab,0x34fe1324,0x34fbaccd
.long 0x35000000,0x34ff4e6d,0x34fd3aac,0x34f9c79d,0x35000000,0x34ff0e58,0x34fc3b28,0x34f78bc5
.long 0x35000000,0x34fec46d,0x34fb14be,0x34f4fa0b,0x35000000,0x34fe70b0,0x34f9c79d,0x34f21352
.long 0x35000000,0x34fe1324,0x34f853f8,0x34eed89e,0x35000000,0x34fdabcc,0x34f6ba07,0x34eb4b0c
.long 0x35000000,0x34fd3aac,0x34f4fa0b,0x34e76bd8,0x35000000,0x34fcbfc9,0x34f31447,0x34e33c5a
.long 0x35000000,0x34fc3b28,0x34f10908,0x34debe05,0x35000000,0x34fbaccd,0x34eed89e,0x34d9f26a
.long 0x35000000,0x35000000,0x35000000,0x35000000,0x34ffb10f,0x34ff84ab,0x34ff4e6d,0x34ff0e58
.long 0x34fec46d,0x34fe1324,0x34fd3aac,0x34fc3b28,0x34fd3aac,0x34fbaccd,0x34f9c79d,0x34f78bc5
.long 0x34fb14be,0x34f853f8,0x34f4fa0b,0x34f10908,0x34f853f8,0x34f40bdd,0x34eed89e,0x34e8bf3c
.long 0x34f4fa0b,0x34eed89e,0x34e76bd8,0x34debe05,0x34f10908,0x34e8bf3c,0x34debe05,0x34d31849
.long 0x34ec835e,0x34e1c598,0x34d4db31,0x34c5e403,0x34e76bd8,0x34d9f26a,0x34c9d112,0x34b73a23
.long 0x34e1c598,0x34d14d3d,0x34bdaef9,0x34a73656,0x34db941a,0x34c7de65,0x34b085bb,0x3495f6d9
.long 0x34d4db31,0x34bdaef9,0x34a26799,0x34839c3d,0x34cd9f02,0x34b2c8c9,0x3493682a,0x3460924f
.long 0x34c5e403,0x34a73656,0x34839c3d,0x3438442a,0x34bdaef9,0x349b02c6,0x34663375,0x340e9a22
.long 0x35000000,0x35000000,0x35000000,0x35000000,0x34fec46d,0x34fe70b0,0x34fe1324,0x34fdabcc
.long 0x34fb14be,0x34f9c79d,0x34f853f8,0x34f6ba07,0x34f4fa0b,0x34f21352,0x34eed89e,0x34eb4b0c
.long 0x34ec835e,0x34e76bd8,0x34e1c598,0x34db941a,0x34e1c598,0x34d9f26a,0x34d14d3d,0x34c7de65
.long 0x34d4db31,0x34c9d112,0x34bdaef9,0x34b085bb,0x34c5e403,0x34b73a23,0x34a73656,0x3495f6d9
.long 0x34b504f3,0x34a26799,0x348e39da,0x34715aea,0x34a26799,0x348b9a6b,0x34663375,0x343263ef
.long 0x348e39da,0x34663375,0x342c7cd4,0x33e05c13,0x34715aea,0x343263ef,0x33e05c13,0x332fb680
.long 0x3443ef15,0x33f8cfcc,0x3348bd36,0xb2c8fb30,0x3414a031,0x3389cf86,0xb2490ab0,0xb3bb6ecf
.long 0x33c7c5c2,0x32490ab0,0xb3964083,0xb4209ae5,0x3348bd36,0xb32fb680,0xb4088e93,0xb460924f
.long 0x35000000,0x35000000,0x35000000,0x35000000,0x34fd3aac,0x34fcbfc9,0x34fc3b28,0x34fbaccd
.long 0x34f4fa0b,0x34f31447,0x34f10908,0x34eed89e,0x34e76bd8,0x34e33c5a,0x34debe05,0x34d9f26a
.long 0x34d4db31,0x34cd9f02,0x34c5e403,0x34bdaef9,0x34bdaef9,0x34b2c8c9,0x34a73656,0x349b02c6
.long 0x34a26799,0x3493682a,0x34839c3d,0x34663375,0x34839c3d,0x3460924f,0x3438442a,0x340e9a22
.long 0x3443ef15,0x3414a031,0x33c7c5c2,0x3348bd36,0x33f8cfcc,0x3389cf86,0x32490ab0,0xb32fb680
.long 0x3348bd36,0xb2490ab0,0xb3964083,0xb4088e93,0xb2c8fb30,0xb3bb6ecf,0xb4209ae5,0xb460924f
.long 0xb3c7c5c2,0xb42c7cd4,0xb4715aea,0xb4987fc0,0xb42c7cd4,0xb476e0cb,0xb49d7fd1,0xb4bb8f3b
.long 0xb4715aea,0xb49d7fd1,0xb4bdaef9,0xb4d84853,0xb4987fc0,0xb4bb8f3b,0xb4d84853,0xb4edb293
.long 0x35000000,0x34fb14be,0x34ec835e,0x34d4db31,0x35000000,0x34fa7302,0x34ea09a7,0x34cf7a1f
.long 0x35000000,0x34f9c79d,0x34e76bd8,0x34c9d112,0x35000000,0x34f91298,0x34e4aa59,0x34c3e200
.long 0x35000000,0x34f853f8,0x34e1c598,0x34bdaef9,0x35000000,0x34f78bc5,0x34debe05,0x34b73a23
.long 0x35000000,0x34f6ba07,0x34db941a,0x34b085bb,0x35000000,0x34f5dec6,0x34d84853,0x34a99415
.long 0x35000000,0x34f4fa0b,0x34d4db31,0x34a26799,0x35000000,0x34f40bdd,0x34d14d3d,0x349b02c6
.long 0x35000000,0x34f31447,0x34cd9f02,0x3493682a,0x35000000,0x34f21352,0x34c9d112,0x348b9a6b
.long 0x35000000,0x34f10908,0x34c5e403,0x34839c3d,0x35000000,0x34eff573,0x34c1d870,0x3476e0cb
.long 0x35000000,0x34eed89e,0x34bdaef9,0x34663375,0x35000000,0x34edb293,0x34b96842,0x34553641
.long 0x34b504f3,0x348e39da,0x3443ef15,0x33c7c5c2,0x34abeb4a,0x3480e7e4,0x34209ae5,0x3361bc2e
.long 0x34a26799,0x34663375,0x33f8cfcc,0x32490ab0,0x34987fc0,0x3449b953,0x33af10a2,0xb2fb2b74
.long 0x348e39da,0x342c7cd4,0x3348bd36,0xb3964083,0x34839c3d,0x340e9a22,0x32490ab0,0xb3ec9a7f
.long 0x34715aea,0x33e05c13,0xb2c8fb30,0xb4209ae5,0x345ae880,0x33a2abb6,0xb37ab273,0xb449b953
.long 0x3443ef15,0x3348bd36,0xb3c7c5c2,0xb4715aea,0x342c7cd4,0x3296c32c,0xb4088e93,0xb48b9a6b
.long 0x3414a031,0xb2490ab0,0xb42c7cd4,0xb49d7fd1,0x33f8cfcc,0xb32fb680,0xb44f7bca,0xb4ae3bde
.long 0x33c7c5c2,0xb3964083,0xb4715aea,0xb4bdaef9,0x33964083,0xb3d41501,0xb488f59b,0xb4cbbbf8
.long 0x3348bd36,0xb4088e93,0xb4987fc0,0xb4d84853,0x32c8fb30,0xb4268f12,0xb4a73656,0xb4e33c5a
.long 0x0,0xb3c7c5c2,0xb443ef15,0xb48e39da,0xb348bd36,0xb41aa086,0xb47c5d27,0xb4a99415
.long 0xb3c7c5c2,0xb44f7bca,0xb4987fc0,0xb4c1d870,0xb414a031,0xb480e7e4,0xb4b085bb,0xb4d695e5
.long 0xb443ef15,0xb4987fc0,0xb4c5e403,0xb4e76bd8,0xb4715aea,0xb4ae3bde,0xb4d84853,0xb4f40bdd
.long 0xb48e39da,0xb4c1d870,0xb4e76bd8,0xb4fc3b28,0xb4a26799,0xb4d31849,0xb4f31447,0xb4ffd397
.long 0xb4b504f3,0xb4e1c598,0xb4fb14be,0xb4fec46d,0xb4c5e403,0xb4edb293,0xb4ff4e6d,0xb4f91298
.long 0xb4d4db31,0xb4f6ba07,0xb4ffb10f,0xb4eed89e,0xb4e1c598,0xb4fcbfc9,0xb4fc3b28,0xb4e04621
.long 0xb4ec835e,0xb4ffb10f,0xb4f4fa0b,0xb4cd9f02,0xb4f4fa0b,0xb4ff84ab,0xb4ea09a7,0xb4b73a23
.long 0xb4fb14be,0xb4fc3b28,0xb4db941a,0xb49d7fd1,0xb4fec46d,0xb4f5dec6,0xb4c9d112,0xb480e7e4
.long 0xb4b504f3,0xb4d4db31,0xb4ec835e,0xb4fb14be,0xb4cd9f02,0xb4e8bf3c,0xb4f9c79d,0xb4fffb11
.long 0xb4e1c598,0xb4f6ba07,0xb4ffb10f,0xb4fc3b28,0xb4f10908,0xb4fe70b0,0xb4fe1324,0xb4eff573
.long 0xb4fb14be,0xb4ffb10f,0xb4f4fa0b,0xb4db941a,0xb4ffb10f,0xb4fa7302,0xb4e4aa59,0xb4bfc767
.long 0xb4fec46d,0xb4eed89e,0xb4cd9f02,0xb49d7fd1,0xb4f853f8,0xb4dd2d53,0xb4b085bb,0xb46bcbbb
.long 0xb4ec835e,0xb4c5e403,0xb48e39da,0xb414a031,0xb4db941a,0xb4a99415,0xb44f7bca,0xb361bc2e
.long 0xb4c5e403,0xb488f59b,0xb3f8cfcc,0x3316a905,0xb4abeb4a,0xb449b953,0xb316a905,0x34027dc0
.long 0xb48e39da,0xb3f8cfcc,0x3348bd36,0x345ae880,0xb45ae880,0xb32fb680,0x34088e93,0x3495f6d9
.long 0xb414a031,0x3316a905,0x345ae880,0x34b96842,0xb3964083,0x33ec9a7f,0x3493682a,0x34d695e5
.long 0x0,0x0,0x0,0x0,0x0,0xb1c90e90,0xb2490ab0,0xb296c32c
.long 0x0,0xb2490ab0,0xb2c8fb30,0xb316a905,0x0,0xb296c32c,0xb316a905,0xb361bc2e
.long 0x0,0xb2c8fb30,0xb348bd36,0xb3964083,0x0,0xb2fb2b74,0xb37ab273,0xb3bb6ecf
.long 0x0,0xb316a905,0xb3964083,0xb3e05c13,0x0,0xb32fb680,0xb3af10a2,0xb4027dc0
.long 0x0,0xb348bd36,0xb3c7c5c2,0xb414a031,0x0,0xb361bc2e,0xb3e05c13,0xb4268f12
.long 0x0,0xb37ab273,0xb3f8cfcc,0xb438442a,0x0,0xb389cf86,0xb4088e93,0xb449b953
.long 0x0,0xb3964083,0xb414a031,0xb45ae880,0x0,0xb3a2abb6,0xb4209ae5,0xb46bcbbb
.long 0x0,0xb3af10a2,0xb42c7cd4,0xb47c5d27,0x0,0xb3bb6ecf,0xb438442a,0xb4864b82
.long 0x0,0x0,0x0,0x0,0xb2c8fb30,0xb2fb2b74,0xb316a905,0xb32fb680
.long 0xb348bd36,0xb37ab273,0xb3964083,0xb3af10a2,0xb3964083,0xb3bb6ecf,0xb3e05c13,0xb4027dc0
.long 0xb3c7c5c2,0xb3f8cfcc,0xb414a031,0xb42c7cd4,0xb3f8cfcc,0xb41aa086,0xb438442a,0xb4553641
.long 0xb414a031,0xb438442a,0xb45ae880,0xb47c5d27,0xb42c7cd4,0xb4553641,0xb47c5d27,0xb490d3cd
.long 0xb443ef15,0xb4715aea,0xb48e39da,0xb4a26799,0xb45ae880,0xb4864b82,0xb49d7fd1,0xb4b2c8c9
.long 0xb4715aea,0xb493682a,0xb4abeb4a,0xb4c1d870,0xb4839c3d,0xb49ff6cb,0xb4b96842,0xb4cf7a1f
.long 0xb48e39da,0xb4abeb4a,0xb4c5e403,0xb4db941a,0xb4987fc0,0xb4b73a23,0xb4d14d3d,0xb4e60f88
.long 0xb4a26799,0xb4c1d870,0xb4db941a,0xb4eed89e,0xb4abeb4a,0xb4cbbbf8,0xb4e4aa59,0xb4f5dec6
.long 0x0,0x0,0x0,0x0,0xb348bd36,0xb361bc2e,0xb37ab273,0xb389cf86
.long 0xb3c7c5c2,0xb3e05c13,0xb3f8cfcc,0xb4088e93,0xb414a031,0xb4268f12,0xb438442a,0xb449b953
.long 0xb443ef15,0xb45ae880,0xb4715aea,0xb4839c3d,0xb4715aea,0xb4864b82,0xb493682a,0xb49ff6cb
.long 0xb48e39da,0xb49d7fd1,0xb4abeb4a,0xb4b96842,0xb4a26799,0xb4b2c8c9,0xb4c1d870,0xb4cf7a1f
.long 0xb4b504f3,0xb4c5e403,0xb4d4db31,0xb4e1c598,0xb4c5e403,0xb4d695e5,0xb4e4aa59,0xb4eff573
.long 0xb4d4db31,0xb4e4aa59,0xb4f10908,0xb4f9c79d,0xb4e1c598,0xb4eff573,0xb4f9c79d,0xb4ff0e58
.long 0xb4ec835e,0xb4f853f8,0xb4fec46d,0xb4ffb10f,0xb4f4fa0b,0xb4fdabcc,0xb4ffec43,0xb4fbaccd
.long 0xb4fb14be,0xb4ffec43,0xb4fd3aac,0xb4f31447,0xb4fec46d,0xb4ff0e58,0xb4f6ba07,0xb4e60f88
.long 0x0,0x0,0x0,0x0,0xb3964083,0xb3a2abb6,0xb3af10a2,0xb3bb6ecf
.long 0xb414a031,0xb4209ae5,0xb42c7cd4,0xb438442a,0xb45ae880,0xb46bcbbb,0xb47c5d27,0xb4864b82
.long 0xb48e39da,0xb4987fc0,0xb4a26799,0xb4abeb4a,0xb4abeb4a,0xb4b73a23,0xb4c1d870,0xb4cbbbf8
.long 0xb4c5e403,0xb4d14d3d,0xb4db941a,0xb4e4aa59,0xb4db941a,0xb4e60f88,0xb4eed89e,0xb4f5dec6
.long 0xb4ec835e,0xb4f4fa0b,0xb4fb14be,0xb4fec46d,0xb4f853f8,0xb4fdabcc,0xb4ffec43,0xb4ff0e58
.long 0xb4fec46d,0xb4ffec43,0xb4fd3aac,0xb4f6ba07,0xb4ffb10f,0xb4fbaccd,0xb4f31447,0xb4e60f88
.long 0xb4fb14be,0xb4f10908,0xb4e1c598,0xb4cd9f02,0xb4f10908,0xb4e04621,0xb4c9d112,0xb4ae3bde
.long 0xb4e1c598,0xb4c9d112,0xb4abeb4a,0xb488f59b,0xb4cd9f02,0xb4ae3bde,0xb488f59b,0xb43e1d4a
.long 0x0,0xb3c7c5c2,0xb443ef15,0xb48e39da,0x0,0xb3d41501,0xb44f7bca,0xb495f6d9
.long 0x0,0xb3e05c13,0xb45ae880,0xb49d7fd1,0x0,0xb3ec9a7f,0xb4663375,0xb4a4d225
.long 0x0,0xb3f8cfcc,0xb4715aea,0xb4abeb4a,0x0,0xb4027dc0,0xb47c5d27,0xb4b2c8c9
.long 0x0,0xb4088e93,0xb4839c3d,0xb4b96842,0x0,0xb40e9a22,0xb488f59b,0xb4bfc767
.long 0x0,0xb414a031,0xb48e39da,0xb4c5e403,0x0,0xb41aa086,0xb493682a,0xb4cbbbf8
.long 0x0,0xb4209ae5,0xb4987fc0,0xb4d14d3d,0x0,0xb4268f12,0xb49d7fd1,0xb4d695e5
.long 0x0,0xb42c7cd4,0xb4a26799,0xb4db941a,0x0,0xb43263ef,0xb4a73656,0xb4e04621
.long 0x0,0xb438442a,0xb4abeb4a,0xb4e4aa59,0x0,0xb43e1d4a,0xb4b085bb,0xb4e8bf3c
.long 0xb4b504f3,0xb4d4db31,0xb4ec835e,0xb4fb14be,0xb4bdaef9,0xb4dd2d53,0xb4f31447,0xb4fe70b0
.long 0xb4c5e403,0xb4e4aa59,0xb4f853f8,0xb4ffec43,0xb4cd9f02,0xb4eb4b0c,0xb4fc3b28,0xb4ff84ab
.long 0xb4d4db31,0xb4f10908,0xb4fec46d,0xb4fd3aac,0xb4db941a,0xb4f5dec6,0xb4ffec43,0xb4f91298
.long 0xb4e1c598,0xb4f9c79d,0xb4ffb10f,0xb4f31447,0xb4e76bd8,0xb4fcbfc9,0xb4fe1324,0xb4eb4b0c
.long 0xb4ec835e,0xb4fec46d,0xb4fb14be,0xb4e1c598,0xb4f10908,0xb4ffd397,0xb4f6ba07,0xb4d695e5
.long 0xb4f4fa0b,0xb4ffec43,0xb4f10908,0xb4c9d112,0xb4f853f8,0xb4ff0e58,0xb4ea09a7,0xb4bb8f3b
.long 0xb4fb14be,0xb4fd3aac,0xb4e1c598,0xb4abeb4a,0xb4fd3aac,0xb4fa7302,0xb4d84853,0xb49b02c6
.long 0xb4fec46d,0xb4f6ba07,0xb4cd9f02,0xb488f59b,0xb4ffb10f,0xb4f21352,0xb4c1d870,0xb46bcbbb
.long 0xb5000000,0xb4fb14be,0xb4ec835e,0xb4d4db31,0xb4fec46d,0xb4f40bdd,0xb4debe05,0xb4bfc767
.long 0xb4fb14be,0xb4ea09a7,0xb4cd9f02,0xb4a73656,0xb4f4fa0b,0xb4dd2d53,0xb4b96842,0xb48b9a6b
.long 0xb4ec835e,0xb4cd9f02,0xb4a26799,0xb45ae880,0xb4e1c598,0xb4bb8f3b,0xb488f59b,0xb41aa086
.long 0xb4d4db31,0xb4a73656,0xb45ae880,0xb3af10a2,0xb4c5e403,0xb490d3cd,0xb4209ae5,0xb296c32c
.long 0xb4b504f3,0xb4715aea,0xb3c7c5c2,0x3348bd36,0xb4a26799,0xb43e1d4a,0xb316a905,0x33ec9a7f
.long 0xb48e39da,0xb4088e93,0x32c8fb30,0x3438442a,0xb4715aea,0xb3a2abb6,0x33af10a2,0x3476e0cb
.long 0xb443ef15,0xb2c8fb30,0x3414a031,0x34987fc0,0xb414a031,0x32fb2b74,0x344f7bca,0x34b2c8c9
.long 0xb3c7c5c2,0x33af10a2,0x34839c3d,0x34c9d112,0xb348bd36,0x340e9a22,0x349d7fd1,0x34dd2d53
.long 0xb4b504f3,0xb48e39da,0xb443ef15,0xb3c7c5c2,0xb4987fc0,0xb4553641,0xb3e05c13,0xb1c90e90
.long 0xb4715aea,0xb4088e93,0xb2c8fb30,0x33af10a2,0xb42c7cd4,0xb361bc2e,0x337ab273,0x343263ef
.long 0xb3c7c5c2,0x32c8fb30,0x3414a031,0x34839c3d,0xb2c8fb30,0x33d41501,0x34663375,0x34a99415
.long 0x3348bd36,0x3438442a,0x34987fc0,0x34c9d112,0x33f8cfcc,0x3480e7e4,0x34b96842,0x34e33c5a
.long 0x3443ef15,0x34a26799,0x34d4db31,0x34f4fa0b,0x34839c3d,0x34bfc767,0x34ea09a7,0x34fe70b0
.long 0x34a26799,0x34d84853,0x34f853f8,0x34ff4e6d,0x34bdaef9,0x34eb4b0c,0x34ff4e6d,0x34f78bc5
.long 0x34d4db31,0x34f853f8,0x34fec46d,0x34e76bd8,0x34e76bd8,0x34ff0e58,0x34f6ba07,0x34cf7a1f
.long 0x34f4fa0b,0x34ff4e6d,0x34e76bd8,0x34b085bb,0x34fd3aac,0x34f91298,0x34d14d3d,0x348b9a6b
.long 0x3f80,0x3f80,0x3f80,0x3f80,0x3f80,0x3dc93f7f,0x3e483f7b,0x3e953f75
.long 0x3f80,0x3e483f7b,0x3ec43f6d,0x3f0e3f55,0x3f80,0x3e953f75,0x3f0e3f55,0x3f463f22
.long 0x3f80,0x3ec43f6d,0x3f353f35,0x3f6d3ec4,0x3f80,0x3ef13f62,0x3f553f0e,0x3f7f3dc9
.long 0x3f80,0x3f0e3f55,0x3f6d3ec4,0x3f7bbe48,0x3f80,0x3f223f46,0x3f7b3e48,0x3f62bef1
.long 0x3f80,0x3f353f35,0x3f800000,0x3f35bf35,0x3f80,0x3f463f22,0x3f7bbe48,0x3ef1bf62
.long 0x3f80,0x3f553f0e,0x3f6dbec4,0x3e48bf7b,0x3f80,0x3f623ef1,0x3f55bf0e,0xbdc9bf7f
.long 0x3f80,0x3f6d3ec4,0x3f35bf35,0xbec4bf6d,0x3f80,0x3f753e95,0x3f0ebf55,0xbf22bf46
.long 0x3f80,0x3f7b3e48,0x3ec4bf6d,0xbf55bf0e,0x3f80,0x3f7f3dc9,0x3e48bf7b,0xbf75be95
.long 0x3f80,0x3f80,0x3f80,0x3f80,0x3ec43f6d,0x3ef13f62,0x3f0e3f55,0x3f223f46
.long 0x3f353f35,0x3f553f0e,0x3f6d3ec4,0x3f7b3e48,0x3f6d3ec4,0x3f7f3dc9,0x3f7bbe48,0x3f62bef1
.long 0x3f800000,0x3f6dbec4,0x3f35bf35,0x3ec4bf6d,0x3f6dbec4,0x3f22bf46,0x3e48bf7b,0xbe95bf75
.long 0x3f35bf35,0x3e48bf7b,0xbec4bf6d,0xbf55bf0e,0x3ec4bf6d,0xbe95bf75,0xbf55bf0e,0xbf7f3dc9
.long 0xbf80,0xbf35bf35,0xbf800000,0xbf353f35,0xbec4bf6d,0xbf75be95,0xbf553f0e,0xbdc93f7f
.long 0xbf35bf35,0xbf7b3e48,0xbec43f6d,0x3f0e3f55,0xbf6dbec4,0xbf463f22,0x3e483f7b,0x3f753e95
.long 0xbf800000,0xbec43f6d,0x3f353f35,0x3f6dbec4,0xbf6d3ec4,0x3dc93f7f,0x3f7b3e48,0x3ef1bf62
.long 0xbf353f35,0x3f0e3f55,0x3f6dbec4,0xbe48bf7b,0xbec43f6d,0x3f623ef1,0x3f0ebf55,0xbf46bf22
.long 0x3f80,0x3f80,0x3f80,0x3f80,0x3f353f35,0x3f463f22,0x3f553f0e,0x3f623ef1
.long 0x3f800000,0x3f7bbe48,0x3f6dbec4,0x3f55bf0e,0x3f35bf35,0x3ef1bf62,0x3e48bf7b,0xbdc9bf7f
.long 0xbf80,0xbec4bf6d,0xbf35bf35,0xbf6dbec4,0xbf35bf35,0xbf75be95,0xbf7b3e48,0xbf463f22
.long 0xbf800000,0xbf553f0e,0xbec43f6d,0x3e483f7b,0xbf353f35,0xbdc93f7f,0x3f0e3f55,0x3f753e95
.long 0x3f80,0x3f353f35,0x3f800000,0x3f35bf35,0x3f353f35,0x3f7fbdc9,0x3f0ebf55,0xbe95bf75
.long 0x3f800000,0x3f0ebf55,0xbec4bf6d,0xbf7bbe48,0x3f35bf35,0xbe95bf75,0xbf7bbe48,0xbf223f46
.long 0xbf80,0xbf6dbec4,0xbf353f35,0x3ec43f6d,0xbf35bf35,0xbf623ef1,0x3e483f7b,0x3f7f3dc9
.long 0xbf800000,0xbe483f7b,0x3f6d3ec4,0x3f0ebf55,0xbf353f35,0x3f223f46,0x3f55bf0e,0xbef1bf62
.long 0x3f80,0x3f80,0x3f80,0x3f80,0x3f6d3ec4,0x3f753e95,0x3f7b3e48,0x3f7f3dc9
.long 0x3f35bf35,0x3f0ebf55,0x3ec4bf6d,0x3e48bf7b,0xbec4bf6d,0xbf22bf46,0xbf55bf0e,0xbf75be95
.long 0xbf800000,0xbf6d3ec4,0xbf353f35,0xbec43f6d,0xbec43f6d,0x3dc93f7f,0x3f0e3f55,0x3f623ef1
.long 0x3f353f35,0x3f7b3e48,0x3f6dbec4,0x3f0ebf55,0x3f6dbec4,0x3ef1bf62,0xbe48bf7b,0xbf46bf22
.long 0xbf80,0xbf35bf35,0xbf800000,0xbf353f35,0xbf6dbec4,0xbf623ef1,0xbe483f7b,0x3f223f46
.long 0xbf353f35,0x3e483f7b,0x3f6d3ec4,0x3f55bf0e,0x3ec43f6d,0x3f7f3dc9,0x3f0ebf55,0xbef1bf62
.long 0x3f800000,0x3ec4bf6d,0xbf35bf35,0xbf6d3ec4,0x3ec4bf6d,0xbf46bf22,0xbf553f0e,0x3e953f75
.long 0xbf35bf35,0xbf553f0e,0x3ec43f6d,0x3f7bbe48,0xbf6d3ec4,0x3e953f75,0x3f7bbe48,0xbdc9bf7f
.long 0x3f800000,0x3f800000,0x3f800000,0x3f800000,0x3f800000,0x3f7fbdc9,0x3f7bbe48,0x3f75be95
.long 0x3f800000,0x3f7bbe48,0x3f6dbec4,0x3f55bf0e,0x3f800000,0x3f75be95,0x3f55bf0e,0x3f22bf46
.long 0x3f800000,0x3f6dbec4,0x3f35bf35,0x3ec4bf6d,0x3f800000,0x3f62bef1,0x3f0ebf55,0x3dc9bf7f
.long 0x3f800000,0x3f55bf0e,0x3ec4bf6d,0xbe48bf7b,0x3f800000,0x3f46bf22,0x3e48bf7b,0xbef1bf62
.long 0x3f800000,0x3f35bf35,0xbf80,0xbf35bf35,0x3f800000,0x3f22bf46,0xbe48bf7b,0xbf62bef1
.long 0x3f800000,0x3f0ebf55,0xbec4bf6d,0xbf7bbe48,0x3f800000,0x3ef1bf62,0xbf0ebf55,0xbf7f3dc9
.long 0x3f800000,0x3ec4bf6d,0xbf35bf35,0xbf6d3ec4,0x3f800000,0x3e95bf75,0xbf55bf0e,0xbf463f22
.long 0x3f800000,0x3e48bf7b,0xbf6dbec4,0xbf0e3f55,0x3f800000,0x3dc9bf7f,0xbf7bbe48,0xbe953f75
.long 0x3f800000,0x3f800000,0x3f800000,0x3f800000,0x3f6dbec4,0x3f62bef1,0x3f55bf0e,0x3f46bf22
.long 0x3f35bf35,0x3f0ebf55,0x3ec4bf6d,0x3e48bf7b,0x3ec4bf6d,0x3dc9bf7f,0xbe48bf7b,0xbef1bf62
.long 0xbf80,0xbec4bf6d,0xbf35bf35,0xbf6dbec4,0xbec4bf6d,0xbf46bf22,0xbf7bbe48,0xbf753e95
.long 0xbf35bf35,0xbf7bbe48,0xbf6d3ec4,0xbf0e3f55,0xbf6dbec4,0xbf753e95,0xbf0e3f55,0x3dc93f7f
.long 0xbf800000,0xbf353f35,0x3f80,0x3f353f35,0xbf6d3ec4,0xbe953f75,0x3f0e3f55,0x3f7f3dc9
.long 0xbf353f35,0x3e483f7b,0x3f6d3ec4,0x3f55bf0e,0xbec43f6d,0x3f223f46,0x3f7bbe48,0x3e95bf75
.long 0x3f80,0x3f6d3ec4,0x3f35bf35,0xbec4bf6d,0x3ec43f6d,0x3f7fbdc9,0x3e48bf7b,0xbf62bef1
.long 0x3f353f35,0x3f55bf0e,0xbec4bf6d,0xbf7b3e48,0x3f6d3ec4,0x3ef1bf62,0xbf55bf0e,0xbf223f46
.long 0x3f800000,0x3f800000,0x3f800000,0x3f800000,0x3f35bf35,0x3f22bf46,0x3f0ebf55,0x3ef1bf62
.long 0xbf80,0xbe48bf7b,0xbec4bf6d,0xbf0ebf55,0xbf35bf35,0xbf62bef1,0xbf7bbe48,0xbf7f3dc9
.long 0xbf800000,0xbf6d3ec4,0xbf353f35,0xbec43f6d,0xbf353f35,0xbe953f75,0x3e483f7b,0x3f223f46
.long 0x3f80,0x3f0e3f55,0x3f6d3ec4,0x3f7bbe48,0x3f353f35,0x3f7f3dc9,0x3f55bf0e,0x3e95bf75
.long 0x3f800000,0x3f35bf35,0xbf80,0xbf35bf35,0x3f35bf35,0xbdc9bf7f,0xbf55bf0e,0xbf753e95
.long 0xbf80,0xbf55bf0e,0xbf6d3ec4,0xbe483f7b,0xbf35bf35,0xbf753e95,0xbe483f7b,0x3f463f22
.long 0xbf800000,0xbec43f6d,0x3f353f35,0x3f6dbec4,0xbf353f35,0x3ef13f62,0x3f7bbe48,0x3dc9bf7f
.long 0x3f80,0x3f7b3e48,0x3ec4bf6d,0xbf55bf0e,0x3f353f35,0x3f46bf22,0xbf0ebf55,0xbf623ef1
.long 0x3f800000,0x3f800000,0x3f800000,0x3f800000,0x3ec4bf6d,0x3e95bf75,0x3e48bf7b,0x3dc9bf7f
.long 0xbf35bf35,0xbf55bf0e,0xbf6dbec4,0xbf7bbe48,0xbf6d3ec4,0xbf463f22,0xbf0e3f55,0xbe953f75
.long 0x3f80,0x3ec43f6d,0x3f353f35,0x3f6d3ec4,0x3f6d3ec4,0x3f7fbdc9,0x3f55bf0e,0x3ef1bf62
.long 0x3f35bf35,0x3e48bf7b,0xbec4bf6d,0xbf55bf0e,0xbec4bf6d,0xbf62bef1,0xbf7b3e48,0xbf223f46
.long 0xbf800000,0xbf353f35,0x3f80,0x3f353f35,0xbec43f6d,0x3ef13f62,0x3f7b3e48,0x3f46bf22
.long 0x3f353f35,0x3f7bbe48,0x3ec4bf6d,0xbf0ebf55,0x3f6dbec4,0x3dc9bf7f,0xbf55bf0e,0xbf623ef1
.long 0xbf80,0xbf6dbec4,0xbf353f35,0x3ec43f6d,0xbf6dbec4,0xbf223f46,0x3f0e3f55,0x3f75be95
.long 0xbf353f35,0x3f0e3f55,0x3f6dbec4,0xbe48bf7b,0x3ec43f6d,0x3f75be95,0xbe48bf7b,0xbf7f3dc9
.long 0x3f80,0x3f80,0x3f80,0x3f80,0x3f800000,0x3f7fbdc9,0x3f7bbe48,0x3f75be95
.long 0xbf80,0xbe48bf7b,0xbec4bf6d,0xbf0ebf55,0xbf800000,0xbf753e95,0xbf553f0e,0xbf223f46
.long 0x3f80,0x3ec43f6d,0x3f353f35,0x3f6d3ec4,0x3f800000,0x3f62bef1,0x3f0ebf55,0x3dc9bf7f
.long 0xbf80,0xbf0ebf55,0xbf6dbec4,0xbf7b3e48,0xbf800000,0xbf463f22,0xbe483f7b,0x3ef13f62
.long 0x3f80,0x3f353f35,0x3f800000,0x3f35bf35,0x3f800000,0x3f22bf46,0xbe48bf7b,0xbf62bef1
.long 0xbf80,0xbf55bf0e,0xbf6d3ec4,0xbe483f7b,0xbf800000,0xbef13f62,0x3f0e3f55,0x3f7fbdc9
.long 0x3f80,0x3f6d3ec4,0x3f35bf35,0xbec4bf6d,0x3f800000,0x3e95bf75,0xbf55bf0e,0xbf463f22
.long 0xbf80,0xbf7bbe48,0xbec43f6d,0x3f553f0e,0xbf800000,0xbdc93f7f,0x3f7b3e48,0x3e95bf75
.long 0x3f80,0x3f80,0x3f80,0x3f80,0x3f6dbec4,0x3f62bef1,0x3f55bf0e,0x3f46bf22
.long 0xbf35bf35,0xbf55bf0e,0xbf6dbec4,0xbf7bbe48,0xbec43f6d,0xbdc93f7f,0x3e483f7b,0x3ef13f62
.long 0x3f800000,0x3f6dbec4,0x3f35bf35,0x3ec4bf6d,0xbec4bf6d,0xbf46bf22,0xbf7bbe48,0xbf753e95
.long 0xbf353f35,0xbe483f7b,0x3ec43f6d,0x3f553f0e,0x3f6d3ec4,0x3f75be95,0x3f0ebf55,0xbdc9bf7f
.long 0xbf80,0xbf35bf35,0xbf800000,0xbf353f35,0xbf6d3ec4,0xbe953f75,0x3f0e3f55,0x3f7f3dc9
.long 0x3f353f35,0x3f7bbe48,0x3ec4bf6d,0xbf0ebf55,0x3ec4bf6d,0xbf22bf46,0xbf7b3e48,0xbe953f75
.long 0xbf800000,0xbec43f6d,0x3f353f35,0x3f6dbec4,0x3ec43f6d,0x3f7fbdc9,0x3e48bf7b,0xbf62bef1
.long 0x3f35bf35,0xbf0ebf55,0xbf6d3ec4,0x3e483f7b,0xbf6dbec4,0xbef13f62,0x3f553f0e,0x3f22bf46
.long 0x3f80,0x3f80,0x3f80,0x3f80,0x3f35bf35,0x3f22bf46,0x3f0ebf55,0x3ef1bf62
.long 0xbf800000,0xbf7b3e48,0xbf6d3ec4,0xbf553f0e,0x3f353f35,0x3f623ef1,0x3f7b3e48,0x3f7fbdc9
.long 0xbf80,0xbec4bf6d,0xbf35bf35,0xbf6dbec4,0xbf353f35,0xbe953f75,0x3e483f7b,0x3f223f46
.long 0x3f800000,0x3f55bf0e,0x3ec4bf6d,0xbe48bf7b,0xbf35bf35,0xbf7fbdc9,0xbf553f0e,0xbe953f75
.long 0x3f80,0x3f353f35,0x3f800000,0x3f35bf35,0x3f35bf35,0xbdc9bf7f,0xbf55bf0e,0xbf753e95
.long 0xbf800000,0xbf0e3f55,0x3ec43f6d,0x3f7b3e48,0x3f353f35,0x3f75be95,0x3e48bf7b,0xbf46bf22
.long 0xbf80,0xbf6dbec4,0xbf353f35,0x3ec43f6d,0xbf353f35,0x3ef13f62,0x3f7bbe48,0x3dc9bf7f
.long 0x3f800000,0x3e48bf7b,0xbf6dbec4,0xbf0e3f55,0xbf35bf35,0xbf463f22,0x3f0e3f55,0x3f62bef1
.long 0x3f80,0x3f80,0x3f80,0x3f80,0x3ec4bf6d,0x3e95bf75,0x3e48bf7b,0x3dc9bf7f
.long 0xbf353f35,0xbf0e3f55,0xbec43f6d,0xbe483f7b,0x3f6dbec4,0x3f46bf22,0x3f0ebf55,0x3e95bf75
.long 0xbf800000,0xbf6d3ec4,0xbf353f35,0xbec43f6d,0x3f6d3ec4,0x3f7fbdc9,0x3f55bf0e,0x3ef1bf62
.long 0xbf35bf35,0xbf7bbe48,0xbf6d3ec4,0xbf0e3f55,0x3ec43f6d,0x3f623ef1,0x3f7bbe48,0x3f22bf46
.long 0xbf80,0xbf35bf35,0xbf800000,0xbf353f35,0xbec43f6d,0x3ef13f62,0x3f7b3e48,0x3f46bf22
.long 0x3f35bf35,0xbe48bf7b,0xbf6dbec4,0xbf553f0e,0xbf6d3ec4,0xbdc93f7f,0x3f553f0e,0x3f62bef1
.long 0x3f800000,0x3ec4bf6d,0xbf35bf35,0xbf6d3ec4,0xbf6dbec4,0xbf223f46,0x3f0e3f55,0x3f75be95
.long 0x3f353f35,0x3f55bf0e,0xbec4bf6d,0xbf7b3e48,0xbec4bf6d,0xbf753e95,0x3e483f7b,0x3f7fbdc9
.long 0x3f800000,0x3f800000,0x3f800000,0x3f800000,0xbf80,0xbdc9bf7f,0xbe48bf7b,0xbe95bf75
.long 0xbf800000,0xbf7b3e48,0xbf6d3ec4,0xbf553f0e,0x3f80,0x3e953f75,0x3f0e3f55,0x3f463f22
.long 0x3f800000,0x3f6dbec4,0x3f35bf35,0x3ec4bf6d,0xbf80,0xbef1bf62,0xbf55bf0e,0xbf7fbdc9
.long 0xbf800000,0xbf553f0e,0xbec43f6d,0x3e483f7b,0x3f80,0x3f223f46,0x3f7b3e48,0x3f62bef1
.long 0x3f800000,0x3f35bf35,0xbf80,0xbf35bf35,0xbf80,0xbf46bf22,0xbf7b3e48,0xbef13f62
.long 0xbf800000,0xbf0e3f55,0x3ec43f6d,0x3f7b3e48,0x3f80,0x3f623ef1,0x3f55bf0e,0xbdc9bf7f
.long 0x3f800000,0x3ec4bf6d,0xbf35bf35,0xbf6d3ec4,0xbf80,0xbf75be95,0xbf0e3f55,0x3f223f46
.long 0xbf800000,0xbe483f7b,0x3f6d3ec4,0x3f0ebf55,0x3f80,0x3f7f3dc9,0x3e48bf7b,0xbf75be95
.long 0x3f800000,0x3f800000,0x3f800000,0x3f800000,0xbec4bf6d,0xbef1bf62,0xbf0ebf55,0xbf22bf46
.long 0xbf353f35,0xbf0e3f55,0xbec43f6d,0xbe483f7b,0x3f6d3ec4,0x3f7f3dc9,0x3f7bbe48,0x3f62bef1
.long 0xbf80,0xbec4bf6d,0xbf35bf35,0xbf6dbec4,0xbf6d3ec4,0xbf223f46,0xbe483f7b,0x3e953f75
.long 0x3f353f35,0x3f7b3e48,0x3f6dbec4,0x3f0ebf55,0x3ec4bf6d,0xbe95bf75,0xbf55bf0e,0xbf7f3dc9
.long 0xbf800000,0xbf353f35,0x3f80,0x3f353f35,0x3ec43f6d,0x3f753e95,0x3f55bf0e,0x3dc9bf7f
.long 0x3f35bf35,0xbe48bf7b,0xbf6dbec4,0xbf553f0e,0xbf6dbec4,0xbf463f22,0x3e483f7b,0x3f753e95
.long 0x3f80,0x3f6d3ec4,0x3f35bf35,0xbec4bf6d,0x3f6dbec4,0xbdc9bf7f,0xbf7bbe48,0xbef13f62
.long 0xbf35bf35,0xbf553f0e,0x3ec43f6d,0x3f7bbe48,0xbec43f6d,0x3f623ef1,0x3f0ebf55,0xbf46bf22
.long 0x3f800000,0x3f800000,0x3f800000,0x3f800000,0xbf35bf35,0xbf46bf22,0xbf55bf0e,0xbf62bef1
.long 0x3f80,0x3e483f7b,0x3ec43f6d,0x3f0e3f55,0x3f35bf35,0x3ef1bf62,0x3e48bf7b,0xbdc9bf7f
.long 0xbf800000,0xbf6d3ec4,0xbf353f35,0xbec43f6d,0x3f353f35,0x3f753e95,0x3f7bbe48,0x3f46bf22
.long 0xbf80,0xbf0ebf55,0xbf6dbec4,0xbf7b3e48,0xbf353f35,0xbdc93f7f,0x3f0e3f55,0x3f753e95
.long 0x3f800000,0x3f35bf35,0xbf80,0xbf35bf35,0xbf35bf35,0xbf7f3dc9,0xbf0e3f55,0x3e953f75
.long 0x3f80,0x3f553f0e,0x3f6dbec4,0x3e48bf7b,0x3f35bf35,0xbe95bf75,0xbf7bbe48,0xbf223f46
.long 0xbf800000,0xbec43f6d,0x3f353f35,0x3f6dbec4,0x3f353f35,0x3f62bef1,0xbe48bf7b,0xbf7fbdc9
.long 0xbf80,0xbf7bbe48,0xbec43f6d,0x3f553f0e,0xbf353f35,0x3f223f46,0x3f55bf0e,0xbef1bf62
.long 0x3f800000,0x3f800000,0x3f800000,0x3f800000,0xbf6dbec4,0xbf75be95,0xbf7bbe48,0xbf7fbdc9
.long 0x3f353f35,0x3f553f0e,0x3f6d3ec4,0x3f7b3e48,0xbec4bf6d,0xbf22bf46,0xbf55bf0e,0xbf75be95
.long 0x3f80,0x3ec43f6d,0x3f353f35,0x3f6d3ec4,0x3ec4bf6d,0xbdc9bf7f,0xbf0ebf55,0xbf62bef1
.long 0xbf353f35,0xbe483f7b,0x3ec43f6d,0x3f553f0e,0x3f6dbec4,0x3ef1bf62,0xbe48bf7b,0xbf46bf22
.long 0xbf800000,0xbf353f35,0x3f80,0x3f353f35,0x3f6d3ec4,0x3f62bef1,0x3e48bf7b,0xbf22bf46
.long 0xbf35bf35,0xbf7b3e48,0xbec43f6d,0x3f0e3f55,0x3ec43f6d,0x3f7f3dc9,0x3f0ebf55,0xbef1bf62
.long 0xbf80,0xbf6dbec4,0xbf353f35,0x3ec43f6d,0xbec43f6d,0x3f463f22,0x3f55bf0e,0xbe95bf75
.long 0x3f35bf35,0xbf0ebf55,0xbf6d3ec4,0x3e483f7b,0xbf6d3ec4,0x3e953f75,0x3f7bbe48,0xbdc9bf7f
.long 0x3f80,0x3f80,0x3f80,0x3f80,0xbf80,0xbdc9bf7f,0xbe48bf7b,0xbe95bf75
.long 0x3f80,0x3e483f7b,0x3ec43f6d,0x3f0e3f55,0xbf80,0xbe95bf75,0xbf0ebf55,0xbf46bf22
.long 0x3f80,0x3ec43f6d,0x3f353f35,0x3f6d3ec4,0xbf80,0xbef1bf62,0xbf55bf0e,0xbf7fbdc9
.long 0x3f80,0x3f0e3f55,0x3f6d3ec4,0x3f7bbe48,0xbf80,0xbf22bf46,0xbf7bbe48,0xbf623ef1
.long 0x3f80,0x3f353f35,0x3f800000,0x3f35bf35,0xbf80,0xbf46bf22,0xbf7b3e48,0xbef13f62
.long 0x3f80,0x3f553f0e,0x3f6dbec4,0x3e48bf7b,0xbf80,0xbf62bef1,0xbf553f0e,0x3dc93f7f
.long 0x3f80,0x3f6d3ec4,0x3f35bf35,0xbec4bf6d,0xbf80,0xbf75be95,0xbf0e3f55,0x3f223f46
.long 0x3f80,0x3f7b3e48,0x3ec4bf6d,0xbf55bf0e,0xbf80,0xbf7fbdc9,0xbe483f7b,0x3f753e95
.long 0x3f80,0x3f80,0x3f80,0x3f80,0xbec4bf6d,0xbef1bf62,0xbf0ebf55,0xbf22bf46
.long 0x3f353f35,0x3f553f0e,0x3f6d3ec4,0x3f7b3e48,0xbf6dbec4,0xbf7fbdc9,0xbf7b3e48,0xbf623ef1
.long 0x3f800000,0x3f6dbec4,0x3f35bf35,0x3ec4bf6d,0xbf6d3ec4,0xbf223f46,0xbe483f7b,0x3e953f75
.long 0x3f35bf35,0x3e48bf7b,0xbec4bf6d,0xbf55bf0e,0xbec43f6d,0x3e953f75,0x3f553f0e,0x3f7fbdc9
.long 0xbf80,0xbf35bf35,0xbf800000,0xbf353f35,0x3ec43f6d,0x3f753e95,0x3f55bf0e,0x3dc9bf7f
.long 0xbf35bf35,0xbf7b3e48,0xbec43f6d,0x3f0e3f55,0x3f6d3ec4,0x3f46bf22,0xbe48bf7b,0xbf75be95
.long 0xbf800000,0xbec43f6d,0x3f353f35,0x3f6dbec4,0x3f6dbec4,0xbdc9bf7f,0xbf7bbe48,0xbef13f62
.long 0xbf353f35,0x3f0e3f55,0x3f6dbec4,0xbe48bf7b,0x3ec4bf6d,0xbf62bef1,0xbf0e3f55,0x3f463f22
.long 0x3f80,0x3f80,0x3f80,0x3f80,0xbf35bf35,0xbf46bf22,0xbf55bf0e,0xbf62bef1
.long 0x3f800000,0x3f7bbe48,0x3f6dbec4,0x3f55bf0e,0xbf353f35,0xbef13f62,0xbe483f7b,0x3dc93f7f
.long 0xbf80,0xbec4bf6d,0xbf35bf35,0xbf6dbec4,0x3f353f35,0x3f753e95,0x3f7bbe48,0x3f46bf22
.long 0xbf800000,0xbf553f0e,0xbec43f6d,0x3e483f7b,0x3f35bf35,0x3dc9bf7f,0xbf0ebf55,0xbf75be95
.long 0x3f80,0x3f353f35,0x3f800000,0x3f35bf35,0xbf35bf35,0xbf7f3dc9,0xbf0e3f55,0x3e953f75
.long 0x3f800000,0x3f0ebf55,0xbec4bf6d,0xbf7bbe48,0xbf353f35,0x3e953f75,0x3f7b3e48,0x3f22bf46
.long 0xbf80,0xbf6dbec4,0xbf353f35,0x3ec43f6d,0x3f353f35,0x3f62bef1,0xbe48bf7b,0xbf7fbdc9
.long 0xbf800000,0xbe483f7b,0x3f6d3ec4,0x3f0ebf55,0x3f35bf35,0xbf22bf46,0xbf553f0e,0x3ef13f62
.long 0x3f80,0x3f80,0x3f80,0x3f80,0xbf6dbec4,0xbf75be95,0xbf7bbe48,0xbf7fbdc9
.long 0x3f35bf35,0x3f0ebf55,0x3ec4bf6d,0x3e48bf7b,0x3ec43f6d,0x3f223f46,0x3f553f0e,0x3f753e95
.long 0xbf800000,0xbf6d3ec4,0xbf353f35,0xbec43f6d,0x3ec4bf6d,0xbdc9bf7f,0xbf0ebf55,0xbf62bef1
.long 0x3f353f35,0x3f7b3e48,0x3f6dbec4,0x3f0ebf55,0xbf6d3ec4,0xbef13f62,0x3e483f7b,0x3f463f22
.long 0xbf80,0xbf35bf35,0xbf800000,0xbf353f35,0x3f6d3ec4,0x3f62bef1,0x3e48bf7b,0xbf22bf46
.long 0xbf353f35,0x3e483f7b,0x3f6d3ec4,0x3f55bf0e,0xbec4bf6d,0xbf7fbdc9,0xbf0e3f55,0x3ef13f62
.long 0x3f800000,0x3ec4bf6d,0xbf35bf35,0xbf6d3ec4,0xbec43f6d,0x3f463f22,0x3f55bf0e,0xbe95bf75
.long 0xbf35bf35,0xbf553f0e,0x3ec43f6d,0x3f7bbe48,0x3f6dbec4,0xbe95bf75,0xbf7b3e48,0x3dc93f7f
.long 0x3f800000,0x3f800000,0x3f800000,0x3f800000,0xbf800000,0xbf7f3dc9,0xbf7b3e48,0xbf753e95
.long 0x3f800000,0x3f7bbe48,0x3f6dbec4,0x3f55bf0e,0xbf800000,0xbf753e95,0xbf553f0e,0xbf223f46
.long 0x3f800000,0x3f6dbec4,0x3f35bf35,0x3ec4bf6d,0xbf800000,0xbf623ef1,0xbf0e3f55,0xbdc93f7f
.long 0x3f800000,0x3f55bf0e,0x3ec4bf6d,0xbe48bf7b,0xbf800000,0xbf463f22,0xbe483f7b,0x3ef13f62
.long 0x3f800000,0x3f35bf35,0xbf80,0xbf35bf35,0xbf800000,0xbf223f46,0x3e483f7b,0x3f623ef1
.long 0x3f800000,0x3f0ebf55,0xbec4bf6d,0xbf7bbe48,0xbf800000,0xbef13f62,0x3f0e3f55,0x3f7fbdc9
.long 0x3f800000,0x3ec4bf6d,0xbf35bf35,0xbf6d3ec4,0xbf800000,0xbe953f75,0x3f553f0e,0x3f46bf22
.long 0x3f800000,0x3e48bf7b,0xbf6dbec4,0xbf0e3f55,0xbf800000,0xbdc93f7f,0x3f7b3e48,0x3e95bf75
.long 0x3f800000,0x3f800000,0x3f800000,0x3f800000,0xbf6d3ec4,0xbf623ef1,0xbf553f0e,0xbf463f22
.long 0x3f35bf35,0x3f0ebf55,0x3ec4bf6d,0x3e48bf7b,0xbec43f6d,0xbdc93f7f,0x3e483f7b,0x3ef13f62
.long 0xbf80,0xbec4bf6d,0xbf35bf35,0xbf6dbec4,0x3ec43f6d,0x3f463f22,0x3f7b3e48,0x3f75be95
.long 0xbf35bf35,0xbf7bbe48,0xbf6d3ec4,0xbf0e3f55,0x3f6d3ec4,0x3f75be95,0x3f0ebf55,0xbdc9bf7f
.long 0xbf800000,0xbf353f35,0x3f80,0x3f353f35,0x3f6dbec4,0x3e95bf75,0xbf0ebf55,0xbf7fbdc9
.long 0xbf353f35,0x3e483f7b,0x3f6d3ec4,0x3f55bf0e,0x3ec4bf6d,0xbf22bf46,0xbf7b3e48,0xbe953f75
.long 0x3f80,0x3f6d3ec4,0x3f35bf35,0xbec4bf6d,0xbec4bf6d,0xbf7f3dc9,0xbe483f7b,0x3f623ef1
.long 0x3f353f35,0x3f55bf0e,0xbec4bf6d,0xbf7b3e48,0xbf6dbec4,0xbef13f62,0x3f553f0e,0x3f22bf46
.long 0x3f800000,0x3f800000,0x3f800000,0x3f800000,0xbf353f35,0xbf223f46,0xbf0e3f55,0xbef13f62
.long 0xbf80,0xbe48bf7b,0xbec4bf6d,0xbf0ebf55,0x3f353f35,0x3f623ef1,0x3f7b3e48,0x3f7fbdc9
.long 0xbf800000,0xbf6d3ec4,0xbf353f35,0xbec43f6d,0x3f35bf35,0x3e95bf75,0xbe48bf7b,0xbf22bf46
.long 0x3f80,0x3f0e3f55,0x3f6d3ec4,0x3f7bbe48,0xbf35bf35,0xbf7fbdc9,0xbf553f0e,0xbe953f75
.long 0x3f800000,0x3f35bf35,0xbf80,0xbf35bf35,0xbf353f35,0x3dc93f7f,0x3f553f0e,0x3f75be95
.long 0xbf80,0xbf55bf0e,0xbf6d3ec4,0xbe483f7b,0x3f353f35,0x3f75be95,0x3e48bf7b,0xbf46bf22
.long 0xbf800000,0xbec43f6d,0x3f353f35,0x3f6dbec4,0x3f35bf35,0xbef1bf62,0xbf7b3e48,0xbdc93f7f
.long 0x3f80,0x3f7b3e48,0x3ec4bf6d,0xbf55bf0e,0xbf35bf35,0xbf463f22,0x3f0e3f55,0x3f62bef1
.long 0x3f800000,0x3f800000,0x3f800000,0x3f800000,0xbec43f6d,0xbe953f75,0xbe483f7b,0xbdc93f7f
.long 0xbf35bf35,0xbf55bf0e,0xbf6dbec4,0xbf7bbe48,0x3f6dbec4,0x3f46bf22,0x3f0ebf55,0x3e95bf75
.long 0x3f80,0x3ec43f6d,0x3f353f35,0x3f6d3ec4,0xbf6dbec4,0xbf7f3dc9,0xbf553f0e,0xbef13f62
.long 0x3f35bf35,0x3e48bf7b,0xbec4bf6d,0xbf55bf0e,0x3ec43f6d,0x3f623ef1,0x3f7bbe48,0x3f22bf46
.long 0xbf800000,0xbf353f35,0x3f80,0x3f353f35,0x3ec4bf6d,0xbef1bf62,0xbf7bbe48,0xbf463f22
.long 0x3f353f35,0x3f7bbe48,0x3ec4bf6d,0xbf0ebf55,0xbf6d3ec4,0xbdc93f7f,0x3f553f0e,0x3f62bef1
.long 0xbf80,0xbf6dbec4,0xbf353f35,0x3ec43f6d,0x3f6d3ec4,0x3f22bf46,0xbf0ebf55,0xbf753e95
.long 0xbf353f35,0x3f0e3f55,0x3f6dbec4,0xbe48bf7b,0xbec4bf6d,0xbf753e95,0x3e483f7b,0x3f7fbdc9
.long 0x3f80,0x3f80,0x3f80,0x3f80,0xbf800000,0xbf7f3dc9,0xbf7b3e48,0xbf753e95
.long 0xbf80,0xbe48bf7b,0xbec4bf6d,0xbf0ebf55,0x3f800000,0x3f75be95,0x3f55bf0e,0x3f22bf46
.long 0x3f80,0x3ec43f6d,0x3f353f35,0x3f6d3ec4,0xbf800000,0xbf623ef1,0xbf0e3f55,0xbdc93f7f
.long 0xbf80,0xbf0ebf55,0xbf6dbec4,0xbf7b3e48,0x3f800000,0x3f46bf22,0x3e48bf7b,0xbef1bf62
.long 0x3f80,0x3f353f35,0x3f800000,0x3f35bf35,0xbf800000,0xbf223f46,0x3e483f7b,0x3f623ef1
.long 0xbf80,0xbf55bf0e,0xbf6d3ec4,0xbe483f7b,0x3f800000,0x3ef1bf62,0xbf0ebf55,0xbf7f3dc9
.long 0x3f80,0x3f6d3ec4,0x3f35bf35,0xbec4bf6d,0xbf800000,0xbe953f75,0x3f553f0e,0x3f46bf22
.long 0xbf80,0xbf7bbe48,0xbec43f6d,0x3f553f0e,0x3f800000,0x3dc9bf7f,0xbf7bbe48,0xbe953f75
.long 0x3f80,0x3f80,0x3f80,0x3f80,0xbf6d3ec4,0xbf623ef1,0xbf553f0e,0xbf463f22
.long 0xbf35bf35,0xbf55bf0e,0xbf6dbec4,0xbf7bbe48,0x3ec4bf6d,0x3dc9bf7f,0xbe48bf7b,0xbef1bf62
.long 0x3f800000,0x3f6dbec4,0x3f35bf35,0x3ec4bf6d,0x3ec43f6d,0x3f463f22,0x3f7b3e48,0x3f75be95
.long 0xbf353f35,0xbe483f7b,0x3ec43f6d,0x3f553f0e,0xbf6dbec4,0xbf753e95,0xbf0e3f55,0x3dc93f7f
.long 0xbf80,0xbf35bf35,0xbf800000,0xbf353f35,0x3f6dbec4,0x3e95bf75,0xbf0ebf55,0xbf7fbdc9
.long 0x3f353f35,0x3f7bbe48,0x3ec4bf6d,0xbf0ebf55,0xbec43f6d,0x3f223f46,0x3f7bbe48,0x3e95bf75
.long 0xbf800000,0xbec43f6d,0x3f353f35,0x3f6dbec4,0xbec4bf6d,0xbf7f3dc9,0xbe483f7b,0x3f623ef1
.long 0x3f35bf35,0xbf0ebf55,0xbf6d3ec4,0x3e483f7b,0x3f6d3ec4,0x3ef1bf62,0xbf55bf0e,0xbf223f46
.long 0x3f80,0x3f80,0x3f80,0x3f80,0xbf353f35,0xbf223f46,0xbf0e3f55,0xbef13f62
.long 0xbf800000,0xbf7b3e48,0xbf6d3ec4,0xbf553f0e,0xbf35bf35,0xbf62bef1,0xbf7bbe48,0xbf7f3dc9
.long 0xbf80,0xbec4bf6d,0xbf35bf35,0xbf6dbec4,0x3f35bf35,0x3e95bf75,0xbe48bf7b,0xbf22bf46
.long 0x3f800000,0x3f55bf0e,0x3ec4bf6d,0xbe48bf7b,0x3f353f35,0x3f7f3dc9,0x3f55bf0e,0x3e95bf75
.long 0x3f80,0x3f353f35,0x3f800000,0x3f35bf35,0xbf353f35,0x3dc93f7f,0x3f553f0e,0x3f75be95
.long 0xbf800000,0xbf0e3f55,0x3ec43f6d,0x3f7b3e48,0xbf35bf35,0xbf753e95,0xbe483f7b,0x3f463f22
.long 0xbf80,0xbf6dbec4,0xbf353f35,0x3ec43f6d,0x3f35bf35,0xbef1bf62,0xbf7b3e48,0xbdc93f7f
.long 0x3f800000,0x3e48bf7b,0xbf6dbec4,0xbf0e3f55,0x3f353f35,0x3f46bf22,0xbf0ebf55,0xbf623ef1
.long 0x3f80,0x3f80,0x3f80,0x3f80,0xbec43f6d,0xbe953f75,0xbe483f7b,0xbdc93f7f
.long 0xbf353f35,0xbf0e3f55,0xbec43f6d,0xbe483f7b,0xbf6d3ec4,0xbf463f22,0xbf0e3f55,0xbe953f75
.long 0xbf800000,0xbf6d3ec4,0xbf353f35,0xbec43f6d,0xbf6dbec4,0xbf7f3dc9,0xbf553f0e,0xbef13f62
.long 0xbf35bf35,0xbf7bbe48,0xbf6d3ec4,0xbf0e3f55,0xbec4bf6d,0xbf62bef1,0xbf7b3e48,0xbf223f46
.long 0xbf80,0xbf35bf35,0xbf800000,0xbf353f35,0x3ec4bf6d,0xbef1bf62,0xbf7bbe48,0xbf463f22
.long 0x3f35bf35,0xbe48bf7b,0xbf6dbec4,0xbf553f0e,0x3f6dbec4,0x3dc9bf7f,0xbf55bf0e,0xbf623ef1
.long 0x3f800000,0x3ec4bf6d,0xbf35bf35,0xbf6d3ec4,0x3f6d3ec4,0x3f22bf46,0xbf0ebf55,0xbf753e95
.long 0x3f353f35,0x3f55bf0e,0xbec4bf6d,0xbf7b3e48,0x3ec43f6d,0x3f75be95,0xbe48bf7b,0xbf7f3dc9
.long 0x3f800000,0x3f800000,0x3f800000,0x3f800000,0x3f80,0x3dc93f7f,0x3e483f7b,0x3e953f75
.long 0xbf800000,0xbf7b3e48,0xbf6d3ec4,0xbf553f0e,0xbf80,0xbe95bf75,0xbf0ebf55,0xbf46bf22
.long 0x3f800000,0x3f6dbec4,0x3f35bf35,0x3ec4bf6d,0x3f80,0x3ef13f62,0x3f553f0e,0x3f7f3dc9
.long 0xbf800000,0xbf553f0e,0xbec43f6d,0x3e483f7b,0xbf80,0xbf22bf46,0xbf7bbe48,0xbf623ef1
.long 0x3f800000,0x3f35bf35,0xbf80,0xbf35bf35,0x3f80,0x3f463f22,0x3f7bbe48,0x3ef1bf62
.long 0xbf800000,0xbf0e3f55,0x3ec43f6d,0x3f7b3e48,0xbf80,0xbf62bef1,0xbf553f0e,0x3dc93f7f
.long 0x3f800000,0x3ec4bf6d,0xbf35bf35,0xbf6d3ec4,0x3f80,0x3f753e95,0x3f0ebf55,0xbf22bf46
.long 0xbf800000,0xbe483f7b,0x3f6d3ec4,0x3f0ebf55,0xbf80,0xbf7fbdc9,0xbe483f7b,0x3f753e95
.long 0x3f800000,0x3f800000,0x3f800000,0x3f800000,0x3ec43f6d,0x3ef13f62,0x3f0e3f55,0x3f223f46
.long 0xbf353f35,0xbf0e3f55,0xbec43f6d,0xbe483f7b,0xbf6dbec4,0xbf7fbdc9,0xbf7b3e48,0xbf623ef1
.long 0xbf80,0xbec4bf6d,0xbf35bf35,0xbf6dbec4,0x3f6dbec4,0x3f22bf46,0x3e48bf7b,0xbe95bf75
.long 0x3f353f35,0x3f7b3e48,0x3f6dbec4,0x3f0ebf55,0xbec43f6d,0x3e953f75,0x3f553f0e,0x3f7fbdc9
.long 0xbf800000,0xbf353f35,0x3f80,0x3f353f35,0xbec4bf6d,0xbf75be95,0xbf553f0e,0xbdc93f7f
.long 0x3f35bf35,0xbe48bf7b,0xbf6dbec4,0xbf553f0e,0x3f6d3ec4,0x3f46bf22,0xbe48bf7b,0xbf75be95
.long 0x3f80,0x3f6d3ec4,0x3f35bf35,0xbec4bf6d,0xbf6d3ec4,0x3dc93f7f,0x3f7b3e48,0x3ef1bf62
.long 0xbf35bf35,0xbf553f0e,0x3ec43f6d,0x3f7bbe48,0x3ec4bf6d,0xbf62bef1,0xbf0e3f55,0x3f463f22
.long 0x3f800000,0x3f800000,0x3f800000,0x3f800000,0x3f353f35,0x3f463f22,0x3f553f0e,0x3f623ef1
.long 0x3f80,0x3e483f7b,0x3ec43f6d,0x3f0e3f55,0xbf353f35,0xbef13f62,0xbe483f7b,0x3dc93f7f
.long 0xbf800000,0xbf6d3ec4,0xbf353f35,0xbec43f6d,0xbf35bf35,0xbf75be95,0xbf7b3e48,0xbf463f22
.long 0xbf80,0xbf0ebf55,0xbf6dbec4,0xbf7b3e48,0x3f35bf35,0x3dc9bf7f,0xbf0ebf55,0xbf75be95
.long 0x3f800000,0x3f35bf35,0xbf80,0xbf35bf35,0x3f353f35,0x3f7fbdc9,0x3f0ebf55,0xbe95bf75
.long 0x3f80,0x3f553f0e,0x3f6dbec4,0x3e48bf7b,0xbf353f35,0x3e953f75,0x3f7b3e48,0x3f22bf46
.long 0xbf800000,0xbec43f6d,0x3f353f35,0x3f6dbec4,0xbf35bf35,0xbf623ef1,0x3e483f7b,0x3f7f3dc9
.long 0xbf80,0xbf7bbe48,0xbec43f6d,0x3f553f0e,0x3f35bf35,0xbf22bf46,0xbf553f0e,0x3ef13f62
.long 0x3f800000,0x3f800000,0x3f800000,0x3f800000,0x3f6d3ec4,0x3f753e95,0x3f7b3e48,0x3f7f3dc9
.long 0x3f353f35,0x3f553f0e,0x3f6d3ec4,0x3f7b3e48,0x3ec43f6d,0x3f223f46,0x3f553f0e,0x3f753e95
.long 0x3f80,0x3ec43f6d,0x3f353f35,0x3f6d3ec4,0xbec43f6d,0x3dc93f7f,0x3f0e3f55,0x3f623ef1
.long 0xbf353f35,0xbe483f7b,0x3ec43f6d,0x3f553f0e,0xbf6d3ec4,0xbef13f62,0x3e483f7b,0x3f463f22
.long 0xbf800000,0xbf353f35,0x3f80,0x3f353f35,0xbf6dbec4,0xbf623ef1,0xbe483f7b,0x3f223f46
.long 0xbf35bf35,0xbf7b3e48,0xbec43f6d,0x3f0e3f55,0xbec4bf6d,0xbf7fbdc9,0xbf0e3f55,0x3ef13f62
.long 0xbf80,0xbf6dbec4,0xbf353f35,0x3ec43f6d,0x3ec4bf6d,0xbf46bf22,0xbf553f0e,0x3e953f75
.long 0x3f35bf35,0xbf0ebf55,0xbf6d3ec4,0x3e483f7b,0x3f6dbec4,0xbe95bf75,0xbf7b3e48,0x3dc93f7f
.long 0x3f800000,0x3f800000,0x3f800000,0x3f800000,0x3f800000,0x3f7fffb1,0x3f7ffec4,0x3f7ffd39
.long 0x3f800000,0x3f7ffec4,0x3f7ffb11,0x3f7ff4e6,0x3f800000,0x3f7ffd39,0x3f7ff4e6,0x3f7fe705
.long 0x3f800000,0x3f7ffb11,0x3f7fec43,0x3f7fd397,0x3f800000,0x3f7ff84a,0x3f7fe129,0x3f7fba9e
.long 0x3f800000,0x3f7ff4e6,0x3f7fd397,0x3f7f9c18,0x3f800000,0x3f7ff0e3,0x3f7fc38f,0x3f7f7808
.long 0x3f800000,0x3f7fec43,0x3f7fb10f,0x3f7f4e6d,0x3f800000,0x3f7fe705,0x3f7f9c18,0x3f7f1f49
.long 0x3f800000,0x3f7fe129,0x3f7f84ab,0x3f7eea9d,0x3f800000,0x3f7fdaaf,0x3f7f6ac7,0x3f7eb069
.long 0x3f800000,0x3f7fd397,0x3f7f4e6d,0x3f7e70b0,0x3f800000,0x3f7fcbe2,0x3f7f2f9d,0x3f7e2b72
.long 0x3f800000,0x3f7fc38f,0x3f7f0e58,0x3f7de0b1,0x3f800000,0x3f7fba9e,0x3f7eea9d,0x3f7d906e
.long 0x3f800000,0x3f800000,0x3f800000,0x3f800000,0x3f7ffb11,0x3f7ff84a,0x3f7ff4e6,0x3f7ff0e3
.long 0x3f7fec43,0x3f7fe129,0x3f7fd397,0x3f7fc38f,0x3f7fd397,0x3f7fba9e,0x3f7f9c18,0x3f7f7808
.long 0x3f7fb10f,0x3f7f84ab,0x3f7f4e6d,0x3f7f0e58,0x3f7f84ab,0x3f7f3f54,0x3f7eea9d,0x3f7e868b
.long 0x3f7f4e6d,0x3f7eea9d,0x3f7e70b0,0x3f7de0b1,0x3f7f0e58,0x3f7e868b,0x3f7de0b1,0x3f7d1cdd
.long 0x3f7ec46d,0x3f7e1324,0x3f7d3aac,0x3f7c3b28,0x3f7e70b0,0x3f7d906e,0x3f7c7eb0,0x3f7b3bab
.long 0x3f7e1324,0x3f7cfe73,0x3f7baccd,0x3f7a1e84,0x3f7dabcc,0x3f7c5d3a,0x3f7ac516,0x3f78e3d6
.long 0x3f7d3aac,0x3f7baccd,0x3f79c79d,0x3f778bc5,0x3f7cbfc9,0x3f7aed37,0x3f78b47b,0x3f76167a
.long 0x3f7c3b28,0x3f7a1e84,0x3f778bc5,0x3f748422,0x3f7baccd,0x3f7940c0,0x3f764d97,0x3f72d4eb
.long 0x3f800000,0x3f800000,0x3f800000,0x3f800000,0x3f7fec43,0x3f7fe705,0x3f7fe129,0x3f7fdaaf
.long 0x3f7fb10f,0x3f7f9c18,0x3f7f84ab,0x3f7f6ac7,0x3f7f4e6d,0x3f7f1f49,0x3f7eea9d,0x3f7eb069
.long 0x3f7ec46d,0x3f7e70b0,0x3f7e1324,0x3f7dabcc,0x3f7e1324,0x3f7d906e,0x3f7cfe73,0x3f7c5d3a
.long 0x3f7d3aac,0x3f7c7eb0,0x3f7baccd,0x3f7ac516,0x3f7c3b28,0x3f7b3bab,0x3f7a1e84,0x3f78e3d6
.long 0x3f7b14be,0x3f79c79d,0x3f7853f8,0x3f76ba07,0x3f79c79d,0x3f7822d1,0x3f764d97,0x3f74484b
.long 0x3f7853f8,0x3f764d97,0x3f740bdd,0x3f718f57,0x3f76ba07,0x3f74484b,0x3f718f57,0x3f6e8ff8
.long 0x3f74fa0b,0x3f721352,0x3f6ed89e,0x3f6b4b0c,0x3f731447,0x3f6faf1b,0x3f6be858,0x3f67c187
.long 0x3f710908,0x3f6d1c1d,0x3f68bf3c,0x3f63f473,0x3f6ed89e,0x3f6a5ad9,0x3f655e0b,0x3f5fe4e9
.long 0x3f800000,0x3f800000,0x3f800000,0x3f800000,0x3f7fd397,0x3f7fcbe2,0x3f7fc38f,0x3f7fba9e
.long 0x3f7f4e6d,0x3f7f2f9d,0x3f7f0e58,0x3f7eea9d,0x3f7e70b0,0x3f7e2b72,0x3f7de0b1,0x3f7d906e
.long 0x3f7d3aac,0x3f7cbfc9,0x3f7c3b28,0x3f7baccd,0x3f7baccd,0x3f7aed37,0x3f7a1e84,0x3f7940c0
.long 0x3f79c79d,0x3f78b47b,0x3f778bc5,0x3f764d97,0x3f778bc5,0x3f76167a,0x3f748422,0x3f72d4eb
.long 0x3f74fa0b,0x3f731447,0x3f710908,0x3f6ed89e,0x3f721352,0x3f6faf1b,0x3f6d1c1d,0x3f6a5ad9
.long 0x3f6ed89e,0x3f6be858,0x3f68bf3c,0x3f655e0b,0x3f6b4b0c,0x3f67c187,0x3f63f473,0x3f5fe4e9
.long 0x3f676bd8,0x3f633c5a,0x3f5ebe05,0x3f59f26a,0x3f633c5a,0x3f5e5aa6,0x3f591e6a,0x3f5389c7
.long 0x3f5ebe05,0x3f591e6a,0x3f531849,0x3f4cae79,0x3f59f26a,0x3f5389c7,0x3f4cae79,0x3f456439
.long 0x3f800000,0x3f800000,0x3f800000,0x3f800000,0x3f7fb10f,0x3f7fa6e3,0x3f7f9c18,0x3f7f90b1
.long 0x3f7ec46d,0x3f7e9bc9,0x3f7e70b0,0x3f7e4323,0x3f7d3aac,0x3f7cdf6c,0x3f7c7eb0,0x3f7c187a
.long 0x3f7b14be,0x3f7a7302,0x3f79c79d,0x3f791298,0x3f7853f8,0x3f77583a,0x3f764d97,0x3f75341d
.long 0x3f74fa0b,0x3f73913f,0x3f721352,0x3f708066,0x3f710908,0x3f6f20b0,0x3f6d1c1d,0x3f6afb8c
.long 0x3f6c835e,0x3f6a09a7,0x3f676bd8,0x3f64aa59,0x3f676bd8,0x3f644fac,0x3f6106f2,0x3f5d924d
.long 0x3f61c598,0x3f5df6be,0x3f59f26a,0x3f55b993,0x3f5b941a,0x3f570348,0x3f5233c6,0x3f4d26fd
.long 0x3f54db31,0x3f4f7a1f,0x3f49d112,0x3f43e200,0x3f4d9f02,0x3f476085,0x3f40d0da,0x3f39f2ac
.long 0x3f45e403,0x3f3ebc1b,0x3f373a23,0x3f2f61a5,0x3f3daef9,0x3f3592e7,0x3f2d1469,0x3f24381a
.long 0x3f800000,0x3f800000,0x3f800000,0x3f800000,0x3f7f84ab,0x3f7f7808,0x3f7f6ac7,0x3f7f5ce9
.long 0x3f7e1324,0x3f7de0b1,0x3f7dabcc,0x3f7d7474,0x3f7baccd,0x3f7b3bab,0x3f7ac516,0x3f7a4910
.long 0x3f7853f8,0x3f778bc5,0x3f76ba07,0x3f75dec6,0x3f740bdd,0x3f72d4eb,0x3f718f57,0x3f703b37
.long 0x3f6ed89e,0x3f6d1c1d,0x3f6b4b0c,0x3f696591,0x3f68bf3c,0x3f666771,0x3f63f473,0x3f61668a
.long 0x3f61c598,0x3f5ebe05,0x3f5b941a,0x3f584853,0x3f59f26a,0x3f5627fe,0x3f5233c6,0x3f4e1689
.long 0x3f514d3d,0x3f4cae79,0x3f47de65,0x3f42de29,0x3f47de65,0x3f425b89,0x3f3ca003,0x3f36ad7f
.long 0x3f3daef9,0x3f373a23,0x3f3085bb,0x3f299415,0x3f32c8c9,0x3f2b561b,0x3f239da9,0x3f1ba299
.long 0x3f273656,0x3f1ebc12,0x3f15f6d9,0x3f0cead0,0x3f1b02c6,0x3f11796b,0x3f07a136,0x3efafef7
.long 0x3f800000,0x3f800000,0x3f800000,0x3f800000,0x3f7f4e6d,0x3f7f3f54,0x3f7f2f9d,0x3f7f1f49
.long 0x3f7d3aac,0x3f7cfe73,0x3f7cbfc9,0x3f7c7eb0,0x3f79c79d,0x3f7940c0,0x3f78b47b,0x3f7822d1
.long 0x3f74fa0b,0x3f740bdd,0x3f731447,0x3f721352,0x3f6ed89e,0x3f6d67a1,0x3f6be858,0x3f6a5ad9
.long 0x3f676bd8,0x3f655e0b,0x3f633c5a,0x3f6106f2,0x3f5ebe05,0x3f5bfb34,0x3f591e6a,0x3f5627fe
.long 0x3f54db31,0x3f514d3d,0x3f4d9f02,0x3f49d112,0x3f49d112,0x3f456439,0x3f40d0da,0x3f3c17d9
.long 0x3f3daef9,0x3f385216,0x3f32c8c9,0x3f2d1469,0x3f3085bb,0x3f2a2a80,0x3f239da9,0x3f1ce11f
.long 0x3f226799,0x3f1b02c6,0x3f13682a,0x3f0b9a6b,0x3f13682a,0x3f0af1b7,0x3f0242b1,0x3ef2bd43
.long 0x3f039c3d,0x3ef41f07,0x3ee0924f,0x3ecc9b8b,0x3ee63375,0x3ed0eb2a,0x3ebb31a0,0x3ea5129f
.long 0x3f800000,0x3f800000,0x3f800000,0x3f800000,0x3f7f0e58,0x3f7efcc9,0x3f7eea9d,0x3f7ed7d4
.long 0x3f7c3b28,0x3f7bf531,0x3f7baccd,0x3f7b61fc,0x3f778bc5,0x3f76ef5b,0x3f764d97,0x3f75a67b
.long 0x3f710908,0x3f6ff573,0x3f6ed89e,0x3f6db293,0x3f68bf3c,0x3f671599,0x3f655e0b,0x3f6398ac
.long 0x3f5ebe05,0x3f5c61c7,0x3f59f26a,0x3f577026,0x3f531849,0x3f4fefa8,0x3f4cae79,0x3f495521
.long 0x3f45e403,0x3f41d870,0x3f3daef9,0x3f396842,0x3f373a23,0x3f3238aa,0x3f2d1469,0x3f27ce61
.long 0x3f273656,0x3f212ff9,0x3f1b02c6,0x3f14b039,0x3f15f6d9,0x3f0ee0db,0x3f07a136,0x3f003a06
.long 0x3f039c3d,0x3ef6e0cb,0x3ee63375,0x3ed53641,0x3ee0924f,0x3ece0bea,0x3ebb31a0,0x3ea80b1f
.long 0x3eb8442a,0x3ea395c5,0x3e8e9a22,0x3e72b651,0x3e8e9a22,0x3e6fa8b2,0x3e419b37,0x3e1324ca
.long 0x0,0x0,0x0,0x0,0x0,0xbb490fc6,0xbbc90f88,0xbc16cb58
.long 0x0,0xbbc90f88,0xbc490e90,0xbc96c9b6,0x0,0xbc16cb58,0xbc96c9b6,0xbce22a7a
.long 0x0,0xbc490e90,0xbcc90ab0,0xbd16c32c,0x0,0xbc7b514b,0xbcfb49ba,0xbd3c6dd5
.long 0x0,0xbc96c9b6,0xbd16c32c,0xbd621469,0x0,0xbcafea69,0xbd2fe007,0xbd83db0a
.long 0x0,0xbcc90ab0,0xbd48fb30,0xbd96a905,0x0,0xbce22a7a,0xbd621469,0xbda973ba
.long 0x0,0xbcfb49ba,0xbd7b2b74,0xbdbc3ac3,0x0,0xbd0a342f,0xbd8a200a,0xbdcefdb7
.long 0x0,0xbd16c32c,0xbd96a905,0xbde1bc2e,0x0,0xbd2351cb,0xbda3308c,0xbdf475c0
.long 0x0,0xbd2fe007,0xbdafb680,0xbe039502,0x0,0xbd3c6dd5,0xbdbc3ac3,0xbe0cec4a
.long 0x0,0x0,0x0,0x0,0xbc490e90,0xbc7b514b,0xbc96c9b6,0xbcafea69
.long 0xbcc90ab0,0xbcfb49ba,0xbd16c32c,0xbd2fe007,0xbd16c32c,0xbd3c6dd5,0xbd621469,0xbd83db0a
.long 0xbd48fb30,0xbd7b2b74,0xbd96a905,0xbdafb680,0xbd7b2b74,0xbd9cecf9,0xbdbc3ac3,0xbddb7d37
.long 0xbd96a905,0xbdbc3ac3,0xbde1bc2e,0xbe039502,0xbdafb680,0xbddb7d37,0xbe039502,0xbe195be0
.long 0xbdc8bd36,0xbdfab273,0xbe164083,0xbe2f10a2,0xbde1bc2e,0xbe0cec4a,0xbe28defc,0xbe44b0b9
.long 0xbdfab273,0xbe1c76de,0xbe3b6ecf,0xbe5a3997,0xbe09cf86,0xbe2bf804,0xbe4dee60,0xbe6fa8b2
.long 0xbe164083,0xbe3b6ecf,0xbe605c13,0xbe827dc0,0xbe22abb6,0xbe4ada4f,0xbe72b651,0xbe8d17c0
.long 0xbe2f10a2,0xbe5a3997,0xbe827dc0,0xbe97a117,0xbe3b6ecf,0xbe698bba,0xbe8b9507,0xbea21887
.long 0x0,0x0,0x0,0x0,0xbcc90ab0,0xbce22a7a,0xbcfb49ba,0xbd0a342f
.long 0xbd48fb30,0xbd621469,0xbd7b2b74,0xbd8a200a,0xbd96a905,0xbda973ba,0xbdbc3ac3,0xbdcefdb7
.long 0xbdc8bd36,0xbde1bc2e,0xbdfab273,0xbe09cf86,0xbdfab273,0xbe0cec4a,0xbe1c76de,0xbe2bf804
.long 0xbe164083,0xbe28defc,0xbe3b6ecf,0xbe4dee60,0xbe2f10a2,0xbe44b0b9,0xbe5a3997,0xbe6fa8b2
.long 0xbe47c5c2,0xbe605c13,0xbe78cfcc,0xbe888e93,0xbe605c13,0xbe7bdba4,0xbe8b9507,0xbe9920fe
.long 0xbe78cfcc,0xbe8b9507,0xbe9aa086,0xbea986c4,0xbe888e93,0xbe9920fe,0xbea986c4,0xbeb9bb1e
.long 0xbe94a031,0xbea68f12,0xbeb8442a,0xbec9b953,0xbea09ae5,0xbeb3dca5,0xbec6d529,0xbed97cb9
.long 0xbeac7cd4,0xbec1071e,0xbed53641,0xbee900b7,0xbeb8442a,0xbece0bea,0xbee363fa,0xbef840c8
.long 0x0,0x0,0x0,0x0,0xbd16c32c,0xbd2351cb,0xbd2fe007,0xbd3c6dd5
.long 0xbd96a905,0xbda3308c,0xbdafb680,0xbdbc3ac3,0xbde1bc2e,0xbdf475c0,0xbe039502,0xbe0cec4a
.long 0xbe164083,0xbe22abb6,0xbe2f10a2,0xbe3b6ecf,0xbe3b6ecf,0xbe4ada4f,0xbe5a3997,0xbe698bba
.long 0xbe605c13,0xbe72b651,0xbe827dc0,0xbe8b9507,0xbe827dc0,0xbe8d17c0,0xbe97a117,0xbea21887
.long 0xbe94a031,0xbea09ae5,0xbeac7cd4,0xbeb8442a,0xbea68f12,0xbeb3dca5,0xbec1071e,0xbece0bea
.long 0xbeb8442a,0xbec6d529,0xbed53641,0xbee363fa,0xbec9b953,0xbed97cb9,0xbee900b7,0xbef840c8
.long 0xbedae880,0xbeebcbbb,0xbefc5d27,0xbf064b82,0xbeebcbbb,0xbefdbabb,0xbf07a136,0xbf102dd5
.long 0xbefc5d27,0xbf07a136,0xbf10d3cd,0xbf19c200,0xbf064b82,0xbf102dd5,0xbf19c200,0xbf2302d3
.long 0x0,0x0,0x0,0x0,0xbd48fb30,0xbd55880e,0xbd621469,0xbd6ea038
.long 0xbdc8bd36,0xbdd53db9,0xbde1bc2e,0xbdee3876,0xbe164083,0xbe1f917b,0xbe28defc,0xbe3228d4
.long 0xbe47c5c2,0xbe541501,0xbe605c13,0xbe6c9a7f,0xbe78cfcc,0xbe840270,0xbe8b9507,0xbe931f35
.long 0xbe94a031,0xbe9d9e78,0xbea68f12,0xbeaf713a,0xbeac7cd4,0xbeb6ccc3,0xbec1071e,0xbecb2aae
.long 0xbec3ef15,0xbecf7bca,0xbedae880,0xbee63375,0xbedae880,0xbee79a5d,0xbef41f07,0xbf003a06
.long 0xbef15aea,0xbeff17b2,0xbf064b82,0xbf0cead0,0xbf039c3d,0xbf0af1b7,0xbf121eb0,0xbf19210f
.long 0xbf0e39da,0xbf15f6d9,0xbf1d7fd1,0xbf24d225,0xbf187fc0,0xbf209393,0xbf286605,0xbf2ff3e6
.long 0xbf226799,0xbf2ac082,0xbf32c8c9,0xbf3a7ca4,0xbf2beb4a,0xbf34768f,0xbf3ca003,0xbf446337
.long 0x0,0x0,0x0,0x0,0xbd7b2b74,0xbd83db0a,0xbd8a200a,0xbd9064b4
.long 0xbdfab273,0xbe039502,0xbe09cf86,0xbe1008b7,0xbe3b6ecf,0xbe44b0b9,0xbe4dee60,0xbe57278f
.long 0xbe78cfcc,0xbe827dc0,0xbe888e93,0xbe8e9a22,0xbe9aa086,0xbea21887,0xbea986c4,0xbeb0eacb
.long 0xbeb8442a,0xbec1071e,0xbec9b953,0xbed25a09,0xbed53641,0xbedf28a9,0xbee900b7,0xbef2bd43
.long 0xbef15aea,0xbefc5d27,0xbf039c3d,0xbf08f59b,0xbf064b82,0xbf0c42c9,0xbf121eb0,0xbf17de12
.long 0xbf13682a,0xbf19c200,0xbf1ff6cb,0xbf26050a,0xbf1ff6cb,0xbf269de3,0xbf2d1469,0xbf33587a
.long 0xbf2beb4a,0xbf32c8c9,0xbf396842,0xbf3fc767,0xbf373a23,0xbf3e35c5,0xbf44e3f5,0xbf4b41fa
.long 0xbf41d870,0xbf48d8b3,0xbf4f7a1f,0xbf55b993,0xbf4bbbf8,0xbf52a649,0xbf591e6a,0xbf5f20db
.long 0x0,0x0,0x0,0x0,0xbd96a905,0xbd9cecf9,0xbda3308c,0xbda973ba
.long 0xbe164083,0xbe1c76de,0xbe22abb6,0xbe28defc,0xbe605c13,0xbe698bba,0xbe72b651,0xbe7bdba4
.long 0xbe94a031,0xbe9aa086,0xbea09ae5,0xbea68f12,0xbeb8442a,0xbebf926f,0xbec6d529,0xbece0bea
.long 0xbedae880,0xbee363fa,0xbeebcbbb,0xbef41f07,0xbefc5d27,0xbf02ef9f,0xbf07a136,0xbf0c42c9
.long 0xbf0e39da,0xbf13682a,0xbf187fc0,0xbf1d7fd1,0xbf1d7fd1,0xbf2302d3,0xbf286605,0xbf2da859
.long 0xbf2beb4a,0xbf31a81d,0xbf373a23,0xbf3ca003,0xbf396842,0xbf3f41fc,0xbf44e3f5,0xbf4a4c87
.long 0xbf45e403,0xbf4bbbf8,0xbf514d3d,0xbf5695e5,0xbf514d3d,0xbf570348,0xbf5c61c7,0xbf61668a
.long 0xbf5b941a,0xbf6106f2,0xbf660f88,0xbf6aab7b,0xbf64aa59,0xbf69b7e4,0xbf6e46be,0xbf725470
.long 0x0,0x0,0x0,0x0,0xbdafb680,0xbdb5f8da,0xbdbc3ac3,0xbdc27c39
.long 0xbe2f10a2,0xbe354098,0xbe3b6ecf,0xbe419b37,0xbe827dc0,0xbe870ada,0xbe8b9507,0xbe901c2c
.long 0xbeac7cd4,0xbeb263ef,0xbeb8442a,0xbebe1d4a,0xbed53641,0xbedc53c1,0xbee363fa,0xbeea6681
.long 0xbefc5d27,0xbf0242b1,0xbf064b82,0xbf0a48ad,0xbf10d3cd,0xbf1553b7,0xbf19c200,0xbf1e1e22
.long 0xbf226799,0xbf273656,0xbf2beb4a,0xbf3085bb,0xbf32c8c9,0xbf37c655,0xbf3ca003,0xbf4154e1
.long 0xbf41d870,0xbf46e22a,0xbf4bbbf8,0xbf5064af,0xbf4f7a1f,0xbf546b3b,0xbf591e6a,0xbf5d924d
.long 0xbf5b941a,0xbf604621,0xbf64aa59,0xbf68bf3c,0xbf660f88,0xbf6a5ad9,0xbf6e46be,0xbf71d19f
.long 0xbf6ed89e,0xbf7294f8,0xbf75dec6,0xbf78b47b,0xbf75dec6,0xbf78e3d6,0xbf7b61fc,0xbf7d57de
.long 0x3f800000,0x3f800000,0x3f800000,0x3f800000,0x3f800000,0x3f7fffb1,0x3f7ffec4,0x3f7ffd39
.long 0x3f800000,0x3f7ffec4,0x3f7ffb11,0x3f7ff4e6,0x3f800000,0x3f7ffd39,0x3f7ff4e6,0x3f7fe705
.long 0x3f800000,0x3f7ffb11,0x3f7fec43,0x3f7fd397,0x3f800000,0x3f7ff84a,0x3f7fe129,0x3f7fba9e
.long 0x3f800000,0x3f7ff4e6,0x3f7fd397,0x3f7f9c18,0x3f800000,0x3f7ff0e3,0x3f7fc38f,0x3f7f7808
.long 0x3f800000,0x3f7fec43,0x3f7fb10f,0x3f7f4e6d,0x3f800000,0x3f7fe705,0x3f7f9c18,0x3f7f1f49
.long 0x3f800000,0x3f7fe129,0x3f7f84ab,0x3f7eea9d,0x3f800000,0x3f7fdaaf,0x3f7f6ac7,0x3f7eb069
.long 0x3f800000,0x3f7fd397,0x3f7f4e6d,0x3f7e70b0,0x3f800000,0x3f7fcbe2,0x3f7f2f9d,0x3f7e2b72
.long 0x3f800000,0x3f7fc38f,0x3f7f0e58,0x3f7de0b1,0x3f800000,0x3f7fba9e,0x3f7eea9d,0x3f7d906e
.long 0x3f800000,0x3f800000,0x3f800000,0x3f800000,0x3f7ffb11,0x3f7ff84a,0x3f7ff4e6,0x3f7ff0e3
.long 0x3f7fec43,0x3f7fe129,0x3f7fd397,0x3f7fc38f,0x3f7fd397,0x3f7fba9e,0x3f7f9c18,0x3f7f7808
.long 0x3f7fb10f,0x3f7f84ab,0x3f7f4e6d,0x3f7f0e58,0x3f7f84ab,0x3f7f3f54,0x3f7eea9d,0x3f7e868b
.long 0x3f7f4e6d,0x3f7eea9d,0x3f7e70b0,0x3f7de0b1,0x3f7f0e58,0x3f7e868b,0x3f7de0b1,0x3f7d1cdd
.long 0x3f7ec46d,0x3f7e1324,0x3f7d3aac,0x3f7c3b28,0x3f7e70b0,0x3f7d906e,0x3f7c7eb0,0x3f7b3bab
.long 0x3f7e1324,0x3f7cfe73,0x3f7baccd,0x3f7a1e84,0x3f7dabcc,0x3f7c5d3a,0x3f7ac516,0x3f78e3d6
.long 0x3f7d3aac,0x3f7baccd,0x3f79c79d,0x3f778bc5,0x3f7cbfc9,0x3f7aed37,0x3f78b47b,0x3f76167a
.long 0x3f7c3b28,0x3f7a1e84,0x3f778bc5,0x3f748422,0x3f7baccd,0x3f7940c0,0x3f764d97,0x3f72d4eb
.long 0x3f800000,0x3f800000,0x3f800000,0x3f800000,0x3f7fec43,0x3f7fe705,0x3f7fe129,0x3f7fdaaf
.long 0x3f7fb10f,0x3f7f9c18,0x3f7f84ab,0x3f7f6ac7,0x3f7f4e6d,0x3f7f1f49,0x3f7eea9d,0x3f7eb069
.long 0x3f7ec46d,0x3f7e70b0,0x3f7e1324,0x3f7dabcc,0x3f7e1324,0x3f7d906e,0x3f7cfe73,0x3f7c5d3a
.long 0x3f7d3aac,0x3f7c7eb0,0x3f7baccd,0x3f7ac516,0x3f7c3b28,0x3f7b3bab,0x3f7a1e84,0x3f78e3d6
.long 0x3f7b14be,0x3f79c79d,0x3f7853f8,0x3f76ba07,0x3f79c79d,0x3f7822d1,0x3f764d97,0x3f74484b
.long 0x3f7853f8,0x3f764d97,0x3f740bdd,0x3f718f57,0x3f76ba07,0x3f74484b,0x3f718f57,0x3f6e8ff8
.long 0x3f74fa0b,0x3f721352,0x3f6ed89e,0x3f6b4b0c,0x3f731447,0x3f6faf1b,0x3f6be858,0x3f67c187
.long 0x3f710908,0x3f6d1c1d,0x3f68bf3c,0x3f63f473,0x3f6ed89e,0x3f6a5ad9,0x3f655e0b,0x3f5fe4e9
.long 0x3f800000,0x3f800000,0x3f800000,0x3f800000,0x3f7fd397,0x3f7fcbe2,0x3f7fc38f,0x3f7fba9e
.long 0x3f7f4e6d,0x3f7f2f9d,0x3f7f0e58,0x3f7eea9d,0x3f7e70b0,0x3f7e2b72,0x3f7de0b1,0x3f7d906e
.long 0x3f7d3aac,0x3f7cbfc9,0x3f7c3b28,0x3f7baccd,0x3f7baccd,0x3f7aed37,0x3f7a1e84,0x3f7940c0
.long 0x3f79c79d,0x3f78b47b,0x3f778bc5,0x3f764d97,0x3f778bc5,0x3f76167a,0x3f748422,0x3f72d4eb
.long 0x3f74fa0b,0x3f731447,0x3f710908,0x3f6ed89e,0x3f721352,0x3f6faf1b,0x3f6d1c1d,0x3f6a5ad9
.long 0x3f6ed89e,0x3f6be858,0x3f68bf3c,0x3f655e0b,0x3f6b4b0c,0x3f67c187,0x3f63f473,0x3f5fe4e9
.long 0x3f676bd8,0x3f633c5a,0x3f5ebe05,0x3f59f26a,0x3f633c5a,0x3f5e5aa6,0x3f591e6a,0x3f5389c7
.long 0x3f5ebe05,0x3f591e6a,0x3f531849,0x3f4cae79,0x3f59f26a,0x3f5389c7,0x3f4cae79,0x3f456439
.long 0x3f800000,0x3f7fb10f,0x3f7ec46d,0x3f7d3aac,0x3f800000,0x3f7fa6e3,0x3f7e9bc9,0x3f7cdf6c
.long 0x3f800000,0x3f7f9c18,0x3f7e70b0,0x3f7c7eb0,0x3f800000,0x3f7f90b1,0x3f7e4323,0x3f7c187a
.long 0x3f800000,0x3f7f84ab,0x3f7e1324,0x3f7baccd,0x3f800000,0x3f7f7808,0x3f7de0b1,0x3f7b3bab
.long 0x3f800000,0x3f7f6ac7,0x3f7dabcc,0x3f7ac516,0x3f800000,0x3f7f5ce9,0x3f7d7474,0x3f7a4910
.long 0x3f800000,0x3f7f4e6d,0x3f7d3aac,0x3f79c79d,0x3f800000,0x3f7f3f54,0x3f7cfe73,0x3f7940c0
.long 0x3f800000,0x3f7f2f9d,0x3f7cbfc9,0x3f78b47b,0x3f800000,0x3f7f1f49,0x3f7c7eb0,0x3f7822d1
.long 0x3f800000,0x3f7f0e58,0x3f7c3b28,0x3f778bc5,0x3f800000,0x3f7efcc9,0x3f7bf531,0x3f76ef5b
.long 0x3f800000,0x3f7eea9d,0x3f7baccd,0x3f764d97,0x3f800000,0x3f7ed7d4,0x3f7b61fc,0x3f75a67b
.long 0x3f7b14be,0x3f7853f8,0x3f74fa0b,0x3f710908,0x3f7a7302,0x3f77583a,0x3f73913f,0x3f6f20b0
.long 0x3f79c79d,0x3f764d97,0x3f721352,0x3f6d1c1d,0x3f791298,0x3f75341d,0x3f708066,0x3f6afb8c
.long 0x3f7853f8,0x3f740bdd,0x3f6ed89e,0x3f68bf3c,0x3f778bc5,0x3f72d4eb,0x3f6d1c1d,0x3f666771
.long 0x3f76ba07,0x3f718f57,0x3f6b4b0c,0x3f63f473,0x3f75dec6,0x3f703b37,0x3f696591,0x3f61668a
.long 0x3f74fa0b,0x3f6ed89e,0x3f676bd8,0x3f5ebe05,0x3f740bdd,0x3f6d67a1,0x3f655e0b,0x3f5bfb34
.long 0x3f731447,0x3f6be858,0x3f633c5a,0x3f591e6a,0x3f721352,0x3f6a5ad9,0x3f6106f2,0x3f5627fe
.long 0x3f710908,0x3f68bf3c,0x3f5ebe05,0x3f531849,0x3f6ff573,0x3f671599,0x3f5c61c7,0x3f4fefa8
.long 0x3f6ed89e,0x3f655e0b,0x3f59f26a,0x3f4cae79,0x3f6db293,0x3f6398ac,0x3f577026,0x3f495521
.long 0x3f6c835e,0x3f676bd8,0x3f61c598,0x3f5b941a,0x3f6a09a7,0x3f644fac,0x3f5df6be,0x3f570348
.long 0x3f676bd8,0x3f6106f2,0x3f59f26a,0x3f5233c6,0x3f64aa59,0x3f5d924d,0x3f55b993,0x3f4d26fd
.long 0x3f61c598,0x3f59f26a,0x3f514d3d,0x3f47de65,0x3f5ebe05,0x3f5627fe,0x3f4cae79,0x3f425b89
.long 0x3f5b941a,0x3f5233c6,0x3f47de65,0x3f3ca003,0x3f584853,0x3f4e1689,0x3f42de29,0x3f36ad7f
.long 0x3f54db31,0x3f49d112,0x3f3daef9,0x3f3085bb,0x3f514d3d,0x3f456439,0x3f385216,0x3f2a2a80
.long 0x3f4d9f02,0x3f40d0da,0x3f32c8c9,0x3f239da9,0x3f49d112,0x3f3c17d9,0x3f2d1469,0x3f1ce11f
.long 0x3f45e403,0x3f373a23,0x3f273656,0x3f15f6d9,0x3f41d870,0x3f3238aa,0x3f212ff9,0x3f0ee0db
.long 0x3f3daef9,0x3f2d1469,0x3f1b02c6,0x3f07a136,0x3f396842,0x3f27ce61,0x3f14b039,0x3f003a06
.long 0x3f54db31,0x3f4d9f02,0x3f45e403,0x3f3daef9,0x3f4f7a1f,0x3f476085,0x3f3ebc1b,0x3f3592e7
.long 0x3f49d112,0x3f40d0da,0x3f373a23,0x3f2d1469,0x3f43e200,0x3f39f2ac,0x3f2f61a5,0x3f24381a
.long 0x3f3daef9,0x3f32c8c9,0x3f273656,0x3f1b02c6,0x3f373a23,0x3f2b561b,0x3f1ebc12,0x3f11796b
.long 0x3f3085bb,0x3f239da9,0x3f15f6d9,0x3f07a136,0x3f299415,0x3f1ba299,0x3f0cead0,0x3efafef7
.long 0x3f226799,0x3f13682a,0x3f039c3d,0x3ee63375,0x3f1b02c6,0x3f0af1b7,0x3ef41f07,0x3ed0eb2a
.long 0x3f13682a,0x3f0242b1,0x3ee0924f,0x3ebb31a0,0x3f0b9a6b,0x3ef2bd43,0x3ecc9b8b,0x3ea5129f
.long 0x3f039c3d,0x3ee0924f,0x3eb8442a,0x3e8e9a22,0x3ef6e0cb,0x3ece0bea,0x3ea395c5,0x3e6fa8b2
.long 0x3ee63375,0x3ebb31a0,0x3e8e9a22,0x3e419b37,0x3ed53641,0x3ea80b1f,0x3e72b651,0x3e1324ca
.long 0x0,0x0,0x0,0x0,0x0,0xbb490fc6,0xbbc90f88,0xbc16cb58
.long 0x0,0xbbc90f88,0xbc490e90,0xbc96c9b6,0x0,0xbc16cb58,0xbc96c9b6,0xbce22a7a
.long 0x0,0xbc490e90,0xbcc90ab0,0xbd16c32c,0x0,0xbc7b514b,0xbcfb49ba,0xbd3c6dd5
.long 0x0,0xbc96c9b6,0xbd16c32c,0xbd621469,0x0,0xbcafea69,0xbd2fe007,0xbd83db0a
.long 0x0,0xbcc90ab0,0xbd48fb30,0xbd96a905,0x0,0xbce22a7a,0xbd621469,0xbda973ba
.long 0x0,0xbcfb49ba,0xbd7b2b74,0xbdbc3ac3,0x0,0xbd0a342f,0xbd8a200a,0xbdcefdb7
.long 0x0,0xbd16c32c,0xbd96a905,0xbde1bc2e,0x0,0xbd2351cb,0xbda3308c,0xbdf475c0
.long 0x0,0xbd2fe007,0xbdafb680,0xbe039502,0x0,0xbd3c6dd5,0xbdbc3ac3,0xbe0cec4a
.long 0x0,0x0,0x0,0x0,0xbc490e90,0xbc7b514b,0xbc96c9b6,0xbcafea69
.long 0xbcc90ab0,0xbcfb49ba,0xbd16c32c,0xbd2fe007,0xbd16c32c,0xbd3c6dd5,0xbd621469,0xbd83db0a
.long 0xbd48fb30,0xbd7b2b74,0xbd96a905,0xbdafb680,0xbd7b2b74,0xbd9cecf9,0xbdbc3ac3,0xbddb7d37
.long 0xbd96a905,0xbdbc3ac3,0xbde1bc2e,0xbe039502,0xbdafb680,0xbddb7d37,0xbe039502,0xbe195be0
.long 0xbdc8bd36,0xbdfab273,0xbe164083,0xbe2f10a2,0xbde1bc2e,0xbe0cec4a,0xbe28defc,0xbe44b0b9
.long 0xbdfab273,0xbe1c76de,0xbe3b6ecf,0xbe5a3997,0xbe09cf86,0xbe2bf804,0xbe4dee60,0xbe6fa8b2
.long 0xbe164083,0xbe3b6ecf,0xbe605c13,0xbe827dc0,0xbe22abb6,0xbe4ada4f,0xbe72b651,0xbe8d17c0
.long 0xbe2f10a2,0xbe5a3997,0xbe827dc0,0xbe97a117,0xbe3b6ecf,0xbe698bba,0xbe8b9507,0xbea21887
.long 0x0,0x0,0x0,0x0,0xbcc90ab0,0xbce22a7a,0xbcfb49ba,0xbd0a342f
.long 0xbd48fb30,0xbd621469,0xbd7b2b74,0xbd8a200a,0xbd96a905,0xbda973ba,0xbdbc3ac3,0xbdcefdb7
.long 0xbdc8bd36,0xbde1bc2e,0xbdfab273,0xbe09cf86,0xbdfab273,0xbe0cec4a,0xbe1c76de,0xbe2bf804
.long 0xbe164083,0xbe28defc,0xbe3b6ecf,0xbe4dee60,0xbe2f10a2,0xbe44b0b9,0xbe5a3997,0xbe6fa8b2
.long 0xbe47c5c2,0xbe605c13,0xbe78cfcc,0xbe888e93,0xbe605c13,0xbe7bdba4,0xbe8b9507,0xbe9920fe
.long 0xbe78cfcc,0xbe8b9507,0xbe9aa086,0xbea986c4,0xbe888e93,0xbe9920fe,0xbea986c4,0xbeb9bb1e
.long 0xbe94a031,0xbea68f12,0xbeb8442a,0xbec9b953,0xbea09ae5,0xbeb3dca5,0xbec6d529,0xbed97cb9
.long 0xbeac7cd4,0xbec1071e,0xbed53641,0xbee900b7,0xbeb8442a,0xbece0bea,0xbee363fa,0xbef840c8
.long 0x0,0x0,0x0,0x0,0xbd16c32c,0xbd2351cb,0xbd2fe007,0xbd3c6dd5
.long 0xbd96a905,0xbda3308c,0xbdafb680,0xbdbc3ac3,0xbde1bc2e,0xbdf475c0,0xbe039502,0xbe0cec4a
.long 0xbe164083,0xbe22abb6,0xbe2f10a2,0xbe3b6ecf,0xbe3b6ecf,0xbe4ada4f,0xbe5a3997,0xbe698bba
.long 0xbe605c13,0xbe72b651,0xbe827dc0,0xbe8b9507,0xbe827dc0,0xbe8d17c0,0xbe97a117,0xbea21887
.long 0xbe94a031,0xbea09ae5,0xbeac7cd4,0xbeb8442a,0xbea68f12,0xbeb3dca5,0xbec1071e,0xbece0bea
.long 0xbeb8442a,0xbec6d529,0xbed53641,0xbee363fa,0xbec9b953,0xbed97cb9,0xbee900b7,0xbef840c8
.long 0xbedae880,0xbeebcbbb,0xbefc5d27,0xbf064b82,0xbeebcbbb,0xbefdbabb,0xbf07a136,0xbf102dd5
.long 0xbefc5d27,0xbf07a136,0xbf10d3cd,0xbf19c200,0xbf064b82,0xbf102dd5,0xbf19c200,0xbf2302d3
.long 0x0,0xbd48fb30,0xbdc8bd36,0xbe164083,0x0,0xbd55880e,0xbdd53db9,0xbe1f917b
.long 0x0,0xbd621469,0xbde1bc2e,0xbe28defc,0x0,0xbd6ea038,0xbdee3876,0xbe3228d4
.long 0x0,0xbd7b2b74,0xbdfab273,0xbe3b6ecf,0x0,0xbd83db0a,0xbe039502,0xbe44b0b9
.long 0x0,0xbd8a200a,0xbe09cf86,0xbe4dee60,0x0,0xbd9064b4,0xbe1008b7,0xbe57278f
.long 0x0,0xbd96a905,0xbe164083,0xbe605c13,0x0,0xbd9cecf9,0xbe1c76de,0xbe698bba
.long 0x0,0xbda3308c,0xbe22abb6,0xbe72b651,0x0,0xbda973ba,0xbe28defc,0xbe7bdba4
.long 0x0,0xbdafb680,0xbe2f10a2,0xbe827dc0,0x0,0xbdb5f8da,0xbe354098,0xbe870ada
.long 0x0,0xbdbc3ac3,0xbe3b6ecf,0xbe8b9507,0x0,0xbdc27c39,0xbe419b37,0xbe901c2c
.long 0xbe47c5c2,0xbe78cfcc,0xbe94a031,0xbeac7cd4,0xbe541501,0xbe840270,0xbe9d9e78,0xbeb6ccc3
.long 0xbe605c13,0xbe8b9507,0xbea68f12,0xbec1071e,0xbe6c9a7f,0xbe931f35,0xbeaf713a,0xbecb2aae
.long 0xbe78cfcc,0xbe9aa086,0xbeb8442a,0xbed53641,0xbe827dc0,0xbea21887,0xbec1071e,0xbedf28a9
.long 0xbe888e93,0xbea986c4,0xbec9b953,0xbee900b7,0xbe8e9a22,0xbeb0eacb,0xbed25a09,0xbef2bd43
.long 0xbe94a031,0xbeb8442a,0xbedae880,0xbefc5d27,0xbe9aa086,0xbebf926f,0xbee363fa,0xbf02ef9f
.long 0xbea09ae5,0xbec6d529,0xbeebcbbb,0xbf07a136,0xbea68f12,0xbece0bea,0xbef41f07,0xbf0c42c9
.long 0xbeac7cd4,0xbed53641,0xbefc5d27,0xbf10d3cd,0xbeb263ef,0xbedc53c1,0xbf0242b1,0xbf1553b7
.long 0xbeb8442a,0xbee363fa,0xbf064b82,0xbf19c200,0xbebe1d4a,0xbeea6681,0xbf0a48ad,0xbf1e1e22
.long 0xbec3ef15,0xbedae880,0xbef15aea,0xbf039c3d,0xbecf7bca,0xbee79a5d,0xbeff17b2,0xbf0af1b7
.long 0xbedae880,0xbef41f07,0xbf064b82,0xbf121eb0,0xbee63375,0xbf003a06,0xbf0cead0,0xbf19210f
.long 0xbef15aea,0xbf064b82,0xbf13682a,0xbf1ff6cb,0xbefc5d27,0xbf0c42c9,0xbf19c200,0xbf269de3
.long 0xbf039c3d,0xbf121eb0,0xbf1ff6cb,0xbf2d1469,0xbf08f59b,0xbf17de12,0xbf26050a,0xbf33587a
.long 0xbf0e39da,0xbf1d7fd1,0xbf2beb4a,0xbf396842,0xbf13682a,0xbf2302d3,0xbf31a81d,0xbf3f41fc
.long 0xbf187fc0,0xbf286605,0xbf373a23,0xbf44e3f5,0xbf1d7fd1,0xbf2da859,0xbf3ca003,0xbf4a4c87
.long 0xbf226799,0xbf32c8c9,0xbf41d870,0xbf4f7a1f,0xbf273656,0xbf37c655,0xbf46e22a,0xbf546b3b
.long 0xbf2beb4a,0xbf3ca003,0xbf4bbbf8,0xbf591e6a,0xbf3085bb,0xbf4154e1,0xbf5064af,0xbf5d924d
.long 0xbf0e39da,0xbf187fc0,0xbf226799,0xbf2beb4a,0xbf15f6d9,0xbf209393,0xbf2ac082,0xbf34768f
.long 0xbf1d7fd1,0xbf286605,0xbf32c8c9,0xbf3ca003,0xbf24d225,0xbf2ff3e6,0xbf3a7ca4,0xbf446337
.long 0xbf2beb4a,0xbf373a23,0xbf41d870,0xbf4bbbf8,0xbf32c8c9,0xbf3e35c5,0xbf48d8b3,0xbf52a649
.long 0xbf396842,0xbf44e3f5,0xbf4f7a1f,0xbf591e6a,0xbf3fc767,0xbf4b41fa,0xbf55b993,0xbf5f20db
.long 0xbf45e403,0xbf514d3d,0xbf5b941a,0xbf64aa59,0xbf4bbbf8,0xbf570348,0xbf6106f2,0xbf69b7e4
.long 0xbf514d3d,0xbf5c61c7,0xbf660f88,0xbf6e46be,0xbf5695e5,0xbf61668a,0xbf6aab7b,0xbf725470
.long 0xbf5b941a,0xbf660f88,0xbf6ed89e,0xbf75dec6,0xbf604621,0xbf6a5ad9,0xbf7294f8,0xbf78e3d6
.long 0xbf64aa59,0xbf6e46be,0xbf75dec6,0xbf7b61fc,0xbf68bf3c,0xbf71d19f,0xbf78b47b,0xbf7d57de
.long 0x3f80,0x3f800000,0xbf80,0xbf800000,0x3f80,0x3f7fbdc9,0xbe48bf7b,0xbf753e95
.long 0x3f80,0x3f7bbe48,0xbec4bf6d,0xbf553f0e,0x3f80,0x3f75be95,0xbf0ebf55,0xbf223f46
.long 0x3f80,0x3f6dbec4,0xbf35bf35,0xbec43f6d,0x3f80,0x3f62bef1,0xbf55bf0e,0xbdc93f7f
.long 0x3f80,0x3f55bf0e,0xbf6dbec4,0x3e483f7b,0x3f80,0x3f46bf22,0xbf7bbe48,0x3ef13f62
.long 0x3f80,0x3f35bf35,0xbf800000,0x3f353f35,0x3f80,0x3f22bf46,0xbf7b3e48,0x3f623ef1
.long 0x3f80,0x3f0ebf55,0xbf6d3ec4,0x3f7b3e48,0x3f80,0x3ef1bf62,0xbf553f0e,0x3f7fbdc9
.long 0x3f80,0x3ec4bf6d,0xbf353f35,0x3f6dbec4,0x3f80,0x3e95bf75,0xbf0e3f55,0x3f46bf22
.long 0x3f80,0x3e48bf7b,0xbec43f6d,0x3f0ebf55,0x3f80,0x3dc9bf7f,0xbe483f7b,0x3e95bf75
.long 0x3f80,0x3f800000,0xbf80,0xbf800000,0x3ec43f6d,0x3f62bef1,0xbf0ebf55,0xbf463f22
.long 0x3f353f35,0x3f0ebf55,0xbf6dbec4,0xbe483f7b,0x3f6d3ec4,0x3dc9bf7f,0xbf7b3e48,0x3ef13f62
.long 0x3f800000,0xbec4bf6d,0xbf353f35,0x3f6d3ec4,0x3f6dbec4,0xbf46bf22,0xbe483f7b,0x3f75be95
.long 0x3f35bf35,0xbf7bbe48,0x3ec43f6d,0x3f0ebf55,0x3ec4bf6d,0xbf753e95,0x3f553f0e,0xbdc9bf7f
.long 0xbf80,0xbf353f35,0x3f800000,0xbf35bf35,0xbec4bf6d,0xbe953f75,0x3f55bf0e,0xbf7fbdc9
.long 0xbf35bf35,0x3e483f7b,0x3ec4bf6d,0xbf553f0e,0xbf6dbec4,0x3f223f46,0xbe48bf7b,0xbe953f75
.long 0xbf800000,0x3f6d3ec4,0xbf35bf35,0x3ec43f6d,0xbf6d3ec4,0x3f7fbdc9,0xbf7bbe48,0x3f623ef1
.long 0xbf353f35,0x3f55bf0e,0xbf6d3ec4,0x3f7bbe48,0xbec43f6d,0x3ef1bf62,0xbf0e3f55,0x3f22bf46
.long 0x3f80,0x3f800000,0xbf80,0xbf800000,0x3f353f35,0x3f22bf46,0xbf55bf0e,0xbef13f62
.long 0x3f800000,0xbe48bf7b,0xbf6d3ec4,0x3f0e3f55,0x3f35bf35,0xbf62bef1,0xbe483f7b,0x3f7fbdc9
.long 0xbf80,0xbf6d3ec4,0x3f353f35,0x3ec4bf6d,0xbf35bf35,0xbe953f75,0x3f7bbe48,0xbf22bf46
.long 0xbf800000,0x3f0e3f55,0x3ec4bf6d,0xbf7b3e48,0xbf353f35,0x3f7f3dc9,0xbf0ebf55,0xbe953f75
.long 0x3f80,0x3f35bf35,0xbf800000,0x3f353f35,0x3f353f35,0xbdc9bf7f,0xbf0e3f55,0x3f75be95
.long 0x3f800000,0xbf55bf0e,0x3ec43f6d,0x3e48bf7b,0x3f35bf35,0xbf753e95,0x3f7b3e48,0xbf46bf22
.long 0xbf80,0xbec43f6d,0x3f35bf35,0xbf6d3ec4,0xbf35bf35,0x3ef13f62,0xbe48bf7b,0xbdc93f7f
.long 0xbf800000,0x3f7b3e48,0xbf6dbec4,0x3f553f0e,0xbf353f35,0x3f46bf22,0xbf553f0e,0x3f62bef1
.long 0x3f80,0x3f800000,0xbf80,0xbf800000,0x3f6d3ec4,0x3e95bf75,0xbf7bbe48,0xbdc93f7f
.long 0x3f35bf35,0xbf55bf0e,0xbec43f6d,0x3f7b3e48,0xbec4bf6d,0xbf463f22,0x3f553f0e,0x3e95bf75
.long 0xbf800000,0x3ec43f6d,0x3f35bf35,0xbf6dbec4,0xbec43f6d,0x3f7fbdc9,0xbf0ebf55,0xbef13f62
.long 0x3f353f35,0x3e48bf7b,0xbf6d3ec4,0x3f553f0e,0x3f6dbec4,0xbf62bef1,0x3e483f7b,0x3f22bf46
.long 0xbf80,0xbf353f35,0x3f800000,0xbf35bf35,0xbf6dbec4,0x3ef13f62,0x3e48bf7b,0xbf463f22
.long 0xbf353f35,0x3f7bbe48,0xbf6dbec4,0x3f0e3f55,0x3ec43f6d,0x3dc9bf7f,0xbf0e3f55,0x3f62bef1
.long 0x3f800000,0xbf6dbec4,0x3f353f35,0xbec4bf6d,0x3ec4bf6d,0xbf223f46,0x3f55bf0e,0xbf753e95
.long 0xbf35bf35,0x3f0e3f55,0xbec4bf6d,0x3e483f7b,0xbf6d3ec4,0x3f75be95,0xbf7b3e48,0x3f7fbdc9
.long 0x3f800000,0xbf80,0xbf800000,0x3f80,0x3f800000,0xbdc9bf7f,0xbf7b3e48,0x3e953f75
.long 0x3f800000,0xbe48bf7b,0xbf6d3ec4,0x3f0e3f55,0x3f800000,0xbe95bf75,0xbf553f0e,0x3f463f22
.long 0x3f800000,0xbec4bf6d,0xbf353f35,0x3f6d3ec4,0x3f800000,0xbef1bf62,0xbf0e3f55,0x3f7f3dc9
.long 0x3f800000,0xbf0ebf55,0xbec43f6d,0x3f7bbe48,0x3f800000,0xbf22bf46,0xbe483f7b,0x3f62bef1
.long 0x3f800000,0xbf35bf35,0x3f80,0x3f35bf35,0x3f800000,0xbf46bf22,0x3e483f7b,0x3ef1bf62
.long 0x3f800000,0xbf55bf0e,0x3ec43f6d,0x3e48bf7b,0x3f800000,0xbf62bef1,0x3f0e3f55,0xbdc9bf7f
.long 0x3f800000,0xbf6dbec4,0x3f353f35,0xbec4bf6d,0x3f800000,0xbf75be95,0x3f553f0e,0xbf22bf46
.long 0x3f800000,0xbf7bbe48,0x3f6d3ec4,0xbf55bf0e,0x3f800000,0xbf7fbdc9,0x3f7b3e48,0xbf75be95
.long 0x3f800000,0xbf80,0xbf800000,0x3f80,0x3f6dbec4,0xbef1bf62,0xbf553f0e,0x3f223f46
.long 0x3f35bf35,0xbf55bf0e,0xbec43f6d,0x3f7b3e48,0x3ec4bf6d,0xbf7fbdc9,0x3e483f7b,0x3f62bef1
.long 0xbf80,0xbf6d3ec4,0x3f353f35,0x3ec4bf6d,0xbec4bf6d,0xbf223f46,0x3f7b3e48,0xbe95bf75
.long 0xbf35bf35,0xbe483f7b,0x3f6dbec4,0xbf55bf0e,0xbf6dbec4,0x3e953f75,0x3f0ebf55,0xbf7f3dc9
.long 0xbf800000,0x3f353f35,0xbf80,0xbf353f35,0xbf6d3ec4,0x3f753e95,0xbf0ebf55,0xbdc93f7f
.long 0xbf353f35,0x3f7bbe48,0xbf6dbec4,0x3f0e3f55,0xbec43f6d,0x3f46bf22,0xbf7b3e48,0x3f753e95
.long 0x3f80,0x3ec4bf6d,0xbf353f35,0x3f6dbec4,0x3ec43f6d,0xbdc9bf7f,0xbe483f7b,0x3ef1bf62
.long 0x3f353f35,0xbf0ebf55,0x3ec43f6d,0xbe48bf7b,0x3f6d3ec4,0xbf62bef1,0x3f553f0e,0xbf46bf22
.long 0x3f800000,0xbf80,0xbf800000,0x3f80,0x3f35bf35,0xbf46bf22,0xbf0e3f55,0x3f623ef1
.long 0xbf80,0xbf7b3e48,0x3ec43f6d,0x3f55bf0e,0xbf35bf35,0xbef13f62,0x3f7b3e48,0xbdc9bf7f
.long 0xbf800000,0x3ec43f6d,0x3f35bf35,0xbf6dbec4,0xbf353f35,0x3f753e95,0xbe48bf7b,0xbf463f22
.long 0x3f80,0x3f55bf0e,0xbf6dbec4,0x3e483f7b,0x3f353f35,0x3dc9bf7f,0xbf553f0e,0x3f753e95
.long 0x3f800000,0xbf35bf35,0x3f80,0x3f35bf35,0x3f35bf35,0xbf7f3dc9,0x3f553f0e,0xbe95bf75
.long 0xbf80,0xbf0e3f55,0x3f6dbec4,0xbf7bbe48,0xbf35bf35,0x3e953f75,0x3e48bf7b,0xbf223f46
.long 0xbf800000,0x3f6d3ec4,0xbf35bf35,0x3ec43f6d,0xbf353f35,0x3f62bef1,0xbf7b3e48,0x3f7f3dc9
.long 0x3f80,0x3e48bf7b,0xbec43f6d,0x3f0ebf55,0x3f353f35,0xbf22bf46,0x3f0e3f55,0xbef1bf62
.long 0x3f800000,0xbf80,0xbf800000,0x3f80,0x3ec4bf6d,0xbf75be95,0xbe483f7b,0x3f7f3dc9
.long 0xbf35bf35,0xbf0e3f55,0x3f6d3ec4,0x3e48bf7b,0xbf6d3ec4,0x3f223f46,0x3f0ebf55,0xbf75be95
.long 0x3f80,0x3f6dbec4,0xbf35bf35,0xbec43f6d,0x3f6d3ec4,0xbdc9bf7f,0xbf553f0e,0x3f623ef1
.long 0x3f35bf35,0xbf7bbe48,0x3ec43f6d,0x3f0ebf55,0xbec4bf6d,0xbef13f62,0x3f7bbe48,0xbf46bf22
.long 0xbf800000,0x3f353f35,0xbf80,0xbf353f35,0xbec43f6d,0x3f62bef1,0xbf7bbe48,0x3f223f46
.long 0x3f353f35,0xbe48bf7b,0xbec43f6d,0x3f55bf0e,0x3f6dbec4,0xbf7fbdc9,0x3f553f0e,0xbef1bf62
.long 0xbf80,0xbec43f6d,0x3f35bf35,0xbf6d3ec4,0xbf6dbec4,0x3f463f22,0xbf0ebf55,0x3e953f75
.long 0xbf353f35,0x3f55bf0e,0xbf6d3ec4,0x3f7bbe48,0x3ec43f6d,0xbe95bf75,0x3e483f7b,0xbdc9bf7f
.long 0x3f80,0x3f800000,0xbf80,0xbf800000,0x3f800000,0xbdc9bf7f,0xbf7b3e48,0x3e953f75
.long 0xbf80,0xbf7b3e48,0x3ec43f6d,0x3f55bf0e,0xbf800000,0x3e953f75,0x3f55bf0e,0xbf46bf22
.long 0x3f80,0x3f6dbec4,0xbf35bf35,0xbec43f6d,0x3f800000,0xbef1bf62,0xbf0e3f55,0x3f7f3dc9
.long 0xbf80,0xbf553f0e,0x3f6d3ec4,0xbe48bf7b,0xbf800000,0x3f223f46,0x3e48bf7b,0xbf623ef1
.long 0x3f80,0x3f35bf35,0xbf800000,0x3f353f35,0x3f800000,0xbf46bf22,0x3e483f7b,0x3ef1bf62
.long 0xbf80,0xbf0e3f55,0x3f6dbec4,0xbf7bbe48,0xbf800000,0x3f623ef1,0xbf0ebf55,0x3dc93f7f
.long 0x3f80,0x3ec4bf6d,0xbf353f35,0x3f6dbec4,0x3f800000,0xbf75be95,0x3f553f0e,0xbf22bf46
.long 0xbf80,0xbe483f7b,0x3ec4bf6d,0xbf0e3f55,0xbf800000,0x3f7f3dc9,0xbf7bbe48,0x3f753e95
.long 0x3f80,0x3f800000,0xbf80,0xbf800000,0x3f6dbec4,0xbef1bf62,0xbf553f0e,0x3f223f46
.long 0xbf35bf35,0xbf0e3f55,0x3f6d3ec4,0x3e48bf7b,0xbec43f6d,0x3f7f3dc9,0xbe48bf7b,0xbf623ef1
.long 0x3f800000,0xbec4bf6d,0xbf353f35,0x3f6d3ec4,0xbec4bf6d,0xbf223f46,0x3f7b3e48,0xbe95bf75
.long 0xbf353f35,0x3f7b3e48,0xbec4bf6d,0xbf0e3f55,0x3f6d3ec4,0xbe95bf75,0xbf0e3f55,0x3f7fbdc9
.long 0xbf80,0xbf353f35,0x3f800000,0xbf35bf35,0xbf6d3ec4,0x3f753e95,0xbf0ebf55,0xbdc93f7f
.long 0x3f353f35,0xbe48bf7b,0xbec43f6d,0x3f55bf0e,0x3ec4bf6d,0xbf463f22,0x3f7bbe48,0xbf75be95
.long 0xbf800000,0x3f6d3ec4,0xbf35bf35,0x3ec43f6d,0x3ec43f6d,0xbdc9bf7f,0xbe483f7b,0x3ef1bf62
.long 0x3f35bf35,0xbf553f0e,0x3f6dbec4,0xbf7b3e48,0xbf6dbec4,0x3f623ef1,0xbf55bf0e,0x3f463f22
.long 0x3f80,0x3f800000,0xbf80,0xbf800000,0x3f35bf35,0xbf46bf22,0xbf0e3f55,0x3f623ef1
.long 0xbf800000,0x3e483f7b,0x3f6dbec4,0xbf0ebf55,0x3f353f35,0x3ef1bf62,0xbf7bbe48,0x3dc93f7f
.long 0xbf80,0xbf6d3ec4,0x3f353f35,0x3ec4bf6d,0xbf353f35,0x3f753e95,0xbe48bf7b,0xbf463f22
.long 0x3f800000,0xbf0ebf55,0xbec43f6d,0x3f7bbe48,0xbf35bf35,0xbdc93f7f,0x3f55bf0e,0xbf75be95
.long 0x3f80,0x3f35bf35,0xbf800000,0x3f353f35,0x3f35bf35,0xbf7f3dc9,0x3f553f0e,0xbe95bf75
.long 0xbf800000,0x3f553f0e,0xbec4bf6d,0xbe483f7b,0x3f353f35,0xbe95bf75,0xbe483f7b,0x3f22bf46
.long 0xbf80,0xbec43f6d,0x3f35bf35,0xbf6d3ec4,0xbf353f35,0x3f62bef1,0xbf7b3e48,0x3f7f3dc9
.long 0x3f800000,0xbf7bbe48,0x3f6d3ec4,0xbf55bf0e,0xbf35bf35,0x3f223f46,0xbf0ebf55,0x3ef13f62
.long 0x3f80,0x3f800000,0xbf80,0xbf800000,0x3ec4bf6d,0xbf75be95,0xbe483f7b,0x3f7f3dc9
.long 0xbf353f35,0x3f553f0e,0x3ec4bf6d,0xbf7bbe48,0x3f6dbec4,0xbf22bf46,0xbf0e3f55,0x3f753e95
.long 0xbf800000,0x3ec43f6d,0x3f35bf35,0xbf6dbec4,0x3f6d3ec4,0xbdc9bf7f,0xbf553f0e,0x3f623ef1
.long 0xbf35bf35,0xbe483f7b,0x3f6dbec4,0xbf55bf0e,0x3ec43f6d,0x3ef1bf62,0xbf7b3e48,0x3f463f22
.long 0xbf80,0xbf353f35,0x3f800000,0xbf35bf35,0xbec43f6d,0x3f62bef1,0xbf7bbe48,0x3f223f46
.long 0x3f35bf35,0xbf7b3e48,0x3f6d3ec4,0xbf0ebf55,0xbf6d3ec4,0x3f7f3dc9,0xbf55bf0e,0x3ef13f62
.long 0x3f800000,0xbf6dbec4,0x3f353f35,0xbec4bf6d,0xbf6dbec4,0x3f463f22,0xbf0ebf55,0x3e953f75
.long 0x3f353f35,0xbf0ebf55,0x3ec43f6d,0xbe48bf7b,0xbec4bf6d,0x3e953f75,0xbe48bf7b,0x3dc93f7f
.long 0x3f800000,0xbf80,0xbf800000,0x3f80,0xbf80,0xbf7f3dc9,0x3e483f7b,0x3f75be95
.long 0xbf800000,0x3e483f7b,0x3f6dbec4,0xbf0ebf55,0x3f80,0x3f75be95,0xbf0ebf55,0xbf223f46
.long 0x3f800000,0xbec4bf6d,0xbf353f35,0x3f6d3ec4,0xbf80,0xbf623ef1,0x3f553f0e,0x3dc9bf7f
.long 0xbf800000,0x3f0e3f55,0x3ec4bf6d,0xbf7b3e48,0x3f80,0x3f46bf22,0xbf7bbe48,0x3ef13f62
.long 0x3f800000,0xbf35bf35,0x3f80,0x3f35bf35,0xbf80,0xbf223f46,0x3f7bbe48,0xbf62bef1
.long 0xbf800000,0x3f553f0e,0xbec4bf6d,0xbe483f7b,0x3f80,0x3ef1bf62,0xbf553f0e,0x3f7fbdc9
.long 0x3f800000,0xbf6dbec4,0x3f353f35,0xbec4bf6d,0xbf80,0xbe953f75,0x3f0ebf55,0xbf463f22
.long 0xbf800000,0x3f7b3e48,0xbf6dbec4,0x3f553f0e,0x3f80,0x3dc9bf7f,0xbe483f7b,0x3e95bf75
.long 0x3f800000,0xbf80,0xbf800000,0x3f80,0xbec4bf6d,0xbf623ef1,0x3f0e3f55,0x3f46bf22
.long 0xbf353f35,0x3f553f0e,0x3ec4bf6d,0xbf7bbe48,0x3f6d3ec4,0x3dc9bf7f,0xbf7b3e48,0x3ef13f62
.long 0xbf80,0xbf6d3ec4,0x3f353f35,0x3ec4bf6d,0xbf6d3ec4,0x3f463f22,0x3e48bf7b,0xbf753e95
.long 0x3f353f35,0x3e48bf7b,0xbf6d3ec4,0x3f553f0e,0x3ec4bf6d,0xbf753e95,0x3f553f0e,0xbdc9bf7f
.long 0xbf800000,0x3f353f35,0xbf80,0xbf353f35,0x3ec43f6d,0x3e95bf75,0xbf553f0e,0x3f7f3dc9
.long 0x3f35bf35,0xbf7b3e48,0x3f6d3ec4,0xbf0ebf55,0xbf6dbec4,0x3f223f46,0xbe48bf7b,0xbe953f75
.long 0x3f80,0x3ec4bf6d,0xbf353f35,0x3f6dbec4,0x3f6dbec4,0xbf7f3dc9,0x3f7b3e48,0xbf62bef1
.long 0xbf35bf35,0x3f0e3f55,0xbec4bf6d,0x3e483f7b,0xbec43f6d,0x3ef1bf62,0xbf0e3f55,0x3f22bf46
.long 0x3f800000,0xbf80,0xbf800000,0x3f80,0xbf35bf35,0xbf223f46,0x3f553f0e,0x3ef1bf62
.long 0x3f80,0x3f7bbe48,0xbec4bf6d,0xbf553f0e,0x3f35bf35,0xbf62bef1,0xbe483f7b,0x3f7fbdc9
.long 0xbf800000,0x3ec43f6d,0x3f35bf35,0xbf6dbec4,0x3f353f35,0x3e95bf75,0xbf7b3e48,0x3f223f46
.long 0xbf80,0xbf553f0e,0x3f6d3ec4,0xbe48bf7b,0xbf353f35,0x3f7f3dc9,0xbf0ebf55,0xbe953f75
.long 0x3f800000,0xbf35bf35,0x3f80,0x3f35bf35,0xbf35bf35,0x3dc93f7f,0x3f0ebf55,0xbf753e95
.long 0x3f80,0x3f0ebf55,0xbf6d3ec4,0x3f7b3e48,0x3f35bf35,0xbf753e95,0x3f7b3e48,0xbf46bf22
.long 0xbf800000,0x3f6d3ec4,0xbf35bf35,0x3ec43f6d,0x3f353f35,0xbef1bf62,0x3e483f7b,0x3dc9bf7f
.long 0xbf80,0xbe483f7b,0x3ec4bf6d,0xbf0e3f55,0xbf353f35,0x3f46bf22,0xbf553f0e,0x3f62bef1
.long 0x3f800000,0xbf80,0xbf800000,0x3f80,0xbf6dbec4,0xbe953f75,0x3f7b3e48,0x3dc9bf7f
.long 0x3f353f35,0x3f0ebf55,0xbf6dbec4,0xbe483f7b,0xbec4bf6d,0xbf463f22,0x3f553f0e,0x3e95bf75
.long 0x3f80,0x3f6dbec4,0xbf35bf35,0xbec43f6d,0x3ec4bf6d,0xbf7f3dc9,0x3f0e3f55,0x3ef1bf62
.long 0xbf353f35,0x3f7b3e48,0xbec4bf6d,0xbf0e3f55,0x3f6dbec4,0xbf62bef1,0x3e483f7b,0x3f22bf46
.long 0xbf800000,0x3f353f35,0xbf80,0xbf353f35,0x3f6d3ec4,0xbef1bf62,0xbe483f7b,0x3f46bf22
.long 0xbf35bf35,0x3e483f7b,0x3ec4bf6d,0xbf553f0e,0x3ec43f6d,0x3dc9bf7f,0xbf0e3f55,0x3f62bef1
.long 0xbf80,0xbec43f6d,0x3f35bf35,0xbf6d3ec4,0xbec43f6d,0x3f22bf46,0xbf553f0e,0x3f75be95
.long 0x3f35bf35,0xbf553f0e,0x3f6dbec4,0xbf7b3e48,0xbf6d3ec4,0x3f75be95,0xbf7b3e48,0x3f7fbdc9
.long 0x3f80,0x3f800000,0xbf80,0xbf800000,0xbf80,0xbf7f3dc9,0x3e483f7b,0x3f75be95
.long 0x3f80,0x3f7bbe48,0xbec4bf6d,0xbf553f0e,0xbf80,0xbf753e95,0x3f0e3f55,0x3f22bf46
.long 0x3f80,0x3f6dbec4,0xbf35bf35,0xbec43f6d,0xbf80,0xbf623ef1,0x3f553f0e,0x3dc9bf7f
.long 0x3f80,0x3f55bf0e,0xbf6dbec4,0x3e483f7b,0xbf80,0xbf463f22,0x3f7b3e48,0xbef1bf62
.long 0x3f80,0x3f35bf35,0xbf800000,0x3f353f35,0xbf80,0xbf223f46,0x3f7bbe48,0xbf62bef1
.long 0x3f80,0x3f0ebf55,0xbf6d3ec4,0x3f7b3e48,0xbf80,0xbef13f62,0x3f55bf0e,0xbf7f3dc9
.long 0x3f80,0x3ec4bf6d,0xbf353f35,0x3f6dbec4,0xbf80,0xbe953f75,0x3f0ebf55,0xbf463f22
.long 0x3f80,0x3e48bf7b,0xbec43f6d,0x3f0ebf55,0xbf80,0xbdc93f7f,0x3e48bf7b,0xbe953f75
.long 0x3f80,0x3f800000,0xbf80,0xbf800000,0xbec4bf6d,0xbf623ef1,0x3f0e3f55,0x3f46bf22
.long 0x3f353f35,0x3f0ebf55,0xbf6dbec4,0xbe483f7b,0xbf6dbec4,0xbdc93f7f,0x3f7bbe48,0xbef1bf62
.long 0x3f800000,0xbec4bf6d,0xbf353f35,0x3f6d3ec4,0xbf6d3ec4,0x3f463f22,0x3e48bf7b,0xbf753e95
.long 0x3f35bf35,0xbf7bbe48,0x3ec43f6d,0x3f0ebf55,0xbec43f6d,0x3f75be95,0xbf55bf0e,0x3dc93f7f
.long 0xbf80,0xbf353f35,0x3f800000,0xbf35bf35,0x3ec43f6d,0x3e95bf75,0xbf553f0e,0x3f7f3dc9
.long 0xbf35bf35,0x3e483f7b,0x3ec4bf6d,0xbf553f0e,0x3f6d3ec4,0xbf22bf46,0x3e483f7b,0x3e95bf75
.long 0xbf800000,0x3f6d3ec4,0xbf35bf35,0x3ec43f6d,0x3f6dbec4,0xbf7f3dc9,0x3f7b3e48,0xbf62bef1
.long 0xbf353f35,0x3f55bf0e,0xbf6d3ec4,0x3f7bbe48,0x3ec4bf6d,0xbef13f62,0x3f0ebf55,0xbf223f46
.long 0x3f80,0x3f800000,0xbf80,0xbf800000,0xbf35bf35,0xbf223f46,0x3f553f0e,0x3ef1bf62
.long 0x3f800000,0xbe48bf7b,0xbf6d3ec4,0x3f0e3f55,0xbf353f35,0x3f623ef1,0x3e48bf7b,0xbf7f3dc9
.long 0xbf80,0xbf6d3ec4,0x3f353f35,0x3ec4bf6d,0x3f353f35,0x3e95bf75,0xbf7b3e48,0x3f223f46
.long 0xbf800000,0x3f0e3f55,0x3ec4bf6d,0xbf7b3e48,0x3f35bf35,0xbf7fbdc9,0x3f0e3f55,0x3e95bf75
.long 0x3f80,0x3f35bf35,0xbf800000,0x3f353f35,0xbf35bf35,0x3dc93f7f,0x3f0ebf55,0xbf753e95
.long 0x3f800000,0xbf55bf0e,0x3ec43f6d,0x3e48bf7b,0xbf353f35,0x3f75be95,0xbf7bbe48,0x3f463f22
.long 0xbf80,0xbec43f6d,0x3f35bf35,0xbf6d3ec4,0x3f353f35,0xbef1bf62,0x3e483f7b,0x3dc9bf7f
.long 0xbf800000,0x3f7b3e48,0xbf6dbec4,0x3f553f0e,0x3f35bf35,0xbf463f22,0x3f55bf0e,0xbf623ef1
.long 0x3f80,0x3f800000,0xbf80,0xbf800000,0xbf6dbec4,0xbe953f75,0x3f7b3e48,0x3dc9bf7f
.long 0x3f35bf35,0xbf55bf0e,0xbec43f6d,0x3f7b3e48,0x3ec43f6d,0x3f46bf22,0xbf55bf0e,0xbe953f75
.long 0xbf800000,0x3ec43f6d,0x3f35bf35,0xbf6dbec4,0x3ec4bf6d,0xbf7f3dc9,0x3f0e3f55,0x3ef1bf62
.long 0x3f353f35,0x3e48bf7b,0xbf6d3ec4,0x3f553f0e,0xbf6d3ec4,0x3f623ef1,0xbe48bf7b,0xbf223f46
.long 0xbf80,0xbf353f35,0x3f800000,0xbf35bf35,0x3f6d3ec4,0xbef1bf62,0xbe483f7b,0x3f46bf22
.long 0xbf353f35,0x3f7bbe48,0xbf6dbec4,0x3f0e3f55,0xbec4bf6d,0xbdc93f7f,0x3f0ebf55,0xbf623ef1
.long 0x3f800000,0xbf6dbec4,0x3f353f35,0xbec4bf6d,0xbec43f6d,0x3f22bf46,0xbf553f0e,0x3f75be95
.long 0xbf35bf35,0x3f0e3f55,0xbec4bf6d,0x3e483f7b,0x3f6dbec4,0xbf753e95,0x3f7bbe48,0xbf7f3dc9
.long 0x3f800000,0xbf80,0xbf800000,0x3f80,0xbf800000,0x3dc93f7f,0x3f7bbe48,0xbe95bf75
.long 0x3f800000,0xbe48bf7b,0xbf6d3ec4,0x3f0e3f55,0xbf800000,0x3e953f75,0x3f55bf0e,0xbf46bf22
.long 0x3f800000,0xbec4bf6d,0xbf353f35,0x3f6d3ec4,0xbf800000,0x3ef13f62,0x3f0ebf55,0xbf7fbdc9
.long 0x3f800000,0xbf0ebf55,0xbec43f6d,0x3f7bbe48,0xbf800000,0x3f223f46,0x3e48bf7b,0xbf623ef1
.long 0x3f800000,0xbf35bf35,0x3f80,0x3f35bf35,0xbf800000,0x3f463f22,0xbe48bf7b,0xbef13f62
.long 0x3f800000,0xbf55bf0e,0x3ec43f6d,0x3e48bf7b,0xbf800000,0x3f623ef1,0xbf0ebf55,0x3dc93f7f
.long 0x3f800000,0xbf6dbec4,0x3f353f35,0xbec4bf6d,0xbf800000,0x3f753e95,0xbf55bf0e,0x3f223f46
.long 0x3f800000,0xbf7bbe48,0x3f6d3ec4,0xbf55bf0e,0xbf800000,0x3f7f3dc9,0xbf7bbe48,0x3f753e95
.long 0x3f800000,0xbf80,0xbf800000,0x3f80,0xbf6d3ec4,0x3ef13f62,0x3f55bf0e,0xbf22bf46
.long 0x3f35bf35,0xbf55bf0e,0xbec43f6d,0x3f7b3e48,0xbec43f6d,0x3f7f3dc9,0xbe48bf7b,0xbf623ef1
.long 0xbf80,0xbf6d3ec4,0x3f353f35,0x3ec4bf6d,0x3ec43f6d,0x3f22bf46,0xbf7bbe48,0x3e953f75
.long 0xbf35bf35,0xbe483f7b,0x3f6dbec4,0xbf55bf0e,0x3f6d3ec4,0xbe95bf75,0xbf0e3f55,0x3f7fbdc9
.long 0xbf800000,0x3f353f35,0xbf80,0xbf353f35,0x3f6dbec4,0xbf75be95,0x3f0e3f55,0x3dc9bf7f
.long 0xbf353f35,0x3f7bbe48,0xbf6dbec4,0x3f0e3f55,0x3ec4bf6d,0xbf463f22,0x3f7bbe48,0xbf75be95
.long 0x3f80,0x3ec4bf6d,0xbf353f35,0x3f6dbec4,0xbec4bf6d,0x3dc93f7f,0x3e48bf7b,0xbef13f62
.long 0x3f353f35,0xbf0ebf55,0x3ec43f6d,0xbe48bf7b,0xbf6dbec4,0x3f623ef1,0xbf55bf0e,0x3f463f22
.long 0x3f800000,0xbf80,0xbf800000,0x3f80,0xbf353f35,0x3f463f22,0x3f0ebf55,0xbf62bef1
.long 0xbf80,0xbf7b3e48,0x3ec43f6d,0x3f55bf0e,0x3f353f35,0x3ef1bf62,0xbf7bbe48,0x3dc93f7f
.long 0xbf800000,0x3ec43f6d,0x3f35bf35,0xbf6dbec4,0x3f35bf35,0xbf75be95,0x3e483f7b,0x3f46bf22
.long 0x3f80,0x3f55bf0e,0xbf6dbec4,0x3e483f7b,0xbf35bf35,0xbdc93f7f,0x3f55bf0e,0xbf75be95
.long 0x3f800000,0xbf35bf35,0x3f80,0x3f35bf35,0xbf353f35,0x3f7fbdc9,0xbf55bf0e,0x3e953f75
.long 0xbf80,0xbf0e3f55,0x3f6dbec4,0xbf7bbe48,0x3f353f35,0xbe95bf75,0xbe483f7b,0x3f22bf46
.long 0xbf800000,0x3f6d3ec4,0xbf35bf35,0x3ec43f6d,0x3f35bf35,0xbf623ef1,0x3f7bbe48,0xbf7fbdc9
.long 0x3f80,0x3e48bf7b,0xbec43f6d,0x3f0ebf55,0xbf35bf35,0x3f223f46,0xbf0ebf55,0x3ef13f62
.long 0x3f800000,0xbf80,0xbf800000,0x3f80,0xbec43f6d,0x3f753e95,0x3e48bf7b,0xbf7fbdc9
.long 0xbf35bf35,0xbf0e3f55,0x3f6d3ec4,0x3e48bf7b,0x3f6dbec4,0xbf22bf46,0xbf0e3f55,0x3f753e95
.long 0x3f80,0x3f6dbec4,0xbf35bf35,0xbec43f6d,0xbf6dbec4,0x3dc93f7f,0x3f55bf0e,0xbf62bef1
.long 0x3f35bf35,0xbf7bbe48,0x3ec43f6d,0x3f0ebf55,0x3ec43f6d,0x3ef1bf62,0xbf7b3e48,0x3f463f22
.long 0xbf800000,0x3f353f35,0xbf80,0xbf353f35,0x3ec4bf6d,0xbf623ef1,0x3f7b3e48,0xbf22bf46
.long 0x3f353f35,0xbe48bf7b,0xbec43f6d,0x3f55bf0e,0xbf6d3ec4,0x3f7f3dc9,0xbf55bf0e,0x3ef13f62
.long 0xbf80,0xbec43f6d,0x3f35bf35,0xbf6d3ec4,0x3f6d3ec4,0xbf46bf22,0x3f0e3f55,0xbe95bf75
.long 0xbf353f35,0x3f55bf0e,0xbf6d3ec4,0x3f7bbe48,0xbec4bf6d,0x3e953f75,0xbe48bf7b,0x3dc93f7f
.long 0x3f80,0x3f800000,0xbf80,0xbf800000,0xbf800000,0x3dc93f7f,0x3f7bbe48,0xbe95bf75
.long 0xbf80,0xbf7b3e48,0x3ec43f6d,0x3f55bf0e,0x3f800000,0xbe95bf75,0xbf553f0e,0x3f463f22
.long 0x3f80,0x3f6dbec4,0xbf35bf35,0xbec43f6d,0xbf800000,0x3ef13f62,0x3f0ebf55,0xbf7fbdc9
.long 0xbf80,0xbf553f0e,0x3f6d3ec4,0xbe48bf7b,0x3f800000,0xbf22bf46,0xbe483f7b,0x3f62bef1
.long 0x3f80,0x3f35bf35,0xbf800000,0x3f353f35,0xbf800000,0x3f463f22,0xbe48bf7b,0xbef13f62
.long 0xbf80,0xbf0e3f55,0x3f6dbec4,0xbf7bbe48,0x3f800000,0xbf62bef1,0x3f0e3f55,0xbdc9bf7f
.long 0x3f80,0x3ec4bf6d,0xbf353f35,0x3f6dbec4,0xbf800000,0x3f753e95,0xbf55bf0e,0x3f223f46
.long 0xbf80,0xbe483f7b,0x3ec4bf6d,0xbf0e3f55,0x3f800000,0xbf7fbdc9,0x3f7b3e48,0xbf75be95
.long 0x3f80,0x3f800000,0xbf80,0xbf800000,0xbf6d3ec4,0x3ef13f62,0x3f55bf0e,0xbf22bf46
.long 0xbf35bf35,0xbf0e3f55,0x3f6d3ec4,0x3e48bf7b,0x3ec4bf6d,0xbf7fbdc9,0x3e483f7b,0x3f62bef1
.long 0x3f800000,0xbec4bf6d,0xbf353f35,0x3f6d3ec4,0x3ec43f6d,0x3f22bf46,0xbf7bbe48,0x3e953f75
.long 0xbf353f35,0x3f7b3e48,0xbec4bf6d,0xbf0e3f55,0xbf6dbec4,0x3e953f75,0x3f0ebf55,0xbf7f3dc9
.long 0xbf80,0xbf353f35,0x3f800000,0xbf35bf35,0x3f6dbec4,0xbf75be95,0x3f0e3f55,0x3dc9bf7f
.long 0x3f353f35,0xbe48bf7b,0xbec43f6d,0x3f55bf0e,0xbec43f6d,0x3f46bf22,0xbf7b3e48,0x3f753e95
.long 0xbf800000,0x3f6d3ec4,0xbf35bf35,0x3ec43f6d,0xbec4bf6d,0x3dc93f7f,0x3e48bf7b,0xbef13f62
.long 0x3f35bf35,0xbf553f0e,0x3f6dbec4,0xbf7b3e48,0x3f6d3ec4,0xbf62bef1,0x3f553f0e,0xbf46bf22
.long 0x3f80,0x3f800000,0xbf80,0xbf800000,0xbf353f35,0x3f463f22,0x3f0ebf55,0xbf62bef1
.long 0xbf800000,0x3e483f7b,0x3f6dbec4,0xbf0ebf55,0xbf35bf35,0xbef13f62,0x3f7b3e48,0xbdc9bf7f
.long 0xbf80,0xbf6d3ec4,0x3f353f35,0x3ec4bf6d,0x3f35bf35,0xbf75be95,0x3e483f7b,0x3f46bf22
.long 0x3f800000,0xbf0ebf55,0xbec43f6d,0x3f7bbe48,0x3f353f35,0x3dc9bf7f,0xbf553f0e,0x3f753e95
.long 0x3f80,0x3f35bf35,0xbf800000,0x3f353f35,0xbf353f35,0x3f7fbdc9,0xbf55bf0e,0x3e953f75
.long 0xbf800000,0x3f553f0e,0xbec4bf6d,0xbe483f7b,0xbf35bf35,0x3e953f75,0x3e48bf7b,0xbf223f46
.long 0xbf80,0xbec43f6d,0x3f35bf35,0xbf6d3ec4,0x3f35bf35,0xbf623ef1,0x3f7bbe48,0xbf7fbdc9
.long 0x3f800000,0xbf7bbe48,0x3f6d3ec4,0xbf55bf0e,0x3f353f35,0xbf22bf46,0x3f0e3f55,0xbef1bf62
.long 0x3f80,0x3f800000,0xbf80,0xbf800000,0xbec43f6d,0x3f753e95,0x3e48bf7b,0xbf7fbdc9
.long 0xbf353f35,0x3f553f0e,0x3ec4bf6d,0xbf7bbe48,0xbf6d3ec4,0x3f223f46,0x3f0ebf55,0xbf75be95
.long 0xbf800000,0x3ec43f6d,0x3f35bf35,0xbf6dbec4,0xbf6dbec4,0x3dc93f7f,0x3f55bf0e,0xbf62bef1
.long 0xbf35bf35,0xbe483f7b,0x3f6dbec4,0xbf55bf0e,0xbec4bf6d,0xbef13f62,0x3f7bbe48,0xbf46bf22
.long 0xbf80,0xbf353f35,0x3f800000,0xbf35bf35,0x3ec4bf6d,0xbf623ef1,0x3f7b3e48,0xbf22bf46
.long 0x3f35bf35,0xbf7b3e48,0x3f6d3ec4,0xbf0ebf55,0x3f6dbec4,0xbf7fbdc9,0x3f553f0e,0xbef1bf62
.long 0x3f800000,0xbf6dbec4,0x3f353f35,0xbec4bf6d,0x3f6d3ec4,0xbf46bf22,0x3f0e3f55,0xbe95bf75
.long 0x3f353f35,0xbf0ebf55,0x3ec43f6d,0xbe48bf7b,0x3ec43f6d,0xbe95bf75,0x3e483f7b,0xbdc9bf7f
.long 0x3f800000,0xbf80,0xbf800000,0x3f80,0x3f80,0x3f7fbdc9,0xbe48bf7b,0xbf753e95
.long 0xbf800000,0x3e483f7b,0x3f6dbec4,0xbf0ebf55,0xbf80,0xbf753e95,0x3f0e3f55,0x3f22bf46
.long 0x3f800000,0xbec4bf6d,0xbf353f35,0x3f6d3ec4,0x3f80,0x3f62bef1,0xbf55bf0e,0xbdc93f7f
.long 0xbf800000,0x3f0e3f55,0x3ec4bf6d,0xbf7b3e48,0xbf80,0xbf463f22,0x3f7b3e48,0xbef1bf62
.long 0x3f800000,0xbf35bf35,0x3f80,0x3f35bf35,0x3f80,0x3f22bf46,0xbf7b3e48,0x3f623ef1
.long 0xbf800000,0x3f553f0e,0xbec4bf6d,0xbe483f7b,0xbf80,0xbef13f62,0x3f55bf0e,0xbf7f3dc9
.long 0x3f800000,0xbf6dbec4,0x3f353f35,0xbec4bf6d,0x3f80,0x3e95bf75,0xbf0e3f55,0x3f46bf22
.long 0xbf800000,0x3f7b3e48,0xbf6dbec4,0x3f553f0e,0xbf80,0xbdc93f7f,0x3e48bf7b,0xbe953f75
.long 0x3f800000,0xbf80,0xbf800000,0x3f80,0x3ec43f6d,0x3f62bef1,0xbf0ebf55,0xbf463f22
.long 0xbf353f35,0x3f553f0e,0x3ec4bf6d,0xbf7bbe48,0xbf6dbec4,0xbdc93f7f,0x3f7bbe48,0xbef1bf62
.long 0xbf80,0xbf6d3ec4,0x3f353f35,0x3ec4bf6d,0x3f6dbec4,0xbf46bf22,0xbe483f7b,0x3f75be95
.long 0x3f353f35,0x3e48bf7b,0xbf6d3ec4,0x3f553f0e,0xbec43f6d,0x3f75be95,0xbf55bf0e,0x3dc93f7f
.long 0xbf800000,0x3f353f35,0xbf80,0xbf353f35,0xbec4bf6d,0xbe953f75,0x3f55bf0e,0xbf7fbdc9
.long 0x3f35bf35,0xbf7b3e48,0x3f6d3ec4,0xbf0ebf55,0x3f6d3ec4,0xbf22bf46,0x3e483f7b,0x3e95bf75
.long 0x3f80,0x3ec4bf6d,0xbf353f35,0x3f6dbec4,0xbf6d3ec4,0x3f7fbdc9,0xbf7bbe48,0x3f623ef1
.long 0xbf35bf35,0x3f0e3f55,0xbec4bf6d,0x3e483f7b,0x3ec4bf6d,0xbef13f62,0x3f0ebf55,0xbf223f46
.long 0x3f800000,0xbf80,0xbf800000,0x3f80,0x3f353f35,0x3f22bf46,0xbf55bf0e,0xbef13f62
.long 0x3f80,0x3f7bbe48,0xbec4bf6d,0xbf553f0e,0xbf353f35,0x3f623ef1,0x3e48bf7b,0xbf7f3dc9
.long 0xbf800000,0x3ec43f6d,0x3f35bf35,0xbf6dbec4,0xbf35bf35,0xbe953f75,0x3f7bbe48,0xbf22bf46
.long 0xbf80,0xbf553f0e,0x3f6d3ec4,0xbe48bf7b,0x3f35bf35,0xbf7fbdc9,0x3f0e3f55,0x3e95bf75
.long 0x3f800000,0xbf35bf35,0x3f80,0x3f35bf35,0x3f353f35,0xbdc9bf7f,0xbf0e3f55,0x3f75be95
.long 0x3f80,0x3f0ebf55,0xbf6d3ec4,0x3f7b3e48,0xbf353f35,0x3f75be95,0xbf7bbe48,0x3f463f22
.long 0xbf800000,0x3f6d3ec4,0xbf35bf35,0x3ec43f6d,0xbf35bf35,0x3ef13f62,0xbe48bf7b,0xbdc93f7f
.long 0xbf80,0xbe483f7b,0x3ec4bf6d,0xbf0e3f55,0x3f35bf35,0xbf463f22,0x3f55bf0e,0xbf623ef1
.long 0x3f800000,0xbf80,0xbf800000,0x3f80,0x3f6d3ec4,0x3e95bf75,0xbf7bbe48,0xbdc93f7f
.long 0x3f353f35,0x3f0ebf55,0xbf6dbec4,0xbe483f7b,0x3ec43f6d,0x3f46bf22,0xbf55bf0e,0xbe953f75
.long 0x3f80,0x3f6dbec4,0xbf35bf35,0xbec43f6d,0xbec43f6d,0x3f7fbdc9,0xbf0ebf55,0xbef13f62
.long 0xbf353f35,0x3f7b3e48,0xbec4bf6d,0xbf0e3f55,0xbf6d3ec4,0x3f623ef1,0xbe48bf7b,0xbf223f46
.long 0xbf800000,0x3f353f35,0xbf80,0xbf353f35,0xbf6dbec4,0x3ef13f62,0x3e48bf7b,0xbf463f22
.long 0xbf35bf35,0x3e483f7b,0x3ec4bf6d,0xbf553f0e,0xbec4bf6d,0xbdc93f7f,0x3f0ebf55,0xbf623ef1
.long 0xbf80,0xbec43f6d,0x3f35bf35,0xbf6d3ec4,0x3ec4bf6d,0xbf223f46,0x3f55bf0e,0xbf753e95
.long 0x3f35bf35,0xbf553f0e,0x3f6dbec4,0xbf7b3e48,0x3f6dbec4,0xbf753e95,0x3f7bbe48,0xbf7f3dc9
.long 0x3f800000,0x3f7fb10f,0x3f7ec46d,0x3f7d3aac,0x3f800000,0x3f7fa6e3,0x3f7e9bc9,0x3f7cdf6c
.long 0x3f800000,0x3f7f9c18,0x3f7e70b0,0x3f7c7eb0,0x3f800000,0x3f7f90b1,0x3f7e4323,0x3f7c187a
.long 0x3f800000,0x3f7f84ab,0x3f7e1324,0x3f7baccd,0x3f800000,0x3f7f7808,0x3f7de0b1,0x3f7b3bab
.long 0x3f800000,0x3f7f6ac7,0x3f7dabcc,0x3f7ac516,0x3f800000,0x3f7f5ce9,0x3f7d7474,0x3f7a4910
.long 0x3f800000,0x3f7f4e6d,0x3f7d3aac,0x3f79c79d,0x3f800000,0x3f7f3f54,0x3f7cfe73,0x3f7940c0
.long 0x3f800000,0x3f7f2f9d,0x3f7cbfc9,0x3f78b47b,0x3f800000,0x3f7f1f49,0x3f7c7eb0,0x3f7822d1
.long 0x3f800000,0x3f7f0e58,0x3f7c3b28,0x3f778bc5,0x3f800000,0x3f7efcc9,0x3f7bf531,0x3f76ef5b
.long 0x3f800000,0x3f7eea9d,0x3f7baccd,0x3f764d97,0x3f800000,0x3f7ed7d4,0x3f7b61fc,0x3f75a67b
.long 0x3f7b14be,0x3f7853f8,0x3f74fa0b,0x3f710908,0x3f7a7302,0x3f77583a,0x3f73913f,0x3f6f20b0
.long 0x3f79c79d,0x3f764d97,0x3f721352,0x3f6d1c1d,0x3f791298,0x3f75341d,0x3f708066,0x3f6afb8c
.long 0x3f7853f8,0x3f740bdd,0x3f6ed89e,0x3f68bf3c,0x3f778bc5,0x3f72d4eb,0x3f6d1c1d,0x3f666771
.long 0x3f76ba07,0x3f718f57,0x3f6b4b0c,0x3f63f473,0x3f75dec6,0x3f703b37,0x3f696591,0x3f61668a
.long 0x3f74fa0b,0x3f6ed89e,0x3f676bd8,0x3f5ebe05,0x3f740bdd,0x3f6d67a1,0x3f655e0b,0x3f5bfb34
.long 0x3f731447,0x3f6be858,0x3f633c5a,0x3f591e6a,0x3f721352,0x3f6a5ad9,0x3f6106f2,0x3f5627fe
.long 0x3f710908,0x3f68bf3c,0x3f5ebe05,0x3f531849,0x3f6ff573,0x3f671599,0x3f5c61c7,0x3f4fefa8
.long 0x3f6ed89e,0x3f655e0b,0x3f59f26a,0x3f4cae79,0x3f6db293,0x3f6398ac,0x3f577026,0x3f495521
.long 0x3f6c835e,0x3f676bd8,0x3f61c598,0x3f5b941a,0x3f6a09a7,0x3f644fac,0x3f5df6be,0x3f570348
.long 0x3f676bd8,0x3f6106f2,0x3f59f26a,0x3f5233c6,0x3f64aa59,0x3f5d924d,0x3f55b993,0x3f4d26fd
.long 0x3f61c598,0x3f59f26a,0x3f514d3d,0x3f47de65,0x3f5ebe05,0x3f5627fe,0x3f4cae79,0x3f425b89
.long 0x3f5b941a,0x3f5233c6,0x3f47de65,0x3f3ca003,0x3f584853,0x3f4e1689,0x3f42de29,0x3f36ad7f
.long 0x3f54db31,0x3f49d112,0x3f3daef9,0x3f3085bb,0x3f514d3d,0x3f456439,0x3f385216,0x3f2a2a80
.long 0x3f4d9f02,0x3f40d0da,0x3f32c8c9,0x3f239da9,0x3f49d112,0x3f3c17d9,0x3f2d1469,0x3f1ce11f
.long 0x3f45e403,0x3f373a23,0x3f273656,0x3f15f6d9,0x3f41d870,0x3f3238aa,0x3f212ff9,0x3f0ee0db
.long 0x3f3daef9,0x3f2d1469,0x3f1b02c6,0x3f07a136,0x3f396842,0x3f27ce61,0x3f14b039,0x3f003a06
.long 0x3f54db31,0x3f4d9f02,0x3f45e403,0x3f3daef9,0x3f4f7a1f,0x3f476085,0x3f3ebc1b,0x3f3592e7
.long 0x3f49d112,0x3f40d0da,0x3f373a23,0x3f2d1469,0x3f43e200,0x3f39f2ac,0x3f2f61a5,0x3f24381a
.long 0x3f3daef9,0x3f32c8c9,0x3f273656,0x3f1b02c6,0x3f373a23,0x3f2b561b,0x3f1ebc12,0x3f11796b
.long 0x3f3085bb,0x3f239da9,0x3f15f6d9,0x3f07a136,0x3f299415,0x3f1ba299,0x3f0cead0,0x3efafef7
.long 0x3f226799,0x3f13682a,0x3f039c3d,0x3ee63375,0x3f1b02c6,0x3f0af1b7,0x3ef41f07,0x3ed0eb2a
.long 0x3f13682a,0x3f0242b1,0x3ee0924f,0x3ebb31a0,0x3f0b9a6b,0x3ef2bd43,0x3ecc9b8b,0x3ea5129f
.long 0x3f039c3d,0x3ee0924f,0x3eb8442a,0x3e8e9a22,0x3ef6e0cb,0x3ece0bea,0x3ea395c5,0x3e6fa8b2
.long 0x3ee63375,0x3ebb31a0,0x3e8e9a22,0x3e419b37,0x3ed53641,0x3ea80b1f,0x3e72b651,0x3e1324ca
.long 0x3f3504f3,0x3f2beb4a,0x3f226799,0x3f187fc0,0x3f2beb4a,0x3f21cbfb,0x3f173c07,0x3f0c42c9
.long 0x3f226799,0x3f173c07,0x3f0b9a6b,0x3eff17b2,0x3f187fc0,0x3f0c42c9,0x3eff17b2,0x3ee4cbfe
.long 0x3f0e39da,0x3f00e7e4,0x3ee63375,0x3ec9b953,0x3f039c3d,0x3eea6681,0x3ecc9b8b,0x3eadf73c
.long 0x3ef15aea,0x3ed25a09,0x3eb263ef,0x3e919ddd,0x3edae880,0x3eb9bb1e,0x3e97a117,0x3e698bba
.long 0x3ec3ef15,0x3ea09ae5,0x3e78cfcc,0x3e2f10a2,0x3eac7cd4,0x3e870ada,0x3e419b37,0x3de7fa9a
.long 0x3e94a031,0x3e5a3997,0x3e09cf86,0x3d621469,0x3e78cfcc,0x3e25c58c,0x3da3308c,0xbb490fc6
.long 0x3e47c5c2,0x3de1bc2e,0x3cc90ab0,0xbd7b2b74,0x3e164083,0x3d6ea038,0xbcfb49ba,0xbdf475c0
.long 0x3dc8bd36,0x3bc90f88,0xbdafb680,0xbe354098,0x3d48fb30,0xbd3c6dd5,0xbe1008b7,0xbe6fa8b2
.long 0x3f0e39da,0x3f039c3d,0x3ef15aea,0x3edae880,0x3f00e7e4,0x3eea6681,0x3ed25a09,0x3eb9bb1e
.long 0x3ee63375,0x3ecc9b8b,0x3eb263ef,0x3e97a117,0x3ec9b953,0x3eadf73c,0x3e919ddd,0x3e698bba
.long 0x3eac7cd4,0x3e8e9a22,0x3e605c13,0x3e22abb6,0x3e8e9a22,0x3e5d4b1a,0x3e1c76de,0x3db5f8da
.long 0x3e605c13,0x3e1c76de,0x3dafb680,0x3c96c9b6,0x3e22abb6,0x3db5f8da,0x3c96c9b6,0xbd55880e
.long 0x3dc8bd36,0x3cc90ab0,0xbd48fb30,0xbdfab273,0x3d16c32c,0xbd2351cb,0xbdee3876,0xbe44b0b9
.long 0xbcc90ab0,0xbdd53db9,0xbe3b6ecf,0xbe8586ce,0xbdafb680,0xbe2bf804,0xbe7ee6e1,0xbea80b1f
.long 0xbe164083,0xbe6c9a7f,0xbea09ae5,0xbec9b953,0xbe541501,0xbe9620d2,0xbec1071e,0xbeea6681
.long 0xbe888e93,0xbeb554ec,0xbee0924f,0xbf04f484,0xbea68f12,0xbed3c867,0xbeff17b2,0xbf140c5f
.long 0x3ec3ef15,0x3eac7cd4,0x3e94a031,0x3e78cfcc,0x3ea09ae5,0x3e870ada,0x3e5a3997,0x3e25c58c
.long 0x3e78cfcc,0x3e419b37,0x3e09cf86,0x3da3308c,0x3e2f10a2,0x3de7fa9a,0x3d621469,0xbb490fc6
.long 0x3dc8bd36,0x3d16c32c,0xbcc90ab0,0xbdafb680,0x3cc90ab0,0xbd2351cb,0xbdd53db9,0xbe2bf804
.long 0xbd48fb30,0xbdee3876,0xbe3b6ecf,0xbe7ee6e1,0xbdfab273,0xbe44b0b9,0xbe8586ce,0xbea80b1f
.long 0xbe47c5c2,0xbe888e93,0xbeac7cd4,0xbecf7bca,0xbe888e93,0xbeadf73c,0xbed25a09,0xbef58035
.long 0xbeac7cd4,0xbed25a09,0xbef6e0cb,0xbf0cead0,0xbecf7bca,0xbef58035,0xbf0cead0,0xbf1e1e22
.long 0xbef15aea,0xbf0b9a6b,0xbf1d7fd1,0xbf2e3bde,0xbf08f59b,0xbf1ba299,0xbf2d1469,0xbf3d27b8
.long 0xbf187fc0,0xbf2ac082,0xbf3b8f3b,0xbf4ac77f,0xbf273656,0xbf38dd65,0xbf48d8b3,0xbf570348
.long 0x3e47c5c2,0x3e164083,0x3dc8bd36,0x3d48fb30,0x3de1bc2e,0x3d6ea038,0x3bc90f88,0xbd3c6dd5
.long 0x3cc90ab0,0xbcfb49ba,0xbdafb680,0xbe1008b7,0xbd7b2b74,0xbdf475c0,0xbe354098,0xbe6fa8b2
.long 0xbe164083,0xbe541501,0xbe888e93,0xbea68f12,0xbe6c9a7f,0xbe9620d2,0xbeb554ec,0xbed3c867
.long 0xbea09ae5,0xbec1071e,0xbee0924f,0xbeff17b2,0xbec9b953,0xbeea6681,0xbf04f484,0xbf140c5f
.long 0xbef15aea,0xbf08f59b,0xbf187fc0,0xbf273656,0xbf0b9a6b,0xbf1ba299,0xbf2ac082,0xbf38dd65
.long 0xbf1d7fd1,0xbf2d1469,0xbf3b8f3b,0xbf48d8b3,0xbf2e3bde,0xbf3d27b8,0xbf4ac77f,0xbf570348
.long 0xbf3daef9,0xbf4bbbf8,0xbf584853,0xbf633c5a,0xbf4bbbf8,0xbf58b3a1,0xbf63f473,0xbf6d67a1
.long 0xbf584853,0xbf63f473,0xbf6db293,0xbf756d97,0xbf633c5a,0xbf6d67a1,0xbf756d97,0xbf7b3bab
.long 0x0,0xbd48fb30,0xbdc8bd36,0xbe164083,0x0,0xbd55880e,0xbdd53db9,0xbe1f917b
.long 0x0,0xbd621469,0xbde1bc2e,0xbe28defc,0x0,0xbd6ea038,0xbdee3876,0xbe3228d4
.long 0x0,0xbd7b2b74,0xbdfab273,0xbe3b6ecf,0x0,0xbd83db0a,0xbe039502,0xbe44b0b9
.long 0x0,0xbd8a200a,0xbe09cf86,0xbe4dee60,0x0,0xbd9064b4,0xbe1008b7,0xbe57278f
.long 0x0,0xbd96a905,0xbe164083,0xbe605c13,0x0,0xbd9cecf9,0xbe1c76de,0xbe698bba
.long 0x0,0xbda3308c,0xbe22abb6,0xbe72b651,0x0,0xbda973ba,0xbe28defc,0xbe7bdba4
.long 0x0,0xbdafb680,0xbe2f10a2,0xbe827dc0,0x0,0xbdb5f8da,0xbe354098,0xbe870ada
.long 0x0,0xbdbc3ac3,0xbe3b6ecf,0xbe8b9507,0x0,0xbdc27c39,0xbe419b37,0xbe901c2c
.long 0xbe47c5c2,0xbe78cfcc,0xbe94a031,0xbeac7cd4,0xbe541501,0xbe840270,0xbe9d9e78,0xbeb6ccc3
.long 0xbe605c13,0xbe8b9507,0xbea68f12,0xbec1071e,0xbe6c9a7f,0xbe931f35,0xbeaf713a,0xbecb2aae
.long 0xbe78cfcc,0xbe9aa086,0xbeb8442a,0xbed53641,0xbe827dc0,0xbea21887,0xbec1071e,0xbedf28a9
.long 0xbe888e93,0xbea986c4,0xbec9b953,0xbee900b7,0xbe8e9a22,0xbeb0eacb,0xbed25a09,0xbef2bd43
.long 0xbe94a031,0xbeb8442a,0xbedae880,0xbefc5d27,0xbe9aa086,0xbebf926f,0xbee363fa,0xbf02ef9f
.long 0xbea09ae5,0xbec6d529,0xbeebcbbb,0xbf07a136,0xbea68f12,0xbece0bea,0xbef41f07,0xbf0c42c9
.long 0xbeac7cd4,0xbed53641,0xbefc5d27,0xbf10d3cd,0xbeb263ef,0xbedc53c1,0xbf0242b1,0xbf1553b7
.long 0xbeb8442a,0xbee363fa,0xbf064b82,0xbf19c200,0xbebe1d4a,0xbeea6681,0xbf0a48ad,0xbf1e1e22
.long 0xbec3ef15,0xbedae880,0xbef15aea,0xbf039c3d,0xbecf7bca,0xbee79a5d,0xbeff17b2,0xbf0af1b7
.long 0xbedae880,0xbef41f07,0xbf064b82,0xbf121eb0,0xbee63375,0xbf003a06,0xbf0cead0,0xbf19210f
.long 0xbef15aea,0xbf064b82,0xbf13682a,0xbf1ff6cb,0xbefc5d27,0xbf0c42c9,0xbf19c200,0xbf269de3
.long 0xbf039c3d,0xbf121eb0,0xbf1ff6cb,0xbf2d1469,0xbf08f59b,0xbf17de12,0xbf26050a,0xbf33587a
.long 0xbf0e39da,0xbf1d7fd1,0xbf2beb4a,0xbf396842,0xbf13682a,0xbf2302d3,0xbf31a81d,0xbf3f41fc
.long 0xbf187fc0,0xbf286605,0xbf373a23,0xbf44e3f5,0xbf1d7fd1,0xbf2da859,0xbf3ca003,0xbf4a4c87
.long 0xbf226799,0xbf32c8c9,0xbf41d870,0xbf4f7a1f,0xbf273656,0xbf37c655,0xbf46e22a,0xbf546b3b
.long 0xbf2beb4a,0xbf3ca003,0xbf4bbbf8,0xbf591e6a,0xbf3085bb,0xbf4154e1,0xbf5064af,0xbf5d924d
.long 0xbf0e39da,0xbf187fc0,0xbf226799,0xbf2beb4a,0xbf15f6d9,0xbf209393,0xbf2ac082,0xbf34768f
.long 0xbf1d7fd1,0xbf286605,0xbf32c8c9,0xbf3ca003,0xbf24d225,0xbf2ff3e6,0xbf3a7ca4,0xbf446337
.long 0xbf2beb4a,0xbf373a23,0xbf41d870,0xbf4bbbf8,0xbf32c8c9,0xbf3e35c5,0xbf48d8b3,0xbf52a649
.long 0xbf396842,0xbf44e3f5,0xbf4f7a1f,0xbf591e6a,0xbf3fc767,0xbf4b41fa,0xbf55b993,0xbf5f20db
.long 0xbf45e403,0xbf514d3d,0xbf5b941a,0xbf64aa59,0xbf4bbbf8,0xbf570348,0xbf6106f2,0xbf69b7e4
.long 0xbf514d3d,0xbf5c61c7,0xbf660f88,0xbf6e46be,0xbf5695e5,0xbf61668a,0xbf6aab7b,0xbf725470
.long 0xbf5b941a,0xbf660f88,0xbf6ed89e,0xbf75dec6,0xbf604621,0xbf6a5ad9,0xbf7294f8,0xbf78e3d6
.long 0xbf64aa59,0xbf6e46be,0xbf75dec6,0xbf7b61fc,0xbf68bf3c,0xbf71d19f,0xbf78b47b,0xbf7d57de
.long 0xbf3504f3,0xbf3daef9,0xbf45e403,0xbf4d9f02,0xbf3daef9,0xbf466354,0xbf4e8d90,0xbf5627fe
.long 0xbf45e403,0xbf4e8d90,0xbf5695e5,0xbf5df6be,0xbf4d9f02,0xbf5627fe,0xbf5df6be,0xbf650479
.long 0xbf54db31,0xbf5d2d53,0xbf64aa59,0xbf6b4b0c,0xbf5b941a,0xbf6398ac,0xbf6aab7b,0xbf70c501
.long 0xbf61c598,0xbf696591,0xbf6ff573,0xbf756d97,0xbf676bd8,0xbf6e8ff8,0xbf748422,0xbf7940c0
.long 0xbf6c835e,0xbf731447,0xbf7853f8,0xbf7c3b28,0xbf710908,0xbf76ef5b,0xbf7b61fc,0xbf7e5a38
.long 0xbf74fa0b,0xbf7a1e84,0xbf7dabcc,0xbf7f9c18,0xbf7853f8,0xbf7c9f8a,0xbf7f2f9d,0xbf7fffb1
.long 0xbf7b14be,0xbf7e70b0,0xbf7fec43,0xbf7f84ab,0xbf7d3aac,0xbf7f90b1,0xbf7fe129,0xbf7e2b72
.long 0xbf7ec46d,0xbf7ffec4,0xbf7f0e58,0xbf7bf531,0xbf7fb10f,0xbf7fba9e,0xbf7d7474,0xbf78e3d6
.long 0xbf54db31,0xbf5b941a,0xbf61c598,0xbf676bd8,0xbf5d2d53,0xbf6398ac,0xbf696591,0xbf6e8ff8
.long 0xbf64aa59,0xbf6aab7b,0xbf6ff573,0xbf748422,0xbf6b4b0c,0xbf70c501,0xbf756d97,0xbf7940c0
.long 0xbf710908,0xbf75dec6,0xbf79c79d,0xbf7cbfc9,0xbf75dec6,0xbf79f35e,0xbf7cfe73,0xbf7efcc9
.long 0xbf79c79d,0xbf7cfe73,0xbf7f0e58,0xbf7ff4e6,0xbf7cbfc9,0xbf7efcc9,0xbf7ff4e6,0xbf7fa6e3
.long 0xbf7ec46d,0xbf7fec43,0xbf7fb10f,0xbf7e1324,0xbf7fd397,0xbf7fcbe2,0xbf7e4323,0xbf7b3bab
.long 0xbf7fec43,0xbf7e9bc9,0xbf7baccd,0xbf772417,0xbf7f0e58,0xbf7c5d3a,0xbf77f110,0xbf71d19f
.long 0xbf7d3aac,0xbf791298,0xbf731447,0xbf6b4b0c,0xbf7a7302,0xbf74bf62,0xbf6d1c1d,0xbf6398ac
.long 0xbf76ba07,0xbf6f6830,0xbf660f88,0xbf5ac450,0xbf721352,0xbf6912ae,0xbf5df6be,0xbf50d937
.long 0xbf6c835e,0xbf710908,0xbf74fa0b,0xbf7853f8,0xbf731447,0xbf76ef5b,0xbf7a1e84,0xbf7c9f8a
.long 0xbf7853f8,0xbf7b61fc,0xbf7dabcc,0xbf7f2f9d,0xbf7c3b28,0xbf7e5a38,0xbf7f9c18,0xbf7fffb1
.long 0xbf7ec46d,0xbf7fd397,0xbf7fec43,0xbf7f0e58,0xbf7fec43,0xbf7fcbe2,0xbf7e9bc9,0xbf7c5d3a
.long 0xbf7fb10f,0xbf7e4323,0xbf7baccd,0xbf77f110,0xbf7e1324,0xbf7b3bab,0xbf772417,0xbf71d19f
.long 0xbf7b14be,0xbf76ba07,0xbf710908,0xbf6a09a7,0xbf76ba07,0xbf70c501,0xbf696591,0xbf60a6cf
.long 0xbf710908,0xbf696591,0xbf604621,0xbf55b993,0xbf6a09a7,0xbf60a6cf,0xbf55b993,0xbf495521
.long 0xbf61c598,0xbf5695e5,0xbf49d112,0xbf3b8f3b,0xbf584853,0xbf4b41fa,0xbf3ca003,0xbf2c800f
.long 0xbf4d9f02,0xbf3ebc1b,0xbf2e3bde,0xbf1c420c,0xbf41d870,0xbf311722,0xbf1ebc12,0xbf0af1b7
.long 0xbf7b14be,0xbf7d3aac,0xbf7ec46d,0xbf7fb10f,0xbf7e70b0,0xbf7f90b1,0xbf7ffec4,0xbf7fba9e
.long 0xbf7fec43,0xbf7fe129,0xbf7f0e58,0xbf7d7474,0xbf7f84ab,0xbf7e2b72,0xbf7bf531,0xbf78e3d6
.long 0xbf7d3aac,0xbf7a7302,0xbf76ba07,0xbf721352,0xbf791298,0xbf74bf62,0xbf6f6830,0xbf6912ae
.long 0xbf731447,0xbf6d1c1d,0xbf660f88,0xbf5df6be,0xbf6b4b0c,0xbf6398ac,0xbf5ac450,0xbf50d937
.long 0xbf61c598,0xbf584853,0xbf4d9f02,0xbf41d870,0xbf5695e5,0xbf4b41fa,0xbf3ebc1b,0xbf311722
.long 0xbf49d112,0xbf3ca003,0xbf2e3bde,0xbf1ebc12,0xbf3b8f3b,0xbf2c800f,0xbf1c420c,0xbf0af1b7
.long 0xbf2beb4a,0xbf1b02c6,0xbf08f59b,0xbeebcbbb,0xbf1b02c6,0xbf084b92,0xbee900b7,0xbebf926f
.long 0xbf08f59b,0xbee900b7,0xbebe1d4a,0xbe919ddd,0xbeebcbbb,0xbebf926f,0xbe919ddd,0xbe44b0b9
.long 0x3f800000,0x3f800000,0x3f800000,0x3f800000,0x3f7fb10f,0x3f7fa6e3,0x3f7f9c18,0x3f7f90b1
.long 0x3f7ec46d,0x3f7e9bc9,0x3f7e70b0,0x3f7e4323,0x3f7d3aac,0x3f7cdf6c,0x3f7c7eb0,0x3f7c187a
.long 0x3f7b14be,0x3f7a7302,0x3f79c79d,0x3f791298,0x3f7853f8,0x3f77583a,0x3f764d97,0x3f75341d
.long 0x3f74fa0b,0x3f73913f,0x3f721352,0x3f708066,0x3f710908,0x3f6f20b0,0x3f6d1c1d,0x3f6afb8c
.long 0x3f6c835e,0x3f6a09a7,0x3f676bd8,0x3f64aa59,0x3f676bd8,0x3f644fac,0x3f6106f2,0x3f5d924d
.long 0x3f61c598,0x3f5df6be,0x3f59f26a,0x3f55b993,0x3f5b941a,0x3f570348,0x3f5233c6,0x3f4d26fd
.long 0x3f54db31,0x3f4f7a1f,0x3f49d112,0x3f43e200,0x3f4d9f02,0x3f476085,0x3f40d0da,0x3f39f2ac
.long 0x3f45e403,0x3f3ebc1b,0x3f373a23,0x3f2f61a5,0x3f3daef9,0x3f3592e7,0x3f2d1469,0x3f24381a
.long 0x3f800000,0x3f800000,0x3f800000,0x3f800000,0x3f7f84ab,0x3f7f7808,0x3f7f6ac7,0x3f7f5ce9
.long 0x3f7e1324,0x3f7de0b1,0x3f7dabcc,0x3f7d7474,0x3f7baccd,0x3f7b3bab,0x3f7ac516,0x3f7a4910
.long 0x3f7853f8,0x3f778bc5,0x3f76ba07,0x3f75dec6,0x3f740bdd,0x3f72d4eb,0x3f718f57,0x3f703b37
.long 0x3f6ed89e,0x3f6d1c1d,0x3f6b4b0c,0x3f696591,0x3f68bf3c,0x3f666771,0x3f63f473,0x3f61668a
.long 0x3f61c598,0x3f5ebe05,0x3f5b941a,0x3f584853,0x3f59f26a,0x3f5627fe,0x3f5233c6,0x3f4e1689
.long 0x3f514d3d,0x3f4cae79,0x3f47de65,0x3f42de29,0x3f47de65,0x3f425b89,0x3f3ca003,0x3f36ad7f
.long 0x3f3daef9,0x3f373a23,0x3f3085bb,0x3f299415,0x3f32c8c9,0x3f2b561b,0x3f239da9,0x3f1ba299
.long 0x3f273656,0x3f1ebc12,0x3f15f6d9,0x3f0cead0,0x3f1b02c6,0x3f11796b,0x3f07a136,0x3efafef7
.long 0x3f800000,0x3f800000,0x3f800000,0x3f800000,0x3f7f4e6d,0x3f7f3f54,0x3f7f2f9d,0x3f7f1f49
.long 0x3f7d3aac,0x3f7cfe73,0x3f7cbfc9,0x3f7c7eb0,0x3f79c79d,0x3f7940c0,0x3f78b47b,0x3f7822d1
.long 0x3f74fa0b,0x3f740bdd,0x3f731447,0x3f721352,0x3f6ed89e,0x3f6d67a1,0x3f6be858,0x3f6a5ad9
.long 0x3f676bd8,0x3f655e0b,0x3f633c5a,0x3f6106f2,0x3f5ebe05,0x3f5bfb34,0x3f591e6a,0x3f5627fe
.long 0x3f54db31,0x3f514d3d,0x3f4d9f02,0x3f49d112,0x3f49d112,0x3f456439,0x3f40d0da,0x3f3c17d9
.long 0x3f3daef9,0x3f385216,0x3f32c8c9,0x3f2d1469,0x3f3085bb,0x3f2a2a80,0x3f239da9,0x3f1ce11f
.long 0x3f226799,0x3f1b02c6,0x3f13682a,0x3f0b9a6b,0x3f13682a,0x3f0af1b7,0x3f0242b1,0x3ef2bd43
.long 0x3f039c3d,0x3ef41f07,0x3ee0924f,0x3ecc9b8b,0x3ee63375,0x3ed0eb2a,0x3ebb31a0,0x3ea5129f
.long 0x3f800000,0x3f800000,0x3f800000,0x3f800000,0x3f7f0e58,0x3f7efcc9,0x3f7eea9d,0x3f7ed7d4
.long 0x3f7c3b28,0x3f7bf531,0x3f7baccd,0x3f7b61fc,0x3f778bc5,0x3f76ef5b,0x3f764d97,0x3f75a67b
.long 0x3f710908,0x3f6ff573,0x3f6ed89e,0x3f6db293,0x3f68bf3c,0x3f671599,0x3f655e0b,0x3f6398ac
.long 0x3f5ebe05,0x3f5c61c7,0x3f59f26a,0x3f577026,0x3f531849,0x3f4fefa8,0x3f4cae79,0x3f495521
.long 0x3f45e403,0x3f41d870,0x3f3daef9,0x3f396842,0x3f373a23,0x3f3238aa,0x3f2d1469,0x3f27ce61
.long 0x3f273656,0x3f212ff9,0x3f1b02c6,0x3f14b039,0x3f15f6d9,0x3f0ee0db,0x3f07a136,0x3f003a06
.long 0x3f039c3d,0x3ef6e0cb,0x3ee63375,0x3ed53641,0x3ee0924f,0x3ece0bea,0x3ebb31a0,0x3ea80b1f
.long 0x3eb8442a,0x3ea395c5,0x3e8e9a22,0x3e72b651,0x3e8e9a22,0x3e6fa8b2,0x3e419b37,0x3e1324ca
.long 0x3f3504f3,0x3f2beb4a,0x3f226799,0x3f187fc0,0x3f2beb4a,0x3f21cbfb,0x3f173c07,0x3f0c42c9
.long 0x3f226799,0x3f173c07,0x3f0b9a6b,0x3eff17b2,0x3f187fc0,0x3f0c42c9,0x3eff17b2,0x3ee4cbfe
.long 0x3f0e39da,0x3f00e7e4,0x3ee63375,0x3ec9b953,0x3f039c3d,0x3eea6681,0x3ecc9b8b,0x3eadf73c
.long 0x3ef15aea,0x3ed25a09,0x3eb263ef,0x3e919ddd,0x3edae880,0x3eb9bb1e,0x3e97a117,0x3e698bba
.long 0x3ec3ef15,0x3ea09ae5,0x3e78cfcc,0x3e2f10a2,0x3eac7cd4,0x3e870ada,0x3e419b37,0x3de7fa9a
.long 0x3e94a031,0x3e5a3997,0x3e09cf86,0x3d621469,0x3e78cfcc,0x3e25c58c,0x3da3308c,0xbb490fc6
.long 0x3e47c5c2,0x3de1bc2e,0x3cc90ab0,0xbd7b2b74,0x3e164083,0x3d6ea038,0xbcfb49ba,0xbdf475c0
.long 0x3dc8bd36,0x3bc90f88,0xbdafb680,0xbe354098,0x3d48fb30,0xbd3c6dd5,0xbe1008b7,0xbe6fa8b2
.long 0x3f0e39da,0x3f039c3d,0x3ef15aea,0x3edae880,0x3f00e7e4,0x3eea6681,0x3ed25a09,0x3eb9bb1e
.long 0x3ee63375,0x3ecc9b8b,0x3eb263ef,0x3e97a117,0x3ec9b953,0x3eadf73c,0x3e919ddd,0x3e698bba
.long 0x3eac7cd4,0x3e8e9a22,0x3e605c13,0x3e22abb6,0x3e8e9a22,0x3e5d4b1a,0x3e1c76de,0x3db5f8da
.long 0x3e605c13,0x3e1c76de,0x3dafb680,0x3c96c9b6,0x3e22abb6,0x3db5f8da,0x3c96c9b6,0xbd55880e
.long 0x3dc8bd36,0x3cc90ab0,0xbd48fb30,0xbdfab273,0x3d16c32c,0xbd2351cb,0xbdee3876,0xbe44b0b9
.long 0xbcc90ab0,0xbdd53db9,0xbe3b6ecf,0xbe8586ce,0xbdafb680,0xbe2bf804,0xbe7ee6e1,0xbea80b1f
.long 0xbe164083,0xbe6c9a7f,0xbea09ae5,0xbec9b953,0xbe541501,0xbe9620d2,0xbec1071e,0xbeea6681
.long 0xbe888e93,0xbeb554ec,0xbee0924f,0xbf04f484,0xbea68f12,0xbed3c867,0xbeff17b2,0xbf140c5f
.long 0x3ec3ef15,0x3eac7cd4,0x3e94a031,0x3e78cfcc,0x3ea09ae5,0x3e870ada,0x3e5a3997,0x3e25c58c
.long 0x3e78cfcc,0x3e419b37,0x3e09cf86,0x3da3308c,0x3e2f10a2,0x3de7fa9a,0x3d621469,0xbb490fc6
.long 0x3dc8bd36,0x3d16c32c,0xbcc90ab0,0xbdafb680,0x3cc90ab0,0xbd2351cb,0xbdd53db9,0xbe2bf804
.long 0xbd48fb30,0xbdee3876,0xbe3b6ecf,0xbe7ee6e1,0xbdfab273,0xbe44b0b9,0xbe8586ce,0xbea80b1f
.long 0xbe47c5c2,0xbe888e93,0xbeac7cd4,0xbecf7bca,0xbe888e93,0xbeadf73c,0xbed25a09,0xbef58035
.long 0xbeac7cd4,0xbed25a09,0xbef6e0cb,0xbf0cead0,0xbecf7bca,0xbef58035,0xbf0cead0,0xbf1e1e22
.long 0xbef15aea,0xbf0b9a6b,0xbf1d7fd1,0xbf2e3bde,0xbf08f59b,0xbf1ba299,0xbf2d1469,0xbf3d27b8
.long 0xbf187fc0,0xbf2ac082,0xbf3b8f3b,0xbf4ac77f,0xbf273656,0xbf38dd65,0xbf48d8b3,0xbf570348
.long 0x3e47c5c2,0x3e164083,0x3dc8bd36,0x3d48fb30,0x3de1bc2e,0x3d6ea038,0x3bc90f88,0xbd3c6dd5
.long 0x3cc90ab0,0xbcfb49ba,0xbdafb680,0xbe1008b7,0xbd7b2b74,0xbdf475c0,0xbe354098,0xbe6fa8b2
.long 0xbe164083,0xbe541501,0xbe888e93,0xbea68f12,0xbe6c9a7f,0xbe9620d2,0xbeb554ec,0xbed3c867
.long 0xbea09ae5,0xbec1071e,0xbee0924f,0xbeff17b2,0xbec9b953,0xbeea6681,0xbf04f484,0xbf140c5f
.long 0xbef15aea,0xbf08f59b,0xbf187fc0,0xbf273656,0xbf0b9a6b,0xbf1ba299,0xbf2ac082,0xbf38dd65
.long 0xbf1d7fd1,0xbf2d1469,0xbf3b8f3b,0xbf48d8b3,0xbf2e3bde,0xbf3d27b8,0xbf4ac77f,0xbf570348
.long 0xbf3daef9,0xbf4bbbf8,0xbf584853,0xbf633c5a,0xbf4bbbf8,0xbf58b3a1,0xbf63f473,0xbf6d67a1
.long 0xbf584853,0xbf63f473,0xbf6db293,0xbf756d97,0xbf633c5a,0xbf6d67a1,0xbf756d97,0xbf7b3bab
.long 0x0,0x0,0x0,0x0,0xbd48fb30,0xbd55880e,0xbd621469,0xbd6ea038
.long 0xbdc8bd36,0xbdd53db9,0xbde1bc2e,0xbdee3876,0xbe164083,0xbe1f917b,0xbe28defc,0xbe3228d4
.long 0xbe47c5c2,0xbe541501,0xbe605c13,0xbe6c9a7f,0xbe78cfcc,0xbe840270,0xbe8b9507,0xbe931f35
.long 0xbe94a031,0xbe9d9e78,0xbea68f12,0xbeaf713a,0xbeac7cd4,0xbeb6ccc3,0xbec1071e,0xbecb2aae
.long 0xbec3ef15,0xbecf7bca,0xbedae880,0xbee63375,0xbedae880,0xbee79a5d,0xbef41f07,0xbf003a06
.long 0xbef15aea,0xbeff17b2,0xbf064b82,0xbf0cead0,0xbf039c3d,0xbf0af1b7,0xbf121eb0,0xbf19210f
.long 0xbf0e39da,0xbf15f6d9,0xbf1d7fd1,0xbf24d225,0xbf187fc0,0xbf209393,0xbf286605,0xbf2ff3e6
.long 0xbf226799,0xbf2ac082,0xbf32c8c9,0xbf3a7ca4,0xbf2beb4a,0xbf34768f,0xbf3ca003,0xbf446337
.long 0x0,0x0,0x0,0x0,0xbd7b2b74,0xbd83db0a,0xbd8a200a,0xbd9064b4
.long 0xbdfab273,0xbe039502,0xbe09cf86,0xbe1008b7,0xbe3b6ecf,0xbe44b0b9,0xbe4dee60,0xbe57278f
.long 0xbe78cfcc,0xbe827dc0,0xbe888e93,0xbe8e9a22,0xbe9aa086,0xbea21887,0xbea986c4,0xbeb0eacb
.long 0xbeb8442a,0xbec1071e,0xbec9b953,0xbed25a09,0xbed53641,0xbedf28a9,0xbee900b7,0xbef2bd43
.long 0xbef15aea,0xbefc5d27,0xbf039c3d,0xbf08f59b,0xbf064b82,0xbf0c42c9,0xbf121eb0,0xbf17de12
.long 0xbf13682a,0xbf19c200,0xbf1ff6cb,0xbf26050a,0xbf1ff6cb,0xbf269de3,0xbf2d1469,0xbf33587a
.long 0xbf2beb4a,0xbf32c8c9,0xbf396842,0xbf3fc767,0xbf373a23,0xbf3e35c5,0xbf44e3f5,0xbf4b41fa
.long 0xbf41d870,0xbf48d8b3,0xbf4f7a1f,0xbf55b993,0xbf4bbbf8,0xbf52a649,0xbf591e6a,0xbf5f20db
.long 0x0,0x0,0x0,0x0,0xbd96a905,0xbd9cecf9,0xbda3308c,0xbda973ba
.long 0xbe164083,0xbe1c76de,0xbe22abb6,0xbe28defc,0xbe605c13,0xbe698bba,0xbe72b651,0xbe7bdba4
.long 0xbe94a031,0xbe9aa086,0xbea09ae5,0xbea68f12,0xbeb8442a,0xbebf926f,0xbec6d529,0xbece0bea
.long 0xbedae880,0xbee363fa,0xbeebcbbb,0xbef41f07,0xbefc5d27,0xbf02ef9f,0xbf07a136,0xbf0c42c9
.long 0xbf0e39da,0xbf13682a,0xbf187fc0,0xbf1d7fd1,0xbf1d7fd1,0xbf2302d3,0xbf286605,0xbf2da859
.long 0xbf2beb4a,0xbf31a81d,0xbf373a23,0xbf3ca003,0xbf396842,0xbf3f41fc,0xbf44e3f5,0xbf4a4c87
.long 0xbf45e403,0xbf4bbbf8,0xbf514d3d,0xbf5695e5,0xbf514d3d,0xbf570348,0xbf5c61c7,0xbf61668a
.long 0xbf5b941a,0xbf6106f2,0xbf660f88,0xbf6aab7b,0xbf64aa59,0xbf69b7e4,0xbf6e46be,0xbf725470
.long 0x0,0x0,0x0,0x0,0xbdafb680,0xbdb5f8da,0xbdbc3ac3,0xbdc27c39
.long 0xbe2f10a2,0xbe354098,0xbe3b6ecf,0xbe419b37,0xbe827dc0,0xbe870ada,0xbe8b9507,0xbe901c2c
.long 0xbeac7cd4,0xbeb263ef,0xbeb8442a,0xbebe1d4a,0xbed53641,0xbedc53c1,0xbee363fa,0xbeea6681
.long 0xbefc5d27,0xbf0242b1,0xbf064b82,0xbf0a48ad,0xbf10d3cd,0xbf1553b7,0xbf19c200,0xbf1e1e22
.long 0xbf226799,0xbf273656,0xbf2beb4a,0xbf3085bb,0xbf32c8c9,0xbf37c655,0xbf3ca003,0xbf4154e1
.long 0xbf41d870,0xbf46e22a,0xbf4bbbf8,0xbf5064af,0xbf4f7a1f,0xbf546b3b,0xbf591e6a,0xbf5d924d
.long 0xbf5b941a,0xbf604621,0xbf64aa59,0xbf68bf3c,0xbf660f88,0xbf6a5ad9,0xbf6e46be,0xbf71d19f
.long 0xbf6ed89e,0xbf7294f8,0xbf75dec6,0xbf78b47b,0xbf75dec6,0xbf78e3d6,0xbf7b61fc,0xbf7d57de
.long 0xbf3504f3,0xbf3daef9,0xbf45e403,0xbf4d9f02,0xbf3daef9,0xbf466354,0xbf4e8d90,0xbf5627fe
.long 0xbf45e403,0xbf4e8d90,0xbf5695e5,0xbf5df6be,0xbf4d9f02,0xbf5627fe,0xbf5df6be,0xbf650479
.long 0xbf54db31,0xbf5d2d53,0xbf64aa59,0xbf6b4b0c,0xbf5b941a,0xbf6398ac,0xbf6aab7b,0xbf70c501
.long 0xbf61c598,0xbf696591,0xbf6ff573,0xbf756d97,0xbf676bd8,0xbf6e8ff8,0xbf748422,0xbf7940c0
.long 0xbf6c835e,0xbf731447,0xbf7853f8,0xbf7c3b28,0xbf710908,0xbf76ef5b,0xbf7b61fc,0xbf7e5a38
.long 0xbf74fa0b,0xbf7a1e84,0xbf7dabcc,0xbf7f9c18,0xbf7853f8,0xbf7c9f8a,0xbf7f2f9d,0xbf7fffb1
.long 0xbf7b14be,0xbf7e70b0,0xbf7fec43,0xbf7f84ab,0xbf7d3aac,0xbf7f90b1,0xbf7fe129,0xbf7e2b72
.long 0xbf7ec46d,0xbf7ffec4,0xbf7f0e58,0xbf7bf531,0xbf7fb10f,0xbf7fba9e,0xbf7d7474,0xbf78e3d6
.long 0xbf54db31,0xbf5b941a,0xbf61c598,0xbf676bd8,0xbf5d2d53,0xbf6398ac,0xbf696591,0xbf6e8ff8
.long 0xbf64aa59,0xbf6aab7b,0xbf6ff573,0xbf748422,0xbf6b4b0c,0xbf70c501,0xbf756d97,0xbf7940c0
.long 0xbf710908,0xbf75dec6,0xbf79c79d,0xbf7cbfc9,0xbf75dec6,0xbf79f35e,0xbf7cfe73,0xbf7efcc9
.long 0xbf79c79d,0xbf7cfe73,0xbf7f0e58,0xbf7ff4e6,0xbf7cbfc9,0xbf7efcc9,0xbf7ff4e6,0xbf7fa6e3
.long 0xbf7ec46d,0xbf7fec43,0xbf7fb10f,0xbf7e1324,0xbf7fd397,0xbf7fcbe2,0xbf7e4323,0xbf7b3bab
.long 0xbf7fec43,0xbf7e9bc9,0xbf7baccd,0xbf772417,0xbf7f0e58,0xbf7c5d3a,0xbf77f110,0xbf71d19f
.long 0xbf7d3aac,0xbf791298,0xbf731447,0xbf6b4b0c,0xbf7a7302,0xbf74bf62,0xbf6d1c1d,0xbf6398ac
.long 0xbf76ba07,0xbf6f6830,0xbf660f88,0xbf5ac450,0xbf721352,0xbf6912ae,0xbf5df6be,0xbf50d937
.long 0xbf6c835e,0xbf710908,0xbf74fa0b,0xbf7853f8,0xbf731447,0xbf76ef5b,0xbf7a1e84,0xbf7c9f8a
.long 0xbf7853f8,0xbf7b61fc,0xbf7dabcc,0xbf7f2f9d,0xbf7c3b28,0xbf7e5a38,0xbf7f9c18,0xbf7fffb1
.long 0xbf7ec46d,0xbf7fd397,0xbf7fec43,0xbf7f0e58,0xbf7fec43,0xbf7fcbe2,0xbf7e9bc9,0xbf7c5d3a
.long 0xbf7fb10f,0xbf7e4323,0xbf7baccd,0xbf77f110,0xbf7e1324,0xbf7b3bab,0xbf772417,0xbf71d19f
.long 0xbf7b14be,0xbf76ba07,0xbf710908,0xbf6a09a7,0xbf76ba07,0xbf70c501,0xbf696591,0xbf60a6cf
.long 0xbf710908,0xbf696591,0xbf604621,0xbf55b993,0xbf6a09a7,0xbf60a6cf,0xbf55b993,0xbf495521
.long 0xbf61c598,0xbf5695e5,0xbf49d112,0xbf3b8f3b,0xbf584853,0xbf4b41fa,0xbf3ca003,0xbf2c800f
.long 0xbf4d9f02,0xbf3ebc1b,0xbf2e3bde,0xbf1c420c,0xbf41d870,0xbf311722,0xbf1ebc12,0xbf0af1b7
.long 0xbf7b14be,0xbf7d3aac,0xbf7ec46d,0xbf7fb10f,0xbf7e70b0,0xbf7f90b1,0xbf7ffec4,0xbf7fba9e
.long 0xbf7fec43,0xbf7fe129,0xbf7f0e58,0xbf7d7474,0xbf7f84ab,0xbf7e2b72,0xbf7bf531,0xbf78e3d6
.long 0xbf7d3aac,0xbf7a7302,0xbf76ba07,0xbf721352,0xbf791298,0xbf74bf62,0xbf6f6830,0xbf6912ae
.long 0xbf731447,0xbf6d1c1d,0xbf660f88,0xbf5df6be,0xbf6b4b0c,0xbf6398ac,0xbf5ac450,0xbf50d937
.long 0xbf61c598,0xbf584853,0xbf4d9f02,0xbf41d870,0xbf5695e5,0xbf4b41fa,0xbf3ebc1b,0xbf311722
.long 0xbf49d112,0xbf3ca003,0xbf2e3bde,0xbf1ebc12,0xbf3b8f3b,0xbf2c800f,0xbf1c420c,0xbf0af1b7
.long 0xbf2beb4a,0xbf1b02c6,0xbf08f59b,0xbeebcbbb,0xbf1b02c6,0xbf084b92,0xbee900b7,0xbebf926f
.long 0xbf08f59b,0xbee900b7,0xbebe1d4a,0xbe919ddd,0xbeebcbbb,0xbebf926f,0xbe919ddd,0xbe44b0b9
.long 0x3f80,0xbf80,0x3f80,0xbf80,0x3f80,0xbdc9bf7f,0x3e483f7b,0xbe95bf75
.long 0x3f80,0xbe48bf7b,0x3ec43f6d,0xbf0ebf55,0x3f80,0xbe95bf75,0x3f0e3f55,0xbf46bf22
.long 0x3f80,0xbec4bf6d,0x3f353f35,0xbf6dbec4,0x3f80,0xbef1bf62,0x3f553f0e,0xbf7fbdc9
.long 0x3f80,0xbf0ebf55,0x3f6d3ec4,0xbf7b3e48,0x3f80,0xbf22bf46,0x3f7b3e48,0xbf623ef1
.long 0x3f80,0xbf35bf35,0x3f800000,0xbf353f35,0x3f80,0xbf46bf22,0x3f7bbe48,0xbef13f62
.long 0x3f80,0xbf55bf0e,0x3f6dbec4,0xbe483f7b,0x3f80,0xbf62bef1,0x3f55bf0e,0x3dc93f7f
.long 0x3f80,0xbf6dbec4,0x3f35bf35,0x3ec43f6d,0x3f80,0xbf75be95,0x3f0ebf55,0x3f223f46
.long 0x3f80,0xbf7bbe48,0x3ec4bf6d,0x3f553f0e,0x3f80,0xbf7fbdc9,0x3e48bf7b,0x3f753e95
.long 0x3f80,0xbf80,0x3f80,0xbf80,0x3ec43f6d,0xbef1bf62,0x3f0e3f55,0xbf22bf46
.long 0x3f353f35,0xbf55bf0e,0x3f6d3ec4,0xbf7bbe48,0x3f6d3ec4,0xbf7fbdc9,0x3f7bbe48,0xbf623ef1
.long 0x3f800000,0xbf6d3ec4,0x3f35bf35,0xbec43f6d,0x3f6dbec4,0xbf223f46,0x3e48bf7b,0x3e953f75
.long 0x3f35bf35,0xbe483f7b,0xbec4bf6d,0x3f553f0e,0x3ec4bf6d,0x3e953f75,0xbf55bf0e,0x3f7fbdc9
.long 0xbf80,0x3f353f35,0xbf800000,0x3f35bf35,0xbec4bf6d,0x3f753e95,0xbf553f0e,0x3dc9bf7f
.long 0xbf35bf35,0x3f7bbe48,0xbec43f6d,0xbf0ebf55,0xbf6dbec4,0x3f46bf22,0x3e483f7b,0xbf75be95
.long 0xbf800000,0x3ec4bf6d,0x3f353f35,0xbf6d3ec4,0xbf6d3ec4,0xbdc9bf7f,0x3f7b3e48,0xbef13f62
.long 0xbf353f35,0xbf0ebf55,0x3f6dbec4,0x3e483f7b,0xbec43f6d,0xbf62bef1,0x3f0ebf55,0x3f463f22
.long 0x3f80,0xbf80,0x3f80,0xbf80,0x3f353f35,0xbf46bf22,0x3f553f0e,0xbf62bef1
.long 0x3f800000,0xbf7b3e48,0x3f6dbec4,0xbf553f0e,0x3f35bf35,0xbef13f62,0x3e48bf7b,0x3dc93f7f
.long 0xbf80,0x3ec43f6d,0xbf35bf35,0x3f6d3ec4,0xbf35bf35,0x3f753e95,0xbf7b3e48,0x3f46bf22
.long 0xbf800000,0x3f55bf0e,0xbec43f6d,0xbe48bf7b,0xbf353f35,0x3dc9bf7f,0x3f0e3f55,0xbf75be95
.long 0x3f80,0xbf35bf35,0x3f800000,0xbf353f35,0x3f353f35,0xbf7f3dc9,0x3f0ebf55,0x3e953f75
.long 0x3f800000,0xbf0e3f55,0xbec4bf6d,0x3f7b3e48,0x3f35bf35,0x3e953f75,0xbf7bbe48,0x3f22bf46
.long 0xbf80,0x3f6d3ec4,0xbf353f35,0xbec4bf6d,0xbf35bf35,0x3f62bef1,0x3e483f7b,0xbf7fbdc9
.long 0xbf800000,0x3e48bf7b,0x3f6d3ec4,0xbf0e3f55,0xbf353f35,0xbf22bf46,0x3f55bf0e,0x3ef13f62
.long 0x3f80,0xbf80,0x3f80,0xbf80,0x3f6d3ec4,0xbf75be95,0x3f7b3e48,0xbf7fbdc9
.long 0x3f35bf35,0xbf0e3f55,0x3ec4bf6d,0xbe483f7b,0xbec4bf6d,0x3f223f46,0xbf55bf0e,0x3f753e95
.long 0xbf800000,0x3f6dbec4,0xbf353f35,0x3ec4bf6d,0xbec43f6d,0xbdc9bf7f,0x3f0e3f55,0xbf62bef1
.long 0x3f353f35,0xbf7bbe48,0x3f6dbec4,0xbf0e3f55,0x3f6dbec4,0xbef13f62,0xbe48bf7b,0x3f463f22
.long 0xbf80,0x3f353f35,0xbf800000,0x3f35bf35,0xbf6dbec4,0x3f62bef1,0xbe483f7b,0xbf22bf46
.long 0xbf353f35,0xbe48bf7b,0x3f6d3ec4,0xbf553f0e,0x3ec43f6d,0xbf7fbdc9,0x3f0ebf55,0x3ef13f62
.long 0x3f800000,0xbec43f6d,0xbf35bf35,0x3f6dbec4,0x3ec4bf6d,0x3f463f22,0xbf553f0e,0xbe95bf75
.long 0xbf35bf35,0x3f55bf0e,0x3ec43f6d,0xbf7b3e48,0xbf6d3ec4,0xbe95bf75,0x3f7bbe48,0x3dc93f7f
.long 0x3f800000,0xbf800000,0x3f800000,0xbf800000,0x3f800000,0xbf7f3dc9,0x3f7bbe48,0xbf753e95
.long 0x3f800000,0xbf7b3e48,0x3f6dbec4,0xbf553f0e,0x3f800000,0xbf753e95,0x3f55bf0e,0xbf223f46
.long 0x3f800000,0xbf6d3ec4,0x3f35bf35,0xbec43f6d,0x3f800000,0xbf623ef1,0x3f0ebf55,0xbdc93f7f
.long 0x3f800000,0xbf553f0e,0x3ec4bf6d,0x3e483f7b,0x3f800000,0xbf463f22,0x3e48bf7b,0x3ef13f62
.long 0x3f800000,0xbf353f35,0xbf80,0x3f353f35,0x3f800000,0xbf223f46,0xbe48bf7b,0x3f623ef1
.long 0x3f800000,0xbf0e3f55,0xbec4bf6d,0x3f7b3e48,0x3f800000,0xbef13f62,0xbf0ebf55,0x3f7fbdc9
.long 0x3f800000,0xbec43f6d,0xbf35bf35,0x3f6dbec4,0x3f800000,0xbe953f75,0xbf55bf0e,0x3f46bf22
.long 0x3f800000,0xbe483f7b,0xbf6dbec4,0x3f0ebf55,0x3f800000,0xbdc93f7f,0xbf7bbe48,0x3e95bf75
.long 0x3f800000,0xbf800000,0x3f800000,0xbf800000,0x3f6dbec4,0xbf623ef1,0x3f55bf0e,0xbf463f22
.long 0x3f35bf35,0xbf0e3f55,0x3ec4bf6d,0xbe483f7b,0x3ec4bf6d,0xbdc93f7f,0xbe48bf7b,0x3ef13f62
.long 0xbf80,0x3ec43f6d,0xbf35bf35,0x3f6d3ec4,0xbec4bf6d,0x3f463f22,0xbf7bbe48,0x3f75be95
.long 0xbf35bf35,0x3f7b3e48,0xbf6d3ec4,0x3f0ebf55,0xbf6dbec4,0x3f75be95,0xbf0e3f55,0xbdc9bf7f
.long 0xbf800000,0x3f35bf35,0x3f80,0xbf35bf35,0xbf6d3ec4,0x3e95bf75,0x3f0e3f55,0xbf7fbdc9
.long 0xbf353f35,0xbe48bf7b,0x3f6d3ec4,0xbf553f0e,0xbec43f6d,0xbf22bf46,0x3f7bbe48,0xbe953f75
.long 0x3f80,0xbf6dbec4,0x3f35bf35,0x3ec43f6d,0x3ec43f6d,0xbf7f3dc9,0x3e48bf7b,0x3f623ef1
.long 0x3f353f35,0xbf553f0e,0xbec4bf6d,0x3f7bbe48,0x3f6d3ec4,0xbef13f62,0xbf55bf0e,0x3f22bf46
.long 0x3f800000,0xbf800000,0x3f800000,0xbf800000,0x3f35bf35,0xbf223f46,0x3f0ebf55,0xbef13f62
.long 0xbf80,0x3e483f7b,0xbec4bf6d,0x3f0e3f55,0xbf35bf35,0x3f623ef1,0xbf7bbe48,0x3f7fbdc9
.long 0xbf800000,0x3f6dbec4,0xbf353f35,0x3ec4bf6d,0xbf353f35,0x3e95bf75,0x3e483f7b,0xbf22bf46
.long 0x3f80,0xbf0ebf55,0x3f6d3ec4,0xbf7b3e48,0x3f353f35,0xbf7fbdc9,0x3f55bf0e,0xbe953f75
.long 0x3f800000,0xbf353f35,0xbf80,0x3f353f35,0x3f35bf35,0x3dc93f7f,0xbf55bf0e,0x3f75be95
.long 0xbf80,0x3f553f0e,0xbf6d3ec4,0x3e48bf7b,0xbf35bf35,0x3f75be95,0xbe483f7b,0xbf46bf22
.long 0xbf800000,0x3ec4bf6d,0x3f353f35,0xbf6d3ec4,0xbf353f35,0xbef1bf62,0x3f7bbe48,0xbdc93f7f
.long 0x3f80,0xbf7bbe48,0x3ec4bf6d,0x3f553f0e,0x3f353f35,0xbf463f22,0xbf0ebf55,0x3f62bef1
.long 0x3f800000,0xbf800000,0x3f800000,0xbf800000,0x3ec4bf6d,0xbe953f75,0x3e48bf7b,0xbdc93f7f
.long 0xbf35bf35,0x3f553f0e,0xbf6dbec4,0x3f7b3e48,0xbf6d3ec4,0x3f46bf22,0xbf0e3f55,0x3e95bf75
.long 0x3f80,0xbec4bf6d,0x3f353f35,0xbf6dbec4,0x3f6d3ec4,0xbf7f3dc9,0x3f55bf0e,0xbef13f62
.long 0x3f35bf35,0xbe483f7b,0xbec4bf6d,0x3f553f0e,0xbec4bf6d,0x3f623ef1,0xbf7b3e48,0x3f22bf46
.long 0xbf800000,0x3f35bf35,0x3f80,0xbf35bf35,0xbec43f6d,0xbef1bf62,0x3f7b3e48,0xbf463f22
.long 0x3f353f35,0xbf7b3e48,0x3ec4bf6d,0x3f0e3f55,0x3f6dbec4,0xbdc93f7f,0xbf55bf0e,0x3f62bef1
.long 0xbf80,0x3f6d3ec4,0xbf353f35,0xbec4bf6d,0xbf6dbec4,0x3f22bf46,0x3f0e3f55,0xbf753e95
.long 0xbf353f35,0xbf0ebf55,0x3f6dbec4,0x3e483f7b,0x3ec43f6d,0xbf753e95,0xbe48bf7b,0x3f7fbdc9
.long 0x3f80,0xbf80,0x3f80,0xbf80,0x3f800000,0xbf7f3dc9,0x3f7bbe48,0xbf753e95
.long 0xbf80,0x3e483f7b,0xbec4bf6d,0x3f0e3f55,0xbf800000,0x3f75be95,0xbf553f0e,0x3f22bf46
.long 0x3f80,0xbec4bf6d,0x3f353f35,0xbf6dbec4,0x3f800000,0xbf623ef1,0x3f0ebf55,0xbdc93f7f
.long 0xbf80,0x3f0e3f55,0xbf6dbec4,0x3f7bbe48,0xbf800000,0x3f46bf22,0xbe483f7b,0xbef1bf62
.long 0x3f80,0xbf35bf35,0x3f800000,0xbf353f35,0x3f800000,0xbf223f46,0xbe48bf7b,0x3f623ef1
.long 0xbf80,0x3f553f0e,0xbf6d3ec4,0x3e48bf7b,0xbf800000,0x3ef1bf62,0x3f0e3f55,0xbf7f3dc9
.long 0x3f80,0xbf6dbec4,0x3f35bf35,0x3ec43f6d,0x3f800000,0xbe953f75,0xbf55bf0e,0x3f46bf22
.long 0xbf80,0x3f7b3e48,0xbec43f6d,0xbf55bf0e,0xbf800000,0x3dc9bf7f,0x3f7b3e48,0xbe953f75
.long 0x3f80,0xbf80,0x3f80,0xbf80,0x3f6dbec4,0xbf623ef1,0x3f55bf0e,0xbf463f22
.long 0xbf35bf35,0x3f553f0e,0xbf6dbec4,0x3f7b3e48,0xbec43f6d,0x3dc9bf7f,0x3e483f7b,0xbef1bf62
.long 0x3f800000,0xbf6d3ec4,0x3f35bf35,0xbec43f6d,0xbec4bf6d,0x3f463f22,0xbf7bbe48,0x3f75be95
.long 0xbf353f35,0x3e48bf7b,0x3ec43f6d,0xbf55bf0e,0x3f6d3ec4,0xbf753e95,0x3f0ebf55,0x3dc93f7f
.long 0xbf80,0x3f353f35,0xbf800000,0x3f35bf35,0xbf6d3ec4,0x3e95bf75,0x3f0e3f55,0xbf7fbdc9
.long 0x3f353f35,0xbf7b3e48,0x3ec4bf6d,0x3f0e3f55,0x3ec4bf6d,0x3f223f46,0xbf7b3e48,0x3e95bf75
.long 0xbf800000,0x3ec4bf6d,0x3f353f35,0xbf6d3ec4,0x3ec43f6d,0xbf7f3dc9,0x3e48bf7b,0x3f623ef1
.long 0x3f35bf35,0x3f0e3f55,0xbf6d3ec4,0xbe48bf7b,0xbf6dbec4,0x3ef1bf62,0x3f553f0e,0xbf223f46
.long 0x3f80,0xbf80,0x3f80,0xbf80,0x3f35bf35,0xbf223f46,0x3f0ebf55,0xbef13f62
.long 0xbf800000,0x3f7bbe48,0xbf6d3ec4,0x3f55bf0e,0x3f353f35,0xbf62bef1,0x3f7b3e48,0xbf7f3dc9
.long 0xbf80,0x3ec43f6d,0xbf35bf35,0x3f6d3ec4,0xbf353f35,0x3e95bf75,0x3e483f7b,0xbf22bf46
.long 0x3f800000,0xbf553f0e,0x3ec4bf6d,0x3e483f7b,0xbf35bf35,0x3f7f3dc9,0xbf553f0e,0x3e95bf75
.long 0x3f80,0xbf35bf35,0x3f800000,0xbf353f35,0x3f35bf35,0x3dc93f7f,0xbf55bf0e,0x3f75be95
.long 0xbf800000,0x3f0ebf55,0x3ec43f6d,0xbf7bbe48,0x3f353f35,0xbf753e95,0x3e48bf7b,0x3f463f22
.long 0xbf80,0x3f6d3ec4,0xbf353f35,0xbec4bf6d,0xbf353f35,0xbef1bf62,0x3f7bbe48,0xbdc93f7f
.long 0x3f800000,0xbe483f7b,0xbf6dbec4,0x3f0ebf55,0xbf35bf35,0x3f46bf22,0x3f0e3f55,0xbf623ef1
.long 0x3f80,0xbf80,0x3f80,0xbf80,0x3ec4bf6d,0xbe953f75,0x3e48bf7b,0xbdc93f7f
.long 0xbf353f35,0x3f0ebf55,0xbec43f6d,0x3e48bf7b,0x3f6dbec4,0xbf463f22,0x3f0ebf55,0xbe953f75
.long 0xbf800000,0x3f6dbec4,0xbf353f35,0x3ec4bf6d,0x3f6d3ec4,0xbf7f3dc9,0x3f55bf0e,0xbef13f62
.long 0xbf35bf35,0x3f7b3e48,0xbf6d3ec4,0x3f0ebf55,0x3ec43f6d,0xbf62bef1,0x3f7bbe48,0xbf223f46
.long 0xbf80,0x3f353f35,0xbf800000,0x3f35bf35,0xbec43f6d,0xbef1bf62,0x3f7b3e48,0xbf463f22
.long 0x3f35bf35,0x3e483f7b,0xbf6dbec4,0x3f55bf0e,0xbf6d3ec4,0x3dc9bf7f,0x3f553f0e,0xbf623ef1
.long 0x3f800000,0xbec43f6d,0xbf35bf35,0x3f6dbec4,0xbf6dbec4,0x3f22bf46,0x3f0e3f55,0xbf753e95
.long 0x3f353f35,0xbf553f0e,0xbec4bf6d,0x3f7bbe48,0xbec4bf6d,0x3f75be95,0x3e483f7b,0xbf7f3dc9
.long 0x3f800000,0xbf800000,0x3f800000,0xbf800000,0xbf80,0x3dc93f7f,0xbe48bf7b,0x3e953f75
.long 0xbf800000,0x3f7bbe48,0xbf6d3ec4,0x3f55bf0e,0x3f80,0xbe95bf75,0x3f0e3f55,0xbf46bf22
.long 0x3f800000,0xbf6d3ec4,0x3f35bf35,0xbec43f6d,0xbf80,0x3ef13f62,0xbf55bf0e,0x3f7f3dc9
.long 0xbf800000,0x3f55bf0e,0xbec43f6d,0xbe48bf7b,0x3f80,0xbf22bf46,0x3f7b3e48,0xbf623ef1
.long 0x3f800000,0xbf353f35,0xbf80,0x3f353f35,0xbf80,0x3f463f22,0xbf7b3e48,0x3ef1bf62
.long 0xbf800000,0x3f0ebf55,0x3ec43f6d,0xbf7bbe48,0x3f80,0xbf62bef1,0x3f55bf0e,0x3dc93f7f
.long 0x3f800000,0xbec43f6d,0xbf35bf35,0x3f6dbec4,0xbf80,0x3f753e95,0xbf0e3f55,0xbf22bf46
.long 0xbf800000,0x3e48bf7b,0x3f6d3ec4,0xbf0e3f55,0x3f80,0xbf7fbdc9,0x3e48bf7b,0x3f753e95
.long 0x3f800000,0xbf800000,0x3f800000,0xbf800000,0xbec4bf6d,0x3ef13f62,0xbf0ebf55,0x3f223f46
.long 0xbf353f35,0x3f0ebf55,0xbec43f6d,0x3e48bf7b,0x3f6d3ec4,0xbf7fbdc9,0x3f7bbe48,0xbf623ef1
.long 0xbf80,0x3ec43f6d,0xbf35bf35,0x3f6d3ec4,0xbf6d3ec4,0x3f22bf46,0xbe483f7b,0xbe95bf75
.long 0x3f353f35,0xbf7bbe48,0x3f6dbec4,0xbf0e3f55,0x3ec4bf6d,0x3e953f75,0xbf55bf0e,0x3f7fbdc9
.long 0xbf800000,0x3f35bf35,0x3f80,0xbf35bf35,0x3ec43f6d,0xbf75be95,0x3f55bf0e,0xbdc93f7f
.long 0x3f35bf35,0x3e483f7b,0xbf6dbec4,0x3f55bf0e,0xbf6dbec4,0x3f46bf22,0x3e483f7b,0xbf75be95
.long 0x3f80,0xbf6dbec4,0x3f35bf35,0x3ec43f6d,0x3f6dbec4,0x3dc93f7f,0xbf7bbe48,0x3ef1bf62
.long 0xbf35bf35,0x3f55bf0e,0x3ec43f6d,0xbf7b3e48,0xbec43f6d,0xbf62bef1,0x3f0ebf55,0x3f463f22
.long 0x3f800000,0xbf800000,0x3f800000,0xbf800000,0xbf35bf35,0x3f463f22,0xbf55bf0e,0x3f623ef1
.long 0x3f80,0xbe48bf7b,0x3ec43f6d,0xbf0ebf55,0x3f35bf35,0xbef13f62,0x3e48bf7b,0x3dc93f7f
.long 0xbf800000,0x3f6dbec4,0xbf353f35,0x3ec4bf6d,0x3f353f35,0xbf75be95,0x3f7bbe48,0xbf463f22
.long 0xbf80,0x3f0e3f55,0xbf6dbec4,0x3f7bbe48,0xbf353f35,0x3dc9bf7f,0x3f0e3f55,0xbf75be95
.long 0x3f800000,0xbf353f35,0xbf80,0x3f353f35,0xbf35bf35,0x3f7fbdc9,0xbf0e3f55,0xbe95bf75
.long 0x3f80,0xbf55bf0e,0x3f6dbec4,0xbe483f7b,0x3f35bf35,0x3e953f75,0xbf7bbe48,0x3f22bf46
.long 0xbf800000,0x3ec4bf6d,0x3f353f35,0xbf6d3ec4,0x3f353f35,0xbf623ef1,0xbe48bf7b,0x3f7f3dc9
.long 0xbf80,0x3f7b3e48,0xbec43f6d,0xbf55bf0e,0xbf353f35,0xbf22bf46,0x3f55bf0e,0x3ef13f62
.long 0x3f800000,0xbf800000,0x3f800000,0xbf800000,0xbf6dbec4,0x3f753e95,0xbf7bbe48,0x3f7f3dc9
.long 0x3f353f35,0xbf55bf0e,0x3f6d3ec4,0xbf7bbe48,0xbec4bf6d,0x3f223f46,0xbf55bf0e,0x3f753e95
.long 0x3f80,0xbec4bf6d,0x3f353f35,0xbf6dbec4,0x3ec4bf6d,0x3dc93f7f,0xbf0ebf55,0x3f623ef1
.long 0xbf353f35,0x3e48bf7b,0x3ec43f6d,0xbf55bf0e,0x3f6dbec4,0xbef13f62,0xbe48bf7b,0x3f463f22
.long 0xbf800000,0x3f35bf35,0x3f80,0xbf35bf35,0x3f6d3ec4,0xbf623ef1,0x3e48bf7b,0x3f223f46
.long 0xbf35bf35,0x3f7bbe48,0xbec43f6d,0xbf0ebf55,0x3ec43f6d,0xbf7fbdc9,0x3f0ebf55,0x3ef13f62
.long 0xbf80,0x3f6d3ec4,0xbf353f35,0xbec4bf6d,0xbec43f6d,0xbf46bf22,0x3f55bf0e,0x3e953f75
.long 0x3f35bf35,0x3f0e3f55,0xbf6d3ec4,0xbe48bf7b,0xbf6d3ec4,0xbe95bf75,0x3f7bbe48,0x3dc93f7f
.long 0x3f80,0xbf80,0x3f80,0xbf80,0xbf80,0x3dc93f7f,0xbe48bf7b,0x3e953f75
.long 0x3f80,0xbe48bf7b,0x3ec43f6d,0xbf0ebf55,0xbf80,0x3e953f75,0xbf0ebf55,0x3f463f22
.long 0x3f80,0xbec4bf6d,0x3f353f35,0xbf6dbec4,0xbf80,0x3ef13f62,0xbf55bf0e,0x3f7f3dc9
.long 0x3f80,0xbf0ebf55,0x3f6d3ec4,0xbf7b3e48,0xbf80,0x3f223f46,0xbf7bbe48,0x3f62bef1
.long 0x3f80,0xbf35bf35,0x3f800000,0xbf353f35,0xbf80,0x3f463f22,0xbf7b3e48,0x3ef1bf62
.long 0x3f80,0xbf55bf0e,0x3f6dbec4,0xbe483f7b,0xbf80,0x3f623ef1,0xbf553f0e,0xbdc9bf7f
.long 0x3f80,0xbf6dbec4,0x3f35bf35,0x3ec43f6d,0xbf80,0x3f753e95,0xbf0e3f55,0xbf22bf46
.long 0x3f80,0xbf7bbe48,0x3ec4bf6d,0x3f553f0e,0xbf80,0x3f7f3dc9,0xbe483f7b,0xbf75be95
.long 0x3f80,0xbf80,0x3f80,0xbf80,0xbec4bf6d,0x3ef13f62,0xbf0ebf55,0x3f223f46
.long 0x3f353f35,0xbf55bf0e,0x3f6d3ec4,0xbf7bbe48,0xbf6dbec4,0x3f7f3dc9,0xbf7b3e48,0x3f62bef1
.long 0x3f800000,0xbf6d3ec4,0x3f35bf35,0xbec43f6d,0xbf6d3ec4,0x3f22bf46,0xbe483f7b,0xbe95bf75
.long 0x3f35bf35,0xbe483f7b,0xbec4bf6d,0x3f553f0e,0xbec43f6d,0xbe95bf75,0x3f553f0e,0xbf7f3dc9
.long 0xbf80,0x3f353f35,0xbf800000,0x3f35bf35,0x3ec43f6d,0xbf75be95,0x3f55bf0e,0xbdc93f7f
.long 0xbf35bf35,0x3f7bbe48,0xbec43f6d,0xbf0ebf55,0x3f6d3ec4,0xbf463f22,0xbe48bf7b,0x3f753e95
.long 0xbf800000,0x3ec4bf6d,0x3f353f35,0xbf6d3ec4,0x3f6dbec4,0x3dc93f7f,0xbf7bbe48,0x3ef1bf62
.long 0xbf353f35,0xbf0ebf55,0x3f6dbec4,0x3e483f7b,0x3ec4bf6d,0x3f623ef1,0xbf0e3f55,0xbf46bf22
.long 0x3f80,0xbf80,0x3f80,0xbf80,0xbf35bf35,0x3f463f22,0xbf55bf0e,0x3f623ef1
.long 0x3f800000,0xbf7b3e48,0x3f6dbec4,0xbf553f0e,0xbf353f35,0x3ef1bf62,0xbe483f7b,0xbdc9bf7f
.long 0xbf80,0x3ec43f6d,0xbf35bf35,0x3f6d3ec4,0x3f353f35,0xbf75be95,0x3f7bbe48,0xbf463f22
.long 0xbf800000,0x3f55bf0e,0xbec43f6d,0xbe48bf7b,0x3f35bf35,0xbdc93f7f,0xbf0ebf55,0x3f753e95
.long 0x3f80,0xbf35bf35,0x3f800000,0xbf353f35,0xbf35bf35,0x3f7fbdc9,0xbf0e3f55,0xbe95bf75
.long 0x3f800000,0xbf0e3f55,0xbec4bf6d,0x3f7b3e48,0xbf353f35,0xbe95bf75,0x3f7b3e48,0xbf223f46
.long 0xbf80,0x3f6d3ec4,0xbf353f35,0xbec4bf6d,0x3f353f35,0xbf623ef1,0xbe48bf7b,0x3f7f3dc9
.long 0xbf800000,0x3e48bf7b,0x3f6d3ec4,0xbf0e3f55,0x3f35bf35,0x3f223f46,0xbf553f0e,0xbef1bf62
.long 0x3f80,0xbf80,0x3f80,0xbf80,0xbf6dbec4,0x3f753e95,0xbf7bbe48,0x3f7f3dc9
.long 0x3f35bf35,0xbf0e3f55,0x3ec4bf6d,0xbe483f7b,0x3ec43f6d,0xbf22bf46,0x3f553f0e,0xbf75be95
.long 0xbf800000,0x3f6dbec4,0xbf353f35,0x3ec4bf6d,0x3ec4bf6d,0x3dc93f7f,0xbf0ebf55,0x3f623ef1
.long 0x3f353f35,0xbf7bbe48,0x3f6dbec4,0xbf0e3f55,0xbf6d3ec4,0x3ef1bf62,0x3e483f7b,0xbf46bf22
.long 0xbf80,0x3f353f35,0xbf800000,0x3f35bf35,0x3f6d3ec4,0xbf623ef1,0x3e48bf7b,0x3f223f46
.long 0xbf353f35,0xbe48bf7b,0x3f6d3ec4,0xbf553f0e,0xbec4bf6d,0x3f7f3dc9,0xbf0e3f55,0xbef1bf62
.long 0x3f800000,0xbec43f6d,0xbf35bf35,0x3f6dbec4,0xbec43f6d,0xbf46bf22,0x3f55bf0e,0x3e953f75
.long 0xbf35bf35,0x3f55bf0e,0x3ec43f6d,0xbf7b3e48,0x3f6dbec4,0x3e953f75,0xbf7b3e48,0xbdc9bf7f
.long 0x3f800000,0xbf800000,0x3f800000,0xbf800000,0xbf800000,0x3f7fbdc9,0xbf7b3e48,0x3f75be95
.long 0x3f800000,0xbf7b3e48,0x3f6dbec4,0xbf553f0e,0xbf800000,0x3f75be95,0xbf553f0e,0x3f22bf46
.long 0x3f800000,0xbf6d3ec4,0x3f35bf35,0xbec43f6d,0xbf800000,0x3f62bef1,0xbf0e3f55,0x3dc9bf7f
.long 0x3f800000,0xbf553f0e,0x3ec4bf6d,0x3e483f7b,0xbf800000,0x3f46bf22,0xbe483f7b,0xbef1bf62
.long 0x3f800000,0xbf353f35,0xbf80,0x3f353f35,0xbf800000,0x3f22bf46,0x3e483f7b,0xbf62bef1
.long 0x3f800000,0xbf0e3f55,0xbec4bf6d,0x3f7b3e48,0xbf800000,0x3ef1bf62,0x3f0e3f55,0xbf7f3dc9
.long 0x3f800000,0xbec43f6d,0xbf35bf35,0x3f6dbec4,0xbf800000,0x3e95bf75,0x3f553f0e,0xbf463f22
.long 0x3f800000,0xbe483f7b,0xbf6dbec4,0x3f0ebf55,0xbf800000,0x3dc9bf7f,0x3f7b3e48,0xbe953f75
.long 0x3f800000,0xbf800000,0x3f800000,0xbf800000,0xbf6d3ec4,0x3f62bef1,0xbf553f0e,0x3f46bf22
.long 0x3f35bf35,0xbf0e3f55,0x3ec4bf6d,0xbe483f7b,0xbec43f6d,0x3dc9bf7f,0x3e483f7b,0xbef1bf62
.long 0xbf80,0x3ec43f6d,0xbf35bf35,0x3f6d3ec4,0x3ec43f6d,0xbf46bf22,0x3f7b3e48,0xbf753e95
.long 0xbf35bf35,0x3f7b3e48,0xbf6d3ec4,0x3f0ebf55,0x3f6d3ec4,0xbf753e95,0x3f0ebf55,0x3dc93f7f
.long 0xbf800000,0x3f35bf35,0x3f80,0xbf35bf35,0x3f6dbec4,0xbe953f75,0xbf0ebf55,0x3f7f3dc9
.long 0xbf353f35,0xbe48bf7b,0x3f6d3ec4,0xbf553f0e,0x3ec4bf6d,0x3f223f46,0xbf7b3e48,0x3e95bf75
.long 0x3f80,0xbf6dbec4,0x3f35bf35,0x3ec43f6d,0xbec4bf6d,0x3f7fbdc9,0xbe483f7b,0xbf62bef1
.long 0x3f353f35,0xbf553f0e,0xbec4bf6d,0x3f7bbe48,0xbf6dbec4,0x3ef1bf62,0x3f553f0e,0xbf223f46
.long 0x3f800000,0xbf800000,0x3f800000,0xbf800000,0xbf353f35,0x3f22bf46,0xbf0e3f55,0x3ef1bf62
.long 0xbf80,0x3e483f7b,0xbec4bf6d,0x3f0e3f55,0x3f353f35,0xbf62bef1,0x3f7b3e48,0xbf7f3dc9
.long 0xbf800000,0x3f6dbec4,0xbf353f35,0x3ec4bf6d,0x3f35bf35,0xbe953f75,0xbe48bf7b,0x3f223f46
.long 0x3f80,0xbf0ebf55,0x3f6d3ec4,0xbf7b3e48,0xbf35bf35,0x3f7f3dc9,0xbf553f0e,0x3e95bf75
.long 0x3f800000,0xbf353f35,0xbf80,0x3f353f35,0xbf353f35,0xbdc9bf7f,0x3f553f0e,0xbf753e95
.long 0xbf80,0x3f553f0e,0xbf6d3ec4,0x3e48bf7b,0x3f353f35,0xbf753e95,0x3e48bf7b,0x3f463f22
.long 0xbf800000,0x3ec4bf6d,0x3f353f35,0xbf6d3ec4,0x3f35bf35,0x3ef13f62,0xbf7b3e48,0x3dc9bf7f
.long 0x3f80,0xbf7bbe48,0x3ec4bf6d,0x3f553f0e,0xbf35bf35,0x3f46bf22,0x3f0e3f55,0xbf623ef1
.long 0x3f800000,0xbf800000,0x3f800000,0xbf800000,0xbec43f6d,0x3e95bf75,0xbe483f7b,0x3dc9bf7f
.long 0xbf35bf35,0x3f553f0e,0xbf6dbec4,0x3f7b3e48,0x3f6dbec4,0xbf463f22,0x3f0ebf55,0xbe953f75
.long 0x3f80,0xbec4bf6d,0x3f353f35,0xbf6dbec4,0xbf6dbec4,0x3f7fbdc9,0xbf553f0e,0x3ef1bf62
.long 0x3f35bf35,0xbe483f7b,0xbec4bf6d,0x3f553f0e,0x3ec43f6d,0xbf62bef1,0x3f7bbe48,0xbf223f46
.long 0xbf800000,0x3f35bf35,0x3f80,0xbf35bf35,0x3ec4bf6d,0x3ef13f62,0xbf7bbe48,0x3f46bf22
.long 0x3f353f35,0xbf7b3e48,0x3ec4bf6d,0x3f0e3f55,0xbf6d3ec4,0x3dc9bf7f,0x3f553f0e,0xbf623ef1
.long 0xbf80,0x3f6d3ec4,0xbf353f35,0xbec4bf6d,0x3f6d3ec4,0xbf223f46,0xbf0ebf55,0x3f75be95
.long 0xbf353f35,0xbf0ebf55,0x3f6dbec4,0x3e483f7b,0xbec4bf6d,0x3f75be95,0x3e483f7b,0xbf7f3dc9
.long 0x3f80,0xbf80,0x3f80,0xbf80,0xbf800000,0x3f7fbdc9,0xbf7b3e48,0x3f75be95
.long 0xbf80,0x3e483f7b,0xbec4bf6d,0x3f0e3f55,0x3f800000,0xbf753e95,0x3f55bf0e,0xbf223f46
.long 0x3f80,0xbec4bf6d,0x3f353f35,0xbf6dbec4,0xbf800000,0x3f62bef1,0xbf0e3f55,0x3dc9bf7f
.long 0xbf80,0x3f0e3f55,0xbf6dbec4,0x3f7bbe48,0x3f800000,0xbf463f22,0x3e48bf7b,0x3ef13f62
.long 0x3f80,0xbf35bf35,0x3f800000,0xbf353f35,0xbf800000,0x3f22bf46,0x3e483f7b,0xbf62bef1
.long 0xbf80,0x3f553f0e,0xbf6d3ec4,0x3e48bf7b,0x3f800000,0xbef13f62,0xbf0ebf55,0x3f7fbdc9
.long 0x3f80,0xbf6dbec4,0x3f35bf35,0x3ec43f6d,0xbf800000,0x3e95bf75,0x3f553f0e,0xbf463f22
.long 0xbf80,0x3f7b3e48,0xbec43f6d,0xbf55bf0e,0x3f800000,0xbdc93f7f,0xbf7bbe48,0x3e95bf75
.long 0x3f80,0xbf80,0x3f80,0xbf80,0xbf6d3ec4,0x3f62bef1,0xbf553f0e,0x3f46bf22
.long 0xbf35bf35,0x3f553f0e,0xbf6dbec4,0x3f7b3e48,0x3ec4bf6d,0xbdc93f7f,0xbe48bf7b,0x3ef13f62
.long 0x3f800000,0xbf6d3ec4,0x3f35bf35,0xbec43f6d,0x3ec43f6d,0xbf46bf22,0x3f7b3e48,0xbf753e95
.long 0xbf353f35,0x3e48bf7b,0x3ec43f6d,0xbf55bf0e,0xbf6dbec4,0x3f75be95,0xbf0e3f55,0xbdc9bf7f
.long 0xbf80,0x3f353f35,0xbf800000,0x3f35bf35,0x3f6dbec4,0xbe953f75,0xbf0ebf55,0x3f7f3dc9
.long 0x3f353f35,0xbf7b3e48,0x3ec4bf6d,0x3f0e3f55,0xbec43f6d,0xbf22bf46,0x3f7bbe48,0xbe953f75
.long 0xbf800000,0x3ec4bf6d,0x3f353f35,0xbf6d3ec4,0xbec4bf6d,0x3f7fbdc9,0xbe483f7b,0xbf62bef1
.long 0x3f35bf35,0x3f0e3f55,0xbf6d3ec4,0xbe48bf7b,0x3f6d3ec4,0xbef13f62,0xbf55bf0e,0x3f22bf46
.long 0x3f80,0xbf80,0x3f80,0xbf80,0xbf353f35,0x3f22bf46,0xbf0e3f55,0x3ef1bf62
.long 0xbf800000,0x3f7bbe48,0xbf6d3ec4,0x3f55bf0e,0xbf35bf35,0x3f623ef1,0xbf7bbe48,0x3f7fbdc9
.long 0xbf80,0x3ec43f6d,0xbf35bf35,0x3f6d3ec4,0x3f35bf35,0xbe953f75,0xbe48bf7b,0x3f223f46
.long 0x3f800000,0xbf553f0e,0x3ec4bf6d,0x3e483f7b,0x3f353f35,0xbf7fbdc9,0x3f55bf0e,0xbe953f75
.long 0x3f80,0xbf35bf35,0x3f800000,0xbf353f35,0xbf353f35,0xbdc9bf7f,0x3f553f0e,0xbf753e95
.long 0xbf800000,0x3f0ebf55,0x3ec43f6d,0xbf7bbe48,0xbf35bf35,0x3f75be95,0xbe483f7b,0xbf46bf22
.long 0xbf80,0x3f6d3ec4,0xbf353f35,0xbec4bf6d,0x3f35bf35,0x3ef13f62,0xbf7b3e48,0x3dc9bf7f
.long 0x3f800000,0xbe483f7b,0xbf6dbec4,0x3f0ebf55,0x3f353f35,0xbf463f22,0xbf0ebf55,0x3f62bef1
.long 0x3f80,0xbf80,0x3f80,0xbf80,0xbec43f6d,0x3e95bf75,0xbe483f7b,0x3dc9bf7f
.long 0xbf353f35,0x3f0ebf55,0xbec43f6d,0x3e48bf7b,0xbf6d3ec4,0x3f46bf22,0xbf0e3f55,0x3e95bf75
.long 0xbf800000,0x3f6dbec4,0xbf353f35,0x3ec4bf6d,0xbf6dbec4,0x3f7fbdc9,0xbf553f0e,0x3ef1bf62
.long 0xbf35bf35,0x3f7b3e48,0xbf6d3ec4,0x3f0ebf55,0xbec4bf6d,0x3f623ef1,0xbf7b3e48,0x3f22bf46
.long 0xbf80,0x3f353f35,0xbf800000,0x3f35bf35,0x3ec4bf6d,0x3ef13f62,0xbf7bbe48,0x3f46bf22
.long 0x3f35bf35,0x3e483f7b,0xbf6dbec4,0x3f55bf0e,0x3f6dbec4,0xbdc93f7f,0xbf55bf0e,0x3f62bef1
.long 0x3f800000,0xbec43f6d,0xbf35bf35,0x3f6dbec4,0x3f6d3ec4,0xbf223f46,0xbf0ebf55,0x3f75be95
.long 0x3f353f35,0xbf553f0e,0xbec4bf6d,0x3f7bbe48,0x3ec43f6d,0xbf753e95,0xbe48bf7b,0x3f7fbdc9
.long 0x3f800000,0xbf800000,0x3f800000,0xbf800000,0x3f80,0xbdc9bf7f,0x3e483f7b,0xbe95bf75
.long 0xbf800000,0x3f7bbe48,0xbf6d3ec4,0x3f55bf0e,0xbf80,0x3e953f75,0xbf0ebf55,0x3f463f22
.long 0x3f800000,0xbf6d3ec4,0x3f35bf35,0xbec43f6d,0x3f80,0xbef1bf62,0x3f553f0e,0xbf7fbdc9
.long 0xbf800000,0x3f55bf0e,0xbec43f6d,0xbe48bf7b,0xbf80,0x3f223f46,0xbf7bbe48,0x3f62bef1
.long 0x3f800000,0xbf353f35,0xbf80,0x3f353f35,0x3f80,0xbf46bf22,0x3f7bbe48,0xbef13f62
.long 0xbf800000,0x3f0ebf55,0x3ec43f6d,0xbf7bbe48,0xbf80,0x3f623ef1,0xbf553f0e,0xbdc9bf7f
.long 0x3f800000,0xbec43f6d,0xbf35bf35,0x3f6dbec4,0x3f80,0xbf75be95,0x3f0ebf55,0x3f223f46
.long 0xbf800000,0x3e48bf7b,0x3f6d3ec4,0xbf0e3f55,0xbf80,0x3f7f3dc9,0xbe483f7b,0xbf75be95
.long 0x3f800000,0xbf800000,0x3f800000,0xbf800000,0x3ec43f6d,0xbef1bf62,0x3f0e3f55,0xbf22bf46
.long 0xbf353f35,0x3f0ebf55,0xbec43f6d,0x3e48bf7b,0xbf6dbec4,0x3f7f3dc9,0xbf7b3e48,0x3f62bef1
.long 0xbf80,0x3ec43f6d,0xbf35bf35,0x3f6d3ec4,0x3f6dbec4,0xbf223f46,0x3e48bf7b,0x3e953f75
.long 0x3f353f35,0xbf7bbe48,0x3f6dbec4,0xbf0e3f55,0xbec43f6d,0xbe95bf75,0x3f553f0e,0xbf7f3dc9
.long 0xbf800000,0x3f35bf35,0x3f80,0xbf35bf35,0xbec4bf6d,0x3f753e95,0xbf553f0e,0x3dc9bf7f
.long 0x3f35bf35,0x3e483f7b,0xbf6dbec4,0x3f55bf0e,0x3f6d3ec4,0xbf463f22,0xbe48bf7b,0x3f753e95
.long 0x3f80,0xbf6dbec4,0x3f35bf35,0x3ec43f6d,0xbf6d3ec4,0xbdc9bf7f,0x3f7b3e48,0xbef13f62
.long 0xbf35bf35,0x3f55bf0e,0x3ec43f6d,0xbf7b3e48,0x3ec4bf6d,0x3f623ef1,0xbf0e3f55,0xbf46bf22
.long 0x3f800000,0xbf800000,0x3f800000,0xbf800000,0x3f353f35,0xbf46bf22,0x3f553f0e,0xbf62bef1
.long 0x3f80,0xbe48bf7b,0x3ec43f6d,0xbf0ebf55,0xbf353f35,0x3ef1bf62,0xbe483f7b,0xbdc9bf7f
.long 0xbf800000,0x3f6dbec4,0xbf353f35,0x3ec4bf6d,0xbf35bf35,0x3f753e95,0xbf7b3e48,0x3f46bf22
.long 0xbf80,0x3f0e3f55,0xbf6dbec4,0x3f7bbe48,0x3f35bf35,0xbdc93f7f,0xbf0ebf55,0x3f753e95
.long 0x3f800000,0xbf353f35,0xbf80,0x3f353f35,0x3f353f35,0xbf7f3dc9,0x3f0ebf55,0x3e953f75
.long 0x3f80,0xbf55bf0e,0x3f6dbec4,0xbe483f7b,0xbf353f35,0xbe95bf75,0x3f7b3e48,0xbf223f46
.long 0xbf800000,0x3ec4bf6d,0x3f353f35,0xbf6d3ec4,0xbf35bf35,0x3f62bef1,0x3e483f7b,0xbf7fbdc9
.long 0xbf80,0x3f7b3e48,0xbec43f6d,0xbf55bf0e,0x3f35bf35,0x3f223f46,0xbf553f0e,0xbef1bf62
.long 0x3f800000,0xbf800000,0x3f800000,0xbf800000,0x3f6d3ec4,0xbf75be95,0x3f7b3e48,0xbf7fbdc9
.long 0x3f353f35,0xbf55bf0e,0x3f6d3ec4,0xbf7bbe48,0x3ec43f6d,0xbf22bf46,0x3f553f0e,0xbf75be95
.long 0x3f80,0xbec4bf6d,0x3f353f35,0xbf6dbec4,0xbec43f6d,0xbdc9bf7f,0x3f0e3f55,0xbf62bef1
.long 0xbf353f35,0x3e48bf7b,0x3ec43f6d,0xbf55bf0e,0xbf6d3ec4,0x3ef1bf62,0x3e483f7b,0xbf46bf22
.long 0xbf800000,0x3f35bf35,0x3f80,0xbf35bf35,0xbf6dbec4,0x3f62bef1,0xbe483f7b,0xbf22bf46
.long 0xbf35bf35,0x3f7bbe48,0xbec43f6d,0xbf0ebf55,0xbec4bf6d,0x3f7f3dc9,0xbf0e3f55,0xbef1bf62
.long 0xbf80,0x3f6d3ec4,0xbf353f35,0xbec4bf6d,0x3ec4bf6d,0x3f463f22,0xbf553f0e,0xbe95bf75
.long 0x3f35bf35,0x3f0e3f55,0xbf6d3ec4,0xbe48bf7b,0x3f6dbec4,0x3e953f75,0xbf7b3e48,0xbdc9bf7f
.long 0x3f800000,0x3f7ec46d,0x3f7b14be,0x3f74fa0b,0x3f800000,0x3f7eb069,0x3f7ac516,0x3f74484b
.long 0x3f800000,0x3f7e9bc9,0x3f7a7302,0x3f73913f,0x3f800000,0x3f7e868b,0x3f7a1e84,0x3f72d4eb
.long 0x3f800000,0x3f7e70b0,0x3f79c79d,0x3f721352,0x3f800000,0x3f7e5a38,0x3f796e4e,0x3f714c7a
.long 0x3f800000,0x3f7e4323,0x3f791298,0x3f708066,0x3f800000,0x3f7e2b72,0x3f78b47b,0x3f6faf1b
.long 0x3f800000,0x3f7e1324,0x3f7853f8,0x3f6ed89e,0x3f800000,0x3f7dfa38,0x3f77f110,0x3f6dfcf2
.long 0x3f800000,0x3f7de0b1,0x3f778bc5,0x3f6d1c1d,0x3f800000,0x3f7dc68c,0x3f772417,0x3f6c3624
.long 0x3f800000,0x3f7dabcc,0x3f76ba07,0x3f6b4b0c,0x3f800000,0x3f7d906e,0x3f764d97,0x3f6a5ad9
.long 0x3f800000,0x3f7d7474,0x3f75dec6,0x3f696591,0x3f800000,0x3f7d57de,0x3f756d97,0x3f686b39
.long 0x3f6c835e,0x3f61c598,0x3f54db31,0x3f45e403,0x3f6b4b0c,0x3f5fe4e9,0x3f5233c6,0x3f425b89
.long 0x3f6a09a7,0x3f5df6be,0x3f4f7a1f,0x3f3ebc1b,0x3f68bf3c,0x3f5bfb34,0x3f4cae79,0x3f3b0629
.long 0x3f676bd8,0x3f59f26a,0x3f49d112,0x3f373a23,0x3f660f88,0x3f57dc7f,0x3f46e22a,0x3f33587a
.long 0x3f64aa59,0x3f55b993,0x3f43e200,0x3f2f61a5,0x3f633c5a,0x3f5389c7,0x3f40d0da,0x3f2b561b
.long 0x3f61c598,0x3f514d3d,0x3f3daef9,0x3f273656,0x3f604621,0x3f4f0417,0x3f3a7ca4,0x3f2302d3
.long 0x3f5ebe05,0x3f4cae79,0x3f373a23,0x3f1ebc12,0x3f5d2d53,0x3f4a4c87,0x3f33e7bc,0x3f1a6293
.long 0x3f5b941a,0x3f47de65,0x3f3085bb,0x3f15f6d9,0x3f59f26a,0x3f456439,0x3f2d1469,0x3f11796b
.long 0x3f584853,0x3f42de29,0x3f299415,0x3f0cead0,0x3f5695e5,0x3f404c5c,0x3f26050a,0x3f084b92
.long 0x3f3504f3,0x3f226799,0x3f0e39da,0x3ef15aea,0x3f3085bb,0x3f1ce11f,0x3f07a136,0x3ee1fb6a
.long 0x3f2beb4a,0x3f173c07,0x3f00e7e4,0x3ed25a09,0x3f273656,0x3f11796b,0x3ef41f07,0x3ec27b55
.long 0x3f226799,0x3f0b9a6b,0x3ee63375,0x3eb263ef,0x3f1d7fd1,0x3f05a02c,0x3ed8106b,0x3ea21887
.long 0x3f187fc0,0x3eff17b2,0x3ec9b953,0x3e919ddd,0x3f13682a,0x3ef2bd43,0x3ebb31a0,0x3e80f8c0
.long 0x3f0e39da,0x3ee63375,0x3eac7cd4,0x3e605c13,0x3f08f59b,0x3ed97cb9,0x3e9d9e78,0x3e3e853e
.long 0x3f039c3d,0x3ecc9b8b,0x3e8e9a22,0x3e1c76de,0x3efc5d27,0x3ebf926f,0x3e7ee6e1,0x3df475c0
.long 0x3ef15aea,0x3eb263ef,0x3e605c13,0x3dafb680,0x3ee63375,0x3ea5129f,0x3e419b37,0x3d55880e
.long 0x3edae880,0x3e97a117,0x3e22abb6,0x3c96c9b6,0x3ecf7bca,0x3e8a11f7,0x3e039502,0xbc7b514b
.long 0x3ec3ef15,0x3e94a031,0x3e47c5c2,0x3dc8bd36,0x3eb263ef,0x3e80f8c0,0x3e1c76de,0x3d55880e
.long 0x3ea09ae5,0x3e5a3997,0x3de1bc2e,0x3bc90f88,0x3e8e9a22,0x3e3228d4,0x3d8a200a,0xbd2351cb
.long 0x3e78cfcc,0x3e09cf86,0x3cc90ab0,0xbdafb680,0x3e541501,0x3dc27c39,0xbc96c9b6,0xbe06b26e
.long 0x3e2f10a2,0x3d621469,0xbd7b2b74,0xbe354098,0x3e09cf86,0x3c7b514b,0xbdd53db9,0xbe636c83
.long 0x3dc8bd36,0xbcc90ab0,0xbe164083,0xbe888e93,0x3d7b2b74,0xbd83db0a,0xbe419b37,0xbe9f1cdf
.long 0x3cc90ab0,0xbdd53db9,0xbe6c9a7f,0xbeb554ec,0xbc490e90,0xbe1324ca,0xbe8b9507,0xbecb2aae
.long 0xbd48fb30,0xbe3b6ecf,0xbea09ae5,0xbee0924f,0xbdafb680,0xbe636c83,0xbeb554ec,0xbef58035
.long 0xbdfab273,0xbe8586ce,0xbec9b953,0xbf04f484,0xbe22abb6,0xbe9920fe,0xbeddbe79,0xbf0ee0db
.long 0x0,0xbdc8bd36,0xbe47c5c2,0xbe94a031,0xbd48fb30,0xbe195be0,0xbe7ee6e1,0xbeb0eacb
.long 0xbdc8bd36,0xbe4dee60,0xbe9aa086,0xbecc9b8b,0xbe164083,0xbe80f8c0,0xbeb554ec,0xbee79a5d
.long 0xbe47c5c2,0xbe9aa086,0xbecf7bca,0xbf00e7e4,0xbe78cfcc,0xbeb3dca5,0xbee900b7,0xbf0d9281
.long 0xbe94a031,0xbecc9b8b,0xbf00e7e4,0xbf19c200,0xbeac7cd4,0xbee4cbfe,0xbf0cead0,0xbf256bcb
.long 0xbec3ef15,0xbefc5d27,0xbf187fc0,0xbf3085bb,0xbedae880,0xbf099f4e,0xbf239da9,0xbf3b0629
.long 0xbef15aea,0xbf14b039,0xbf2e3bde,0xbf44e3f5,0xbf039c3d,0xbf1f599f,0xbf385216,0xbf4e1689
.long 0xbf0e39da,0xbf299415,0xbf41d870,0xbf5695e5,0xbf187fc0,0xbf33587a,0xbf4ac77f,0xbf5e5aa6
.long 0xbf226799,0xbf3ca003,0xbf531849,0xbf655e0b,0xbf2beb4a,0xbf456439,0xbf5ac450,0xbf6b99fb
.long 0xbec3ef15,0xbef15aea,0xbf0e39da,0xbf226799,0xbee0924f,0xbf06f686,0xbf1c420c,0xbf2ff3e6
.long 0xbefc5d27,0xbf14b039,0xbf299415,0xbf3ca003,0xbf0b9a6b,0xbf21cbfb,0xbf36206c,0xbf485bca
.long 0xbf187fc0,0xbf2e3bde,0xbf41d870,0xbf531849,0xbf24d225,0xbf39f2ac,0xbf4cae79,0xbf5cc7d1
.long 0xbf3085bb,0xbf44e3f5,0xbf5695e5,0xbf655e0b,0xbf3b8f3b,0xbf4f0417,0xbf5f8327,0xbf6cd007
.long 0xbf45e403,0xbf584853,0xbf676bd8,0xbf731447,0xbf4f7a1f,0xbf60a6cf,0xbf6e46be,0xbf7822d1
.long 0xbf584853,0xbf6816a8,0xbf740bdd,0xbf7bf531,0xbf604621,0xbf6e8ff8,0xbf78b47b,0xbf7e868b
.long 0xbf676bd8,0xbf740bdd,0xbf7c3b28,0xbf7fd397,0xbf6db293,0xbf788486,0xbf7e9bc9,0xbf7fdaaf
.long 0xbf731447,0xbf7bf531,0xbf7fd397,0xbf7e9bc9,0xbf778bc5,0xbf7e5a38,0xbf7fe129,0xbf7c187a
.long 0xbf3504f3,0xbf45e403,0xbf54db31,0xbf61c598,0xbf41d870,0xbf51c0c2,0xbf5f8327,0xbf6afb8c
.long 0xbf4d9f02,0xbf5c61c7,0xbf68bf3c,0xbf7294f8,0xbf584853,0xbf65b710,0xbf708066,0xbf788486
.long 0xbf61c598,0xbf6db293,0xbf76ba07,0xbf7cbfc9,0xbf6a09a7,0xbf74484b,0xbf7b61fc,0xbf7f3f54
.long 0xbf710908,0xbf796e4e,0xbf7e70b0,0xbf7ffec4,0xbf76ba07,0xbf7d1cdd,0xbf7fe129,0xbf7efcc9
.long 0xbf7b14be,0xbf7f4e6d,0xbf7fb10f,0xbf7c3b28,0xbf7e1324,0xbf7fffb1,0xbf7de0b1,0xbf77beb7
.long 0xbf7fb10f,0xbf7f2f9d,0xbf7a7302,0xbf718f57,0xbf7fec43,0xbf7cdf6c,0xbf756d97,0xbf69b7e4
.long 0xbf7ec46d,0xbf791298,0xbf6ed89e,0xbf604621,0xbf7c3b28,0xbf73ced9,0xbf66becc,0xbf554aa4
.long 0xbf7853f8,0xbf6d1c1d,0xbf5d2d53,0xbf48d8b3,0xbf731447,0xbf650479,0xbf5233c6,0xbf3b0629
.long 0xbf6c835e,0xbf74fa0b,0xbf7b14be,0xbf7ec46d,0xbf740bdd,0xbf7a9c59,0xbf7e9bc9,0xbf7fffb1
.long 0xbf79c79d,0xbf7e4323,0xbf7ffb11,0xbf7eea9d,0xbf7dabcc,0xbf7fe705,0xbf7f2f9d,0xbf7b87b2
.long 0xbf7fb10f,0xbf7f84ab,0xbf7c3b28,0xbf75dec6,0xbf7fd397,0xbf7d1cdd,0xbf772417,0xbf6dfcf2
.long 0xbf7e1324,0xbf78b47b,0xbf6ff573,0xbf63f473,0xbf7a7302,0xbf725470,0xbf66becc,0xbf57dc7f
.long 0xbf74fa0b,0xbf6a09a7,0xbf5b941a,0xbf49d112,0xbf6db293,0xbf5fe4e9,0xbf4e8d90,0xbf39f2ac
.long 0xbf64aa59,0xbf53fac3,0xbf3fc767,0xbf286605,0xbf59f26a,0xbf466354,0xbf2f61a5,0xbf1553b7
.long 0xbf4d9f02,0xbf373a23,0xbf1d7fd1,0xbf00e7e4,0xbf3fc767,0xbf269de3,0xbf0a48ad,0xbed6a399
.long 0xbf3085bb,0xbf14b039,0xbeebcbbb,0xbea986c4,0xbf1ff6cb,0xbf019573,0xbec1071e,0xbe75c35a
.long 0x0,0xbdc8bd36,0xbe47c5c2,0xbe94a031,0x0,0xbdcefdb7,0xbe4dee60,0xbe9920fe
.long 0x0,0xbdd53db9,0xbe541501,0xbe9d9e78,0x0,0xbddb7d37,0xbe5a3997,0xbea21887
.long 0x0,0xbde1bc2e,0xbe605c13,0xbea68f12,0x0,0xbde7fa9a,0xbe667c66,0xbeab0201
.long 0x0,0xbdee3876,0xbe6c9a7f,0xbeaf713a,0x0,0xbdf475c0,0xbe72b651,0xbeb3dca5
.long 0x0,0xbdfab273,0xbe78cfcc,0xbeb8442a,0x0,0xbe007745,0xbe7ee6e1,0xbebca7af
.long 0x0,0xbe039502,0xbe827dc0,0xbec1071e,0x0,0xbe06b26e,0xbe8586ce,0xbec5625c
.long 0x0,0xbe09cf86,0xbe888e93,0xbec9b953,0x0,0xbe0cec4a,0xbe8b9507,0xbece0bea
.long 0x0,0xbe1008b7,0xbe8e9a22,0xbed25a09,0x0,0xbe1324ca,0xbe919ddd,0xbed6a399
.long 0xbec3ef15,0xbef15aea,0xbf0e39da,0xbf226799,0xbec9b953,0xbef840c8,0xbf121eb0,0xbf269de3
.long 0xbecf7bca,0xbeff17b2,0xbf15f6d9,0xbf2ac082,0xbed53641,0xbf02ef9f,0xbf19c200,0xbf2ecef7
.long 0xbedae880,0xbf064b82,0xbf1d7fd1,0xbf32c8c9,0xbee0924f,0xbf099f4e,0xbf212ff9,0xbf36ad7f
.long 0xbee63375,0xbf0cead0,0xbf24d225,0xbf3a7ca4,0xbeebcbbb,0xbf102dd5,0xbf286605,0xbf3e35c5
.long 0xbef15aea,0xbf13682a,0xbf2beb4a,0xbf41d870,0xbef6e0cb,0xbf16999f,0xbf2f61a5,0xbf456439
.long 0xbefc5d27,0xbf19c200,0xbf32c8c9,0xbf48d8b3,0xbf00e7e4,0xbf1ce11f,0xbf36206c,0xbf4c3578
.long 0xbf039c3d,0xbf1ff6cb,0xbf396842,0xbf4f7a1f,0xbf064b82,0xbf2302d3,0xbf3ca003,0xbf52a649
.long 0xbf08f59b,0xbf26050a,0xbf3fc767,0xbf55b993,0xbf0b9a6b,0xbf28fd41,0xbf42de29,0xbf58b3a1
.long 0xbf3504f3,0xbf45e403,0xbf54db31,0xbf61c598,0xbf396842,0xbf4a4c87,0xbf591e6a,0xbf65b710
.long 0xbf3daef9,0xbf4e8d90,0xbf5d2d53,0xbf696591,0xbf41d870,0xbf52a649,0xbf6106f2,0xbf6cd007
.long 0xbf45e403,0xbf5695e5,0xbf64aa59,0xbf6ff573,0xbf49d112,0xbf5a5ba0,0xbf6816a8,0xbf72d4eb
.long 0xbf4d9f02,0xbf5df6be,0xbf6b4b0c,0xbf756d97,0xbf514d3d,0xbf61668a,0xbf6e46be,0xbf77beb7
.long 0xbf54db31,0xbf64aa59,0xbf710908,0xbf79c79d,0xbf584853,0xbf67c187,0xbf73913f,0xbf7b87b2
.long 0xbf5b941a,0xbf6aab7b,0xbf75dec6,0xbf7cfe73,0xbf5ebe05,0xbf6d67a1,0xbf77f110,0xbf7e2b72
.long 0xbf61c598,0xbf6ff573,0xbf79c79d,0xbf7f0e58,0xbf64aa59,0xbf725470,0xbf7b61fc,0xbf7fa6e3
.long 0xbf676bd8,0xbf748422,0xbf7cbfc9,0xbf7ff4e6,0xbf6a09a7,0xbf76841b,0xbf7de0b1,0xbf7ff84a
.long 0xbf6c835e,0xbf74fa0b,0xbf7b14be,0xbf7ec46d,0xbf6ff573,0xbf77beb7,0xbf7cfe73,0xbf7fa6e3
.long 0xbf731447,0xbf7a1e84,0xbf7e70b0,0xbf7ffec4,0xbf75dec6,0xbf7c187a,0xbf7f6ac7,0xbf7fcbe2
.long 0xbf7853f8,0xbf7dabcc,0xbf7fec43,0xbf7f0e58,0xbf7a7302,0xbf7ed7d4,0xbf7ff4e6,0xbf7dc68c
.long 0xbf7c3b28,0xbf7f9c18,0xbf7f84ab,0xbf7bf531,0xbf7dabcc,0xbf7ff84a,0xbf7e9bc9,0xbf799b43
.long 0xbf7ec46d,0xbf7fec43,0xbf7d3aac,0xbf76ba07,0xbf7f84ab,0xbf7f7808,0xbf7b61fc,0xbf73530e
.long 0xbf7fec43,0xbf7e9bc9,0xbf791298,0xbf6f6830,0xbf7ffb11,0xbf7d57de,0xbf764d97,0xbf6afb8c
.long 0xbf7fb10f,0xbf7baccd,0xbf731447,0xbf660f88,0xbf7f0e58,0xbf799b43,0xbf6f6830,0xbf60a6cf
.long 0xbf7e1324,0xbf772417,0xbf6b4b0c,0xbf5ac450,0xbf7cbfc9,0xbf74484b,0xbf66becc,0xbf546b3b
.long 0xbf800000,0xbf7ec46d,0xbf7b14be,0xbf74fa0b,0xbf7fb10f,0xbf7d1cdd,0xbf77f110,0xbf703b37
.long 0xbf7ec46d,0xbf7ac516,0xbf740bdd,0xbf6aab7b,0xbf7d3aac,0xbf77beb7,0xbf6f6830,0xbf644fac
.long 0xbf7b14be,0xbf740bdd,0xbf6a09a7,0xbf5d2d53,0xbf7853f8,0xbf6faf1b,0xbf63f473,0xbf554aa4
.long 0xbf74fa0b,0xbf6aab7b,0xbf5d2d53,0xbf4cae79,0xbf710908,0xbf650479,0xbf55b993,0xbf436051
.long 0xbf6c835e,0xbf5ebe05,0xbf4d9f02,0xbf396842,0xbf676bd8,0xbf57dc7f,0xbf44e3f5,0xbf2ecef7
.long 0xbf61c598,0xbf5064af,0xbf3b8f3b,0xbf239da9,0xbf5b941a,0xbf485bca,0xbf31a81d,0xbf17de12
.long 0xbf54db31,0xbf3fc767,0xbf273656,0xbf0b9a6b,0xbf4d9f02,0xbf36ad7f,0xbf1c420c,0xbefdbabb
.long 0xbf45e403,0xbf2d1469,0xbf10d3cd,0xbee363fa,0xbf3daef9,0xbf2302d3,0xbf04f484,0xbec8477c
.long 0xbf6c835e,0xbf61c598,0xbf54db31,0xbf45e403,0xbf660f88,0xbf5988ad,0xbf4ac77f,0xbf39f2ac
.long 0xbf5ebe05,0xbf5064af,0xbf3fc767,0xbf2d1469,0xbf5695e5,0xbf466354,0xbf33e7bc,0xbf1f599f
.long 0xbf4d9f02,0xbf3b8f3b,0xbf273656,0xbf10d3cd,0xbf43e200,0xbf2ff3e6,0xbf19c200,0xbf019573
.long 0xbf396842,0xbf239da9,0xbf0b9a6b,0xbee363fa,0xbf2e3bde,0xbf16999f,0xbef9a02d,0xbec27b55
.long 0xbf226799,0xbf08f59b,0xbedae880,0xbea09ae5,0xbf15f6d9,0xbef58035,0xbebb31a0,0xbe7bdba4
.long 0xbf08f59b,0xbed8106b,0xbe9aa086,0xbe354098,0xbef6e0cb,0xbeb9bb1e,0xbe72b651,0xbddb7d37
.long 0xbedae880,0xbe9aa086,0xbe2f10a2,0xbd16c32c,0xbebe1d4a,0xbe75c35a,0xbdd53db9,0x3d0a342f
.long 0xbea09ae5,0xbe354098,0xbd16c32c,0x3dd53db9,0xbe827dc0,0xbde7fa9a,0x3cfb49ba,0x3e3228d4
.long 0xbf3504f3,0xbf226799,0xbf0e39da,0xbef15aea,0xbf273656,0xbf12c39a,0xbef9a02d,0xbecb2aae
.long 0xbf187fc0,0xbf0242b1,0xbed53641,0xbea395c5,0xbf08f59b,0xbee1fb6a,0xbeaf713a,0xbe75c35a
.long 0xbef15aea,0xbebe1d4a,0xbe888e93,0xbe22abb6,0xbecf7bca,0xbe9920fe,0xbe419b37,0xbd9cecf9
.long 0xbeac7cd4,0xbe667c66,0xbde1bc2e,0x3bc90f88,0xbe888e93,0xbe195be0,0xbcfb49ba,0x3db5f8da
.long 0xbe47c5c2,0xbd96a905,0x3d48fb30,0x3e2f10a2,0xbdfab273,0x3b490fc6,0x3e039502,0x3e80f8c0
.long 0xbd48fb30,0x3da3308c,0x3e541501,0x3ea986c4,0x3cc90ab0,0x3e1f917b,0x3e919ddd,0x3ed0eb2a
.long 0x3dc8bd36,0x3e6c9a7f,0x3eb8442a,0x3ef6e0cb,0x3e2f10a2,0x3e9c1faf,0x3eddbe79,0x3f0d9281
.long 0x3e78cfcc,0x3ec1071e,0x3f00e7e4,0x3f1ebc12,0x3ea09ae5,0x3ee4cbfe,0x3f121eb0,0x3f2ecef7
.long 0xbec3ef15,0xbe94a031,0xbe47c5c2,0xbdc8bd36,0xbe9aa086,0xbe5101f1,0xbdd53db9,0xbb490fc6
.long 0xbe605c13,0xbdee3876,0xbc490e90,0x3dbc3ac3,0xbe09cf86,0xbce22a7a,0x3da3308c,0x3e3e853e
.long 0xbd48fb30,0x3d7b2b74,0x3e2f10a2,0x3e8e9a22,0x3d16c32c,0x3e195be0,0x3e8586ce,0x3ebca7af
.long 0x3dfab273,0x3e72b651,0x3eb263ef,0x3ee900b7,0x3e541501,0x3ea5129f,0x3eddbe79,0x3f099f4e
.long 0x3e94a031,0x3ecf7bca,0x3f039c3d,0x3f1d7fd1,0x3ebe1d4a,0x3ef840c8,0x3f173c07,0x3f2ff3e6
.long 0x3ee63375,0x3f0f8784,0x3f299415,0x3f40d0da,0x3f064b82,0x3f21cbfb,0x3f3a7ca4,0x3f4fefa8
.long 0x3f187fc0,0x3f32c8c9,0x3f49d112,0x3f5d2d53,0x3f299415,0x3f425b89,0x3f577026,0x3f686b39
.long 0x3f396842,0x3f5064af,0x3f633c5a,0x3f718f57,0x3f47de65,0x3f5cc7d1,0x3f6d1c1d,0x3f788486
.long 0x3f800000,0x3f800000,0x3f800000,0x3f800000,0x3f7ec46d,0x3f7eb069,0x3f7e9bc9,0x3f7e868b
.long 0x3f7b14be,0x3f7ac516,0x3f7a7302,0x3f7a1e84,0x3f74fa0b,0x3f74484b,0x3f73913f,0x3f72d4eb
.long 0x3f6c835e,0x3f6b4b0c,0x3f6a09a7,0x3f68bf3c,0x3f61c598,0x3f5fe4e9,0x3f5df6be,0x3f5bfb34
.long 0x3f54db31,0x3f5233c6,0x3f4f7a1f,0x3f4cae79,0x3f45e403,0x3f425b89,0x3f3ebc1b,0x3f3b0629
.long 0x3f3504f3,0x3f3085bb,0x3f2beb4a,0x3f273656,0x3f226799,0x3f1ce11f,0x3f173c07,0x3f11796b
.long 0x3f0e39da,0x3f07a136,0x3f00e7e4,0x3ef41f07,0x3ef15aea,0x3ee1fb6a,0x3ed25a09,0x3ec27b55
.long 0x3ec3ef15,0x3eb263ef,0x3ea09ae5,0x3e8e9a22,0x3e94a031,0x3e80f8c0,0x3e5a3997,0x3e3228d4
.long 0x3e47c5c2,0x3e1c76de,0x3de1bc2e,0x3d8a200a,0x3dc8bd36,0x3d55880e,0x3bc90f88,0xbd2351cb
.long 0x3f800000,0x3f800000,0x3f800000,0x3f800000,0x3f7e70b0,0x3f7e5a38,0x3f7e4323,0x3f7e2b72
.long 0x3f79c79d,0x3f796e4e,0x3f791298,0x3f78b47b,0x3f721352,0x3f714c7a,0x3f708066,0x3f6faf1b
.long 0x3f676bd8,0x3f660f88,0x3f64aa59,0x3f633c5a,0x3f59f26a,0x3f57dc7f,0x3f55b993,0x3f5389c7
.long 0x3f49d112,0x3f46e22a,0x3f43e200,0x3f40d0da,0x3f373a23,0x3f33587a,0x3f2f61a5,0x3f2b561b
.long 0x3f226799,0x3f1d7fd1,0x3f187fc0,0x3f13682a,0x3f0b9a6b,0x3f05a02c,0x3eff17b2,0x3ef2bd43
.long 0x3ee63375,0x3ed8106b,0x3ec9b953,0x3ebb31a0,0x3eb263ef,0x3ea21887,0x3e919ddd,0x3e80f8c0
.long 0x3e78cfcc,0x3e541501,0x3e2f10a2,0x3e09cf86,0x3e09cf86,0x3dc27c39,0x3d621469,0x3c7b514b
.long 0x3cc90ab0,0xbc96c9b6,0xbd7b2b74,0xbdd53db9,0xbdafb680,0xbe06b26e,0xbe354098,0xbe636c83
.long 0x3f800000,0x3f800000,0x3f800000,0x3f800000,0x3f7e1324,0x3f7dfa38,0x3f7de0b1,0x3f7dc68c
.long 0x3f7853f8,0x3f77f110,0x3f778bc5,0x3f772417,0x3f6ed89e,0x3f6dfcf2,0x3f6d1c1d,0x3f6c3624
.long 0x3f61c598,0x3f604621,0x3f5ebe05,0x3f5d2d53,0x3f514d3d,0x3f4f0417,0x3f4cae79,0x3f4a4c87
.long 0x3f3daef9,0x3f3a7ca4,0x3f373a23,0x3f33e7bc,0x3f273656,0x3f2302d3,0x3f1ebc12,0x3f1a6293
.long 0x3f0e39da,0x3f08f59b,0x3f039c3d,0x3efc5d27,0x3ee63375,0x3ed97cb9,0x3ecc9b8b,0x3ebf926f
.long 0x3eac7cd4,0x3e9d9e78,0x3e8e9a22,0x3e7ee6e1,0x3e605c13,0x3e3e853e,0x3e1c76de,0x3df475c0
.long 0x3dc8bd36,0x3d7b2b74,0x3cc90ab0,0xbc490e90,0xbcc90ab0,0xbd83db0a,0xbdd53db9,0xbe1324ca
.long 0xbe164083,0xbe419b37,0xbe6c9a7f,0xbe8b9507,0xbe888e93,0xbe9f1cdf,0xbeb554ec,0xbecb2aae
.long 0x3f800000,0x3f800000,0x3f800000,0x3f800000,0x3f7dabcc,0x3f7d906e,0x3f7d7474,0x3f7d57de
.long 0x3f76ba07,0x3f764d97,0x3f75dec6,0x3f756d97,0x3f6b4b0c,0x3f6a5ad9,0x3f696591,0x3f686b39
.long 0x3f5b941a,0x3f59f26a,0x3f584853,0x3f5695e5,0x3f47de65,0x3f456439,0x3f42de29,0x3f404c5c
.long 0x3f3085bb,0x3f2d1469,0x3f299415,0x3f26050a,0x3f15f6d9,0x3f11796b,0x3f0cead0,0x3f084b92
.long 0x3ef15aea,0x3ee63375,0x3edae880,0x3ecf7bca,0x3eb263ef,0x3ea5129f,0x3e97a117,0x3e8a11f7
.long 0x3e605c13,0x3e419b37,0x3e22abb6,0x3e039502,0x3dafb680,0x3d55880e,0x3c96c9b6,0xbc7b514b
.long 0xbd48fb30,0xbdafb680,0xbdfab273,0xbe22abb6,0xbe3b6ecf,0xbe636c83,0xbe8586ce,0xbe9920fe
.long 0xbea09ae5,0xbeb554ec,0xbec9b953,0xbeddbe79,0xbee0924f,0xbef58035,0xbf04f484,0xbf0ee0db
.long 0x0,0xbd48fb30,0xbdc8bd36,0xbe164083,0xbdc8bd36,0xbe195be0,0xbe4dee60,0xbe80f8c0
.long 0xbe47c5c2,0xbe7ee6e1,0xbe9aa086,0xbeb554ec,0xbe94a031,0xbeb0eacb,0xbecc9b8b,0xbee79a5d
.long 0xbec3ef15,0xbee0924f,0xbefc5d27,0xbf0b9a6b,0xbef15aea,0xbf06f686,0xbf14b039,0xbf21cbfb
.long 0xbf0e39da,0xbf1c420c,0xbf299415,0xbf36206c,0xbf226799,0xbf2ff3e6,0xbf3ca003,0xbf485bca
.long 0xbf3504f3,0xbf41d870,0xbf4d9f02,0xbf584853,0xbf45e403,0xbf51c0c2,0xbf5c61c7,0xbf65b710
.long 0xbf54db31,0xbf5f8327,0xbf68bf3c,0xbf708066,0xbf61c598,0xbf6afb8c,0xbf7294f8,0xbf788486
.long 0xbf6c835e,0xbf740bdd,0xbf79c79d,0xbf7dabcc,0xbf74fa0b,0xbf7a9c59,0xbf7e4323,0xbf7fe705
.long 0xbf7b14be,0xbf7e9bc9,0xbf7ffb11,0xbf7f2f9d,0xbf7ec46d,0xbf7fffb1,0xbf7eea9d,0xbf7b87b2
.long 0xbe47c5c2,0xbe78cfcc,0xbe94a031,0xbeac7cd4,0xbe9aa086,0xbeb3dca5,0xbecc9b8b,0xbee4cbfe
.long 0xbecf7bca,0xbee900b7,0xbf00e7e4,0xbf0cead0,0xbf00e7e4,0xbf0d9281,0xbf19c200,0xbf256bcb
.long 0xbf187fc0,0xbf24d225,0xbf3085bb,0xbf3b8f3b,0xbf2e3bde,0xbf39f2ac,0xbf44e3f5,0xbf4f0417
.long 0xbf41d870,0xbf4cae79,0xbf5695e5,0xbf5f8327,0xbf531849,0xbf5cc7d1,0xbf655e0b,0xbf6cd007
.long 0xbf61c598,0xbf6a09a7,0xbf710908,0xbf76ba07,0xbf6db293,0xbf74484b,0xbf796e4e,0xbf7d1cdd
.long 0xbf76ba07,0xbf7b61fc,0xbf7e70b0,0xbf7fe129,0xbf7cbfc9,0xbf7f3f54,0xbf7ffec4,0xbf7efcc9
.long 0xbf7fb10f,0xbf7fd397,0xbf7e1324,0xbf7a7302,0xbf7f84ab,0xbf7d1cdd,0xbf78b47b,0xbf725470
.long 0xbf7c3b28,0xbf772417,0xbf6ff573,0xbf66becc,0xbf75dec6,0xbf6dfcf2,0xbf63f473,0xbf57dc7f
.long 0xbec3ef15,0xbedae880,0xbef15aea,0xbf039c3d,0xbefc5d27,0xbf099f4e,0xbf14b039,0xbf1f599f
.long 0xbf187fc0,0xbf239da9,0xbf2e3bde,0xbf385216,0xbf3085bb,0xbf3b0629,0xbf44e3f5,0xbf4e1689
.long 0xbf45e403,0xbf4f7a1f,0xbf584853,0xbf604621,0xbf584853,0xbf60a6cf,0xbf6816a8,0xbf6e8ff8
.long 0xbf676bd8,0xbf6e46be,0xbf740bdd,0xbf78b47b,0xbf731447,0xbf7822d1,0xbf7bf531,0xbf7e868b
.long 0xbf7b14be,0xbf7e1324,0xbf7fb10f,0xbf7fec43,0xbf7f4e6d,0xbf7fffb1,0xbf7f2f9d,0xbf7cdf6c
.long 0xbf7fb10f,0xbf7de0b1,0xbf7a7302,0xbf756d97,0xbf7c3b28,0xbf77beb7,0xbf718f57,0xbf69b7e4
.long 0xbf74fa0b,0xbf6db293,0xbf64aa59,0xbf59f26a,0xbf6a09a7,0xbf5fe4e9,0xbf53fac3,0xbf466354
.long 0xbf5b941a,0xbf4e8d90,0xbf3fc767,0xbf2f61a5,0xbf49d112,0xbf39f2ac,0xbf286605,0xbf1553b7
.long 0xbf0e39da,0xbf187fc0,0xbf226799,0xbf2beb4a,0xbf299415,0xbf33587a,0xbf3ca003,0xbf456439
.long 0xbf41d870,0xbf4ac77f,0xbf531849,0xbf5ac450,0xbf5695e5,0xbf5e5aa6,0xbf655e0b,0xbf6b99fb
.long 0xbf676bd8,0xbf6db293,0xbf731447,0xbf778bc5,0xbf740bdd,0xbf788486,0xbf7bf531,0xbf7e5a38
.long 0xbf7c3b28,0xbf7e9bc9,0xbf7fd397,0xbf7fe129,0xbf7fd397,0xbf7fdaaf,0xbf7e9bc9,0xbf7c187a
.long 0xbf7ec46d,0xbf7c3b28,0xbf7853f8,0xbf731447,0xbf791298,0xbf73ced9,0xbf6d1c1d,0xbf650479
.long 0xbf6ed89e,0xbf66becc,0xbf5d2d53,0xbf5233c6,0xbf604621,0xbf554aa4,0xbf48d8b3,0xbf3b0629
.long 0xbf4d9f02,0xbf3fc767,0xbf3085bb,0xbf1ff6cb,0xbf373a23,0xbf269de3,0xbf14b039,0xbf019573
.long 0xbf1d7fd1,0xbf0a48ad,0xbeebcbbb,0xbec1071e,0xbf00e7e4,0xbed6a399,0xbea986c4,0xbe75c35a
.long 0x0,0x0,0x0,0x0,0xbdc8bd36,0xbdcefdb7,0xbdd53db9,0xbddb7d37
.long 0xbe47c5c2,0xbe4dee60,0xbe541501,0xbe5a3997,0xbe94a031,0xbe9920fe,0xbe9d9e78,0xbea21887
.long 0xbec3ef15,0xbec9b953,0xbecf7bca,0xbed53641,0xbef15aea,0xbef840c8,0xbeff17b2,0xbf02ef9f
.long 0xbf0e39da,0xbf121eb0,0xbf15f6d9,0xbf19c200,0xbf226799,0xbf269de3,0xbf2ac082,0xbf2ecef7
.long 0xbf3504f3,0xbf396842,0xbf3daef9,0xbf41d870,0xbf45e403,0xbf4a4c87,0xbf4e8d90,0xbf52a649
.long 0xbf54db31,0xbf591e6a,0xbf5d2d53,0xbf6106f2,0xbf61c598,0xbf65b710,0xbf696591,0xbf6cd007
.long 0xbf6c835e,0xbf6ff573,0xbf731447,0xbf75dec6,0xbf74fa0b,0xbf77beb7,0xbf7a1e84,0xbf7c187a
.long 0xbf7b14be,0xbf7cfe73,0xbf7e70b0,0xbf7f6ac7,0xbf7ec46d,0xbf7fa6e3,0xbf7ffec4,0xbf7fcbe2
.long 0x0,0x0,0x0,0x0,0xbde1bc2e,0xbde7fa9a,0xbdee3876,0xbdf475c0
.long 0xbe605c13,0xbe667c66,0xbe6c9a7f,0xbe72b651,0xbea68f12,0xbeab0201,0xbeaf713a,0xbeb3dca5
.long 0xbedae880,0xbee0924f,0xbee63375,0xbeebcbbb,0xbf064b82,0xbf099f4e,0xbf0cead0,0xbf102dd5
.long 0xbf1d7fd1,0xbf212ff9,0xbf24d225,0xbf286605,0xbf32c8c9,0xbf36ad7f,0xbf3a7ca4,0xbf3e35c5
.long 0xbf45e403,0xbf49d112,0xbf4d9f02,0xbf514d3d,0xbf5695e5,0xbf5a5ba0,0xbf5df6be,0xbf61668a
.long 0xbf64aa59,0xbf6816a8,0xbf6b4b0c,0xbf6e46be,0xbf6ff573,0xbf72d4eb,0xbf756d97,0xbf77beb7
.long 0xbf7853f8,0xbf7a7302,0xbf7c3b28,0xbf7dabcc,0xbf7dabcc,0xbf7ed7d4,0xbf7f9c18,0xbf7ff84a
.long 0xbf7fec43,0xbf7ff4e6,0xbf7f84ab,0xbf7e9bc9,0xbf7f0e58,0xbf7dc68c,0xbf7bf531,0xbf799b43
.long 0x0,0x0,0x0,0x0,0xbdfab273,0xbe007745,0xbe039502,0xbe06b26e
.long 0xbe78cfcc,0xbe7ee6e1,0xbe827dc0,0xbe8586ce,0xbeb8442a,0xbebca7af,0xbec1071e,0xbec5625c
.long 0xbef15aea,0xbef6e0cb,0xbefc5d27,0xbf00e7e4,0xbf13682a,0xbf16999f,0xbf19c200,0xbf1ce11f
.long 0xbf2beb4a,0xbf2f61a5,0xbf32c8c9,0xbf36206c,0xbf41d870,0xbf456439,0xbf48d8b3,0xbf4c3578
.long 0xbf54db31,0xbf584853,0xbf5b941a,0xbf5ebe05,0xbf64aa59,0xbf67c187,0xbf6aab7b,0xbf6d67a1
.long 0xbf710908,0xbf73913f,0xbf75dec6,0xbf77f110,0xbf79c79d,0xbf7b87b2,0xbf7cfe73,0xbf7e2b72
.long 0xbf7ec46d,0xbf7f84ab,0xbf7fec43,0xbf7ffb11,0xbf7fec43,0xbf7f7808,0xbf7e9bc9,0xbf7d57de
.long 0xbf7d3aac,0xbf7b61fc,0xbf791298,0xbf764d97,0xbf76ba07,0xbf73530e,0xbf6f6830,0xbf6afb8c
.long 0x0,0x0,0x0,0x0,0xbe09cf86,0xbe0cec4a,0xbe1008b7,0xbe1324ca
.long 0xbe888e93,0xbe8b9507,0xbe8e9a22,0xbe919ddd,0xbec9b953,0xbece0bea,0xbed25a09,0xbed6a399
.long 0xbf039c3d,0xbf064b82,0xbf08f59b,0xbf0b9a6b,0xbf1ff6cb,0xbf2302d3,0xbf26050a,0xbf28fd41
.long 0xbf396842,0xbf3ca003,0xbf3fc767,0xbf42de29,0xbf4f7a1f,0xbf52a649,0xbf55b993,0xbf58b3a1
.long 0xbf61c598,0xbf64aa59,0xbf676bd8,0xbf6a09a7,0xbf6ff573,0xbf725470,0xbf748422,0xbf76841b
.long 0xbf79c79d,0xbf7b61fc,0xbf7cbfc9,0xbf7de0b1,0xbf7f0e58,0xbf7fa6e3,0xbf7ff4e6,0xbf7ff84a
.long 0xbf7fb10f,0xbf7f0e58,0xbf7e1324,0xbf7cbfc9,0xbf7baccd,0xbf799b43,0xbf772417,0xbf74484b
.long 0xbf731447,0xbf6f6830,0xbf6b4b0c,0xbf66becc,0xbf660f88,0xbf60a6cf,0xbf5ac450,0xbf546b3b
.long 0xbf800000,0xbf7fb10f,0xbf7ec46d,0xbf7d3aac,0xbf7ec46d,0xbf7d1cdd,0xbf7ac516,0xbf77beb7
.long 0xbf7b14be,0xbf77f110,0xbf740bdd,0xbf6f6830,0xbf74fa0b,0xbf703b37,0xbf6aab7b,0xbf644fac
.long 0xbf6c835e,0xbf660f88,0xbf5ebe05,0xbf5695e5,0xbf61c598,0xbf5988ad,0xbf5064af,0xbf466354
.long 0xbf54db31,0xbf4ac77f,0xbf3fc767,0xbf33e7bc,0xbf45e403,0xbf39f2ac,0xbf2d1469,0xbf1f599f
.long 0xbf3504f3,0xbf273656,0xbf187fc0,0xbf08f59b,0xbf226799,0xbf12c39a,0xbf0242b1,0xbee1fb6a
.long 0xbf0e39da,0xbef9a02d,0xbed53641,0xbeaf713a,0xbef15aea,0xbecb2aae,0xbea395c5,0xbe75c35a
.long 0xbec3ef15,0xbe9aa086,0xbe605c13,0xbe09cf86,0xbe94a031,0xbe5101f1,0xbdee3876,0xbce22a7a
.long 0xbe47c5c2,0xbdd53db9,0xbc490e90,0x3da3308c,0xbdc8bd36,0xbb490fc6,0x3dbc3ac3,0x3e3e853e
.long 0xbf7b14be,0xbf7853f8,0xbf74fa0b,0xbf710908,0xbf740bdd,0xbf6faf1b,0xbf6aab7b,0xbf650479
.long 0xbf6a09a7,0xbf63f473,0xbf5d2d53,0xbf55b993,0xbf5d2d53,0xbf554aa4,0xbf4cae79,0xbf436051
.long 0xbf4d9f02,0xbf43e200,0xbf396842,0xbf2e3bde,0xbf3b8f3b,0xbf2ff3e6,0xbf239da9,0xbf16999f
.long 0xbf273656,0xbf19c200,0xbf0b9a6b,0xbef9a02d,0xbf10d3cd,0xbf019573,0xbee363fa,0xbec27b55
.long 0xbef15aea,0xbecf7bca,0xbeac7cd4,0xbe888e93,0xbebe1d4a,0xbe9920fe,0xbe667c66,0xbe195be0
.long 0xbe888e93,0xbe419b37,0xbde1bc2e,0xbcfb49ba,0xbe22abb6,0xbd9cecf9,0x3bc90f88,0x3db5f8da
.long 0xbd48fb30,0x3d16c32c,0x3dfab273,0x3e541501,0x3d7b2b74,0x3e195be0,0x3e72b651,0x3ea5129f
.long 0x3e2f10a2,0x3e8586ce,0x3eb263ef,0x3eddbe79,0x3e8e9a22,0x3ebca7af,0x3ee900b7,0x3f099f4e
.long 0xbf6c835e,0xbf676bd8,0xbf61c598,0xbf5b941a,0xbf5ebe05,0xbf57dc7f,0xbf5064af,0xbf485bca
.long 0xbf4d9f02,0xbf44e3f5,0xbf3b8f3b,0xbf31a81d,0xbf396842,0xbf2ecef7,0xbf239da9,0xbf17de12
.long 0xbf226799,0xbf15f6d9,0xbf08f59b,0xbef6e0cb,0xbf08f59b,0xbef58035,0xbed8106b,0xbeb9bb1e
.long 0xbedae880,0xbebb31a0,0xbe9aa086,0xbe72b651,0xbea09ae5,0xbe7bdba4,0xbe354098,0xbddb7d37
.long 0xbe47c5c2,0xbdfab273,0xbd48fb30,0x3cc90ab0,0xbd96a905,0x3b490fc6,0x3da3308c,0x3e1f917b
.long 0x3d48fb30,0x3e039502,0x3e541501,0x3e919ddd,0x3e2f10a2,0x3e80f8c0,0x3ea986c4,0x3ed0eb2a
.long 0x3e94a031,0x3ebe1d4a,0x3ee63375,0x3f064b82,0x3ecf7bca,0x3ef840c8,0x3f0f8784,0x3f21cbfb
.long 0x3f039c3d,0x3f173c07,0x3f299415,0x3f3a7ca4,0x3f1d7fd1,0x3f2ff3e6,0x3f40d0da,0x3f4fefa8
.long 0xbf54db31,0xbf4d9f02,0xbf45e403,0xbf3daef9,0xbf3fc767,0xbf36ad7f,0xbf2d1469,0xbf2302d3
.long 0xbf273656,0xbf1c420c,0xbf10d3cd,0xbf04f484,0xbf0b9a6b,0xbefdbabb,0xbee363fa,0xbec8477c
.long 0xbedae880,0xbebe1d4a,0xbea09ae5,0xbe827dc0,0xbe9aa086,0xbe75c35a,0xbe354098,0xbde7fa9a
.long 0xbe2f10a2,0xbdd53db9,0xbd16c32c,0x3cfb49ba,0xbd16c32c,0x3d0a342f,0x3dd53db9,0x3e3228d4
.long 0x3dc8bd36,0x3e2f10a2,0x3e78cfcc,0x3ea09ae5,0x3e6c9a7f,0x3e9c1faf,0x3ec1071e,0x3ee4cbfe
.long 0x3eb8442a,0x3eddbe79,0x3f00e7e4,0x3f121eb0,0x3ef6e0cb,0x3f0d9281,0x3f1ebc12,0x3f2ecef7
.long 0x3f187fc0,0x3f299415,0x3f396842,0x3f47de65,0x3f32c8c9,0x3f425b89,0x3f5064af,0x3f5cc7d1
.long 0x3f49d112,0x3f577026,0x3f633c5a,0x3f6d1c1d,0x3f5d2d53,0x3f686b39,0x3f718f57,0x3f788486
.long 0x3f80,0xbf800000,0xbf80,0x3f800000,0x3f80,0xbf7f3dc9,0xbe48bf7b,0x3f75be95
.long 0x3f80,0xbf7b3e48,0xbec4bf6d,0x3f55bf0e,0x3f80,0xbf753e95,0xbf0ebf55,0x3f22bf46
.long 0x3f80,0xbf6d3ec4,0xbf35bf35,0x3ec4bf6d,0x3f80,0xbf623ef1,0xbf55bf0e,0x3dc9bf7f
.long 0x3f80,0xbf553f0e,0xbf6dbec4,0xbe48bf7b,0x3f80,0xbf463f22,0xbf7bbe48,0xbef1bf62
.long 0x3f80,0xbf353f35,0xbf800000,0xbf35bf35,0x3f80,0xbf223f46,0xbf7b3e48,0xbf62bef1
.long 0x3f80,0xbf0e3f55,0xbf6d3ec4,0xbf7bbe48,0x3f80,0xbef13f62,0xbf553f0e,0xbf7f3dc9
.long 0x3f80,0xbec43f6d,0xbf353f35,0xbf6d3ec4,0x3f80,0xbe953f75,0xbf0e3f55,0xbf463f22
.long 0x3f80,0xbe483f7b,0xbec43f6d,0xbf0e3f55,0x3f80,0xbdc93f7f,0xbe483f7b,0xbe953f75
.long 0x3f80,0xbf800000,0xbf80,0x3f800000,0x3ec43f6d,0xbf623ef1,0xbf0ebf55,0x3f46bf22
.long 0x3f353f35,0xbf0e3f55,0xbf6dbec4,0x3e48bf7b,0x3f6d3ec4,0xbdc93f7f,0xbf7b3e48,0xbef1bf62
.long 0x3f800000,0x3ec43f6d,0xbf353f35,0xbf6dbec4,0x3f6dbec4,0x3f463f22,0xbe483f7b,0xbf753e95
.long 0x3f35bf35,0x3f7b3e48,0x3ec43f6d,0xbf0e3f55,0x3ec4bf6d,0x3f75be95,0x3f553f0e,0x3dc93f7f
.long 0xbf80,0x3f35bf35,0x3f800000,0x3f353f35,0xbec4bf6d,0x3e95bf75,0x3f55bf0e,0x3f7f3dc9
.long 0xbf35bf35,0xbe48bf7b,0x3ec4bf6d,0x3f55bf0e,0xbf6dbec4,0xbf22bf46,0xbe48bf7b,0x3e95bf75
.long 0xbf800000,0xbf6dbec4,0xbf35bf35,0xbec4bf6d,0xbf6d3ec4,0xbf7f3dc9,0xbf7bbe48,0xbf62bef1
.long 0xbf353f35,0xbf553f0e,0xbf6d3ec4,0xbf7b3e48,0xbec43f6d,0xbef13f62,0xbf0e3f55,0xbf223f46
.long 0x3f80,0xbf800000,0xbf80,0x3f800000,0x3f353f35,0xbf223f46,0xbf55bf0e,0x3ef1bf62
.long 0x3f800000,0x3e483f7b,0xbf6d3ec4,0xbf0ebf55,0x3f35bf35,0x3f623ef1,0xbe483f7b,0xbf7f3dc9
.long 0xbf80,0x3f6dbec4,0x3f353f35,0xbec43f6d,0xbf35bf35,0x3e95bf75,0x3f7bbe48,0x3f223f46
.long 0xbf800000,0xbf0ebf55,0x3ec4bf6d,0x3f7bbe48,0xbf353f35,0xbf7fbdc9,0xbf0ebf55,0x3e95bf75
.long 0x3f80,0xbf353f35,0xbf800000,0xbf35bf35,0x3f353f35,0x3dc93f7f,0xbf0e3f55,0xbf753e95
.long 0x3f800000,0x3f553f0e,0x3ec43f6d,0xbe483f7b,0x3f35bf35,0x3f75be95,0x3f7b3e48,0x3f463f22
.long 0xbf80,0x3ec4bf6d,0x3f35bf35,0x3f6dbec4,0xbf35bf35,0xbef1bf62,0xbe48bf7b,0x3dc9bf7f
.long 0xbf800000,0xbf7bbe48,0xbf6dbec4,0xbf55bf0e,0xbf353f35,0xbf463f22,0xbf553f0e,0xbf623ef1
.long 0x3f80,0xbf800000,0xbf80,0x3f800000,0x3f6d3ec4,0xbe953f75,0xbf7bbe48,0x3dc9bf7f
.long 0x3f35bf35,0x3f553f0e,0xbec43f6d,0xbf7bbe48,0xbec4bf6d,0x3f46bf22,0x3f553f0e,0xbe953f75
.long 0xbf800000,0xbec4bf6d,0x3f35bf35,0x3f6d3ec4,0xbec43f6d,0xbf7f3dc9,0xbf0ebf55,0x3ef1bf62
.long 0x3f353f35,0xbe483f7b,0xbf6d3ec4,0xbf55bf0e,0x3f6dbec4,0x3f623ef1,0x3e483f7b,0xbf223f46
.long 0xbf80,0x3f35bf35,0x3f800000,0x3f353f35,0xbf6dbec4,0xbef1bf62,0x3e48bf7b,0x3f46bf22
.long 0xbf353f35,0xbf7b3e48,0xbf6dbec4,0xbf0ebf55,0x3ec43f6d,0xbdc93f7f,0xbf0e3f55,0xbf623ef1
.long 0x3f800000,0x3f6d3ec4,0x3f353f35,0x3ec43f6d,0x3ec4bf6d,0x3f22bf46,0x3f55bf0e,0x3f75be95
.long 0xbf35bf35,0xbf0ebf55,0xbec4bf6d,0xbe48bf7b,0xbf6d3ec4,0xbf753e95,0xbf7b3e48,0xbf7f3dc9
.long 0x3f800000,0x3f80,0xbf800000,0xbf80,0x3f800000,0x3dc93f7f,0xbf7b3e48,0xbe95bf75
.long 0x3f800000,0x3e483f7b,0xbf6d3ec4,0xbf0ebf55,0x3f800000,0x3e953f75,0xbf553f0e,0xbf46bf22
.long 0x3f800000,0x3ec43f6d,0xbf353f35,0xbf6dbec4,0x3f800000,0x3ef13f62,0xbf0e3f55,0xbf7fbdc9
.long 0x3f800000,0x3f0e3f55,0xbec43f6d,0xbf7b3e48,0x3f800000,0x3f223f46,0xbe483f7b,0xbf623ef1
.long 0x3f800000,0x3f353f35,0x3f80,0xbf353f35,0x3f800000,0x3f463f22,0x3e483f7b,0xbef13f62
.long 0x3f800000,0x3f553f0e,0x3ec43f6d,0xbe483f7b,0x3f800000,0x3f623ef1,0x3f0e3f55,0x3dc93f7f
.long 0x3f800000,0x3f6d3ec4,0x3f353f35,0x3ec43f6d,0x3f800000,0x3f753e95,0x3f553f0e,0x3f223f46
.long 0x3f800000,0x3f7b3e48,0x3f6d3ec4,0x3f553f0e,0x3f800000,0x3f7f3dc9,0x3f7b3e48,0x3f753e95
.long 0x3f800000,0x3f80,0xbf800000,0xbf80,0x3f6dbec4,0x3ef13f62,0xbf553f0e,0xbf22bf46
.long 0x3f35bf35,0x3f553f0e,0xbec43f6d,0xbf7bbe48,0x3ec4bf6d,0x3f7f3dc9,0x3e483f7b,0xbf623ef1
.long 0xbf80,0x3f6dbec4,0x3f353f35,0xbec43f6d,0xbec4bf6d,0x3f22bf46,0x3f7b3e48,0x3e953f75
.long 0xbf35bf35,0x3e48bf7b,0x3f6dbec4,0x3f553f0e,0xbf6dbec4,0xbe95bf75,0x3f0ebf55,0x3f7fbdc9
.long 0xbf800000,0xbf35bf35,0xbf80,0x3f35bf35,0xbf6d3ec4,0xbf75be95,0xbf0ebf55,0x3dc9bf7f
.long 0xbf353f35,0xbf7b3e48,0xbf6dbec4,0xbf0ebf55,0xbec43f6d,0xbf463f22,0xbf7b3e48,0xbf75be95
.long 0x3f80,0xbec43f6d,0xbf353f35,0xbf6d3ec4,0x3ec43f6d,0x3dc93f7f,0xbe483f7b,0xbef13f62
.long 0x3f353f35,0x3f0e3f55,0x3ec43f6d,0x3e483f7b,0x3f6d3ec4,0x3f623ef1,0x3f553f0e,0x3f463f22
.long 0x3f800000,0x3f80,0xbf800000,0xbf80,0x3f35bf35,0x3f463f22,0xbf0e3f55,0xbf62bef1
.long 0xbf80,0x3f7bbe48,0x3ec43f6d,0xbf553f0e,0xbf35bf35,0x3ef1bf62,0x3f7b3e48,0x3dc93f7f
.long 0xbf800000,0xbec4bf6d,0x3f35bf35,0x3f6d3ec4,0xbf353f35,0xbf75be95,0xbe48bf7b,0x3f46bf22
.long 0x3f80,0xbf553f0e,0xbf6dbec4,0xbe48bf7b,0x3f353f35,0xbdc93f7f,0xbf553f0e,0xbf75be95
.long 0x3f800000,0x3f353f35,0x3f80,0xbf353f35,0x3f35bf35,0x3f7fbdc9,0x3f553f0e,0x3e953f75
.long 0xbf80,0x3f0ebf55,0x3f6dbec4,0x3f7b3e48,0xbf35bf35,0xbe95bf75,0x3e48bf7b,0x3f22bf46
.long 0xbf800000,0xbf6dbec4,0xbf35bf35,0xbec4bf6d,0xbf353f35,0xbf623ef1,0xbf7b3e48,0xbf7fbdc9
.long 0x3f80,0xbe483f7b,0xbec43f6d,0xbf0e3f55,0x3f353f35,0x3f223f46,0x3f0e3f55,0x3ef13f62
.long 0x3f800000,0x3f80,0xbf800000,0xbf80,0x3ec4bf6d,0x3f753e95,0xbe483f7b,0xbf7fbdc9
.long 0xbf35bf35,0x3f0ebf55,0x3f6d3ec4,0xbe483f7b,0xbf6d3ec4,0xbf22bf46,0x3f0ebf55,0x3f753e95
.long 0x3f80,0xbf6d3ec4,0xbf35bf35,0x3ec4bf6d,0x3f6d3ec4,0x3dc93f7f,0xbf553f0e,0xbf62bef1
.long 0x3f35bf35,0x3f7b3e48,0x3ec43f6d,0xbf0e3f55,0xbec4bf6d,0x3ef1bf62,0x3f7bbe48,0x3f463f22
.long 0xbf800000,0xbf35bf35,0xbf80,0x3f35bf35,0xbec43f6d,0xbf623ef1,0xbf7bbe48,0xbf22bf46
.long 0x3f353f35,0x3e483f7b,0xbec43f6d,0xbf553f0e,0x3f6dbec4,0x3f7f3dc9,0x3f553f0e,0x3ef13f62
.long 0xbf80,0x3ec4bf6d,0x3f35bf35,0x3f6dbec4,0xbf6dbec4,0xbf46bf22,0xbf0ebf55,0xbe95bf75
.long 0xbf353f35,0xbf553f0e,0xbf6d3ec4,0xbf7b3e48,0x3ec43f6d,0x3e953f75,0x3e483f7b,0x3dc93f7f
.long 0x3f80,0xbf800000,0xbf80,0x3f800000,0x3f800000,0x3dc93f7f,0xbf7b3e48,0xbe95bf75
.long 0xbf80,0x3f7bbe48,0x3ec43f6d,0xbf553f0e,0xbf800000,0xbe95bf75,0x3f55bf0e,0x3f463f22
.long 0x3f80,0xbf6d3ec4,0xbf35bf35,0x3ec4bf6d,0x3f800000,0x3ef13f62,0xbf0e3f55,0xbf7fbdc9
.long 0xbf80,0x3f55bf0e,0x3f6d3ec4,0x3e483f7b,0xbf800000,0xbf22bf46,0x3e48bf7b,0x3f62bef1
.long 0x3f80,0xbf353f35,0xbf800000,0xbf35bf35,0x3f800000,0x3f463f22,0x3e483f7b,0xbef13f62
.long 0xbf80,0x3f0ebf55,0x3f6dbec4,0x3f7b3e48,0xbf800000,0xbf62bef1,0xbf0ebf55,0xbdc9bf7f
.long 0x3f80,0xbec43f6d,0xbf353f35,0xbf6d3ec4,0x3f800000,0x3f753e95,0x3f553f0e,0x3f223f46
.long 0xbf80,0x3e48bf7b,0x3ec4bf6d,0x3f0ebf55,0xbf800000,0xbf7fbdc9,0xbf7bbe48,0xbf75be95
.long 0x3f80,0xbf800000,0xbf80,0x3f800000,0x3f6dbec4,0x3ef13f62,0xbf553f0e,0xbf22bf46
.long 0xbf35bf35,0x3f0ebf55,0x3f6d3ec4,0xbe483f7b,0xbec43f6d,0xbf7fbdc9,0xbe48bf7b,0x3f62bef1
.long 0x3f800000,0x3ec43f6d,0xbf353f35,0xbf6dbec4,0xbec4bf6d,0x3f22bf46,0x3f7b3e48,0x3e953f75
.long 0xbf353f35,0xbf7bbe48,0xbec4bf6d,0x3f0ebf55,0x3f6d3ec4,0x3e953f75,0xbf0e3f55,0xbf7f3dc9
.long 0xbf80,0x3f35bf35,0x3f800000,0x3f353f35,0xbf6d3ec4,0xbf75be95,0xbf0ebf55,0x3dc9bf7f
.long 0x3f353f35,0x3e483f7b,0xbec43f6d,0xbf553f0e,0x3ec4bf6d,0x3f46bf22,0x3f7bbe48,0x3f753e95
.long 0xbf800000,0xbf6dbec4,0xbf35bf35,0xbec4bf6d,0x3ec43f6d,0x3dc93f7f,0xbe483f7b,0xbef13f62
.long 0x3f35bf35,0x3f55bf0e,0x3f6dbec4,0x3f7bbe48,0xbf6dbec4,0xbf62bef1,0xbf55bf0e,0xbf46bf22
.long 0x3f80,0xbf800000,0xbf80,0x3f800000,0x3f35bf35,0x3f463f22,0xbf0e3f55,0xbf62bef1
.long 0xbf800000,0xbe48bf7b,0x3f6dbec4,0x3f0e3f55,0x3f353f35,0xbef13f62,0xbf7bbe48,0xbdc9bf7f
.long 0xbf80,0x3f6dbec4,0x3f353f35,0xbec43f6d,0xbf353f35,0xbf75be95,0xbe48bf7b,0x3f46bf22
.long 0x3f800000,0x3f0e3f55,0xbec43f6d,0xbf7b3e48,0xbf35bf35,0x3dc9bf7f,0x3f55bf0e,0x3f753e95
.long 0x3f80,0xbf353f35,0xbf800000,0xbf35bf35,0x3f35bf35,0x3f7fbdc9,0x3f553f0e,0x3e953f75
.long 0xbf800000,0xbf55bf0e,0xbec4bf6d,0x3e48bf7b,0x3f353f35,0x3e953f75,0xbe483f7b,0xbf223f46
.long 0xbf80,0x3ec4bf6d,0x3f35bf35,0x3f6dbec4,0xbf353f35,0xbf623ef1,0xbf7b3e48,0xbf7fbdc9
.long 0x3f800000,0x3f7b3e48,0x3f6d3ec4,0x3f553f0e,0xbf35bf35,0xbf22bf46,0xbf0ebf55,0xbef1bf62
.long 0x3f80,0xbf800000,0xbf80,0x3f800000,0x3ec4bf6d,0x3f753e95,0xbe483f7b,0xbf7fbdc9
.long 0xbf353f35,0xbf55bf0e,0x3ec4bf6d,0x3f7b3e48,0x3f6dbec4,0x3f223f46,0xbf0e3f55,0xbf75be95
.long 0xbf800000,0xbec4bf6d,0x3f35bf35,0x3f6d3ec4,0x3f6d3ec4,0x3dc93f7f,0xbf553f0e,0xbf62bef1
.long 0xbf35bf35,0x3e48bf7b,0x3f6dbec4,0x3f553f0e,0x3ec43f6d,0xbef13f62,0xbf7b3e48,0xbf46bf22
.long 0xbf80,0x3f35bf35,0x3f800000,0x3f353f35,0xbec43f6d,0xbf623ef1,0xbf7bbe48,0xbf22bf46
.long 0x3f35bf35,0x3f7bbe48,0x3f6d3ec4,0x3f0e3f55,0xbf6d3ec4,0xbf7fbdc9,0xbf55bf0e,0xbef1bf62
.long 0x3f800000,0x3f6d3ec4,0x3f353f35,0x3ec43f6d,0xbf6dbec4,0xbf46bf22,0xbf0ebf55,0xbe95bf75
.long 0x3f353f35,0x3f0e3f55,0x3ec43f6d,0x3e483f7b,0xbec4bf6d,0xbe95bf75,0xbe48bf7b,0xbdc9bf7f
.long 0x3f800000,0x3f80,0xbf800000,0xbf80,0xbf80,0x3f7fbdc9,0x3e483f7b,0xbf753e95
.long 0xbf800000,0xbe48bf7b,0x3f6dbec4,0x3f0e3f55,0x3f80,0xbf753e95,0xbf0ebf55,0x3f22bf46
.long 0x3f800000,0x3ec43f6d,0xbf353f35,0xbf6dbec4,0xbf80,0x3f62bef1,0x3f553f0e,0xbdc93f7f
.long 0xbf800000,0xbf0ebf55,0x3ec4bf6d,0x3f7bbe48,0x3f80,0xbf463f22,0xbf7bbe48,0xbef1bf62
.long 0x3f800000,0x3f353f35,0x3f80,0xbf353f35,0xbf80,0x3f22bf46,0x3f7bbe48,0x3f623ef1
.long 0xbf800000,0xbf55bf0e,0xbec4bf6d,0x3e48bf7b,0x3f80,0xbef13f62,0xbf553f0e,0xbf7f3dc9
.long 0x3f800000,0x3f6d3ec4,0x3f353f35,0x3ec43f6d,0xbf80,0x3e95bf75,0x3f0ebf55,0x3f46bf22
.long 0xbf800000,0xbf7bbe48,0xbf6dbec4,0xbf55bf0e,0x3f80,0xbdc93f7f,0xbe483f7b,0xbe953f75
.long 0x3f800000,0x3f80,0xbf800000,0xbf80,0xbec4bf6d,0x3f62bef1,0x3f0e3f55,0xbf463f22
.long 0xbf353f35,0xbf55bf0e,0x3ec4bf6d,0x3f7b3e48,0x3f6d3ec4,0xbdc93f7f,0xbf7b3e48,0xbef1bf62
.long 0xbf80,0x3f6dbec4,0x3f353f35,0xbec43f6d,0xbf6d3ec4,0xbf46bf22,0x3e48bf7b,0x3f75be95
.long 0x3f353f35,0xbe483f7b,0xbf6d3ec4,0xbf55bf0e,0x3ec4bf6d,0x3f75be95,0x3f553f0e,0x3dc93f7f
.long 0xbf800000,0xbf35bf35,0xbf80,0x3f35bf35,0x3ec43f6d,0xbe953f75,0xbf553f0e,0xbf7fbdc9
.long 0x3f35bf35,0x3f7bbe48,0x3f6d3ec4,0x3f0e3f55,0xbf6dbec4,0xbf22bf46,0xbe48bf7b,0x3e95bf75
.long 0x3f80,0xbec43f6d,0xbf353f35,0xbf6d3ec4,0x3f6dbec4,0x3f7fbdc9,0x3f7b3e48,0x3f623ef1
.long 0xbf35bf35,0xbf0ebf55,0xbec4bf6d,0xbe48bf7b,0xbec43f6d,0xbef13f62,0xbf0e3f55,0xbf223f46
.long 0x3f800000,0x3f80,0xbf800000,0xbf80,0xbf35bf35,0x3f22bf46,0x3f553f0e,0xbef13f62
.long 0x3f80,0xbf7b3e48,0xbec4bf6d,0x3f55bf0e,0x3f35bf35,0x3f623ef1,0xbe483f7b,0xbf7f3dc9
.long 0xbf800000,0xbec4bf6d,0x3f35bf35,0x3f6d3ec4,0x3f353f35,0xbe953f75,0xbf7b3e48,0xbf22bf46
.long 0xbf80,0x3f55bf0e,0x3f6d3ec4,0x3e483f7b,0xbf353f35,0xbf7fbdc9,0xbf0ebf55,0x3e95bf75
.long 0x3f800000,0x3f353f35,0x3f80,0xbf353f35,0xbf35bf35,0xbdc9bf7f,0x3f0ebf55,0x3f75be95
.long 0x3f80,0xbf0e3f55,0xbf6d3ec4,0xbf7bbe48,0x3f35bf35,0x3f75be95,0x3f7b3e48,0x3f463f22
.long 0xbf800000,0xbf6dbec4,0xbf35bf35,0xbec4bf6d,0x3f353f35,0x3ef13f62,0x3e483f7b,0xbdc93f7f
.long 0xbf80,0x3e48bf7b,0x3ec4bf6d,0x3f0ebf55,0xbf353f35,0xbf463f22,0xbf553f0e,0xbf623ef1
.long 0x3f800000,0x3f80,0xbf800000,0xbf80,0xbf6dbec4,0x3e95bf75,0x3f7b3e48,0xbdc93f7f
.long 0x3f353f35,0xbf0e3f55,0xbf6dbec4,0x3e48bf7b,0xbec4bf6d,0x3f46bf22,0x3f553f0e,0xbe953f75
.long 0x3f80,0xbf6d3ec4,0xbf35bf35,0x3ec4bf6d,0x3ec4bf6d,0x3f7fbdc9,0x3f0e3f55,0xbef13f62
.long 0xbf353f35,0xbf7bbe48,0xbec4bf6d,0x3f0ebf55,0x3f6dbec4,0x3f623ef1,0x3e483f7b,0xbf223f46
.long 0xbf800000,0xbf35bf35,0xbf80,0x3f35bf35,0x3f6d3ec4,0x3ef13f62,0xbe483f7b,0xbf463f22
.long 0xbf35bf35,0xbe48bf7b,0x3ec4bf6d,0x3f55bf0e,0x3ec43f6d,0xbdc93f7f,0xbf0e3f55,0xbf623ef1
.long 0xbf80,0x3ec4bf6d,0x3f35bf35,0x3f6dbec4,0xbec43f6d,0xbf223f46,0xbf553f0e,0xbf753e95
.long 0x3f35bf35,0x3f55bf0e,0x3f6dbec4,0x3f7bbe48,0xbf6d3ec4,0xbf753e95,0xbf7b3e48,0xbf7f3dc9
.long 0x3f80,0xbf800000,0xbf80,0x3f800000,0xbf80,0x3f7fbdc9,0x3e483f7b,0xbf753e95
.long 0x3f80,0xbf7b3e48,0xbec4bf6d,0x3f55bf0e,0xbf80,0x3f75be95,0x3f0e3f55,0xbf223f46
.long 0x3f80,0xbf6d3ec4,0xbf35bf35,0x3ec4bf6d,0xbf80,0x3f62bef1,0x3f553f0e,0xbdc93f7f
.long 0x3f80,0xbf553f0e,0xbf6dbec4,0xbe48bf7b,0xbf80,0x3f46bf22,0x3f7b3e48,0x3ef13f62
.long 0x3f80,0xbf353f35,0xbf800000,0xbf35bf35,0xbf80,0x3f22bf46,0x3f7bbe48,0x3f623ef1
.long 0x3f80,0xbf0e3f55,0xbf6d3ec4,0xbf7bbe48,0xbf80,0x3ef1bf62,0x3f55bf0e,0x3f7fbdc9
.long 0x3f80,0xbec43f6d,0xbf353f35,0xbf6d3ec4,0xbf80,0x3e95bf75,0x3f0ebf55,0x3f46bf22
.long 0x3f80,0xbe483f7b,0xbec43f6d,0xbf0e3f55,0xbf80,0x3dc9bf7f,0x3e48bf7b,0x3e95bf75
.long 0x3f80,0xbf800000,0xbf80,0x3f800000,0xbec4bf6d,0x3f62bef1,0x3f0e3f55,0xbf463f22
.long 0x3f353f35,0xbf0e3f55,0xbf6dbec4,0x3e48bf7b,0xbf6dbec4,0x3dc9bf7f,0x3f7bbe48,0x3ef13f62
.long 0x3f800000,0x3ec43f6d,0xbf353f35,0xbf6dbec4,0xbf6d3ec4,0xbf46bf22,0x3e48bf7b,0x3f75be95
.long 0x3f35bf35,0x3f7b3e48,0x3ec43f6d,0xbf0e3f55,0xbec43f6d,0xbf753e95,0xbf55bf0e,0xbdc9bf7f
.long 0xbf80,0x3f35bf35,0x3f800000,0x3f353f35,0x3ec43f6d,0xbe953f75,0xbf553f0e,0xbf7fbdc9
.long 0xbf35bf35,0xbe48bf7b,0x3ec4bf6d,0x3f55bf0e,0x3f6d3ec4,0x3f223f46,0x3e483f7b,0xbe953f75
.long 0xbf800000,0xbf6dbec4,0xbf35bf35,0xbec4bf6d,0x3f6dbec4,0x3f7fbdc9,0x3f7b3e48,0x3f623ef1
.long 0xbf353f35,0xbf553f0e,0xbf6d3ec4,0xbf7b3e48,0x3ec4bf6d,0x3ef1bf62,0x3f0ebf55,0x3f22bf46
.long 0x3f80,0xbf800000,0xbf80,0x3f800000,0xbf35bf35,0x3f22bf46,0x3f553f0e,0xbef13f62
.long 0x3f800000,0x3e483f7b,0xbf6d3ec4,0xbf0ebf55,0xbf353f35,0xbf62bef1,0x3e48bf7b,0x3f7fbdc9
.long 0xbf80,0x3f6dbec4,0x3f353f35,0xbec43f6d,0x3f353f35,0xbe953f75,0xbf7b3e48,0xbf22bf46
.long 0xbf800000,0xbf0ebf55,0x3ec4bf6d,0x3f7bbe48,0x3f35bf35,0x3f7f3dc9,0x3f0e3f55,0xbe953f75
.long 0x3f80,0xbf353f35,0xbf800000,0xbf35bf35,0xbf35bf35,0xbdc9bf7f,0x3f0ebf55,0x3f75be95
.long 0x3f800000,0x3f553f0e,0x3ec43f6d,0xbe483f7b,0xbf353f35,0xbf753e95,0xbf7bbe48,0xbf46bf22
.long 0xbf80,0x3ec4bf6d,0x3f35bf35,0x3f6dbec4,0x3f353f35,0x3ef13f62,0x3e483f7b,0xbdc93f7f
.long 0xbf800000,0xbf7bbe48,0xbf6dbec4,0xbf55bf0e,0x3f35bf35,0x3f46bf22,0x3f55bf0e,0x3f62bef1
.long 0x3f80,0xbf800000,0xbf80,0x3f800000,0xbf6dbec4,0x3e95bf75,0x3f7b3e48,0xbdc93f7f
.long 0x3f35bf35,0x3f553f0e,0xbec43f6d,0xbf7bbe48,0x3ec43f6d,0xbf463f22,0xbf55bf0e,0x3e95bf75
.long 0xbf800000,0xbec4bf6d,0x3f35bf35,0x3f6d3ec4,0x3ec4bf6d,0x3f7fbdc9,0x3f0e3f55,0xbef13f62
.long 0x3f353f35,0xbe483f7b,0xbf6d3ec4,0xbf55bf0e,0xbf6d3ec4,0xbf62bef1,0xbe48bf7b,0x3f22bf46
.long 0xbf80,0x3f35bf35,0x3f800000,0x3f353f35,0x3f6d3ec4,0x3ef13f62,0xbe483f7b,0xbf463f22
.long 0xbf353f35,0xbf7b3e48,0xbf6dbec4,0xbf0ebf55,0xbec4bf6d,0x3dc9bf7f,0x3f0ebf55,0x3f62bef1
.long 0x3f800000,0x3f6d3ec4,0x3f353f35,0x3ec43f6d,0xbec43f6d,0xbf223f46,0xbf553f0e,0xbf753e95
.long 0xbf35bf35,0xbf0ebf55,0xbec4bf6d,0xbe48bf7b,0x3f6dbec4,0x3f75be95,0x3f7bbe48,0x3f7fbdc9
.long 0x3f800000,0x3f80,0xbf800000,0xbf80,0xbf800000,0xbdc9bf7f,0x3f7bbe48,0x3e953f75
.long 0x3f800000,0x3e483f7b,0xbf6d3ec4,0xbf0ebf55,0xbf800000,0xbe95bf75,0x3f55bf0e,0x3f463f22
.long 0x3f800000,0x3ec43f6d,0xbf353f35,0xbf6dbec4,0xbf800000,0xbef1bf62,0x3f0ebf55,0x3f7f3dc9
.long 0x3f800000,0x3f0e3f55,0xbec43f6d,0xbf7b3e48,0xbf800000,0xbf22bf46,0x3e48bf7b,0x3f62bef1
.long 0x3f800000,0x3f353f35,0x3f80,0xbf353f35,0xbf800000,0xbf46bf22,0xbe48bf7b,0x3ef1bf62
.long 0x3f800000,0x3f553f0e,0x3ec43f6d,0xbe483f7b,0xbf800000,0xbf62bef1,0xbf0ebf55,0xbdc9bf7f
.long 0x3f800000,0x3f6d3ec4,0x3f353f35,0x3ec43f6d,0xbf800000,0xbf75be95,0xbf55bf0e,0xbf22bf46
.long 0x3f800000,0x3f7b3e48,0x3f6d3ec4,0x3f553f0e,0xbf800000,0xbf7fbdc9,0xbf7bbe48,0xbf75be95
.long 0x3f800000,0x3f80,0xbf800000,0xbf80,0xbf6d3ec4,0xbef1bf62,0x3f55bf0e,0x3f223f46
.long 0x3f35bf35,0x3f553f0e,0xbec43f6d,0xbf7bbe48,0xbec43f6d,0xbf7fbdc9,0xbe48bf7b,0x3f62bef1
.long 0xbf80,0x3f6dbec4,0x3f353f35,0xbec43f6d,0x3ec43f6d,0xbf223f46,0xbf7bbe48,0xbe95bf75
.long 0xbf35bf35,0x3e48bf7b,0x3f6dbec4,0x3f553f0e,0x3f6d3ec4,0x3e953f75,0xbf0e3f55,0xbf7f3dc9
.long 0xbf800000,0xbf35bf35,0xbf80,0x3f35bf35,0x3f6dbec4,0x3f753e95,0x3f0e3f55,0xbdc93f7f
.long 0xbf353f35,0xbf7b3e48,0xbf6dbec4,0xbf0ebf55,0x3ec4bf6d,0x3f46bf22,0x3f7bbe48,0x3f753e95
.long 0x3f80,0xbec43f6d,0xbf353f35,0xbf6d3ec4,0xbec4bf6d,0xbdc9bf7f,0x3e48bf7b,0x3ef1bf62
.long 0x3f353f35,0x3f0e3f55,0x3ec43f6d,0x3e483f7b,0xbf6dbec4,0xbf62bef1,0xbf55bf0e,0xbf46bf22
.long 0x3f800000,0x3f80,0xbf800000,0xbf80,0xbf353f35,0xbf46bf22,0x3f0ebf55,0x3f623ef1
.long 0xbf80,0x3f7bbe48,0x3ec43f6d,0xbf553f0e,0x3f353f35,0xbef13f62,0xbf7bbe48,0xbdc9bf7f
.long 0xbf800000,0xbec4bf6d,0x3f35bf35,0x3f6d3ec4,0x3f35bf35,0x3f753e95,0x3e483f7b,0xbf463f22
.long 0x3f80,0xbf553f0e,0xbf6dbec4,0xbe48bf7b,0xbf35bf35,0x3dc9bf7f,0x3f55bf0e,0x3f753e95
.long 0x3f800000,0x3f353f35,0x3f80,0xbf353f35,0xbf353f35,0xbf7f3dc9,0xbf55bf0e,0xbe95bf75
.long 0xbf80,0x3f0ebf55,0x3f6dbec4,0x3f7b3e48,0x3f353f35,0x3e953f75,0xbe483f7b,0xbf223f46
.long 0xbf800000,0xbf6dbec4,0xbf35bf35,0xbec4bf6d,0x3f35bf35,0x3f62bef1,0x3f7bbe48,0x3f7f3dc9
.long 0x3f80,0xbe483f7b,0xbec43f6d,0xbf0e3f55,0xbf35bf35,0xbf22bf46,0xbf0ebf55,0xbef1bf62
.long 0x3f800000,0x3f80,0xbf800000,0xbf80,0xbec43f6d,0xbf75be95,0x3e48bf7b,0x3f7f3dc9
.long 0xbf35bf35,0x3f0ebf55,0x3f6d3ec4,0xbe483f7b,0x3f6dbec4,0x3f223f46,0xbf0e3f55,0xbf75be95
.long 0x3f80,0xbf6d3ec4,0xbf35bf35,0x3ec4bf6d,0xbf6dbec4,0xbdc9bf7f,0x3f55bf0e,0x3f623ef1
.long 0x3f35bf35,0x3f7b3e48,0x3ec43f6d,0xbf0e3f55,0x3ec43f6d,0xbef13f62,0xbf7b3e48,0xbf46bf22
.long 0xbf800000,0xbf35bf35,0xbf80,0x3f35bf35,0x3ec4bf6d,0x3f62bef1,0x3f7b3e48,0x3f223f46
.long 0x3f353f35,0x3e483f7b,0xbec43f6d,0xbf553f0e,0xbf6d3ec4,0xbf7fbdc9,0xbf55bf0e,0xbef1bf62
.long 0xbf80,0x3ec4bf6d,0x3f35bf35,0x3f6dbec4,0x3f6d3ec4,0x3f463f22,0x3f0e3f55,0x3e953f75
.long 0xbf353f35,0xbf553f0e,0xbf6d3ec4,0xbf7b3e48,0xbec4bf6d,0xbe95bf75,0xbe48bf7b,0xbdc9bf7f
.long 0x3f80,0xbf800000,0xbf80,0x3f800000,0xbf800000,0xbdc9bf7f,0x3f7bbe48,0x3e953f75
.long 0xbf80,0x3f7bbe48,0x3ec43f6d,0xbf553f0e,0x3f800000,0x3e953f75,0xbf553f0e,0xbf46bf22
.long 0x3f80,0xbf6d3ec4,0xbf35bf35,0x3ec4bf6d,0xbf800000,0xbef1bf62,0x3f0ebf55,0x3f7f3dc9
.long 0xbf80,0x3f55bf0e,0x3f6d3ec4,0x3e483f7b,0x3f800000,0x3f223f46,0xbe483f7b,0xbf623ef1
.long 0x3f80,0xbf353f35,0xbf800000,0xbf35bf35,0xbf800000,0xbf46bf22,0xbe48bf7b,0x3ef1bf62
.long 0xbf80,0x3f0ebf55,0x3f6dbec4,0x3f7b3e48,0x3f800000,0x3f623ef1,0x3f0e3f55,0x3dc93f7f
.long 0x3f80,0xbec43f6d,0xbf353f35,0xbf6d3ec4,0xbf800000,0xbf75be95,0xbf55bf0e,0xbf22bf46
.long 0xbf80,0x3e48bf7b,0x3ec4bf6d,0x3f0ebf55,0x3f800000,0x3f7f3dc9,0x3f7b3e48,0x3f753e95
.long 0x3f80,0xbf800000,0xbf80,0x3f800000,0xbf6d3ec4,0xbef1bf62,0x3f55bf0e,0x3f223f46
.long 0xbf35bf35,0x3f0ebf55,0x3f6d3ec4,0xbe483f7b,0x3ec4bf6d,0x3f7f3dc9,0x3e483f7b,0xbf623ef1
.long 0x3f800000,0x3ec43f6d,0xbf353f35,0xbf6dbec4,0x3ec43f6d,0xbf223f46,0xbf7bbe48,0xbe95bf75
.long 0xbf353f35,0xbf7bbe48,0xbec4bf6d,0x3f0ebf55,0xbf6dbec4,0xbe95bf75,0x3f0ebf55,0x3f7fbdc9
.long 0xbf80,0x3f35bf35,0x3f800000,0x3f353f35,0x3f6dbec4,0x3f753e95,0x3f0e3f55,0xbdc93f7f
.long 0x3f353f35,0x3e483f7b,0xbec43f6d,0xbf553f0e,0xbec43f6d,0xbf463f22,0xbf7b3e48,0xbf75be95
.long 0xbf800000,0xbf6dbec4,0xbf35bf35,0xbec4bf6d,0xbec4bf6d,0xbdc9bf7f,0x3e48bf7b,0x3ef1bf62
.long 0x3f35bf35,0x3f55bf0e,0x3f6dbec4,0x3f7bbe48,0x3f6d3ec4,0x3f623ef1,0x3f553f0e,0x3f463f22
.long 0x3f80,0xbf800000,0xbf80,0x3f800000,0xbf353f35,0xbf46bf22,0x3f0ebf55,0x3f623ef1
.long 0xbf800000,0xbe48bf7b,0x3f6dbec4,0x3f0e3f55,0xbf35bf35,0x3ef1bf62,0x3f7b3e48,0x3dc93f7f
.long 0xbf80,0x3f6dbec4,0x3f353f35,0xbec43f6d,0x3f35bf35,0x3f753e95,0x3e483f7b,0xbf463f22
.long 0x3f800000,0x3f0e3f55,0xbec43f6d,0xbf7b3e48,0x3f353f35,0xbdc93f7f,0xbf553f0e,0xbf75be95
.long 0x3f80,0xbf353f35,0xbf800000,0xbf35bf35,0xbf353f35,0xbf7f3dc9,0xbf55bf0e,0xbe95bf75
.long 0xbf800000,0xbf55bf0e,0xbec4bf6d,0x3e48bf7b,0xbf35bf35,0xbe95bf75,0x3e48bf7b,0x3f22bf46
.long 0xbf80,0x3ec4bf6d,0x3f35bf35,0x3f6dbec4,0x3f35bf35,0x3f62bef1,0x3f7bbe48,0x3f7f3dc9
.long 0x3f800000,0x3f7b3e48,0x3f6d3ec4,0x3f553f0e,0x3f353f35,0x3f223f46,0x3f0e3f55,0x3ef13f62
.long 0x3f80,0xbf800000,0xbf80,0x3f800000,0xbec43f6d,0xbf75be95,0x3e48bf7b,0x3f7f3dc9
.long 0xbf353f35,0xbf55bf0e,0x3ec4bf6d,0x3f7b3e48,0xbf6d3ec4,0xbf22bf46,0x3f0ebf55,0x3f753e95
.long 0xbf800000,0xbec4bf6d,0x3f35bf35,0x3f6d3ec4,0xbf6dbec4,0xbdc9bf7f,0x3f55bf0e,0x3f623ef1
.long 0xbf35bf35,0x3e48bf7b,0x3f6dbec4,0x3f553f0e,0xbec4bf6d,0x3ef1bf62,0x3f7bbe48,0x3f463f22
.long 0xbf80,0x3f35bf35,0x3f800000,0x3f353f35,0x3ec4bf6d,0x3f62bef1,0x3f7b3e48,0x3f223f46
.long 0x3f35bf35,0x3f7bbe48,0x3f6d3ec4,0x3f0e3f55,0x3f6dbec4,0x3f7f3dc9,0x3f553f0e,0x3ef13f62
.long 0x3f800000,0x3f6d3ec4,0x3f353f35,0x3ec43f6d,0x3f6d3ec4,0x3f463f22,0x3f0e3f55,0x3e953f75
.long 0x3f353f35,0x3f0e3f55,0x3ec43f6d,0x3e483f7b,0x3ec43f6d,0x3e953f75,0x3e483f7b,0x3dc93f7f
.long 0x3f800000,0x3f80,0xbf800000,0xbf80,0x3f80,0xbf7f3dc9,0xbe48bf7b,0x3f75be95
.long 0xbf800000,0xbe48bf7b,0x3f6dbec4,0x3f0e3f55,0xbf80,0x3f75be95,0x3f0e3f55,0xbf223f46
.long 0x3f800000,0x3ec43f6d,0xbf353f35,0xbf6dbec4,0x3f80,0xbf623ef1,0xbf55bf0e,0x3dc9bf7f
.long 0xbf800000,0xbf0ebf55,0x3ec4bf6d,0x3f7bbe48,0xbf80,0x3f46bf22,0x3f7b3e48,0x3ef13f62
.long 0x3f800000,0x3f353f35,0x3f80,0xbf353f35,0x3f80,0xbf223f46,0xbf7b3e48,0xbf62bef1
.long 0xbf800000,0xbf55bf0e,0xbec4bf6d,0x3e48bf7b,0xbf80,0x3ef1bf62,0x3f55bf0e,0x3f7fbdc9
.long 0x3f800000,0x3f6d3ec4,0x3f353f35,0x3ec43f6d,0x3f80,0xbe953f75,0xbf0e3f55,0xbf463f22
.long 0xbf800000,0xbf7bbe48,0xbf6dbec4,0xbf55bf0e,0xbf80,0x3dc9bf7f,0x3e48bf7b,0x3e95bf75
.long 0x3f800000,0x3f80,0xbf800000,0xbf80,0x3ec43f6d,0xbf623ef1,0xbf0ebf55,0x3f46bf22
.long 0xbf353f35,0xbf55bf0e,0x3ec4bf6d,0x3f7b3e48,0xbf6dbec4,0x3dc9bf7f,0x3f7bbe48,0x3ef13f62
.long 0xbf80,0x3f6dbec4,0x3f353f35,0xbec43f6d,0x3f6dbec4,0x3f463f22,0xbe483f7b,0xbf753e95
.long 0x3f353f35,0xbe483f7b,0xbf6d3ec4,0xbf55bf0e,0xbec43f6d,0xbf753e95,0xbf55bf0e,0xbdc9bf7f
.long 0xbf800000,0xbf35bf35,0xbf80,0x3f35bf35,0xbec4bf6d,0x3e95bf75,0x3f55bf0e,0x3f7f3dc9
.long 0x3f35bf35,0x3f7bbe48,0x3f6d3ec4,0x3f0e3f55,0x3f6d3ec4,0x3f223f46,0x3e483f7b,0xbe953f75
.long 0x3f80,0xbec43f6d,0xbf353f35,0xbf6d3ec4,0xbf6d3ec4,0xbf7f3dc9,0xbf7bbe48,0xbf62bef1
.long 0xbf35bf35,0xbf0ebf55,0xbec4bf6d,0xbe48bf7b,0x3ec4bf6d,0x3ef1bf62,0x3f0ebf55,0x3f22bf46
.long 0x3f800000,0x3f80,0xbf800000,0xbf80,0x3f353f35,0xbf223f46,0xbf55bf0e,0x3ef1bf62
.long 0x3f80,0xbf7b3e48,0xbec4bf6d,0x3f55bf0e,0xbf353f35,0xbf62bef1,0x3e48bf7b,0x3f7fbdc9
.long 0xbf800000,0xbec4bf6d,0x3f35bf35,0x3f6d3ec4,0xbf35bf35,0x3e95bf75,0x3f7bbe48,0x3f223f46
.long 0xbf80,0x3f55bf0e,0x3f6d3ec4,0x3e483f7b,0x3f35bf35,0x3f7f3dc9,0x3f0e3f55,0xbe953f75
.long 0x3f800000,0x3f353f35,0x3f80,0xbf353f35,0x3f353f35,0x3dc93f7f,0xbf0e3f55,0xbf753e95
.long 0x3f80,0xbf0e3f55,0xbf6d3ec4,0xbf7bbe48,0xbf353f35,0xbf753e95,0xbf7bbe48,0xbf46bf22
.long 0xbf800000,0xbf6dbec4,0xbf35bf35,0xbec4bf6d,0xbf35bf35,0xbef1bf62,0xbe48bf7b,0x3dc9bf7f
.long 0xbf80,0x3e48bf7b,0x3ec4bf6d,0x3f0ebf55,0x3f35bf35,0x3f46bf22,0x3f55bf0e,0x3f62bef1
.long 0x3f800000,0x3f80,0xbf800000,0xbf80,0x3f6d3ec4,0xbe953f75,0xbf7bbe48,0x3dc9bf7f
.long 0x3f353f35,0xbf0e3f55,0xbf6dbec4,0x3e48bf7b,0x3ec43f6d,0xbf463f22,0xbf55bf0e,0x3e95bf75
.long 0x3f80,0xbf6d3ec4,0xbf35bf35,0x3ec4bf6d,0xbec43f6d,0xbf7f3dc9,0xbf0ebf55,0x3ef1bf62
.long 0xbf353f35,0xbf7bbe48,0xbec4bf6d,0x3f0ebf55,0xbf6d3ec4,0xbf62bef1,0xbe48bf7b,0x3f22bf46
.long 0xbf800000,0xbf35bf35,0xbf80,0x3f35bf35,0xbf6dbec4,0xbef1bf62,0x3e48bf7b,0x3f46bf22
.long 0xbf35bf35,0xbe48bf7b,0x3ec4bf6d,0x3f55bf0e,0xbec4bf6d,0x3dc9bf7f,0x3f0ebf55,0x3f62bef1
.long 0xbf80,0x3ec4bf6d,0x3f35bf35,0x3f6dbec4,0x3ec4bf6d,0x3f22bf46,0x3f55bf0e,0x3f75be95
.long 0x3f35bf35,0x3f55bf0e,0x3f6dbec4,0x3f7bbe48,0x3f6dbec4,0x3f75be95,0x3f7bbe48,0x3f7fbdc9
.long 0x3f800000,0x3f7d3aac,0x3f74fa0b,0x3f676bd8,0x3f800000,0x3f7d1cdd,0x3f748422,0x3f666771
.long 0x3f800000,0x3f7cfe73,0x3f740bdd,0x3f655e0b,0x3f800000,0x3f7cdf6c,0x3f73913f,0x3f644fac
.long 0x3f800000,0x3f7cbfc9,0x3f731447,0x3f633c5a,0x3f800000,0x3f7c9f8a,0x3f7294f8,0x3f62241a
.long 0x3f800000,0x3f7c7eb0,0x3f721352,0x3f6106f2,0x3f800000,0x3f7c5d3a,0x3f718f57,0x3f5fe4e9
.long 0x3f800000,0x3f7c3b28,0x3f710908,0x3f5ebe05,0x3f800000,0x3f7c187a,0x3f708066,0x3f5d924d
.long 0x3f800000,0x3f7bf531,0x3f6ff573,0x3f5c61c7,0x3f800000,0x3f7bd14d,0x3f6f6830,0x3f5b2c79
.long 0x3f800000,0x3f7baccd,0x3f6ed89e,0x3f59f26a,0x3f800000,0x3f7b87b2,0x3f6e46be,0x3f58b3a1
.long 0x3f800000,0x3f7b61fc,0x3f6db293,0x3f577026,0x3f800000,0x3f7b3bab,0x3f6d1c1d,0x3f5627fe
.long 0x3f54db31,0x3f3daef9,0x3f226799,0x3f039c3d,0x3f531849,0x3f3b0629,0x3f1ebc12,0x3efdbabb
.long 0x3f514d3d,0x3f385216,0x3f1b02c6,0x3ef41f07,0x3f4f7a1f,0x3f3592e7,0x3f173c07,0x3eea6681
.long 0x3f4d9f02,0x3f32c8c9,0x3f13682a,0x3ee0924f,0x3f4bbbf8,0x3f2ff3e6,0x3f0f8784,0x3ed6a399
.long 0x3f49d112,0x3f2d1469,0x3f0b9a6b,0x3ecc9b8b,0x3f47de65,0x3f2a2a80,0x3f07a136,0x3ec27b55
.long 0x3f45e403,0x3f273656,0x3f039c3d,0x3eb8442a,0x3f43e200,0x3f24381a,0x3eff17b2,0x3eadf73c
.long 0x3f41d870,0x3f212ff9,0x3ef6e0cb,0x3ea395c5,0x3f3fc767,0x3f1e1e22,0x3eee9479,0x3e9920fe
.long 0x3f3daef9,0x3f1b02c6,0x3ee63375,0x3e8e9a22,0x3f3b8f3b,0x3f17de12,0x3eddbe79,0x3e840270
.long 0x3f396842,0x3f14b039,0x3ed53641,0x3e72b651,0x3f373a23,0x3f11796b,0x3ecc9b8b,0x3e5d4b1a
.long 0x3ec3ef15,0x3e78cfcc,0x3dc8bd36,0xbd48fb30,0x3eb8442a,0x3e5d4b1a,0x3d8a200a,0xbda973ba
.long 0x3eac7cd4,0x3e419b37,0x3d16c32c,0xbdee3876,0x3ea09ae5,0x3e25c58c,0x3bc90f88,0xbe195be0
.long 0x3e94a031,0x3e09cf86,0xbcc90ab0,0xbe3b6ecf,0x3e888e93,0x3ddb7d37,0xbd621469,0xbe5d4b1a
.long 0x3e78cfcc,0x3da3308c,0xbdafb680,0xbe7ee6e1,0x3e605c13,0x3d55880e,0xbdee3876,0xbe901c2c
.long 0x3e47c5c2,0x3cc90ab0,0xbe164083,0xbea09ae5,0x3e2f10a2,0xbb490fc6,0xbe354098,0xbeb0eacb
.long 0x3e164083,0xbcfb49ba,0xbe541501,0xbec1071e,0x3dfab273,0xbd6ea038,0xbe72b651,0xbed0eb2a
.long 0x3dc8bd36,0xbdafb680,0xbe888e93,0xbee0924f,0x3d96a905,0xbde7fa9a,0xbe97a117,0xbeeff7fb
.long 0x3d48fb30,0xbe1008b7,0xbea68f12,0xbeff17b2,0x3cc90ab0,0xbe2bf804,0xbeb554ec,0xbf06f686
.long 0xbe47c5c2,0xbeac7cd4,0xbef15aea,0xbf187fc0,0xbe6c9a7f,0xbebf926f,0xbf0242b1,0xbf21cbfb
.long 0xbe888e93,0xbed25a09,0xbf0b9a6b,0xbf2ac082,0xbe9aa086,0xbee4cbfe,0xbf14b039,0xbf33587a
.long 0xbeac7cd4,0xbef6e0cb,0xbf1d7fd1,0xbf3b8f3b,0xbebe1d4a,0xbf044889,0xbf26050a,0xbf436051
.long 0xbecf7bca,0xbf0cead0,0xbf2e3bde,0xbf4ac77f,0xbee0924f,0xbf1553b7,0xbf36206c,0xbf51c0c2
.long 0xbef15aea,0xbf1d7fd1,0xbf3daef9,0xbf584853,0xbf00e7e4,0xbf256bcb,0xbf44e3f5,0xbf5e5aa6
.long 0xbf08f59b,0xbf2d1469,0xbf4bbbf8,0xbf63f473,0xbf10d3cd,0xbf34768f,0xbf5233c6,0xbf6912ae
.long 0xbf187fc0,0xbf3b8f3b,0xbf584853,0xbf6db293,0xbf1ff6cb,0xbf425b89,0xbf5df6be,0xbf71d19f
.long 0xbf273656,0xbf48d8b3,0xbf633c5a,0xbf756d97,0xbf2e3bde,0xbf4f0417,0xbf6816a8,0xbf788486
.long 0xbf3504f3,0xbf4d9f02,0xbf61c598,0xbf710908,0xbf3daef9,0xbf554aa4,0xbf6816a8,0xbf75a67b
.long 0xbf45e403,0xbf5c61c7,0xbf6db293,0xbf796e4e,0xbf4d9f02,0xbf62df7b,0xbf7294f8,0xbf7c5d3a
.long 0xbf54db31,0xbf68bf3c,0xbf76ba07,0xbf7e70b0,0xbf5b941a,0xbf6dfcf2,0xbf7a1e84,0xbf7fa6e3
.long 0xbf61c598,0xbf7294f8,0xbf7cbfc9,0xbf7ffec4,0xbf676bd8,0xbf76841b,0xbf7e9bc9,0xbf7f7808
.long 0xbf6c835e,0xbf79c79d,0xbf7fb10f,0xbf7e1324,0xbf710908,0xbf7c5d3a,0xbf7ffec4,0xbf7bd14d
.long 0xbf74fa0b,0xbf7e4323,0xbf7f84ab,0xbf78b47b,0xbf7853f8,0xbf7f7808,0xbf7e4323,0xbf74bf62
.long 0xbf7b14be,0xbf7ffb11,0xbf7c3b28,0xbf6ff573,0xbf7d3aac,0xbf7fcbe2,0xbf796e4e,0xbf6a5ad9
.long 0xbf7ec46d,0xbf7eea9d,0xbf75dec6,0xbf63f473,0xbf7fb10f,0xbf7d57de,0xbf718f57,0xbf5cc7d1
.long 0xbf7b14be,0xbf7fb10f,0xbf7ec46d,0xbf7853f8,0xbf7dabcc,0xbf7ff84a,0xbf7c7eb0,0xbf73530e
.long 0xbf7f4e6d,0xbf7f2f9d,0xbf791298,0xbf6d1c1d,0xbf7ffb11,0xbf7d57de,0xbf748422,0xbf65b710
.long 0xbf7fb10f,0xbf7a7302,0xbf6ed89e,0xbf5d2d53,0xbf7e70b0,0xbf76841b,0xbf6816a8,0xbf5389c7
.long 0xbf7c3b28,0xbf718f57,0xbf604621,0xbf48d8b3,0xbf791298,0xbf6b99fb,0xbf577026,0xbf3d27b8
.long 0xbf74fa0b,0xbf64aa59,0xbf4d9f02,0xbf3085bb,0xbf6ff573,0xbf5cc7d1,0xbf42de29,0xbf2302d3
.long 0xbf6a09a7,0xbf53fac3,0xbf373a23,0xbf14b039,0xbf633c5a,0xbf4a4c87,0xbf2ac082,0xbf05a02c
.long 0xbf5b941a,0xbf3fc767,0xbf1d7fd1,0xbeebcbbb,0xbf531849,0xbf34768f,0xbf0f8784,0xbecb2aae
.long 0xbf49d112,0xbf286605,0xbf00e7e4,0xbea986c4,0xbf3fc767,0xbf1ba299,0xbee363fa,0xbe870ada
.long 0xbf6c835e,0xbf5b941a,0xbf45e403,0xbf2beb4a,0xbf64aa59,0xbf50d937,0xbf385216,0xbf1ba299
.long 0xbf5b941a,0xbf44e3f5,0xbf299415,0xbf0a48ad,0xbf514d3d,0xbf37c655,0xbf19c200,0xbeeff7fb
.long 0xbf45e403,0xbf299415,0xbf08f59b,0xbec9b953,0xbf396842,0xbf1a6293,0xbeee9479,0xbea21887
.long 0xbf2beb4a,0xbf0a48ad,0xbec9b953,0xbe72b651,0xbf1d7fd1,0xbef2bd43,0xbea395c5,0xbe1f917b
.long 0xbf0e39da,0xbecf7bca,0xbe78cfcc,0xbd96a905,0xbefc5d27,0xbeab0201,0xbe28defc,0x3c16cb58
.long 0xbedae880,0xbe8586ce,0xbdafb680,0x3dbc3ac3,0xbeb8442a,0xbe3e853e,0xbbc90f88,0x3e3228d4
.long 0xbe94a031,0xbde1bc2e,0x3d96a905,0x3e827dc0,0xbe605c13,0xbd0a342f,0x3e1c76de,0x3eab0201
.long 0xbe164083,0x3d2fe007,0x3e6c9a7f,0x3ed25a09,0xbd96a905,0x3df475c0,0x3e9d9e78,0x3ef840c8
.long 0xbf0e39da,0xbedae880,0xbe94a031,0xbe164083,0xbef6e0cb,0xbeb0eacb,0xbe4dee60,0xbd55880e
.long 0xbecf7bca,0xbe8586ce,0xbde1bc2e,0x3d2fe007,0xbea68f12,0xbe3228d4,0xbc96c9b6,0x3e0cec4a
.long 0xbe78cfcc,0xbdafb680,0x3d96a905,0x3e6c9a7f,0xbe22abb6,0x3b490fc6,0x3e28defc,0x3ea5129f
.long 0xbd96a905,0x3dbc3ac3,0x3e827dc0,0x3ed25a09,0x3c490e90,0x3e3857ec,0x3eaf713a,0x3efdbabb
.long 0x3dc8bd36,0x3e888e93,0x3edae880,0x3f13682a,0x3e3b6ecf,0x3eb3dca5,0x3f0242b1,0x3f269de3
.long 0x3e888e93,0x3eddbe79,0x3f15f6d9,0x3f385216,0x3eb263ef,0x3f02ef9f,0x3f286605,0x3f485bca
.long 0x3edae880,0x3f15f6d9,0x3f396842,0x3f5695e5,0x3f00e7e4,0x3f27ce61,0x3f48d8b3,0x3f62df7b
.long 0x3f13682a,0x3f385216,0x3f5695e5,0x3f6d1c1d,0x3f24d225,0x3f476085,0x3f628210,0x3f75341d
.long 0x0,0xbe164083,0xbe94a031,0xbedae880,0x0,0xbe195be0,0xbe97a117,0xbedf28a9
.long 0x0,0xbe1c76de,0xbe9aa086,0xbee363fa,0x0,0xbe1f917b,0xbe9d9e78,0xbee79a5d
.long 0x0,0xbe22abb6,0xbea09ae5,0xbeebcbbb,0x0,0xbe25c58c,0xbea395c5,0xbeeff7fb
.long 0x0,0xbe28defc,0xbea68f12,0xbef41f07,0x0,0xbe2bf804,0xbea986c4,0xbef840c8
.long 0x0,0xbe2f10a2,0xbeac7cd4,0xbefc5d27,0x0,0xbe3228d4,0xbeaf713a,0xbf003a06
.long 0x0,0xbe354098,0xbeb263ef,0xbf0242b1,0x0,0xbe3857ec,0xbeb554ec,0xbf044889
.long 0x0,0xbe3b6ecf,0xbeb8442a,0xbf064b82,0x0,0xbe3e853e,0xbebb31a0,0xbf084b92
.long 0x0,0xbe419b37,0xbebe1d4a,0xbf0a48ad,0x0,0xbe44b0b9,0xbec1071e,0xbf0c42c9
.long 0xbf0e39da,0xbf2beb4a,0xbf45e403,0xbf5b941a,0xbf10d3cd,0xbf2ecef7,0xbf48d8b3,0xbf5e5aa6
.long 0xbf13682a,0xbf31a81d,0xbf4bbbf8,0xbf6106f2,0xbf15f6d9,0xbf34768f,0xbf4e8d90,0xbf6398ac
.long 0xbf187fc0,0xbf373a23,0xbf514d3d,0xbf660f88,0xbf1b02c6,0xbf39f2ac,0xbf53fac3,0xbf686b39
.long 0xbf1d7fd1,0xbf3ca003,0xbf5695e5,0xbf6aab7b,0xbf1ff6cb,0xbf3f41fc,0xbf591e6a,0xbf6cd007
.long 0xbf226799,0xbf41d870,0xbf5b941a,0xbf6ed89e,0xbf24d225,0xbf446337,0xbf5df6be,0xbf70c501
.long 0xbf273656,0xbf46e22a,0xbf604621,0xbf7294f8,0xbf299415,0xbf495521,0xbf628210,0xbf74484b
.long 0xbf2beb4a,0xbf4bbbf8,0xbf64aa59,0xbf75dec6,0xbf2e3bde,0xbf4e1689,0xbf66becc,0xbf77583a
.long 0xbf3085bb,0xbf5064af,0xbf68bf3c,0xbf78b47b,0xbf32c8c9,0xbf52a649,0xbf6aab7b,0xbf79f35e
.long 0xbf6c835e,0xbf7853f8,0xbf7ec46d,0xbf7fb10f,0xbf6ed89e,0xbf79f35e,0xbf7f6ac7,0xbf7f1f49
.long 0xbf710908,0xbf7b61fc,0xbf7fd397,0xbf7e4323,0xbf731447,0xbf7c9f8a,0xbf7ffec4,0xbf7d1cdd
.long 0xbf74fa0b,0xbf7dabcc,0xbf7fec43,0xbf7baccd,0xbf76ba07,0xbf7e868b,0xbf7f9c18,0xbf79f35e
.long 0xbf7853f8,0xbf7f2f9d,0xbf7f0e58,0xbf77f110,0xbf79c79d,0xbf7fa6e3,0xbf7e4323,0xbf75a67b
.long 0xbf7b14be,0xbf7fec43,0xbf7d3aac,0xbf731447,0xbf7c3b28,0xbf7fffb1,0xbf7bf531,0xbf703b37
.long 0xbf7d3aac,0xbf7fe129,0xbf7a7302,0xbf6d1c1d,0xbf7e1324,0xbf7f90b1,0xbf78b47b,0xbf69b7e4
.long 0xbf7ec46d,0xbf7f0e58,0xbf76ba07,0xbf660f88,0xbf7f4e6d,0xbf7e5a38,0xbf748422,0xbf62241a
.long 0xbf7fb10f,0xbf7d7474,0xbf721352,0xbf5df6be,0xbf7fec43,0xbf7c5d3a,0xbf6f6830,0xbf5988ad
.long 0xbf7b14be,0xbf710908,0xbf61c598,0xbf4d9f02,0xbf791298,0xbf6d67a1,0xbf5c61c7,0xbf466354
.long 0xbf76ba07,0xbf696591,0xbf5695e5,0xbf3ebc1b,0xbf740bdd,0xbf650479,0xbf5064af,0xbf36ad7f
.long 0xbf710908,0xbf604621,0xbf49d112,0xbf2e3bde,0xbf6db293,0xbf5b2c79,0xbf42de29,0xbf256bcb
.long 0xbf6a09a7,0xbf55b993,0xbf3b8f3b,0xbf1c420c,0xbf660f88,0xbf4fefa8,0xbf33e7bc,0xbf12c39a
.long 0xbf61c598,0xbf49d112,0xbf2beb4a,0xbf08f59b,0xbf5d2d53,0xbf436051,0xbf239da9,0xbefdbabb
.long 0xbf584853,0xbf3ca003,0xbf1b02c6,0xbee900b7,0xbf531849,0xbf3592e7,0xbf121eb0,0xbed3c867
.long 0xbf4d9f02,0xbf2e3bde,0xbf08f59b,0xbebe1d4a,0xbf47de65,0xbf269de3,0xbeff17b2,0xbea80b1f
.long 0xbf41d870,0xbf1ebc12,0xbeebcbbb,0xbe919ddd,0xbf3b8f3b,0xbf16999f,0xbed8106b,0xbe75c35a
.long 0xbf3504f3,0xbf187fc0,0xbef15aea,0xbeac7cd4,0xbf2beb4a,0xbf0d9281,0xbed8106b,0xbe901c2c
.long 0xbf226799,0xbf0242b1,0xbebe1d4a,0xbe667c66,0xbf187fc0,0xbeed3063,0xbea395c5,0xbe2bf804
.long 0xbf0e39da,0xbed53641,0xbe888e93,0xbde1bc2e,0xbf039c3d,0xbebca7af,0xbe5a3997,0xbd55880e
.long 0xbef15aea,0xbea395c5,0xbe22abb6,0x3bc90f88,0xbedae880,0xbe8a11f7,0xbdd53db9,0x3d83db0a
.long 0xbec3ef15,0xbe605c13,0xbd48fb30,0x3dfab273,0xbeac7cd4,0xbe2bf804,0x3bc90f88,0x3e3857ec
.long 0xbe94a031,0xbdee3876,0x3d7b2b74,0x3e72b651,0xbe78cfcc,0xbd83db0a,0x3dee3876,0x3e9620d2
.long 0xbe47c5c2,0xbc490e90,0x3e2f10a2,0x3eb263ef,0xbe164083,0x3d2351cb,0x3e667c66,0x3ece0bea
.long 0xbdc8bd36,0x3dbc3ac3,0x3e8e9a22,0x3ee900b7,0xbd48fb30,0x3e1324ca,0x3ea986c4,0x3f019573
.long 0xbe47c5c2,0xbd48fb30,0x3dc8bd36,0x3e78cfcc,0xbe09cf86,0x3c7b514b,0x3e28defc,0x3e9f1cdf
.long 0xbd96a905,0x3da3308c,0x3e6c9a7f,0x3ec1071e,0xbc490e90,0x3e1324ca,0x3e97a117,0x3ee1fb6a
.long 0x3d48fb30,0x3e541501,0x3eb8442a,0x3f00e7e4,0x3de1bc2e,0x3e8a11f7,0x3ed8106b,0x3f102dd5
.long 0x3e2f10a2,0x3ea986c4,0x3ef6e0cb,0x3f1ebc12,0x3e6c9a7f,0x3ec8477c,0x3f0a48ad,0x3f2c800f
.long 0x3e94a031,0x3ee63375,0x3f187fc0,0x3f396842,0x3eb263ef,0x3f019573,0x3f26050a,0x3f456439
.long 0x3ecf7bca,0x3f0f8784,0x3f32c8c9,0x3f5064af,0x3eebcbbb,0x3f1ce11f,0x3f3ebc1b,0x3f5a5ba0
.long 0x3f039c3d,0x3f299415,0x3f49d112,0x3f633c5a,0x3f10d3cd,0x3f3592e7,0x3f53fac3,0x3f6afb8c
.long 0x3f1d7fd1,0x3f40d0da,0x3f5d2d53,0x3f718f57,0x3f299415,0x3f4b41fa,0x3f655e0b,0x3f76ef5b
.long 0x3ec3ef15,0x3f039c3d,0x3f226799,0x3f3daef9,0x3ee63375,0x3f140c5f,0x3f31a81d,0x3f4b41fa
.long 0x3f039c3d,0x3f239da9,0x3f3fc767,0x3f577026,0x3f13682a,0x3f3238aa,0x3f4cae79,0x3f62241a
.long 0x3f226799,0x3f3fc767,0x3f584853,0x3f6b4b0c,0x3f3085bb,0x3f4c3578,0x3f628210,0x3f72d4eb
.long 0x3f3daef9,0x3f577026,0x3f6b4b0c,0x3f78b47b,0x3f49d112,0x3f61668a,0x3f7294f8,0x3f7cdf6c
.long 0x3f54db31,0x3f6a09a7,0x3f7853f8,0x3f7f4e6d,0x3f5ebe05,0x3f714c7a,0x3f7c7eb0,0x3f7ffd39
.long 0x3f676bd8,0x3f772417,0x3f7f0e58,0x3f7eea9d,0x3f6ed89e,0x3f7b87b2,0x3f7ffec4,0x3f7c187a
.long 0x3f74fa0b,0x3f7e70b0,0x3f7f4e6d,0x3f778bc5,0x3f79c79d,0x3f7fdaaf,0x3f7cfe73,0x3f714c7a
.long 0x3f7d3aac,0x3f7fc38f,0x3f791298,0x3f696591,0x3f7f4e6d,0x3f7e2b72,0x3f73913f,0x3f5fe4e9
.long 0x3f54db31,0x3f676bd8,0x3f74fa0b,0x3f7d3aac,0x3f604621,0x3f703b37,0x3f7ac516,0x3f7fa6e3
.long 0x3f6a09a7,0x3f772417,0x3f7e70b0,0x3f7fc38f,0x3f721352,0x3f7c187a,0x3f7ff4e6,0x3f7d906e
.long 0x3f7853f8,0x3f7f0e58,0x3f7f4e6d,0x3f791298,0x3f7cbfc9,0x3f7fffb1,0x3f7c7eb0,0x3f725470
.long 0x3f7f4e6d,0x3f7eea9d,0x3f778bc5,0x3f696591,0x3f7ffb11,0x3f7bd14d,0x3f708066,0x3f5e5aa6
.long 0x3f7ec46d,0x3f76ba07,0x3f676bd8,0x3f514d3d,0x3f7baccd,0x3f6faf1b,0x3f5c61c7,0x3f425b89
.long 0x3f76ba07,0x3f66becc,0x3f4f7a1f,0x3f31a81d,0x3f6ff573,0x3f5bfb34,0x3f40d0da,0x3f1f599f
.long 0x3f676bd8,0x3f4f7a1f,0x3f3085bb,0x3f0b9a6b,0x3f5d2d53,0x3f4154e1,0x3f1ebc12,0x3eed3063
.long 0x3f514d3d,0x3f31a81d,0x3f0b9a6b,0x3ec1071e,0x3f43e200,0x3f209393,0x3eee9479,0x3e931f35
.long 0x3f800000,0x3f800000,0x3f800000,0x3f800000,0x3f7d3aac,0x3f7d1cdd,0x3f7cfe73,0x3f7cdf6c
.long 0x3f74fa0b,0x3f748422,0x3f740bdd,0x3f73913f,0x3f676bd8,0x3f666771,0x3f655e0b,0x3f644fac
.long 0x3f54db31,0x3f531849,0x3f514d3d,0x3f4f7a1f,0x3f3daef9,0x3f3b0629,0x3f385216,0x3f3592e7
.long 0x3f226799,0x3f1ebc12,0x3f1b02c6,0x3f173c07,0x3f039c3d,0x3efdbabb,0x3ef41f07,0x3eea6681
.long 0x3ec3ef15,0x3eb8442a,0x3eac7cd4,0x3ea09ae5,0x3e78cfcc,0x3e5d4b1a,0x3e419b37,0x3e25c58c
.long 0x3dc8bd36,0x3d8a200a,0x3d16c32c,0x3bc90f88,0xbd48fb30,0xbda973ba,0xbdee3876,0xbe195be0
.long 0xbe47c5c2,0xbe6c9a7f,0xbe888e93,0xbe9aa086,0xbeac7cd4,0xbebf926f,0xbed25a09,0xbee4cbfe
.long 0xbef15aea,0xbf0242b1,0xbf0b9a6b,0xbf14b039,0xbf187fc0,0xbf21cbfb,0xbf2ac082,0xbf33587a
.long 0x3f800000,0x3f800000,0x3f800000,0x3f800000,0x3f7cbfc9,0x3f7c9f8a,0x3f7c7eb0,0x3f7c5d3a
.long 0x3f731447,0x3f7294f8,0x3f721352,0x3f718f57,0x3f633c5a,0x3f62241a,0x3f6106f2,0x3f5fe4e9
.long 0x3f4d9f02,0x3f4bbbf8,0x3f49d112,0x3f47de65,0x3f32c8c9,0x3f2ff3e6,0x3f2d1469,0x3f2a2a80
.long 0x3f13682a,0x3f0f8784,0x3f0b9a6b,0x3f07a136,0x3ee0924f,0x3ed6a399,0x3ecc9b8b,0x3ec27b55
.long 0x3e94a031,0x3e888e93,0x3e78cfcc,0x3e605c13,0x3e09cf86,0x3ddb7d37,0x3da3308c,0x3d55880e
.long 0xbcc90ab0,0xbd621469,0xbdafb680,0xbdee3876,0xbe3b6ecf,0xbe5d4b1a,0xbe7ee6e1,0xbe901c2c
.long 0xbeac7cd4,0xbebe1d4a,0xbecf7bca,0xbee0924f,0xbef6e0cb,0xbf044889,0xbf0cead0,0xbf1553b7
.long 0xbf1d7fd1,0xbf26050a,0xbf2e3bde,0xbf36206c,0xbf3b8f3b,0xbf436051,0xbf4ac77f,0xbf51c0c2
.long 0x3f800000,0x3f800000,0x3f800000,0x3f800000,0x3f7c3b28,0x3f7c187a,0x3f7bf531,0x3f7bd14d
.long 0x3f710908,0x3f708066,0x3f6ff573,0x3f6f6830,0x3f5ebe05,0x3f5d924d,0x3f5c61c7,0x3f5b2c79
.long 0x3f45e403,0x3f43e200,0x3f41d870,0x3f3fc767,0x3f273656,0x3f24381a,0x3f212ff9,0x3f1e1e22
.long 0x3f039c3d,0x3eff17b2,0x3ef6e0cb,0x3eee9479,0x3eb8442a,0x3eadf73c,0x3ea395c5,0x3e9920fe
.long 0x3e47c5c2,0x3e2f10a2,0x3e164083,0x3dfab273,0x3cc90ab0,0xbb490fc6,0xbcfb49ba,0xbd6ea038
.long 0xbe164083,0xbe354098,0xbe541501,0xbe72b651,0xbea09ae5,0xbeb0eacb,0xbec1071e,0xbed0eb2a
.long 0xbef15aea,0xbf00e7e4,0xbf08f59b,0xbf10d3cd,0xbf1d7fd1,0xbf256bcb,0xbf2d1469,0xbf34768f
.long 0xbf3daef9,0xbf44e3f5,0xbf4bbbf8,0xbf5233c6,0xbf584853,0xbf5e5aa6,0xbf63f473,0xbf6912ae
.long 0x3f800000,0x3f800000,0x3f800000,0x3f800000,0x3f7baccd,0x3f7b87b2,0x3f7b61fc,0x3f7b3bab
.long 0x3f6ed89e,0x3f6e46be,0x3f6db293,0x3f6d1c1d,0x3f59f26a,0x3f58b3a1,0x3f577026,0x3f5627fe
.long 0x3f3daef9,0x3f3b8f3b,0x3f396842,0x3f373a23,0x3f1b02c6,0x3f17de12,0x3f14b039,0x3f11796b
.long 0x3ee63375,0x3eddbe79,0x3ed53641,0x3ecc9b8b,0x3e8e9a22,0x3e840270,0x3e72b651,0x3e5d4b1a
.long 0x3dc8bd36,0x3d96a905,0x3d48fb30,0x3cc90ab0,0xbdafb680,0xbde7fa9a,0xbe1008b7,0xbe2bf804
.long 0xbe888e93,0xbe97a117,0xbea68f12,0xbeb554ec,0xbee0924f,0xbeeff7fb,0xbeff17b2,0xbf06f686
.long 0xbf187fc0,0xbf1ff6cb,0xbf273656,0xbf2e3bde,0xbf3b8f3b,0xbf425b89,0xbf48d8b3,0xbf4f0417
.long 0xbf584853,0xbf5df6be,0xbf633c5a,0xbf6816a8,0xbf6db293,0xbf71d19f,0xbf756d97,0xbf788486
.long 0xbf3504f3,0xbf3daef9,0xbf45e403,0xbf4d9f02,0xbf4d9f02,0xbf554aa4,0xbf5c61c7,0xbf62df7b
.long 0xbf61c598,0xbf6816a8,0xbf6db293,0xbf7294f8,0xbf710908,0xbf75a67b,0xbf796e4e,0xbf7c5d3a
.long 0xbf7b14be,0xbf7dabcc,0xbf7f4e6d,0xbf7ffb11,0xbf7fb10f,0xbf7ff84a,0xbf7f2f9d,0xbf7d57de
.long 0xbf7ec46d,0xbf7c7eb0,0xbf791298,0xbf748422,0xbf7853f8,0xbf73530e,0xbf6d1c1d,0xbf65b710
.long 0xbf6c835e,0xbf64aa59,0xbf5b941a,0xbf514d3d,0xbf5b941a,0xbf50d937,0xbf44e3f5,0xbf37c655
.long 0xbf45e403,0xbf385216,0xbf299415,0xbf19c200,0xbf2beb4a,0xbf1ba299,0xbf0a48ad,0xbeeff7fb
.long 0xbf0e39da,0xbef6e0cb,0xbecf7bca,0xbea68f12,0xbedae880,0xbeb0eacb,0xbe8586ce,0xbe3228d4
.long 0xbe94a031,0xbe4dee60,0xbde1bc2e,0xbc96c9b6,0xbe164083,0xbd55880e,0x3d2fe007,0x3e0cec4a
.long 0xbf54db31,0xbf5b941a,0xbf61c598,0xbf676bd8,0xbf68bf3c,0xbf6dfcf2,0xbf7294f8,0xbf76841b
.long 0xbf76ba07,0xbf7a1e84,0xbf7cbfc9,0xbf7e9bc9,0xbf7e70b0,0xbf7fa6e3,0xbf7ffec4,0xbf7f7808
.long 0xbf7fb10f,0xbf7e70b0,0xbf7c3b28,0xbf791298,0xbf7a7302,0xbf76841b,0xbf718f57,0xbf6b99fb
.long 0xbf6ed89e,0xbf6816a8,0xbf604621,0xbf577026,0xbf5d2d53,0xbf5389c7,0xbf48d8b3,0xbf3d27b8
.long 0xbf45e403,0xbf396842,0xbf2beb4a,0xbf1d7fd1,0xbf299415,0xbf1a6293,0xbf0a48ad,0xbef2bd43
.long 0xbf08f59b,0xbeee9479,0xbec9b953,0xbea395c5,0xbec9b953,0xbea21887,0xbe72b651,0xbe1f917b
.long 0xbe78cfcc,0xbe22abb6,0xbd96a905,0x3c490e90,0xbdafb680,0x3b490fc6,0x3dbc3ac3,0x3e3857ec
.long 0x3d96a905,0x3e28defc,0x3e827dc0,0x3eaf713a,0x3e6c9a7f,0x3ea5129f,0x3ed25a09,0x3efdbabb
.long 0xbf6c835e,0xbf710908,0xbf74fa0b,0xbf7853f8,0xbf79c79d,0xbf7c5d3a,0xbf7e4323,0xbf7f7808
.long 0xbf7fb10f,0xbf7ffec4,0xbf7f84ab,0xbf7e4323,0xbf7e1324,0xbf7bd14d,0xbf78b47b,0xbf74bf62
.long 0xbf74fa0b,0xbf6ff573,0xbf6a09a7,0xbf633c5a,0xbf64aa59,0xbf5cc7d1,0xbf53fac3,0xbf4a4c87
.long 0xbf4d9f02,0xbf42de29,0xbf373a23,0xbf2ac082,0xbf3085bb,0xbf2302d3,0xbf14b039,0xbf05a02c
.long 0xbf0e39da,0xbefc5d27,0xbedae880,0xbeb8442a,0xbecf7bca,0xbeab0201,0xbe8586ce,0xbe3e853e
.long 0xbe78cfcc,0xbe28defc,0xbdafb680,0xbbc90f88,0xbd96a905,0x3c16cb58,0x3dbc3ac3,0x3e3228d4
.long 0x3dc8bd36,0x3e3b6ecf,0x3e888e93,0x3eb263ef,0x3e888e93,0x3eb3dca5,0x3eddbe79,0x3f02ef9f
.long 0x3edae880,0x3f0242b1,0x3f15f6d9,0x3f286605,0x3f13682a,0x3f269de3,0x3f385216,0x3f485bca
.long 0xbf7b14be,0xbf7d3aac,0xbf7ec46d,0xbf7fb10f,0xbf7ffb11,0xbf7fcbe2,0xbf7eea9d,0xbf7d57de
.long 0xbf7c3b28,0xbf796e4e,0xbf75dec6,0xbf718f57,0xbf6ff573,0xbf6a5ad9,0xbf63f473,0xbf5cc7d1
.long 0xbf5b941a,0xbf531849,0xbf49d112,0xbf3fc767,0xbf3fc767,0xbf34768f,0xbf286605,0xbf1ba299
.long 0xbf1d7fd1,0xbf0f8784,0xbf00e7e4,0xbee363fa,0xbeebcbbb,0xbecb2aae,0xbea986c4,0xbe870ada
.long 0xbe94a031,0xbe605c13,0xbe164083,0xbd96a905,0xbde1bc2e,0xbd0a342f,0x3d2fe007,0x3df475c0
.long 0x3d96a905,0x3e1c76de,0x3e6c9a7f,0x3e9d9e78,0x3e827dc0,0x3eab0201,0x3ed25a09,0x3ef840c8
.long 0x3edae880,0x3f00e7e4,0x3f13682a,0x3f24d225,0x3f15f6d9,0x3f27ce61,0x3f385216,0x3f476085
.long 0x3f396842,0x3f48d8b3,0x3f5695e5,0x3f628210,0x3f5695e5,0x3f62df7b,0x3f6d1c1d,0x3f75341d
.long 0x0,0x0,0x0,0x0,0xbe164083,0xbe195be0,0xbe1c76de,0xbe1f917b
.long 0xbe94a031,0xbe97a117,0xbe9aa086,0xbe9d9e78,0xbedae880,0xbedf28a9,0xbee363fa,0xbee79a5d
.long 0xbf0e39da,0xbf10d3cd,0xbf13682a,0xbf15f6d9,0xbf2beb4a,0xbf2ecef7,0xbf31a81d,0xbf34768f
.long 0xbf45e403,0xbf48d8b3,0xbf4bbbf8,0xbf4e8d90,0xbf5b941a,0xbf5e5aa6,0xbf6106f2,0xbf6398ac
.long 0xbf6c835e,0xbf6ed89e,0xbf710908,0xbf731447,0xbf7853f8,0xbf79f35e,0xbf7b61fc,0xbf7c9f8a
.long 0xbf7ec46d,0xbf7f6ac7,0xbf7fd397,0xbf7ffec4,0xbf7fb10f,0xbf7f1f49,0xbf7e4323,0xbf7d1cdd
.long 0xbf7b14be,0xbf791298,0xbf76ba07,0xbf740bdd,0xbf710908,0xbf6d67a1,0xbf696591,0xbf650479
.long 0xbf61c598,0xbf5c61c7,0xbf5695e5,0xbf5064af,0xbf4d9f02,0xbf466354,0xbf3ebc1b,0xbf36ad7f
.long 0x0,0x0,0x0,0x0,0xbe22abb6,0xbe25c58c,0xbe28defc,0xbe2bf804
.long 0xbea09ae5,0xbea395c5,0xbea68f12,0xbea986c4,0xbeebcbbb,0xbeeff7fb,0xbef41f07,0xbef840c8
.long 0xbf187fc0,0xbf1b02c6,0xbf1d7fd1,0xbf1ff6cb,0xbf373a23,0xbf39f2ac,0xbf3ca003,0xbf3f41fc
.long 0xbf514d3d,0xbf53fac3,0xbf5695e5,0xbf591e6a,0xbf660f88,0xbf686b39,0xbf6aab7b,0xbf6cd007
.long 0xbf74fa0b,0xbf76ba07,0xbf7853f8,0xbf79c79d,0xbf7dabcc,0xbf7e868b,0xbf7f2f9d,0xbf7fa6e3
.long 0xbf7fec43,0xbf7f9c18,0xbf7f0e58,0xbf7e4323,0xbf7baccd,0xbf79f35e,0xbf77f110,0xbf75a67b
.long 0xbf710908,0xbf6db293,0xbf6a09a7,0xbf660f88,0xbf604621,0xbf5b2c79,0xbf55b993,0xbf4fefa8
.long 0xbf49d112,0xbf42de29,0xbf3b8f3b,0xbf33e7bc,0xbf2e3bde,0xbf256bcb,0xbf1c420c,0xbf12c39a
.long 0x0,0x0,0x0,0x0,0xbe2f10a2,0xbe3228d4,0xbe354098,0xbe3857ec
.long 0xbeac7cd4,0xbeaf713a,0xbeb263ef,0xbeb554ec,0xbefc5d27,0xbf003a06,0xbf0242b1,0xbf044889
.long 0xbf226799,0xbf24d225,0xbf273656,0xbf299415,0xbf41d870,0xbf446337,0xbf46e22a,0xbf495521
.long 0xbf5b941a,0xbf5df6be,0xbf604621,0xbf628210,0xbf6ed89e,0xbf70c501,0xbf7294f8,0xbf74484b
.long 0xbf7b14be,0xbf7c3b28,0xbf7d3aac,0xbf7e1324,0xbf7fec43,0xbf7fffb1,0xbf7fe129,0xbf7f90b1
.long 0xbf7d3aac,0xbf7bf531,0xbf7a7302,0xbf78b47b,0xbf731447,0xbf703b37,0xbf6d1c1d,0xbf69b7e4
.long 0xbf61c598,0xbf5d2d53,0xbf584853,0xbf531849,0xbf49d112,0xbf436051,0xbf3ca003,0xbf3592e7
.long 0xbf2beb4a,0xbf239da9,0xbf1b02c6,0xbf121eb0,0xbf08f59b,0xbefdbabb,0xbee900b7,0xbed3c867
.long 0x0,0x0,0x0,0x0,0xbe3b6ecf,0xbe3e853e,0xbe419b37,0xbe44b0b9
.long 0xbeb8442a,0xbebb31a0,0xbebe1d4a,0xbec1071e,0xbf064b82,0xbf084b92,0xbf0a48ad,0xbf0c42c9
.long 0xbf2beb4a,0xbf2e3bde,0xbf3085bb,0xbf32c8c9,0xbf4bbbf8,0xbf4e1689,0xbf5064af,0xbf52a649
.long 0xbf64aa59,0xbf66becc,0xbf68bf3c,0xbf6aab7b,0xbf75dec6,0xbf77583a,0xbf78b47b,0xbf79f35e
.long 0xbf7ec46d,0xbf7f4e6d,0xbf7fb10f,0xbf7fec43,0xbf7f0e58,0xbf7e5a38,0xbf7d7474,0xbf7c5d3a
.long 0xbf76ba07,0xbf748422,0xbf721352,0xbf6f6830,0xbf660f88,0xbf62241a,0xbf5df6be,0xbf5988ad
.long 0xbf4d9f02,0xbf47de65,0xbf41d870,0xbf3b8f3b,0xbf2e3bde,0xbf269de3,0xbf1ebc12,0xbf16999f
.long 0xbf08f59b,0xbeff17b2,0xbeebcbbb,0xbed8106b,0xbebe1d4a,0xbea80b1f,0xbe919ddd,0xbe75c35a
.long 0xbf3504f3,0xbf2beb4a,0xbf226799,0xbf187fc0,0xbf187fc0,0xbf0d9281,0xbf0242b1,0xbeed3063
.long 0xbef15aea,0xbed8106b,0xbebe1d4a,0xbea395c5,0xbeac7cd4,0xbe901c2c,0xbe667c66,0xbe2bf804
.long 0xbe47c5c2,0xbe09cf86,0xbd96a905,0xbc490e90,0xbd48fb30,0x3c7b514b,0x3da3308c,0x3e1324ca
.long 0x3dc8bd36,0x3e28defc,0x3e6c9a7f,0x3e97a117,0x3e78cfcc,0x3e9f1cdf,0x3ec1071e,0x3ee1fb6a
.long 0x3ec3ef15,0x3ee63375,0x3f039c3d,0x3f13682a,0x3f039c3d,0x3f140c5f,0x3f239da9,0x3f3238aa
.long 0x3f226799,0x3f31a81d,0x3f3fc767,0x3f4cae79,0x3f3daef9,0x3f4b41fa,0x3f577026,0x3f62241a
.long 0x3f54db31,0x3f604621,0x3f6a09a7,0x3f721352,0x3f676bd8,0x3f703b37,0x3f772417,0x3f7c187a
.long 0x3f74fa0b,0x3f7ac516,0x3f7e70b0,0x3f7ff4e6,0x3f7d3aac,0x3f7fa6e3,0x3f7fc38f,0x3f7d906e
.long 0xbf0e39da,0xbf039c3d,0xbef15aea,0xbedae880,0xbed53641,0xbebca7af,0xbea395c5,0xbe8a11f7
.long 0xbe888e93,0xbe5a3997,0xbe22abb6,0xbdd53db9,0xbde1bc2e,0xbd55880e,0x3bc90f88,0x3d83db0a
.long 0x3d48fb30,0x3de1bc2e,0x3e2f10a2,0x3e6c9a7f,0x3e541501,0x3e8a11f7,0x3ea986c4,0x3ec8477c
.long 0x3eb8442a,0x3ed8106b,0x3ef6e0cb,0x3f0a48ad,0x3f00e7e4,0x3f102dd5,0x3f1ebc12,0x3f2c800f
.long 0x3f226799,0x3f3085bb,0x3f3daef9,0x3f49d112,0x3f3fc767,0x3f4c3578,0x3f577026,0x3f61668a
.long 0x3f584853,0x3f628210,0x3f6b4b0c,0x3f7294f8,0x3f6b4b0c,0x3f72d4eb,0x3f78b47b,0x3f7cdf6c
.long 0x3f7853f8,0x3f7cbfc9,0x3f7f4e6d,0x3f7ffb11,0x3f7f0e58,0x3f7fffb1,0x3f7eea9d,0x3f7bd14d
.long 0x3f7f4e6d,0x3f7c7eb0,0x3f778bc5,0x3f708066,0x3f791298,0x3f725470,0x3f696591,0x3f5e5aa6
.long 0xbec3ef15,0xbeac7cd4,0xbe94a031,0xbe78cfcc,0xbe605c13,0xbe2bf804,0xbdee3876,0xbd83db0a
.long 0xbd48fb30,0x3bc90f88,0x3d7b2b74,0x3dee3876,0x3dfab273,0x3e3857ec,0x3e72b651,0x3e9620d2
.long 0x3e94a031,0x3eb263ef,0x3ecf7bca,0x3eebcbbb,0x3ee63375,0x3f019573,0x3f0f8784,0x3f1ce11f
.long 0x3f187fc0,0x3f26050a,0x3f32c8c9,0x3f3ebc1b,0x3f396842,0x3f456439,0x3f5064af,0x3f5a5ba0
.long 0x3f54db31,0x3f5ebe05,0x3f676bd8,0x3f6ed89e,0x3f6a09a7,0x3f714c7a,0x3f772417,0x3f7b87b2
.long 0x3f7853f8,0x3f7c7eb0,0x3f7f0e58,0x3f7ffec4,0x3f7f4e6d,0x3f7ffd39,0x3f7eea9d,0x3f7c187a
.long 0x3f7ec46d,0x3f7baccd,0x3f76ba07,0x3f6ff573,0x3f76ba07,0x3f6faf1b,0x3f66becc,0x3f5bfb34
.long 0x3f676bd8,0x3f5c61c7,0x3f4f7a1f,0x3f40d0da,0x3f514d3d,0x3f425b89,0x3f31a81d,0x3f1f599f
.long 0xbe47c5c2,0xbe164083,0xbdc8bd36,0xbd48fb30,0xbc490e90,0x3d2351cb,0x3dbc3ac3,0x3e1324ca
.long 0x3e2f10a2,0x3e667c66,0x3e8e9a22,0x3ea986c4,0x3eb263ef,0x3ece0bea,0x3ee900b7,0x3f019573
.long 0x3f039c3d,0x3f10d3cd,0x3f1d7fd1,0x3f299415,0x3f299415,0x3f3592e7,0x3f40d0da,0x3f4b41fa
.long 0x3f49d112,0x3f53fac3,0x3f5d2d53,0x3f655e0b,0x3f633c5a,0x3f6afb8c,0x3f718f57,0x3f76ef5b
.long 0x3f74fa0b,0x3f79c79d,0x3f7d3aac,0x3f7f4e6d,0x3f7e70b0,0x3f7fdaaf,0x3f7fc38f,0x3f7e2b72
.long 0x3f7f4e6d,0x3f7cfe73,0x3f791298,0x3f73913f,0x3f778bc5,0x3f714c7a,0x3f696591,0x3f5fe4e9
.long 0x3f676bd8,0x3f5d2d53,0x3f514d3d,0x3f43e200,0x3f4f7a1f,0x3f4154e1,0x3f31a81d,0x3f209393
.long 0x3f3085bb,0x3f1ebc12,0x3f0b9a6b,0x3eee9479,0x3f0b9a6b,0x3eed3063,0x3ec1071e,0x3e931f35
.size fft_tables, 83968
.section .rodata,"a"
.p2align 6
.amdhsa_kernel fft_rows_fwd_kernel
  .amdhsa_next_free_vgpr 162
  .amdhsa_next_free_sgpr 44
  .amdhsa_accum_offset 164
  .amdhsa_group_segment_fixed_size 0
  .amdhsa_kernarg_size 88
  .amdhsa_user_sgpr_count 2
  .amdhsa_user_sgpr_kernarg_segment_ptr 1
  .amdhsa_system_sgpr_workgroup_id_x 1
  .amdhsa_float_denorm_mode_32 3
.end_amdhsa_kernel
.p2align 6
.amdhsa_kernel fft_cols_kernel
  .amdhsa_next_free_vgpr 252
  .amdhsa_next_free_sgpr 44
  .amdhsa_accum_offset 252
  .amdhsa_group_segment_fixed_size 0
  .amdhsa_kernarg_size 88
  .amdhsa_user_sgpr_count 2
  .amdhsa_user_sgpr_kernarg_segment_ptr 1
  .amdhsa_system_sgpr_workgroup_id_x 1
  .amdhsa_float_denorm_mode_32 3
.end_amdhsa_kernel
.p2align 6
.amdhsa_kernel mixer_kernel
  .amdhsa_next_free_vgpr 256
  .amdhsa_next_free_sgpr 68
  .amdhsa_accum_offset 256
  .amdhsa_group_segment_fixed_size 0
  .amdhsa_kernarg_size 88
  .amdhsa_user_sgpr_count 2
  .amdhsa_user_sgpr_kernarg_segment_ptr 1
  .amdhsa_system_sgpr_workgroup_id_x 1
  .amdhsa_float_denorm_mode_32 3
.end_amdhsa_kernel
```
